```python
import torch

def _softmax(x, axis=-1):
    return torch.softmax(x, dim=axis)
def _gelu(x):
    return torch.nn.functional.gelu(x, approximate="tanh")
def _silu(x):
    return torch.nn.functional.silu(x)
def _sigmoid(x):
    return torch.sigmoid(x)
def _layernorm(x, axis=-1, eps=1e-5):
    m = x.mean(dim=axis, keepdim=True)
    v = x.var(dim=axis, keepdim=True, unbiased=False)
    return (x - m) / torch.sqrt(v + eps)
def _scatter_add(tgt, idx, src, axis=0):
    return tgt.clone().index_add_(axis, idx, src)
def _segment_sum(src, seg, n):
    out = torch.zeros((n,) + src.shape[1:], dtype=src.dtype)
    return out.index_add_(0, seg, src)
def _pad(x, pw):
    flat = tuple(v for pair in reversed(pw) for v in pair)
    return torch.nn.functional.pad(x, flat)

kernel_name = 'interleave_layers__linear_kernel_hedgehog__mixer_channel_mlp__prompt'

def setup_inputs():

    _w = (lambda a: (lambda t: t.to(torch.bfloat16) if t.is_floating_point() else t)(torch.as_tensor(a)))
    def _A_setup():
        B, S, D, H = 1, 2048, 512, 32
        Dh = D // H
        return {
            "x": _w((lambda *s: torch.randn(*s, dtype=torch.bfloat16) * 0.05)(B, S, D)),
            "wqkv": _w((lambda *s: torch.randn(*s, dtype=torch.bfloat16) * 0.4)(D, 3 * D)),
            "w_phi": _w((lambda *s: torch.randn(*s, dtype=torch.bfloat16) * 0.4)(H, Dh, Dh) * (Dh ** -0.5)),
            "wo": _w((lambda *s: torch.randn(*s, dtype=torch.bfloat16) * 0.05)(D, D)),
        }
    _A_in = _A_setup()

    def _B_setup():
        B, S, D, F = 1, 2048, 512, 1376
        return {
            "x": _w((lambda *s: torch.randn(*s, dtype=torch.bfloat16) * 0.05)(B, S, D)),
            "w1": _w((lambda *s: torch.randn(*s, dtype=torch.bfloat16) * 3.2)(D, F) * (D ** -0.5)),
            "b1": _w((lambda *s: torch.randn(*s, dtype=torch.bfloat16) * 0.8)(F)),
            "w2": _w((lambda *s: torch.randn(*s, dtype=torch.bfloat16) * 0.8)(F, D) * (F ** -0.5)),
            "b2": _w((lambda *s: torch.randn(*s, dtype=torch.bfloat16) * 0.8)(D)),
        }
    _B_in = _B_setup()

    return {
        "A_x": _A_in["x"],
        "A_wqkv": _A_in["wqkv"],
        "A_w_phi": _A_in["w_phi"],
        "A_wo": _A_in["wo"],
        "B_x": _B_in["x"],
        "B_w1": _B_in["w1"],
        "B_b1": _B_in["b1"],
        "B_w2": _B_in["w2"],
        "B_b2": _B_in["b2"],
    }

def reference(A_x, A_wqkv, A_w_phi, A_wo, B_x, B_w1, B_b1, B_w2, B_b2):
    def _A_ref(x, wqkv, w_phi, wo):
        B, S, D = x.shape
        H = 32; Dh = D // H
        qkv = (lambda x, *d: x.permute(*d))((x @ wqkv).reshape(B, S, 3, H, Dh), 2, 0, 3, 1, 4)
        q, k, v = qkv[0], qkv[1], qkv[2]
        pq = torch.einsum("bhsd,hdf->bhsf", q, w_phi)
        pk = torch.einsum("bhsd,hdf->bhsf", k, w_phi)
        phi_q = torch.concatenate([_softmax(pq, axis=-1), _softmax(-pq, axis=-1)], axis=-1)
        phi_k = torch.concatenate([_softmax(pk, axis=-1), _softmax(-pk, axis=-1)], axis=-1)
        kv = torch.einsum("bhsf,bhsd->bhfd", phi_k, v)
        z  = torch.einsum("bhsf->bhf", phi_k)
        num = torch.einsum("bhqf,bhfd->bhqd", phi_q, kv)
        den = torch.einsum("bhqf,bhf->bhq", phi_q, z)[..., None] + 1e-6
        o = num / den
        return (lambda x, *d: x.permute(*d))(o, 0, 2, 1, 3).reshape(B, S, D) @ wo

    def _B_ref(x, w1, b1, w2, b2):
        y = _layernorm(x, axis=-1)
        h = _gelu(torch.einsum("bsd,df->bsf", y, w1) + b1)
        return torch.einsum("bsf,fd->bsd", h, w2) + b2

    x = A_x
    x = x + _A_ref(_layernorm(x, axis=-1), A_wqkv, A_w_phi, A_wo)
    x = x + _B_ref(_layernorm(x, axis=-1), B_w1, B_b1, B_w2, B_b2)
    x = x + _A_ref(_layernorm(x, axis=-1), A_wqkv, A_w_phi, A_wo)
    x = x + _B_ref(_layernorm(x, axis=-1), B_w1, B_b1, B_w2, B_b2)
    return x
```

```asm
; @launch grid=(256,1,1) block=(256,1,1) lds=163840
.amdgcn_target "amdgcn-amd-amdhsa--gfx950"
.text
.globl interleave_layers__linear_kernel_hedgehog__mixer_channel_mlp__prompt_kernel
.p2align 8
.type interleave_layers__linear_kernel_hedgehog__mixer_channel_mlp__prompt_kernel,@function
interleave_layers__linear_kernel_hedgehog__mixer_channel_mlp__prompt_kernel:
    s_cmp_ge_u32 s2, 256
    s_cbranch_scc1 Lend
    s_load_dwordx8 s[24:31], s[0:1], 0
    s_load_dwordx8 s[32:39], s[0:1], 40
    s_load_dwordx2 s[90:91], s[0:1], 72
    s_load_dwordx2 s[4:5], s[0:1], 88
    s_getpc_b64 s[56:57]
Lpc:
    s_lshr_b32 s44, s2, 3
    s_mul_i32 s44, s44, 1536
    v_min_u32 v2, 11, v0
    v_lshl_add_u32 v2, v2, 7, s44
    v_min_u32 v2, Lcode_end-4-Lpc, v2
    global_load_dword v37, v2, s[56:57]
    v_lshrrev_b32 v1, 6, v0
    v_and_b32 v255, 63, v0
    v_readfirstlane_b32 s16, v1
    s_mov_b32 s6, 268435456
    s_mov_b32 s7, 0x20000
    s_mov_b32 s10, 2097152
    s_mov_b32 s11, 0x20000
    s_mov_b32 s15, 0x20000
    s_mov_b32 s82, 1572864
    s_mov_b32 s83, 0x20000
    s_and_b32 s44, s2, 7
    s_lshr_b32 s45, s2, 3
    s_and_b32 s18, s45, 15
    s_lshr_b32 s45, s45, 4
    s_lshl_b32 s17, s44, 1
    s_add_u32 s17, s17, s45
    s_lshl_b32 s20, s17, 2
    s_add_u32 s20, s20, s16
    s_lshl_b32 s101, s16, 13
    s_lshl_b32 s100, s20, 15
    s_lshr_b32 s84, s18, 1
    s_lshr_b32 s44, s17, 1
    s_add_u32 s84, s84, s44
    v_lshrrev_b32 v64, 3, v255
    v_and_b32 v65, 7, v255
    v_lshrrev_b32 v67, 4, v255
    v_xor_b32 v67, v67, v65
    v_lshlrev_b32 v24, 10, v64
    v_lshl_add_u32 v24, v67, 4, v24
    v_xor_b32 v25, 64, v24
    v_lshlrev_b32 v0, 4, v255
    s_lshl_b32 s99, s16, 10
    s_mul_i32 s41, s16, 49152
    s_lshl_b32 s44, s18, 6
    s_add_u32 s41, s41, s44
    v_lshrrev_b32 v8, 2, v255
    v_mul_u32_u24 v8, 3072, v8
    v_and_b32 v67, 3, v255
    v_lshl_add_u32 v8, v67, 4, v8
    s_waitcnt lgkmcnt(0)
    s_mov_b64 s[8:9], s[24:25]
    s_mov_b64 s[80:81], s[26:27]
    s_load_dword s98, s[4:5], 0
    s_lshl_b32 s44, s17, 4
    s_add_u32 s44, s44, s18
    s_lshl_b32 s44, s44, 2
    s_add_u32 s85, s44, s16
    s_lshl_b32 s44, s85, 11
    buffer_load_dwordx4 v[224:227], v0, s[8:11], s44 offen offset:0
    buffer_load_dwordx4 v[228:231], v0, s[8:11], s44 offen offset:1024
    s_add_u32 m0, s101, 32768
    s_add_u32 s51, s84, 0
    s_and_b32 s51, s51, 7
    s_lshl_b32 s51, s51, 7
    s_add_u32 s51, s51, s100
    buffer_load_dwordx4 v24, s[8:11], s51 offen lds
    s_add_u32 m0, s101, 33792
    s_add_u32 s51, s51, 8192
    buffer_load_dwordx4 v25, s[8:11], s51 offen lds
    s_add_u32 m0, s101, 34816
    s_add_u32 s51, s51, 8192
    buffer_load_dwordx4 v24, s[8:11], s51 offen lds
    s_add_u32 m0, s101, 35840
    s_add_u32 s51, s51, 8192
    buffer_load_dwordx4 v25, s[8:11], s51 offen lds
    s_add_u32 s72, s84, 0
    s_and_b32 s72, s72, 7
    s_mul_i32 s72, s72, 196608
    s_add_u32 s72, s72, s41
    s_add_u32 m0, s99, 0
    s_add_u32 s49, s72, 1024
    buffer_load_dwordx4 v8, s[80:83], s49 offen lds
    s_add_u32 m0, s99, 98304
    s_add_u32 s49, s72, 2048
    buffer_load_dwordx4 v8, s[80:83], s49 offen lds
    v_min_u32 v68, 0xb0, v0
    v_lshlrev_b32 v68, 6, v68
    s_lshr_b32 s49, s2, 3
    s_lshl_b32 s49, s49, 2
    s_add_u32 s49, s49, s16
    s_mul_i32 s49, s49, 12288
    s_mov_b64 exec, 4095
    buffer_load_dword a254, v68, s[80:83], s49 offen offset:384
    s_mov_b64 exec, -1
    s_add_u32 s73, s84, 1
    s_and_b32 s73, s73, 7
    s_mul_i32 s73, s73, 196608
    s_add_u32 s73, s73, s41
    s_add_u32 m0, s99, 4096
    s_add_u32 s49, s73, 1024
    buffer_load_dwordx4 v8, s[80:83], s49 offen lds
    s_add_u32 m0, s99, 102400
    s_add_u32 s49, s73, 2048
    buffer_load_dwordx4 v8, s[80:83], s49 offen lds
    s_add_u32 m0, s101, 36864
    s_add_u32 s51, s84, 1
    s_and_b32 s51, s51, 7
    s_lshl_b32 s51, s51, 7
    s_add_u32 s51, s51, s100
    buffer_load_dwordx4 v24, s[8:11], s51 offen lds
    s_cmp_ge_u32 s2, 64
    s_cselect_b32 s44, 16, 0
    s_cmp_ge_u32 s2, 192
    s_cselect_b32 s44, 32, s44
    s_sub_u32 s45, s2, s44
    s_or_b32 s44, s18, 1
    s_cmp_eq_u32 s44, 7
    s_cselect_b32 s45, 255, s45
    s_lshr_b32 s52, s45, 2
    s_and_b32 s47, s45, 3
    s_lshl_b32 s47, s47, 2
    s_add_u32 s47, s47, s16
    s_and_b32 s46, s47, 7
    s_cmp_lt_u32 s52, 24
    s_cselect_b32 s44, 63, 15
    s_mov_b32 s14, 524288
    s_cselect_b32 s14, 1409024, s14
    s_lshr_b32 s45, s45, 1
    s_and_b32 s45, s45, s44
    s_sub_u32 s44, s52, 32
    s_cmp_lt_u32 s52, 32
    s_mov_b32 s53, 2752
    s_cselect_b32 s53, 1024, s53
    s_cselect_b32 s14, s14, 1409024
    s_cselect_b32 s46, s46, s44
    s_cselect_b32 s47, s45, s47
    s_mul_i32 s48, s47, s53
    s_lshl_b32 s48, s48, 5
    s_lshl_b32 s44, s46, 7
    s_add_u32 s48, s48, s44
    s_cmp_lt_u32 s52, 54
    s_cselect_b32 s48, s48, 268435456
    v_mul_lo_u32 v40, v64, s53
    v_lshl_add_u32 v40, v65, 4, v40
    s_lshl_b32 s53, s53, 3
    s_lshl_b32 s23, s16, 12
    s_mov_b64 s[56:57], s[28:29]
    s_cmp_lt_u32 s52, 24
    s_cselect_b64 s[12:13], s[36:37], s[30:31]
    s_cmp_lt_u32 s52, 32
    s_cselect_b64 s[12:13], s[12:13], s[32:33]
    v_lshrrev_b32 v237, 5, v255
    v_and_b32 v238, 31, v255
    v_and_b32 v239, 15, v255
    v_lshrrev_b32 v240, 4, v255
    v_and_b32 v241, 7, v255
    v_lshrrev_b32 v242, 3, v255
    v_and_b32 v243, 1, v242
    v_bfe_u32 v244, v238, 2, 1
    v_lshrrev_b32 v245, 3, v238
    v_and_b32 v246, 3, v255
    v_lshl_add_u32 v245, v245, 2, v246
    v_lshl_add_u32 v247, v244, 4, v245
    v_and_b32 v251, 1, v240
    v_bfe_u32 v252, v255, 2, 2
    v_and_b32 v253, 1, v255
    v_bfe_u32 v254, v255, 1, 1
    v_lshl_add_u32 v248, v237, 4, v252
    v_lshlrev_b32 v248, 6, v248
    v_lshl_add_u32 v248, v254, 3, v248
    v_lshl_add_u32 v6, v251, 5, v248
    v_lshl_add_u32 v6, v253, 4, v6
    v_lshl_add_u32 v7, v251, 4, v248
    v_lshl_add_u32 v7, v253, 5, v7
    v_add_u32 v7, 98304, v7
    v_bfe_u32 v248, v238, 1, 3
    v_lshlrev_b32 v249, 1, v237
    v_xor_b32 v248, v248, v249
    v_lshlrev_b32 v248, 4, v248
    v_lshl_add_u32 v248, v238, 7, v248
    s_add_u32 s44, s101, 32768
    v_add_u32 v26, s44, v248
    v_xor_b32 v27, 16, v26
    v_xor_b32 v28, 64, v26
    v_xor_b32 v29, 0x50, v26
    s_lshr_b32 s44, s16, 1
    s_lshl_b32 s44, s44, 11
    s_and_b32 s45, s16, 1
    s_lshl_b32 s45, s45, 9
    s_add_u32 s44, s44, s45
    v_add_u32 v30, s44, v6
    v_add_u32 v31, s44, v7
    v_mov_b32 v58, 0x3f803f80
    v_lshrrev_b32 v248, 2, v238
    v_cmp_eq_u32 vcc, 0, v248
    v_cmp_eq_u32 s[60:61], 1, v248
    s_nop 0
    v_cndmask_b32 v48, 0, v58, vcc
    v_cndmask_b32 v52, 0, v58, s[60:61]
    v_cndmask_b32 v49, 0, v58, vcc
    v_cndmask_b32 v53, 0, v58, s[60:61]
    v_cndmask_b32 v50, 0, v58, vcc
    v_cndmask_b32 v54, 0, v58, s[60:61]
    v_cndmask_b32 v51, 0, v58, vcc
    v_cndmask_b32 v55, 0, v58, s[60:61]
    s_mov_b64 s[86:87], s[34:35]
    s_mov_b64 s[88:89], s[38:39]
    s_cmp_lt_u32 s52, 24
    s_mov_b32 s44, 65536
    s_cselect_b32 s44, 176128, s44
    s_mov_b32 s45, 3670016
    s_cselect_b32 s45, 5767168, s45
    s_mul_i32 s58, s46, s44
    s_lshl_b32 s92, s46, 12
    s_lshl_b32 s44, s47, 7
    s_add_u32 s92, s92, s44
    s_add_u32 s92, s92, 262144
    s_cmp_lt_u32 s52, 32
    s_cselect_b32 s45, s45, 4194304
    s_cselect_b32 s92, 268435456, s92
    s_cselect_b32 s61, 32, 1024
    s_cselect_b32 s60, 10, 4
    s_cselect_b32 s93, 3, 5
    s_cselect_b32 s50, 4, 3
    s_cselect_b32 s44, 12, 11
    s_mov_b32 s59, 32768
    s_cselect_b32 s59, 2048, s59
    s_add_u32 s58, s58, s45
    s_lshl_b32 s44, s47, s44
    s_add_u32 s58, s58, s44
    s_cmp_lt_u32 s47, 43
    s_cselect_b32 s58, s58, 268435456
    s_cmp_lt_u32 s52, 54
    s_cselect_b32 s58, s58, 268435456
    s_cselect_b32 s92, s92, 268435456
    s_add_u32 s59, s58, s59
    s_cmp_lt_u32 s52, 53
    s_cselect_b32 s59, s59, 268435456
    s_lshl_b32 s44, s18, 2
    s_add_u32 s44, s44, s16
    s_lshl_b32 s27, s44, 13
    s_add_u32 s27, s27, 1048576
    s_lshl_b32 s28, s44, 10
    s_add_u32 s28, s28, 655360
    v_accvgpr_write_b32 a48, -1
    v_accvgpr_write_b32 a49, -1
    v_accvgpr_write_b32 a50, -1
    v_accvgpr_write_b32 a51, -1
    v_lshlrev_b32 v41, 11, v237
    v_lshl_add_u32 v41, v252, 7, v41
    v_lshl_add_u32 v41, v251, s60, v41
    v_lshl_add_u32 v41, v253, s93, v41
    v_lshl_add_u32 v41, v254, s50, v41
    s_add_u32 s44, s23, 131072
    v_add_u32 v41, s44, v41
    v_add_u32 v42, s61, v41
    v_lshl_add_u32 v43, v237, 3, v252
    v_lshlrev_b32 v43, 5, v43
    v_lshl_add_u32 v43, v251, 4, v43
    v_lshl_add_u32 v43, v254, 3, v43
    v_add_u32 v43, 162048, v43
    v_lshlrev_b32 v44, 2, v238
    v_lshl_add_u32 v44, v237, 11, v44
    v_lshlrev_b32 v3, 3, v238
    v_lshl_add_u32 v3, v237, 10, v3
    v_lshlrev_b32 v19, 11, v237
    v_lshl_add_u32 v19, v243, 10, v19
    v_lshl_add_u32 v19, v251, 9, v19
    v_lshl_add_u32 v19, v241, 4, v19
    v_add_u32 v1, 65536, v0
    v_lshlrev_b32 v2, 2, v255
    v_add_u32 v2, 159744, v2
    v_lshlrev_b32 v21, 2, v239
    v_lshl_add_u32 v21, v240, 7, v21
    v_lshlrev_b32 v4, 6, v237
    v_add_u32 v4, 159744, v4
    s_mul_i32 s60, s16, 7168
    s_add_u32 s60, s60, 131072
    v_mul_u32_u24 v248, 224, v238
    v_add_u32 v248, s60, v248
    v_lshl_add_u32 v9, v237, 6, v248
    v_lshl_add_u32 v10, v237, 5, v248
    v_lshrrev_b32 v248, 2, v255
    v_mul_u32_u24 v248, 224, v248
    v_lshl_add_u32 v248, v246, 3, v248
    s_lshl_b32 s60, s16, 5
    s_add_u32 s60, s60, 131072
    v_add_u32 v11, s60, v248
    s_lshr_b32 s61, s16, 1
    s_lshl_b32 s60, s61, 5
    s_add_u32 s60, s60, 131200
    v_add_u32 v12, s60, v248
    s_mul_i32 s60, s61, 1280
    s_and_b32 s61, s16, 1
    s_lshl_b32 s61, s61, 5
    s_add_u32 s60, s60, s61
    s_add_u32 s60, s60, 161024
    v_mul_u32_u24 v13, 80, v239
    v_lshl_add_u32 v13, v240, 3, v13
    v_add_u32 v13, s60, v13
    v_lshlrev_b32 v16, 4, v239
    v_lshl_add_u32 v16, v237, 8, v16
    v_mul_u32_u24 v14, 80, v247
    v_add_u32 v14, 161024, v14
    v_mov_b32 v248, 159744
    v_cmp_eq_u32 vcc, v237, v244
    v_lshlrev_b32 v15, 6, v239
    v_lshl_add_u32 v15, v240, 4, v15
    v_cndmask_b32 v14, v248, v14, vcc
    v_lshlrev_b32 v248, 7, v237
    v_xor_b32 v17, v248, v0
    s_add_u32 s60, s101, 131072
    v_add_u32 v17, s60, v17
    s_and_b32 s60, s16, 1
    s_lshl_b32 s60, s60, 7
    s_lshr_b32 s61, s16, 1
    s_lshl_b32 s61, s61, 12
    s_add_u32 s60, s60, s61
    v_lshlrev_b32 v248, 9, v242
    v_lshl_add_u32 v248, v241, 4, v248
    v_add_u32 v248, s60, v248
    v_lshlrev_b32 v249, 7, v243
    v_xor_b32 v248, v249, v248
    v_add_u32 v18, 131072, v248
    v_lshlrev_b32 v5, 10, v251
    v_lshl_add_u32 v5, v237, 9, v5
    v_lshl_add_u32 v5, v239, 4, v5
    v_lshlrev_b32 v20, 3, v241
    v_lshl_add_u32 v20, v251, 2, v20
    v_lshl_add_u32 v20, v237, 11, v20
    v_lshlrev_b32 v32, 1, v247
    s_lshl_b32 s60, s16, 8
    v_add_u32 v34, s60, v2
    v_lshlrev_b32 v35, 10, v241
    v_lshl_add_u32 v35, v242, 4, v35
    v_mov_b32 v249, 0
    ds_write_b32 v2, v249 offset:3328
    v_mov_b32 v248, 163072
    v_cmp_eq_u32 vcc, 0, v253
    v_add_u32 v45, 512, v43
    s_nop 0
    v_cndmask_b32 v43, v248, v43, vcc
    v_cndmask_b32 v45, v45, v248, vcc
    s_and_b32 s19, s18, 7
    s_lshr_b32 s60, s18, 3
    s_lshl_b32 s60, s60, 1
    s_lshl_b32 s21, s17, 2
    s_add_u32 s21, s21, s60
    s_mov_b32 s22, 0
    s_and_b32 s60, s18, 3
    s_mul_i32 s60, s60, 11
    s_lshr_b32 s61, s18, 2
    s_add_u32 s3, s60, s61
    s_lshl_b32 s95, 0x11111111, s16
    s_mov_b32 s24, s100
    s_lshl_b32 s60, s18, 11
    s_add_u32 s29, s100, s60
    s_add_u32 s29, s29, 9437184
    s_lshl_b32 s25, s20, 11
    s_add_u32 s25, s25, 393216
    s_lshl_b32 s60, s21, 15
    s_lshl_b32 s61, s19, 12
    s_add_u32 s33, s60, s61
    s_lshl_b32 s61, s16, 7
    s_add_u32 s33, s33, s61
    s_add_u32 s96, s33, 32768
    s_add_u32 s60, s60, s101
    s_add_u32 s31, s60, 9437184
    s_lshl_b32 s61, s19, 7
    s_add_u32 s97, s60, s61
    s_lshl_b32 s26, s20, 7
    s_lshl_b32 s60, s18, 2
    s_add_u32 s60, s60, s26
    s_add_u32 s30, s60, 524288
    s_add_u32 s38, s60, 524352
    s_add_u32 s26, s26, 372736
    s_lshl_b32 s60, s21, 7
    s_add_u32 s32, s60, 524288
    s_add_u32 s40, s60, 524352
    s_lshl_b32 s61, s19, 2
    s_add_u32 s61, s61, s16
    s_lshl_b32 s61, s61, 2
    s_add_u32 s35, s60, s61
    s_add_u32 s35, s35, 532480
    s_lshl_b32 s34, s21, 11
    s_lshl_b32 s60, s19, 8
    s_add_u32 s34, s34, s60
    s_lshl_b32 s60, s16, 6
    s_add_u32 s34, s34, s60
    s_add_u32 s34, s34, 393216
    s_mul_i32 s36, s20, 88064
    s_lshl_b32 s60, s3, 11
    s_add_u32 s36, s36, s60
    s_add_u32 s36, s36, 11534336
    s_add_u32 s63, s36, 8192
    s_add_u32 s37, s36, 16384
    s_mul_i32 s39, s21, 88064
    s_mul_i32 s60, s16, 22528
    s_add_u32 s39, s39, s60
    s_add_u32 s39, s39, 11534336
    s_lshl_b32 s42, s3, 15
    s_add_u32 s42, s42, s23
    s_add_u32 s42, s42, 4194304
    s_add_u32 s43, s42, 262144
    s_lshl_b32 s54, s19, 16
    s_lshl_b32 s60, s16, 14
    s_add_u32 s54, s54, s60
    s_add_u32 s54, s54, 3670016
    s_mul_i32 s55, s19, 176128
    s_mul_i32 s60, s16, 45056
    s_add_u32 s55, s55, s60
    s_add_u32 s55, s55, 5767168
    s_cmp_lt_u32 s18, 11
    s_cselect_b32 s43, s43, 268435456
    s_cselect_b32 s37, s37, 268435456
    s_add_u32 m0, s101, 37888
    s_add_u32 s51, s51, 8192
    buffer_load_dwordx4 v25, s[8:11], s51 offen lds
    s_add_u32 m0, s101, 38912
    s_add_u32 s51, s51, 8192
    buffer_load_dwordx4 v24, s[8:11], s51 offen lds
    s_add_u32 m0, s101, 39936
    s_add_u32 s51, s51, 8192
    buffer_load_dwordx4 v25, s[8:11], s51 offen lds
    s_add_u32 s74, s84, 2
    s_and_b32 s74, s74, 7
    s_mul_i32 s74, s74, 196608
    s_add_u32 s74, s74, s41
    s_add_u32 m0, s99, 8192
    s_add_u32 s49, s74, 1024
    buffer_load_dwordx4 v8, s[80:83], s49 offen lds
    s_add_u32 m0, s99, 106496
    s_add_u32 s49, s74, 2048
    buffer_load_dwordx4 v8, s[80:83], s49 offen lds
    s_add_u32 m0, s101, 65536
    s_add_u32 s51, s84, 2
    s_and_b32 s51, s51, 7
    s_lshl_b32 s51, s51, 7
    s_add_u32 s51, s51, s100
    buffer_load_dwordx4 v24, s[8:11], s51 offen lds
    s_add_u32 m0, s23, 131072
    s_nop 0
    buffer_load_dwordx4 v40, s[12:15], s48 offen lds
    s_add_u32 m0, s23, 132096
    s_add_u32 s48, s48, s53
    buffer_load_dwordx4 v40, s[12:15], s48 offen lds
    s_add_u32 m0, s23, 133120
    s_add_u32 s48, s48, s53
    buffer_load_dwordx4 v40, s[12:15], s48 offen lds
    s_waitcnt vmcnt(13)
    s_waitcnt lgkmcnt(0)
    s_add_u32 s98, s98, 0x9e3779b9
    s_barrier
    ds_read_b128 v[128:131], v26 offset:0
    ds_read_b128 v[132:135], v27 offset:0
    ds_read_b128 v[136:139], v28 offset:0
    ds_read_b128 v[140:143], v29 offset:0
    ds_read_b64_tr_b16 v[96:97], v6 offset:0
    ds_read_b64_tr_b16 v[98:99], v6 offset:256
    ds_read_b64_tr_b16 v[100:101], v7 offset:0
    ds_read_b64_tr_b16 v[102:103], v7 offset:256
    ds_read_b64_tr_b16 v[104:105], v6 offset:512
    ds_read_b64_tr_b16 v[106:107], v6 offset:768
    ds_read_b64_tr_b16 v[108:109], v7 offset:512
    ds_read_b64_tr_b16 v[110:111], v7 offset:768
    ds_read_b64_tr_b16 v[112:113], v6 offset:2048
    ds_read_b64_tr_b16 v[114:115], v6 offset:2304
    ds_read_b64_tr_b16 v[116:117], v7 offset:2048
    ds_read_b64_tr_b16 v[118:119], v7 offset:2304
    ds_read_b64_tr_b16 v[120:121], v30 offset:0
    ds_read_b64_tr_b16 v[122:123], v30 offset:256
    ds_read_b64_tr_b16 v[124:125], v31 offset:0
    ds_read_b64_tr_b16 v[126:127], v31 offset:256
    s_waitcnt lgkmcnt(12)
    v_mfma_f32_32x32x16_bf16 v[64:79], v[96:99], v[128:131], 0
    ds_read_b64_tr_b16 v[96:97], v6 offset:2560
    ds_read_b64_tr_b16 v[98:99], v6 offset:2816
    s_add_u32 m0, s23, 134144
    s_add_u32 s48, s48, s53
    buffer_load_dwordx4 v40, s[12:15], s48 offen lds
    v_mfma_f32_32x32x16_bf16 v[80:95], v[100:103], v[128:131], 0
    ds_read_b64_tr_b16 v[100:101], v7 offset:2560
    ds_read_b64_tr_b16 v[102:103], v7 offset:2816
    s_waitcnt lgkmcnt(4)
    v_mfma_f32_32x32x16_bf16 a[0:15], v[48:51], v[120:123], 0
    v_mfma_f32_32x32x16_bf16 a[0:15], v[52:55], v[124:127], a[0:15]
    s_mov_b64 s[12:13], s[56:57]
    s_mov_b32 s14, 16384
    s_mov_b32 m0, 162048
    s_lshl_b32 s49, s18, 10
    buffer_load_dwordx4 v0, s[12:15], s49 offen lds
    s_add_u32 m0, s101, 66560
    s_add_u32 s51, s51, 8192
    buffer_load_dwordx4 v25, s[8:11], s51 offen lds
    s_add_u32 m0, s101, 67584
    s_add_u32 s51, s51, 8192
    buffer_load_dwordx4 v24, s[8:11], s51 offen lds
    s_add_u32 m0, s101, 68608
    s_add_u32 s51, s51, 8192
    buffer_load_dwordx4 v25, s[8:11], s51 offen lds
    s_add_u32 s75, s84, 3
    s_and_b32 s75, s75, 7
    s_mul_i32 s75, s75, 196608
    s_add_u32 s75, s75, s41
    s_add_u32 m0, s99, 12288
    s_add_u32 s49, s75, 1024
    buffer_load_dwordx4 v8, s[80:83], s49 offen lds
    s_add_u32 m0, s99, 110592
    s_add_u32 s49, s75, 2048
    buffer_load_dwordx4 v8, s[80:83], s49 offen lds
    s_add_u32 m0, s101, 69632
    s_add_u32 s51, s84, 3
    s_and_b32 s51, s51, 7
    s_lshl_b32 s51, s51, 7
    s_add_u32 s51, s51, s100
    buffer_load_dwordx4 v24, s[8:11], s51 offen lds
    s_add_u32 m0, s101, 70656
    s_add_u32 s51, s51, 8192
    buffer_load_dwordx4 v25, s[8:11], s51 offen lds
    s_add_u32 m0, s101, 71680
    s_add_u32 s51, s51, 8192
    buffer_load_dwordx4 v24, s[8:11], s51 offen lds
    s_add_u32 m0, s101, 72704
    s_add_u32 s51, s51, 8192
    buffer_load_dwordx4 v25, s[8:11], s51 offen lds
    s_waitcnt vmcnt(17)
    s_barrier
    ds_read_b128 v[144:147], v26 offset:4096
    ds_read_b128 v[148:151], v27 offset:4096
    ds_read_b128 v[152:155], v28 offset:4096
    ds_read_b128 v[156:159], v29 offset:4096
    v_mfma_f32_32x32x16_bf16 v[64:79], v[104:107], v[132:135], v[64:79]
    ds_read_b64_tr_b16 v[104:105], v6 offset:4096
    ds_read_b64_tr_b16 v[106:107], v6 offset:4352
    s_add_u32 s76, s84, 4
    s_and_b32 s76, s76, 7
    s_mul_i32 s76, s76, 196608
    s_add_u32 s76, s76, s41
    s_add_u32 m0, s99, 16384
    s_add_u32 s49, s76, 1024
    buffer_load_dwordx4 v8, s[80:83], s49 offen lds
    s_add_u32 m0, s99, 114688
    s_add_u32 s49, s76, 2048
    buffer_load_dwordx4 v8, s[80:83], s49 offen lds
    v_mfma_f32_32x32x16_bf16 v[80:95], v[108:111], v[132:135], v[80:95]
    ds_read_b64_tr_b16 v[108:109], v7 offset:4096
    ds_read_b64_tr_b16 v[110:111], v7 offset:4352
    ds_read_b64_tr_b16 v[120:121], v30 offset:4096
    ds_read_b64_tr_b16 v[122:123], v30 offset:4352
    ds_read_b64_tr_b16 v[124:125], v31 offset:4096
    ds_read_b64_tr_b16 v[126:127], v31 offset:4352
    v_mfma_f32_32x32x16_bf16 v[64:79], v[112:115], v[136:139], v[64:79]
    ds_read_b64_tr_b16 v[112:113], v6 offset:4608
    ds_read_b64_tr_b16 v[114:115], v6 offset:4864
    s_add_u32 m0, s101, 32768
    s_add_u32 s51, s84, 4
    s_and_b32 s51, s51, 7
    s_lshl_b32 s51, s51, 7
    s_add_u32 s51, s51, s100
    buffer_load_dwordx4 v24, s[8:11], s51 offen lds
    v_mfma_f32_32x32x16_bf16 v[80:95], v[116:119], v[136:139], v[80:95]
    ds_read_b64_tr_b16 v[116:117], v7 offset:4608
    ds_read_b64_tr_b16 v[118:119], v7 offset:4864
    v_dot2_f32_bf16 v232, v224, v58, 0
    v_dot2_f32_bf16 v233, v224, v224, 0
    v_dot2_f32_bf16 v234, v228, v58, 0
    v_dot2_f32_bf16 v235, v228, v228, 0
    v_dot2_f32_bf16 v232, v225, v58, v232
    v_dot2_f32_bf16 v233, v225, v225, v233
    v_dot2_f32_bf16 v234, v229, v58, v234
    v_dot2_f32_bf16 v235, v229, v229, v235
    v_dot2_f32_bf16 v232, v226, v58, v232
    v_dot2_f32_bf16 v233, v226, v226, v233
    v_dot2_f32_bf16 v234, v230, v58, v234
    v_dot2_f32_bf16 v235, v230, v230, v235
    v_dot2_f32_bf16 v232, v227, v58, v232
    v_dot2_f32_bf16 v233, v227, v227, v233
    v_dot2_f32_bf16 v234, v231, v58, v234
    v_dot2_f32_bf16 v235, v231, v231, v235
    s_nop 0
    v_permlane32_swap_b32 v232, v233
    s_nop 0
    v_permlane32_swap_b32 v234, v235
    v_add_f32 v232, v232, v233
    v_add_f32 v234, v234, v235
    v_lshlrev_b32 v235, 4, v251
    v_lshl_add_u32 v235, v237, 3, v235
    v_permlane16_swap_b32 v232, v234
    v_add_f32 v232, v232, v234
    v_mov_b32 v233, s98
    s_lshl_b32 s44, s85, 5
    v_add_f32_dpp v232, v232, v232 row_ror:8 row_mask:0xf bank_mask:0xf
    s_add_u32 s44, s44, 65536
    s_nop 0
    v_add_f32_dpp v232, v232, v232 row_ror:4 row_mask:0xf bank_mask:0xf
    s_nop 1
    v_add_f32_dpp v232, v232, v232 row_ror:2 row_mask:0xf bank_mask:0xf
    s_nop 1
    v_add_f32_dpp v232, v232, v232 row_ror:1 row_mask:0xf bank_mask:0xf
    s_mov_b32 exec_lo, 0x00010001
    s_mov_b32 exec_hi, 0x00010001
    buffer_store_dwordx2 v[232:233], v235, s[4:7], s44 offen sc1
    s_mov_b64 exec, -1
    s_waitcnt lgkmcnt(15)
    v_mfma_f32_32x32x16_bf16 v[64:79], v[96:99], v[140:143], v[64:79]
    ds_read_b64_tr_b16 v[96:97], v6 offset:6144
    ds_read_b64_tr_b16 v[98:99], v6 offset:6400
    s_add_u32 m0, s101, 33792
    s_add_u32 s51, s51, 8192
    buffer_load_dwordx4 v25, s[8:11], s51 offen lds
    s_add_u32 m0, s101, 34816
    s_add_u32 s51, s51, 8192
    buffer_load_dwordx4 v24, s[8:11], s51 offen lds
    v_mfma_f32_32x32x16_bf16 v[80:95], v[100:103], v[140:143], v[80:95]
    ds_read_b64_tr_b16 v[100:101], v7 offset:6144
    ds_read_b64_tr_b16 v[102:103], v7 offset:6400
    s_waitcnt lgkmcnt(8)
    v_mfma_f32_32x32x16_bf16 a[0:15], v[48:51], v[120:123], a[0:15]
    v_mfma_f32_32x32x16_bf16 a[0:15], v[52:55], v[124:127], a[0:15]
    v_mfma_f32_32x32x16_bf16 v[64:79], v[104:107], v[144:147], v[64:79]
    ds_read_b64_tr_b16 v[104:105], v6 offset:6656
    ds_read_b64_tr_b16 v[106:107], v6 offset:6912
    s_add_u32 m0, s101, 35840
    s_add_u32 s51, s51, 8192
    buffer_load_dwordx4 v25, s[8:11], s51 offen lds
    v_mfma_f32_32x32x16_bf16 v[80:95], v[108:111], v[144:147], v[80:95]
    ds_read_b64_tr_b16 v[108:109], v7 offset:6656
    ds_read_b64_tr_b16 v[110:111], v7 offset:6912
    s_waitcnt vmcnt(13)
    s_barrier
    ds_read_b128 v[160:163], v26 offset:32768
    ds_read_b128 v[164:167], v27 offset:32768
    ds_read_b128 v[168:171], v28 offset:32768
    ds_read_b128 v[172:175], v29 offset:32768
    s_waitcnt lgkmcnt(12)
    v_mfma_f32_32x32x16_bf16 v[64:79], v[112:115], v[148:151], v[64:79]
    ds_read_b64_tr_b16 v[112:113], v6 offset:8192
    ds_read_b64_tr_b16 v[114:115], v6 offset:8448
    s_add_u32 s77, s84, 5
    s_and_b32 s77, s77, 7
    s_mul_i32 s77, s77, 196608
    s_add_u32 s77, s77, s41
    s_add_u32 m0, s99, 20480
    s_add_u32 s49, s77, 1024
    buffer_load_dwordx4 v8, s[80:83], s49 offen lds
    s_add_u32 m0, s99, 118784
    s_add_u32 s49, s77, 2048
    buffer_load_dwordx4 v8, s[80:83], s49 offen lds
    v_mfma_f32_32x32x16_bf16 v[80:95], v[116:119], v[148:151], v[80:95]
    ds_read_b64_tr_b16 v[116:117], v7 offset:8192
    ds_read_b64_tr_b16 v[118:119], v7 offset:8448
    ds_read_b64_tr_b16 v[120:121], v30 offset:8192
    ds_read_b64_tr_b16 v[122:123], v30 offset:8448
    ds_read_b64_tr_b16 v[124:125], v31 offset:8192
    ds_read_b64_tr_b16 v[126:127], v31 offset:8448
    s_waitcnt lgkmcnt(15)
    v_mfma_f32_32x32x16_bf16 v[64:79], v[96:99], v[152:155], v[64:79]
    ds_read_b64_tr_b16 v[96:97], v6 offset:8704
    ds_read_b64_tr_b16 v[98:99], v6 offset:8960
    s_add_u32 m0, s101, 36864
    s_add_u32 s51, s84, 5
    s_and_b32 s51, s51, 7
    s_lshl_b32 s51, s51, 7
    s_add_u32 s51, s51, s100
    buffer_load_dwordx4 v24, s[8:11], s51 offen lds
    v_mfma_f32_32x32x16_bf16 v[80:95], v[100:103], v[152:155], v[80:95]
    ds_read_b64_tr_b16 v[100:101], v7 offset:8704
    ds_read_b64_tr_b16 v[102:103], v7 offset:8960
    s_waitcnt lgkmcnt(15)
    v_mfma_f32_32x32x16_bf16 v[64:79], v[104:107], v[156:159], v[64:79]
    ds_read_b64_tr_b16 v[104:105], v6 offset:10240
    ds_read_b64_tr_b16 v[106:107], v6 offset:10496
    s_add_u32 m0, s101, 37888
    s_add_u32 s51, s51, 8192
    buffer_load_dwordx4 v25, s[8:11], s51 offen lds
    s_add_u32 m0, s101, 38912
    s_add_u32 s51, s51, 8192
    buffer_load_dwordx4 v24, s[8:11], s51 offen lds
    v_mfma_f32_32x32x16_bf16 v[80:95], v[108:111], v[156:159], v[80:95]
    ds_read_b64_tr_b16 v[108:109], v7 offset:10240
    ds_read_b64_tr_b16 v[110:111], v7 offset:10496
    s_waitcnt lgkmcnt(8)
    v_mfma_f32_32x32x16_bf16 a[0:15], v[48:51], v[120:123], a[0:15]
    v_mfma_f32_32x32x16_bf16 a[0:15], v[52:55], v[124:127], a[0:15]
    v_mfma_f32_32x32x16_bf16 v[64:79], v[112:115], v[160:163], v[64:79]
    ds_read_b64_tr_b16 v[112:113], v6 offset:10752
    ds_read_b64_tr_b16 v[114:115], v6 offset:11008
    s_add_u32 m0, s101, 39936
    s_add_u32 s51, s51, 8192
    buffer_load_dwordx4 v25, s[8:11], s51 offen lds
    v_mfma_f32_32x32x16_bf16 v[80:95], v[116:119], v[160:163], v[80:95]
    ds_read_b64_tr_b16 v[116:117], v7 offset:10752
    ds_read_b64_tr_b16 v[118:119], v7 offset:11008
    s_waitcnt vmcnt(13)
    s_barrier
    ds_read_b128 v[176:179], v26 offset:36864
    ds_read_b128 v[180:183], v27 offset:36864
    ds_read_b128 v[184:187], v28 offset:36864
    ds_read_b128 v[188:191], v29 offset:36864
    ds_read_b64_tr_b16 a[16:17], v41 offset:0
    ds_read_b64_tr_b16 a[18:19], v41 offset:512
    ds_read_b64_tr_b16 a[20:21], v42 offset:0
    ds_read_b64_tr_b16 a[22:23], v42 offset:512
    ds_read_b64_tr_b16 a[24:25], v41 offset:64
    ds_read_b64_tr_b16 a[26:27], v41 offset:576
    ds_read_b64_tr_b16 a[28:29], v42 offset:64
    ds_read_b64_tr_b16 a[30:31], v42 offset:576
    s_waitcnt lgkmcnt(15)
    v_mfma_f32_32x32x16_bf16 v[64:79], v[96:99], v[164:167], v[64:79]
    ds_read_b64_tr_b16 v[96:97], v6 offset:12288
    ds_read_b64_tr_b16 v[98:99], v6 offset:12544
    s_add_u32 s78, s84, 6
    s_and_b32 s78, s78, 7
    s_mul_i32 s78, s78, 196608
    s_add_u32 s78, s78, s41
    s_add_u32 m0, s99, 24576
    s_add_u32 s49, s78, 1024
    buffer_load_dwordx4 v8, s[80:83], s49 offen lds
    s_add_u32 m0, s99, 122880
    s_add_u32 s49, s78, 2048
    buffer_load_dwordx4 v8, s[80:83], s49 offen lds
    v_mfma_f32_32x32x16_bf16 v[80:95], v[100:103], v[164:167], v[80:95]
    ds_read_b64_tr_b16 v[100:101], v7 offset:12288
    ds_read_b64_tr_b16 v[102:103], v7 offset:12544
    ds_read_b64_tr_b16 v[120:121], v30 offset:12288
    ds_read_b64_tr_b16 v[122:123], v30 offset:12544
    ds_read_b64_tr_b16 v[124:125], v31 offset:12288
    ds_read_b64_tr_b16 v[126:127], v31 offset:12544
    v_mfma_f32_32x32x16_bf16 v[64:79], v[104:107], v[168:171], v[64:79]
    ds_read_b64_tr_b16 v[104:105], v6 offset:12800
    ds_read_b64_tr_b16 v[106:107], v6 offset:13056
    s_add_u32 m0, s101, 65536
    s_add_u32 s51, s84, 6
    s_and_b32 s51, s51, 7
    s_lshl_b32 s51, s51, 7
    s_add_u32 s51, s51, s100
    buffer_load_dwordx4 v24, s[8:11], s51 offen lds
    v_mfma_f32_32x32x16_bf16 v[80:95], v[108:111], v[168:171], v[80:95]
    ds_read_b64_tr_b16 v[108:109], v7 offset:12800
    ds_read_b64_tr_b16 v[110:111], v7 offset:13056
    s_waitcnt lgkmcnt(12)
    v_mfma_f32_32x32x16_bf16 a[32:47], v[48:51], a[16:19], 0
    v_mfma_f32_32x32x16_bf16 a[32:47], v[48:51], a[20:23], a[32:47]
    v_mfma_f32_32x32x16_bf16 a[32:47], v[52:55], a[24:27], a[32:47]
    v_mfma_f32_32x32x16_bf16 a[32:47], v[52:55], a[28:31], a[32:47]
    buffer_store_dwordx4 a[16:19], v0, s[4:7], s58 offen offset:0 sc1
    v_mfma_f32_32x32x16_bf16 v[64:79], v[112:115], v[172:175], v[64:79]
    ds_read_b64_tr_b16 v[112:113], v6 offset:14336
    ds_read_b64_tr_b16 v[114:115], v6 offset:14592
    s_add_u32 m0, s101, 66560
    s_add_u32 s51, s51, 8192
    buffer_load_dwordx4 v25, s[8:11], s51 offen lds
    s_add_u32 m0, s101, 67584
    s_add_u32 s51, s51, 8192
    buffer_load_dwordx4 v24, s[8:11], s51 offen lds
    v_mfma_f32_32x32x16_bf16 v[80:95], v[116:119], v[172:175], v[80:95]
    ds_read_b64_tr_b16 v[116:117], v7 offset:14336
    ds_read_b64_tr_b16 v[118:119], v7 offset:14592
    s_waitcnt lgkmcnt(8)
    v_mfma_f32_32x32x16_bf16 a[0:15], v[48:51], v[120:123], a[0:15]
    v_mfma_f32_32x32x16_bf16 a[0:15], v[52:55], v[124:127], a[0:15]
    v_mfma_f32_32x32x16_bf16 v[64:79], v[96:99], v[176:179], v[64:79]
    ds_read_b64_tr_b16 v[96:97], v6 offset:14848
    ds_read_b64_tr_b16 v[98:99], v6 offset:15104
    s_add_u32 m0, s101, 68608
    s_add_u32 s51, s51, 8192
    buffer_load_dwordx4 v25, s[8:11], s51 offen lds
    v_mfma_f32_32x32x16_bf16 v[80:95], v[100:103], v[176:179], v[80:95]
    ds_read_b64_tr_b16 v[100:101], v7 offset:14848
    ds_read_b64_tr_b16 v[102:103], v7 offset:15104
    buffer_store_dwordx4 a[20:23], v0, s[4:7], s58 offen offset:1024 sc1
    s_waitcnt vmcnt(14)
    s_barrier
    ds_read_b128 v[192:195], v26 offset:0
    ds_read_b128 v[196:199], v27 offset:0
    ds_read_b128 v[200:203], v28 offset:0
    ds_read_b128 v[204:207], v29 offset:0
    s_waitcnt lgkmcnt(12)
    v_mfma_f32_32x32x16_bf16 v[64:79], v[104:107], v[180:183], v[64:79]
    ds_read_b64_tr_b16 v[104:105], v6 offset:16384
    ds_read_b64_tr_b16 v[106:107], v6 offset:16640
    s_add_u32 s79, s84, 7
    s_and_b32 s79, s79, 7
    s_mul_i32 s79, s79, 196608
    s_add_u32 s79, s79, s41
    s_add_u32 m0, s99, 28672
    s_add_u32 s49, s79, 1024
    buffer_load_dwordx4 v8, s[80:83], s49 offen lds
    s_add_u32 m0, s99, 126976
    s_add_u32 s49, s79, 2048
    buffer_load_dwordx4 v8, s[80:83], s49 offen lds
    v_mfma_f32_32x32x16_bf16 v[80:95], v[108:111], v[180:183], v[80:95]
    ds_read_b64_tr_b16 v[108:109], v7 offset:16384
    ds_read_b64_tr_b16 v[110:111], v7 offset:16640
    ds_read_b64_tr_b16 v[120:121], v30 offset:16384
    ds_read_b64_tr_b16 v[122:123], v30 offset:16640
    ds_read_b64_tr_b16 v[124:125], v31 offset:16384
    ds_read_b64_tr_b16 v[126:127], v31 offset:16640
    s_waitcnt lgkmcnt(15)
    v_mfma_f32_32x32x16_bf16 v[64:79], v[112:115], v[184:187], v[64:79]
    ds_read_b64_tr_b16 v[112:113], v6 offset:16896
    ds_read_b64_tr_b16 v[114:115], v6 offset:17152
    s_add_u32 m0, s101, 69632
    s_add_u32 s51, s84, 7
    s_and_b32 s51, s51, 7
    s_lshl_b32 s51, s51, 7
    s_add_u32 s51, s51, s100
    buffer_load_dwordx4 v24, s[8:11], s51 offen lds
    v_mfma_f32_32x32x16_bf16 v[80:95], v[116:119], v[184:187], v[80:95]
    ds_read_b64_tr_b16 v[116:117], v7 offset:16896
    ds_read_b64_tr_b16 v[118:119], v7 offset:17152
    buffer_store_dwordx4 a[24:27], v0, s[4:7], s59 offen offset:0 sc1
    s_waitcnt lgkmcnt(15)
    v_mfma_f32_32x32x16_bf16 v[64:79], v[96:99], v[188:191], v[64:79]
    ds_read_b64_tr_b16 v[96:97], v6 offset:18432
    ds_read_b64_tr_b16 v[98:99], v6 offset:18688
    s_add_u32 m0, s101, 70656
    s_add_u32 s51, s51, 8192
    buffer_load_dwordx4 v25, s[8:11], s51 offen lds
    s_add_u32 m0, s101, 71680
    s_add_u32 s51, s51, 8192
    buffer_load_dwordx4 v24, s[8:11], s51 offen lds
    v_mfma_f32_32x32x16_bf16 v[80:95], v[100:103], v[188:191], v[80:95]
    ds_read_b64_tr_b16 v[100:101], v7 offset:18432
    ds_read_b64_tr_b16 v[102:103], v7 offset:18688
    s_waitcnt lgkmcnt(8)
    v_mfma_f32_32x32x16_bf16 a[0:15], v[48:51], v[120:123], a[0:15]
    v_mfma_f32_32x32x16_bf16 a[0:15], v[52:55], v[124:127], a[0:15]
    v_mfma_f32_32x32x16_bf16 v[64:79], v[104:107], v[192:195], v[64:79]
    ds_read_b64_tr_b16 v[104:105], v6 offset:18944
    ds_read_b64_tr_b16 v[106:107], v6 offset:19200
    s_add_u32 m0, s101, 72704
    s_add_u32 s51, s51, 8192
    buffer_load_dwordx4 v25, s[8:11], s51 offen lds
    v_mfma_f32_32x32x16_bf16 v[80:95], v[108:111], v[192:195], v[80:95]
    ds_read_b64_tr_b16 v[108:109], v7 offset:18944
    ds_read_b64_tr_b16 v[110:111], v7 offset:19200
    buffer_store_dwordx4 a[28:31], v0, s[4:7], s59 offen offset:1024 sc1
    s_waitcnt vmcnt(16)
    s_barrier
    ds_read_b128 v[208:211], v26 offset:4096
    ds_read_b128 v[212:215], v27 offset:4096
    ds_read_b128 v[216:219], v28 offset:4096
    ds_read_b128 v[220:223], v29 offset:4096
    s_waitcnt lgkmcnt(12)
    v_mfma_f32_32x32x16_bf16 v[64:79], v[112:115], v[196:199], v[64:79]
    ds_read_b64_tr_b16 v[112:113], v6 offset:20480
    ds_read_b64_tr_b16 v[114:115], v6 offset:20736
    v_mfma_f32_32x32x16_bf16 v[80:95], v[116:119], v[196:199], v[80:95]
    ds_read_b64_tr_b16 v[116:117], v7 offset:20480
    ds_read_b64_tr_b16 v[118:119], v7 offset:20736
    v_and_b32 v46, 0x1f0, v0
    s_lshl_b32 s85, s20, 9
    s_add_u32 s85, s85, 65536
    buffer_load_dwordx4 v[56:59], v46, s[4:7], s85 offen sc1
    ds_read_b64_tr_b16 v[120:121], v30 offset:20480
    ds_read_b64_tr_b16 v[122:123], v30 offset:20736
    ds_read_b64_tr_b16 v[124:125], v31 offset:20480
    ds_read_b64_tr_b16 v[126:127], v31 offset:20736
    s_waitcnt lgkmcnt(15)
    v_mfma_f32_32x32x16_bf16 v[64:79], v[96:99], v[200:203], v[64:79]
    ds_read_b64_tr_b16 v[96:97], v6 offset:20992
    ds_read_b64_tr_b16 v[98:99], v6 offset:21248
    v_mfma_f32_32x32x16_bf16 v[80:95], v[100:103], v[200:203], v[80:95]
    ds_read_b64_tr_b16 v[100:101], v7 offset:20992
    ds_read_b64_tr_b16 v[102:103], v7 offset:21248
    buffer_store_dword a32, v44, s[4:7], s92 offen sc1
    s_lshl_b32 s44, s17, 9
    s_add_u32 s44, s44, s27
    s_lshl_b32 s45, s17, 6
    s_add_u32 s45, s45, s28
    v_lshrrev_b32 v36, 9, v0
    v_and_b32 v37, 0x1f0, v0
    v_lshl_add_u32 v38, v36, 19, v37
    v_lshl_add_u32 v39, v36, 16, v37
    buffer_store_dwordx4 a[48:51], v38, s[4:7], s44 offen sc1
    s_mov_b32 exec_lo, 15
    s_mov_b32 exec_hi, 15
    buffer_store_dwordx4 a[48:51], v39, s[4:7], s45 offen sc1
    s_mov_b64 exec, -1
    s_waitcnt lgkmcnt(15)
    v_mfma_f32_32x32x16_bf16 v[64:79], v[104:107], v[204:207], v[64:79]
    ds_read_b64_tr_b16 v[104:105], v6 offset:22528
    ds_read_b64_tr_b16 v[106:107], v6 offset:22784
    v_mfma_f32_32x32x16_bf16 v[80:95], v[108:111], v[204:207], v[80:95]
    ds_read_b64_tr_b16 v[108:109], v7 offset:22528
    ds_read_b64_tr_b16 v[110:111], v7 offset:22784
    s_waitcnt lgkmcnt(8)
    v_mfma_f32_32x32x16_bf16 a[0:15], v[48:51], v[120:123], a[0:15]
    v_mfma_f32_32x32x16_bf16 a[0:15], v[52:55], v[124:127], a[0:15]
    v_mfma_f32_32x32x16_bf16 v[64:79], v[112:115], v[208:211], v[64:79]
    ds_read_b64_tr_b16 v[112:113], v6 offset:23040
    ds_read_b64_tr_b16 v[114:115], v6 offset:23296
    v_mfma_f32_32x32x16_bf16 v[80:95], v[116:119], v[208:211], v[80:95]
    ds_read_b64_tr_b16 v[116:117], v7 offset:23040
    ds_read_b64_tr_b16 v[118:119], v7 offset:23296
    s_waitcnt vmcnt(13)
    s_barrier
    ds_read_b128 v[224:227], v26 offset:32768
    ds_read_b128 v[228:231], v27 offset:32768
    ds_read_b128 v[232:235], v28 offset:32768
    ds_read_b128 v[236:239], v29 offset:32768
    s_waitcnt lgkmcnt(12)
    v_mfma_f32_32x32x16_bf16 v[64:79], v[96:99], v[212:215], v[64:79]
    ds_read_b64_tr_b16 v[96:97], v6 offset:24576
    ds_read_b64_tr_b16 v[98:99], v6 offset:24832
    v_mfma_f32_32x32x16_bf16 v[80:95], v[100:103], v[212:215], v[80:95]
    ds_read_b64_tr_b16 v[100:101], v7 offset:24576
    ds_read_b64_tr_b16 v[102:103], v7 offset:24832
    ds_read_b64_tr_b16 v[120:121], v30 offset:24576
    ds_read_b64_tr_b16 v[122:123], v30 offset:24832
    ds_read_b64_tr_b16 v[124:125], v31 offset:24576
    ds_read_b64_tr_b16 v[126:127], v31 offset:24832
    s_waitcnt lgkmcnt(15)
    v_mfma_f32_32x32x16_bf16 v[64:79], v[104:107], v[216:219], v[64:79]
    ds_read_b64_tr_b16 v[104:105], v6 offset:25088
    ds_read_b64_tr_b16 v[106:107], v6 offset:25344
    v_mfma_f32_32x32x16_bf16 v[80:95], v[108:111], v[216:219], v[80:95]
    ds_read_b64_tr_b16 v[108:109], v7 offset:25088
    ds_read_b64_tr_b16 v[110:111], v7 offset:25344
    s_waitcnt lgkmcnt(15)
    v_mfma_f32_32x32x16_bf16 v[64:79], v[112:115], v[220:223], v[64:79]
    ds_read_b64_tr_b16 v[112:113], v6 offset:26624
    ds_read_b64_tr_b16 v[114:115], v6 offset:26880
    v_mfma_f32_32x32x16_bf16 v[80:95], v[116:119], v[220:223], v[80:95]
    ds_read_b64_tr_b16 v[116:117], v7 offset:26624
    ds_read_b64_tr_b16 v[118:119], v7 offset:26880
    s_waitcnt lgkmcnt(8)
    v_mfma_f32_32x32x16_bf16 a[0:15], v[48:51], v[120:123], a[0:15]
    v_mfma_f32_32x32x16_bf16 a[0:15], v[52:55], v[124:127], a[0:15]
    ds_read_b64_tr_b16 a[240:241], v43 offset:0
    ds_read_b64_tr_b16 a[242:243], v43 offset:128
    ds_read_b64_tr_b16 a[244:245], v45 offset:0
    ds_read_b64_tr_b16 a[246:247], v45 offset:128
    v_mfma_f32_32x32x16_bf16 v[64:79], v[96:99], v[224:227], v[64:79]
    ds_read_b64_tr_b16 v[96:97], v6 offset:27136
    ds_read_b64_tr_b16 v[98:99], v6 offset:27392
    v_mfma_f32_32x32x16_bf16 v[80:95], v[100:103], v[224:227], v[80:95]
    ds_read_b64_tr_b16 v[100:101], v7 offset:27136
    ds_read_b64_tr_b16 v[102:103], v7 offset:27392
    s_waitcnt vmcnt(0)
    s_barrier
    ds_read_b128 v[240:243], v26 offset:36864
    ds_read_b128 v[244:247], v27 offset:36864
    ds_read_b128 v[248:251], v28 offset:36864
    ds_read_b128 v[252:255], v29 offset:36864
    s_getreg_b32 s44, hwreg(HW_REG_XCC_ID)
    s_and_b32 s44, s44, 15
    s_andn2_b32 s45, s98, 15
    s_or_b32 s93, s44, s45
    v_mov_b32 v63, s93
    s_lshl_b32 s45, s17, 4
    s_add_u32 s45, s45, s18
    s_lshl_b32 s45, s45, 6
    s_add_u32 s45, s45, 32768
    s_cmp_eq_u32 s16, 0
    s_cselect_b32 s45, s45, 268435456
    v_lshrrev_b32 v62, 2, v0
    s_mov_b32 exec_hi, 0
    s_mov_b32 exec_lo, 65535
    buffer_store_dword v63, v62, s[4:7], s45 offen sc1
    s_mov_b64 exec, -1
    s_waitcnt lgkmcnt(15)
    v_mfma_f32_32x32x16_bf16 v[64:79], v[104:107], v[228:231], v[64:79]
    ds_read_b64_tr_b16 v[104:105], v6 offset:28672
    ds_read_b64_tr_b16 v[106:107], v6 offset:28928
    s_add_u32 m0, s99, 32768
    s_add_u32 s49, s72, 0
    buffer_load_dwordx4 v8, s[80:83], s49 offen lds
    v_mfma_f32_32x32x16_bf16 v[80:95], v[108:111], v[228:231], v[80:95]
    ds_read_b64_tr_b16 v[108:109], v7 offset:28672
    ds_read_b64_tr_b16 v[110:111], v7 offset:28928
    ds_read_b64_tr_b16 v[120:121], v30 offset:28672
    ds_read_b64_tr_b16 v[122:123], v30 offset:28928
    ds_read_b64_tr_b16 v[124:125], v31 offset:28672
    ds_read_b64_tr_b16 v[126:127], v31 offset:28928
    s_waitcnt lgkmcnt(15)
    v_mfma_f32_32x32x16_bf16 v[64:79], v[112:115], v[232:235], v[64:79]
    ds_read_b64_tr_b16 v[112:113], v6 offset:29184
    ds_read_b64_tr_b16 v[114:115], v6 offset:29440
    s_add_u32 m0, s99, 36864
    s_add_u32 s49, s73, 0
    buffer_load_dwordx4 v8, s[80:83], s49 offen lds
    v_mfma_f32_32x32x16_bf16 v[80:95], v[116:119], v[232:235], v[80:95]
    ds_read_b64_tr_b16 v[116:117], v7 offset:29184
    ds_read_b64_tr_b16 v[118:119], v7 offset:29440
    s_waitcnt lgkmcnt(15)
    v_mfma_f32_32x32x16_bf16 v[64:79], v[96:99], v[236:239], v[64:79]
    ds_read_b64_tr_b16 v[96:97], v6 offset:30720
    ds_read_b64_tr_b16 v[98:99], v6 offset:30976
    s_add_u32 m0, s99, 40960
    s_add_u32 s49, s74, 0
    buffer_load_dwordx4 v8, s[80:83], s49 offen lds
    v_mfma_f32_32x32x16_bf16 v[80:95], v[100:103], v[236:239], v[80:95]
    ds_read_b64_tr_b16 v[100:101], v7 offset:30720
    ds_read_b64_tr_b16 v[102:103], v7 offset:30976
    s_waitcnt lgkmcnt(8)
    v_mfma_f32_32x32x16_bf16 a[0:15], v[48:51], v[120:123], a[0:15]
    v_mfma_f32_32x32x16_bf16 a[0:15], v[52:55], v[124:127], a[0:15]
    v_mfma_f32_32x32x16_bf16 v[64:79], v[104:107], v[240:243], v[64:79]
    ds_read_b64_tr_b16 v[104:105], v6 offset:31232
    ds_read_b64_tr_b16 v[106:107], v6 offset:31488
    s_add_u32 m0, s99, 45056
    s_add_u32 s49, s75, 0
    buffer_load_dwordx4 v8, s[80:83], s49 offen lds
    v_mfma_f32_32x32x16_bf16 v[80:95], v[108:111], v[240:243], v[80:95]
    ds_read_b64_tr_b16 v[108:109], v7 offset:31232
    ds_read_b64_tr_b16 v[110:111], v7 offset:31488
    s_nop 2
    ds_write_b32 v34, a0 offset:1280
    s_mov_b32 s50, 0
Lst0b_2:
    v_cmp_ne_u32 vcc, s98, v57
    s_cbranch_vccnz Lst0_1
    v_cmp_ne_u32 vcc, s98, v59
    s_cbranch_vccnz Lst0_1
    v_mov_b32 v57, v58
    v_mul_f32 v22, 989855744, v56
    v_mul_f32 v57, 989855744, v57
    v_fma_f32 v57, -v22, v22, v57
    v_max_f32 v57, 0, v57
    v_add_f32 v58, 925353388, v57
    v_rsq_f32 v23, v58
    s_mov_b32 s58, -1
    s_mov_b32 s59, 0
    s_waitcnt lgkmcnt(9)
    v_mfma_f32_32x32x16_bf16 v[64:79], v[112:115], v[244:247], v[64:79]
    s_add_u32 m0, s99, 49152
    s_add_u32 s49, s76, 0
    buffer_load_dwordx4 v8, s[80:83], s49 offen lds
    v_mfma_f32_32x32x16_bf16 v[80:95], v[116:119], v[244:247], v[80:95]
    s_waitcnt lgkmcnt(0)
    s_barrier
    ds_read_b32 v120, v2 offset:1280
    ds_read_b32 v121, v2 offset:1536
    ds_read_b32 v122, v2 offset:1792
    ds_read_b32 v123, v2 offset:2048
    v_mov_b32 v42, 0
    v_mov_b32 v43, 0
    v_mov_b32 v46, 0
    v_mov_b32 v47, 0
    v_cndmask_b32 v48, 0, -v22, s[58:59]
    v_cvt_pk_bf16_f32 v44, v48, v48
    v_and_b32 v49, 0xffff0000, v44
    v_sub_f32 v48, v48, v49
    v_cvt_pk_bf16_f32 v45, v48, 0
    v_mfma_f32_32x32x16_bf16 v[64:79], v[96:99], v[248:251], v[64:79]
    v_mfma_f32_32x32x16_bf16 v[80:95], v[100:103], v[248:251], v[80:95]
    s_waitcnt lgkmcnt(0)
    v_add_f32 v120, v120, v121
    v_add_f32 v122, v122, v123
    v_add_f32 v120, v120, v122
    v_cvt_pk_bf16_f32 v41, v120, 0
    v_lshlrev_b32 v51, 16, v41
    v_sub_f32 v51, v120, v51
    v_cvt_pk_bf16_f32 v40, v120, v51
    v_accvgpr_write_b32 a248, v120
    s_nop 0
    v_mfma_f32_32x32x16_bf16 v[64:79], v[40:43], v[44:47], v[64:79]
    v_cndmask_b32 v48, -v22, 0, s[58:59]
    v_cvt_pk_bf16_f32 v44, v48, v48
    v_and_b32 v49, 0xffff0000, v44
    v_sub_f32 v48, v48, v49
    v_cvt_pk_bf16_f32 v45, v48, 0
    s_nop 1
    v_mfma_f32_32x32x16_bf16 v[80:95], v[40:43], v[44:47], v[80:95]
    v_mfma_f32_32x32x16_bf16 v[64:79], v[104:107], v[252:255], v[64:79]
    v_mfma_f32_32x32x16_bf16 v[80:95], v[108:111], v[252:255], v[80:95]
    v_mul_f32 v60, 1069066811, v23
    s_lshl_b32 s46, s17, 9
    s_add_u32 s46, s46, s27
    s_lshl_b32 s48, s17, 6
    s_add_u32 s48, s48, s28
    s_mov_b32 s52, 0x00010001
    s_mov_b32 s53, 0x00010001
    v_lshrrev_b32 v116, 4, v0
    s_add_u32 m0, s99, 53248
    s_add_u32 s49, s77, 0
    buffer_load_dwordx4 v8, s[80:83], s49 offen lds
    v_cvt_pk_bf16_f32 v40, v64, v65
    v_cvt_pk_bf16_f32 v41, v66, v67
    v_cvt_pk_bf16_f32 v42, v68, v69
    v_cvt_pk_bf16_f32 v43, v70, v71
    v_cvt_pk_bf16_f32 v44, v72, v73
    v_cvt_pk_bf16_f32 v45, v74, v75
    v_mfma_f32_32x32x16_bf16 v[96:111], a[240:243], v[40:43], 0
    v_cvt_pk_bf16_f32 v46, v76, v77
    v_cvt_pk_bf16_f32 v47, v78, v79
    v_mul_f32 v80, v80, v23
    s_add_u32 m0, s99, 57344
    s_add_u32 s49, s78, 0
    buffer_load_dwordx4 v8, s[80:83], s49 offen lds
    v_mul_f32 v81, v81, v23
    v_mul_f32 v82, v82, v23
    v_mul_f32 v83, v83, v23
    v_mfma_f32_32x32x16_bf16 v[96:111], a[244:247], v[44:47], v[96:111]
    v_mul_f32 v84, v84, v23
    v_mul_f32 v85, v85, v23
    v_mul_f32 v86, v86, v23
    v_mul_f32 v87, v87, v23
    v_mul_f32 v88, v88, v23
    v_mul_f32 v89, v89, v23
    s_add_u32 m0, s99, 61440
    s_add_u32 s49, s79, 0
    buffer_load_dwordx4 v8, s[80:83], s49 offen lds
    v_cvt_pk_bf16_f32 v48, v80, v81
    v_cvt_pk_bf16_f32 v49, v82, v83
    v_cvt_pk_bf16_f32 v50, v84, v85
    v_cvt_pk_bf16_f32 v51, v86, v87
    v_cvt_pk_bf16_f32 v52, v88, v89
    ds_write_b128 v10, v[48:51] offset:128
    v_pk_mul_f32 v[90:91], v[90:91], v[22:23] op_sel:[0,1]
    v_pk_mul_f32 v[92:93], v[92:93], v[22:23] op_sel:[0,1]
    v_pk_mul_f32 v[94:95], v[94:95], v[22:23] op_sel:[0,1]
    v_cvt_pk_bf16_f32 v53, v90, v91
    v_cvt_pk_bf16_f32 v54, v92, v93
    v_min_u32 v62, 16, v0
    v_lshlrev_b32 v62, 9, v62
    buffer_load_dword a253, v62, s[4:7], s30 offen sc1
    v_cvt_pk_bf16_f32 v55, v94, v95
    ds_write_b128 v10, v[52:55] offset:144
    v_max3_f32 v56, v96, v97, v98
    v_min3_f32 v58, v96, v97, v98
    v_max3_f32 v56, v56, v99, v100
    v_min3_f32 v58, v58, v99, v100
    v_max3_f32 v56, v56, v101, v102
    v_min3_f32 v58, v58, v101, v102
    v_max3_f32 v56, v56, v103, v104
    v_min3_f32 v58, v58, v103, v104
    v_max3_f32 v56, v56, v105, v106
    v_min_u32 v62, 240, v0
    v_lshlrev_b32 v62, 3, v62
    buffer_load_dword a253, v62, s[4:7], s29 offen sc1
    v_min3_f32 v58, v58, v105, v106
    v_max3_f32 v56, v56, v107, v108
    v_min3_f32 v58, v58, v107, v108
    v_max3_f32 v56, v56, v109, v110
    v_min3_f32 v58, v58, v109, v110
    v_max_f32 v56, v56, v111
    v_min_f32 v58, v58, v111
    v_mul_f32 v56, v56, v60
    v_mul_f32 v58, v58, v60
    v_pk_fma_f32 v[64:65], v[96:97], v[60:61], v[56:57] op_sel_hi:[1,0,0] neg_lo:[0,0,1] neg_hi:[0,0,1]
    s_mov_b64 s[12:13], s[90:91]
    s_mov_b32 s14, 2097152
    s_sub_u32 s49, s29, 9437184
    v_min_u32 v62, 0xf0, v0
    v_lshlrev_b32 v62, 3, v62
    buffer_load_dword a253, v62, s[12:15], s49 offen sc1
    buffer_load_dword a253, v62, s[4:7], s25 offen sc1
    v_pk_fma_f32 v[66:67], v[98:99], v[60:61], v[56:57] op_sel_hi:[1,0,0] neg_lo:[0,0,1] neg_hi:[0,0,1]
    v_pk_fma_f32 v[68:69], v[100:101], v[60:61], v[56:57] op_sel_hi:[1,0,0] neg_lo:[0,0,1] neg_hi:[0,0,1]
    v_pk_fma_f32 v[70:71], v[102:103], v[60:61], v[56:57] op_sel_hi:[1,0,0] neg_lo:[0,0,1] neg_hi:[0,0,1]
    v_pk_fma_f32 v[72:73], v[104:105], v[60:61], v[56:57] op_sel_hi:[1,0,0] neg_lo:[0,0,1] neg_hi:[0,0,1]
    v_pk_fma_f32 v[74:75], v[106:107], v[60:61], v[56:57] op_sel_hi:[1,0,0] neg_lo:[0,0,1] neg_hi:[0,0,1]
    v_pk_fma_f32 v[76:77], v[108:109], v[60:61], v[56:57] op_sel_hi:[1,0,0] neg_lo:[0,0,1] neg_hi:[0,0,1]
    v_pk_fma_f32 v[78:79], v[110:111], v[60:61], v[56:57] op_sel_hi:[1,0,0] neg_lo:[0,0,1] neg_hi:[0,0,1]
    v_pk_fma_f32 v[96:97], v[96:97], v[60:61], v[58:59] op_sel_hi:[1,0,0] neg_lo:[1,0,0] neg_hi:[1,0,0]
    v_pk_fma_f32 v[98:99], v[98:99], v[60:61], v[58:59] op_sel_hi:[1,0,0] neg_lo:[1,0,0] neg_hi:[1,0,0]
    v_pk_fma_f32 v[100:101], v[100:101], v[60:61], v[58:59] op_sel_hi:[1,0,0] neg_lo:[1,0,0] neg_hi:[1,0,0]
    v_pk_fma_f32 v[102:103], v[102:103], v[60:61], v[58:59] op_sel_hi:[1,0,0] neg_lo:[1,0,0] neg_hi:[1,0,0]
    v_pk_fma_f32 v[104:105], v[104:105], v[60:61], v[58:59] op_sel_hi:[1,0,0] neg_lo:[1,0,0] neg_hi:[1,0,0]
    v_pk_fma_f32 v[106:107], v[106:107], v[60:61], v[58:59] op_sel_hi:[1,0,0] neg_lo:[1,0,0] neg_hi:[1,0,0]
    v_pk_fma_f32 v[108:109], v[108:109], v[60:61], v[58:59] op_sel_hi:[1,0,0] neg_lo:[1,0,0] neg_hi:[1,0,0]
    v_pk_fma_f32 v[110:111], v[110:111], v[60:61], v[58:59] op_sel_hi:[1,0,0] neg_lo:[1,0,0] neg_hi:[1,0,0]
    v_exp_f32 v64, v64
    v_exp_f32 v65, v65
    v_exp_f32 v66, v66
    v_exp_f32 v67, v67
    v_exp_f32 v68, v68
    v_exp_f32 v69, v69
    v_exp_f32 v70, v70
    v_exp_f32 v71, v71
    v_exp_f32 v72, v72
    v_exp_f32 v73, v73
    v_exp_f32 v74, v74
    v_exp_f32 v75, v75
    v_exp_f32 v76, v76
    v_exp_f32 v77, v77
    v_exp_f32 v78, v78
    v_exp_f32 v79, v79
    v_exp_f32 v96, v96
    v_exp_f32 v97, v97
    v_pk_add_f32 v[56:57], v[64:65], v[66:67]
    v_pk_add_f32 v[56:57], v[56:57], v[68:69]
    v_pk_add_f32 v[56:57], v[56:57], v[70:71]
    v_pk_add_f32 v[56:57], v[56:57], v[72:73]
    v_pk_add_f32 v[56:57], v[56:57], v[74:75]
    v_pk_add_f32 v[56:57], v[56:57], v[76:77]
    v_pk_add_f32 v[56:57], v[56:57], v[78:79]
    v_add_f32 v56, v56, v57
    v_rcp_f32 v56, v56
    v_exp_f32 v98, v98
    v_exp_f32 v99, v99
    v_pk_mul_f32 v[64:65], v[64:65], v[56:57] op_sel_hi:[1,0]
    v_pk_mul_f32 v[66:67], v[66:67], v[56:57] op_sel_hi:[1,0]
    v_pk_mul_f32 v[68:69], v[68:69], v[56:57] op_sel_hi:[1,0]
    v_pk_mul_f32 v[70:71], v[70:71], v[56:57] op_sel_hi:[1,0]
    v_pk_mul_f32 v[72:73], v[72:73], v[56:57] op_sel_hi:[1,0]
    v_pk_mul_f32 v[74:75], v[74:75], v[56:57] op_sel_hi:[1,0]
    v_pk_mul_f32 v[76:77], v[76:77], v[56:57] op_sel_hi:[1,0]
    v_pk_mul_f32 v[78:79], v[78:79], v[56:57] op_sel_hi:[1,0]
    v_cvt_pk_bf16_f32 v80, v64, v65
    v_cvt_pk_bf16_f32 v81, v66, v67
    v_cvt_pk_bf16_f32 v82, v68, v69
    v_cvt_pk_bf16_f32 v83, v70, v71
    v_cvt_pk_bf16_f32 v84, v72, v73
    v_cvt_pk_bf16_f32 v85, v74, v75
    v_cvt_pk_bf16_f32 v86, v76, v77
    v_cvt_pk_bf16_f32 v87, v78, v79
    ds_write_b128 v9, v[80:83]
    ds_write_b128 v9, v[84:87] offset:16
    v_exp_f32 v100, v100
    v_exp_f32 v101, v101
    v_exp_f32 v102, v102
    v_exp_f32 v103, v103
    v_exp_f32 v104, v104
    v_exp_f32 v105, v105
    v_exp_f32 v106, v106
    v_exp_f32 v107, v107
    v_exp_f32 v108, v108
    v_exp_f32 v109, v109
    v_exp_f32 v110, v110
    v_exp_f32 v111, v111
    v_pk_add_f32 v[58:59], v[96:97], v[98:99]
    v_pk_add_f32 v[58:59], v[58:59], v[100:101]
    v_pk_add_f32 v[58:59], v[58:59], v[102:103]
    v_pk_add_f32 v[58:59], v[58:59], v[104:105]
    v_pk_add_f32 v[58:59], v[58:59], v[106:107]
    v_pk_add_f32 v[58:59], v[58:59], v[108:109]
    v_pk_add_f32 v[58:59], v[58:59], v[110:111]
    v_add_f32 v58, v58, v59
    v_rcp_f32 v58, v58
    s_nop 0
    v_pk_mul_f32 v[96:97], v[96:97], v[58:59] op_sel_hi:[1,0]
    v_pk_mul_f32 v[98:99], v[98:99], v[58:59] op_sel_hi:[1,0]
    v_pk_mul_f32 v[100:101], v[100:101], v[58:59] op_sel_hi:[1,0]
    v_pk_mul_f32 v[102:103], v[102:103], v[58:59] op_sel_hi:[1,0]
    v_cvt_pk_bf16_f32 v88, v96, v97
    v_cvt_pk_bf16_f32 v89, v98, v99
    v_cvt_pk_bf16_f32 v90, v100, v101
    v_cvt_pk_bf16_f32 v91, v102, v103
    ds_write_b128 v9, v[88:91] offset:32
    v_pk_mul_f32 v[104:105], v[104:105], v[58:59] op_sel_hi:[1,0]
    v_pk_mul_f32 v[106:107], v[106:107], v[58:59] op_sel_hi:[1,0]
    v_pk_mul_f32 v[108:109], v[108:109], v[58:59] op_sel_hi:[1,0]
    v_pk_mul_f32 v[110:111], v[110:111], v[58:59] op_sel_hi:[1,0]
    v_cvt_pk_bf16_f32 v92, v104, v105
    v_cvt_pk_bf16_f32 v93, v106, v107
    v_cvt_pk_bf16_f32 v94, v108, v109
    v_cvt_pk_bf16_f32 v95, v110, v111
    ds_write_b128 v9, v[92:95] offset:48
    v_mov_b32 v56, 0x3f803f80
    v_mov_b32 v57, 0x3f803f80
    v_mov_b32 v58, 0x3f803f80
    v_mov_b32 v59, 0x3f803f80
    s_lshl_b32 s47, s16, 12
    s_add_u32 s47, s47, 32768
    v_lshlrev_b32 v38, 2, v0
    buffer_load_dword v36, v38, s[4:7], s47 offen sc1
    s_waitcnt lgkmcnt(0)
    s_barrier
    ds_read_b64_tr_b16 v[64:65], v11 offset:0
    ds_read_b64_tr_b16 v[80:81], v12 offset:0
    ds_read_b64_tr_b16 v[66:67], v11 offset:3584
    ds_read_b64_tr_b16 v[82:83], v12 offset:3584
    ds_read_b64_tr_b16 v[68:69], v11 offset:7168
    ds_read_b64_tr_b16 v[84:85], v12 offset:7168
    ds_read_b64_tr_b16 v[70:71], v11 offset:10752
    ds_read_b64_tr_b16 v[86:87], v12 offset:10752
    ds_read_b64_tr_b16 v[72:73], v11 offset:14336
    ds_read_b64_tr_b16 v[88:89], v12 offset:14336
    ds_read_b64_tr_b16 v[74:75], v11 offset:17920
    ds_read_b64_tr_b16 v[90:91], v12 offset:17920
    ds_read_b64_tr_b16 v[76:77], v11 offset:21504
    ds_read_b64_tr_b16 v[92:93], v12 offset:21504
    ds_read_b64_tr_b16 v[78:79], v11 offset:25088
    ds_read_b64_tr_b16 v[94:95], v12 offset:25088
    s_waitcnt lgkmcnt(12)
    v_mfma_f32_16x16x32_bf16 v[60:63], v[64:67], v[80:83], 0
    v_mfma_f32_16x16x32_bf16 v[40:43], v[64:67], v[56:59], 0
    s_waitcnt lgkmcnt(8)
    v_mfma_f32_16x16x32_bf16 v[60:63], v[68:71], v[84:87], v[60:63]
    v_mfma_f32_16x16x32_bf16 v[40:43], v[68:71], v[56:59], v[40:43]
    s_waitcnt lgkmcnt(4)
    v_mfma_f32_16x16x32_bf16 v[60:63], v[72:75], v[88:91], v[60:63]
    v_mfma_f32_16x16x32_bf16 v[40:43], v[72:75], v[56:59], v[40:43]
    s_waitcnt lgkmcnt(0)
    v_mfma_f32_16x16x32_bf16 v[60:63], v[76:79], v[92:95], v[60:63]
    v_mfma_f32_16x16x32_bf16 v[40:43], v[76:79], v[56:59], v[40:43]
    s_nop 6
    v_cvt_pk_bf16_f32 v48, v60, v61
    v_cvt_pk_bf16_f32 v49, v62, v63
    v_cvt_pk_bf16_f32 v50, v60, v61
    v_cvt_pk_bf16_f32 v51, v62, v63
    s_nop 0
    v_permlane16_swap_b32 v48, v50
    v_permlane16_swap_b32 v49, v51
    s_mov_b32 exec_lo, 0xffff
    s_mov_b32 exec_hi, 0xffff
    buffer_store_dwordx4 v[48:51], v16, s[4:7], s46 offen sc1
    s_mov_b64 exec, s[52:53]
    buffer_store_dwordx4 v[40:43], v116, s[4:7], s48 offen sc1
    s_mov_b64 exec, -1
    s_waitcnt vmcnt(7)
    s_barrier
    v_mov_b32 v72, 0x3f803f80
    v_mov_b32 v73, 0x3f803f80
    v_mov_b32 v74, 0x3f803f80
    v_mov_b32 v75, 0x3f803f80
    v_subrev_u32 v34, 2048, v34
    v_subrev_u32 v33, 2048, v2
    ds_read_b64_tr_b16 v[96:97], v6 offset:32768
    ds_read_b64_tr_b16 v[98:99], v6 offset:33024
    ds_read_b64_tr_b16 v[100:101], v6 offset:33280
    ds_read_b64_tr_b16 v[102:103], v6 offset:33536
    ds_read_b64_tr_b16 v[104:105], v6 offset:34816
    ds_read_b64_tr_b16 v[106:107], v6 offset:35072
    ds_read_b64_tr_b16 v[108:109], v6 offset:35328
    ds_read_b64_tr_b16 v[110:111], v6 offset:35584
    ds_read_b64_tr_b16 v[64:65], v6 offset:36864
    ds_read_b64_tr_b16 v[66:67], v6 offset:37120
    ds_read_b64_tr_b16 v[68:69], v6 offset:37376
    ds_read_b64_tr_b16 v[70:71], v6 offset:37632
    s_waitcnt lgkmcnt(8)
    v_mfma_f32_32x32x16_bf16 v[112:127], v[96:99], v[128:131], 0
    ds_read_b64_tr_b16 v[96:97], v6 offset:38912
    ds_read_b64_tr_b16 v[98:99], v6 offset:39168
    ds_read_b64_tr_b16 v[52:53], v30 offset:32768
    ds_read_b64_tr_b16 v[54:55], v30 offset:33024
    v_mfma_f32_32x32x16_bf16 v[112:127], v[100:103], v[132:135], v[112:127]
    ds_read_b64_tr_b16 v[100:101], v6 offset:39424
    ds_read_b64_tr_b16 v[102:103], v6 offset:39680
    s_waitcnt lgkmcnt(10)
    v_mfma_f32_32x32x16_bf16 v[112:127], v[104:107], v[136:139], v[112:127]
    ds_read_b64_tr_b16 v[104:105], v6 offset:40960
    ds_read_b64_tr_b16 v[106:107], v6 offset:41216
    s_waitcnt lgkmcnt(4)
    v_mfma_f32_32x32x16_bf16 v[80:95], v[72:75], v[52:55], 0
    ds_read_b64_tr_b16 v[52:53], v30 offset:36864
    ds_read_b64_tr_b16 v[54:55], v30 offset:37120
    v_bfe_u32 v58, v0, 4, 4
    v_bfe_u32 v56, v0, 8, 1
    v_mfma_f32_32x32x16_bf16 v[112:127], v[108:111], v[140:143], v[112:127]
    ds_read_b64_tr_b16 v[108:109], v6 offset:41472
    ds_read_b64_tr_b16 v[110:111], v6 offset:41728
    v_lshlrev_b32 v56, 3, v56
    v_xor_b32 v58, v58, v56
    v_mfma_f32_32x32x16_bf16 v[112:127], v[64:67], v[144:147], v[112:127]
    ds_read_b64_tr_b16 v[64:65], v6 offset:43008
    ds_read_b64_tr_b16 v[66:67], v6 offset:43264
    s_waitcnt lgkmcnt(4)
    v_mfma_f32_32x32x16_bf16 v[80:95], v[72:75], v[52:55], v[80:95]
    ds_read_b64_tr_b16 v[52:53], v30 offset:40960
    ds_read_b64_tr_b16 v[54:55], v30 offset:41216
    v_mov_b32 v56, 0x3f80
    v_mov_b32 v57, 0x3f800000
    v_mfma_f32_32x32x16_bf16 v[112:127], v[68:71], v[148:151], v[112:127]
    ds_read_b64_tr_b16 v[68:69], v6 offset:43520
    ds_read_b64_tr_b16 v[70:71], v6 offset:43776
    v_cmp_eq_u32 vcc, 0, v58
    v_cmp_eq_u32 s[60:61], 1, v58
    s_nop 0
    v_cndmask_b32 v76, 0, v56, vcc
    v_cndmask_b32 v76, v76, v57, s[60:61]
    s_waitcnt vmcnt(2)
    v_xor_b32 v36, s93, v36
    s_mov_b32 s50, 0
    v_cmp_lt_u32 vcc, 15, v36
    s_cbranch_vccz Lrdyb_4
Lrdy_3:
    s_mov_b64 exec, vcc
    s_sleep 6
    buffer_load_dword v36, v38, s[4:7], s47 offen sc1
    s_add_u32 s50, s50, 1
    s_cmp_gt_u32 s50, 0x20000
    s_cbranch_scc1 Labort
    s_waitcnt vmcnt(0)
    v_xor_b32 v36, s93, v36
    v_cmp_lt_u32 vcc, 15, v36
    s_cbranch_vccnz Lrdy_3
    s_mov_b64 exec, -1
Lrdyb_4:
    s_barrier
    s_add_u32 s49, s54, 0
    buffer_load_dwordx4 a[0:3], v0, s[4:7], s49 offen offset:0 sc1
    buffer_load_dwordx4 a[4:7], v0, s[4:7], s49 offen offset:1024 sc1
    v_mfma_f32_32x32x16_bf16 v[112:127], v[96:99], v[152:155], v[112:127]
    ds_read_b64_tr_b16 v[96:97], v6 offset:45056
    ds_read_b64_tr_b16 v[98:99], v6 offset:45312
    s_waitcnt lgkmcnt(4)
    v_mfma_f32_32x32x16_bf16 v[80:95], v[72:75], v[52:55], v[80:95]
    ds_read_b64_tr_b16 v[52:53], v30 offset:45056
    ds_read_b64_tr_b16 v[54:55], v30 offset:45312
    v_cmp_eq_u32 vcc, 2, v58
    v_cmp_eq_u32 s[60:61], 3, v58
    s_nop 0
    v_cndmask_b32 v77, 0, v56, vcc
    v_cndmask_b32 v77, v77, v57, s[60:61]
    buffer_load_dwordx4 a[8:11], v0, s[4:7], s49 offen offset:2048 sc1
    v_mfma_f32_32x32x16_bf16 v[112:127], v[100:103], v[156:159], v[112:127]
    ds_read_b64_tr_b16 v[100:101], v6 offset:45568
    ds_read_b64_tr_b16 v[102:103], v6 offset:45824
    buffer_load_dwordx4 a[12:15], v0, s[4:7], s49 offen offset:3072 sc1
    v_mfma_f32_32x32x16_bf16 v[112:127], v[104:107], v[160:163], v[112:127]
    ds_read_b64_tr_b16 v[104:105], v6 offset:47104
    ds_read_b64_tr_b16 v[106:107], v6 offset:47360
    s_waitcnt lgkmcnt(4)
    v_mfma_f32_32x32x16_bf16 v[80:95], v[72:75], v[52:55], v[80:95]
    ds_read_b64_tr_b16 v[52:53], v30 offset:49152
    ds_read_b64_tr_b16 v[54:55], v30 offset:49408
    v_cmp_eq_u32 vcc, 4, v58
    v_cmp_eq_u32 s[60:61], 5, v58
    s_nop 0
    v_cndmask_b32 v78, 0, v56, vcc
    v_cndmask_b32 v78, v78, v57, s[60:61]
    s_add_u32 s49, s54, 4096
    buffer_load_dwordx4 a[16:19], v0, s[4:7], s49 offen offset:0 sc1
    v_mfma_f32_32x32x16_bf16 v[112:127], v[108:111], v[164:167], v[112:127]
    ds_read_b64_tr_b16 v[108:109], v6 offset:47616
    ds_read_b64_tr_b16 v[110:111], v6 offset:47872
    v_cmp_eq_u32 vcc, 6, v58
    v_cmp_eq_u32 s[60:61], 7, v58
    s_nop 0
    v_cndmask_b32 v79, 0, v56, vcc
    v_cndmask_b32 v79, v79, v57, s[60:61]
    buffer_load_dwordx4 a[20:23], v0, s[4:7], s49 offen offset:1024 sc1
    v_mfma_f32_32x32x16_bf16 v[112:127], v[64:67], v[168:171], v[112:127]
    ds_read_b64_tr_b16 v[64:65], v6 offset:49152
    ds_read_b64_tr_b16 v[66:67], v6 offset:49408
    s_waitcnt lgkmcnt(4)
    v_mfma_f32_32x32x16_bf16 v[80:95], v[72:75], v[52:55], v[80:95]
    ds_read_b64_tr_b16 v[52:53], v30 offset:53248
    ds_read_b64_tr_b16 v[54:55], v30 offset:53504
    buffer_load_dwordx4 a[24:27], v0, s[4:7], s49 offen offset:2048 sc1
    v_mfma_f32_32x32x16_bf16 v[112:127], v[68:71], v[172:175], v[112:127]
    ds_read_b64_tr_b16 v[68:69], v6 offset:49664
    ds_read_b64_tr_b16 v[70:71], v6 offset:49920
    buffer_load_dwordx4 a[28:31], v0, s[4:7], s49 offen offset:3072 sc1
    v_mfma_f32_32x32x16_bf16 v[112:127], v[96:99], v[176:179], v[112:127]
    ds_read_b64_tr_b16 v[96:97], v6 offset:51200
    ds_read_b64_tr_b16 v[98:99], v6 offset:51456
    s_waitcnt lgkmcnt(4)
    v_mfma_f32_32x32x16_bf16 v[80:95], v[72:75], v[52:55], v[80:95]
    ds_read_b64_tr_b16 v[52:53], v30 offset:57344
    ds_read_b64_tr_b16 v[54:55], v30 offset:57600
    s_add_u32 s49, s54, 8192
    buffer_load_dwordx4 a[32:35], v0, s[4:7], s49 offen offset:0 sc1
    v_mfma_f32_32x32x16_bf16 v[112:127], v[100:103], v[180:183], v[112:127]
    ds_read_b64_tr_b16 v[100:101], v6 offset:51712
    ds_read_b64_tr_b16 v[102:103], v6 offset:51968
    buffer_load_dwordx4 a[36:39], v0, s[4:7], s49 offen offset:1024 sc1
    v_mfma_f32_32x32x16_bf16 v[112:127], v[104:107], v[184:187], v[112:127]
    ds_read_b64_tr_b16 v[104:105], v6 offset:53248
    ds_read_b64_tr_b16 v[106:107], v6 offset:53504
    s_waitcnt lgkmcnt(4)
    v_mfma_f32_32x32x16_bf16 v[80:95], v[72:75], v[52:55], v[80:95]
    ds_read_b64_tr_b16 v[52:53], v30 offset:61440
    ds_read_b64_tr_b16 v[54:55], v30 offset:61696
    buffer_load_dwordx4 a[40:43], v0, s[4:7], s49 offen offset:2048 sc1
    v_mfma_f32_32x32x16_bf16 v[112:127], v[108:111], v[188:191], v[112:127]
    ds_read_b64_tr_b16 v[108:109], v6 offset:53760
    ds_read_b64_tr_b16 v[110:111], v6 offset:54016
    buffer_load_dwordx4 a[44:47], v0, s[4:7], s49 offen offset:3072 sc1
    v_mfma_f32_32x32x16_bf16 v[112:127], v[64:67], v[192:195], v[112:127]
    ds_read_b64_tr_b16 v[64:65], v6 offset:55296
    ds_read_b64_tr_b16 v[66:67], v6 offset:55552
    s_waitcnt lgkmcnt(4)
    v_mfma_f32_32x32x16_bf16 v[80:95], v[72:75], v[52:55], v[80:95]
    s_add_u32 s49, s54, 12288
    buffer_load_dwordx4 a[48:51], v0, s[4:7], s49 offen offset:0 sc1
    v_mfma_f32_32x32x16_bf16 v[112:127], v[68:71], v[196:199], v[112:127]
    ds_read_b64_tr_b16 v[68:69], v6 offset:55808
    ds_read_b64_tr_b16 v[70:71], v6 offset:56064
    buffer_load_dwordx4 a[52:55], v0, s[4:7], s49 offen offset:1024 sc1
    v_mfma_f32_32x32x16_bf16 v[112:127], v[96:99], v[200:203], v[112:127]
    ds_read_b64_tr_b16 v[96:97], v6 offset:57344
    ds_read_b64_tr_b16 v[98:99], v6 offset:57600
    s_nop 2
    ds_write_b32 v34, v80
    buffer_load_dwordx4 a[56:59], v0, s[4:7], s49 offen offset:2048 sc1
    v_mfma_f32_32x32x16_bf16 v[112:127], v[100:103], v[204:207], v[112:127]
    ds_read_b64_tr_b16 v[100:101], v6 offset:57856
    ds_read_b64_tr_b16 v[102:103], v6 offset:58112
    buffer_load_dwordx4 a[60:63], v0, s[4:7], s49 offen offset:3072 sc1
    s_waitcnt lgkmcnt(9)
    v_mfma_f32_32x32x16_bf16 v[112:127], v[104:107], v[208:211], v[112:127]
    ds_read_b64_tr_b16 v[104:105], v6 offset:59392
    ds_read_b64_tr_b16 v[106:107], v6 offset:59648
    s_waitcnt lgkmcnt(4)
    s_barrier
    ds_read_b32 v52, v33 offset:0
    ds_read_b32 v53, v33 offset:256
    ds_read_b32 v54, v33 offset:512
    ds_read_b32 v55, v33 offset:768
    s_add_u32 m0, s23, 65536
    s_add_u32 s49, s42, 0
    buffer_load_dwordx4 v0, s[4:7], s49 offen offset:0 sc1 lds
    v_mfma_f32_32x32x16_bf16 v[112:127], v[108:111], v[212:215], v[112:127]
    ds_read_b64_tr_b16 v[108:109], v6 offset:59904
    ds_read_b64_tr_b16 v[110:111], v6 offset:60160
    buffer_load_dwordx4 v0, s[4:7], s49 offen offset:1024 sc1 lds
    v_mfma_f32_32x32x16_bf16 v[112:127], v[64:67], v[216:219], v[112:127]
    ds_read_b64_tr_b16 v[64:65], v6 offset:61440
    ds_read_b64_tr_b16 v[66:67], v6 offset:61696
    v_mov_b32 v42, 0
    v_mov_b32 v43, 0
    buffer_load_dwordx4 v[160:163], v15, s[4:7], s28 offen sc1
    v_mfma_f32_32x32x16_bf16 v[112:127], v[68:71], v[220:223], v[112:127]
    ds_read_b64_tr_b16 v[68:69], v6 offset:61952
    ds_read_b64_tr_b16 v[70:71], v6 offset:62208
    v_mov_b32 v46, 0
    v_mov_b32 v47, 0
    v_cndmask_b32 v48, 0, -v22, s[58:59]
    s_add_u32 s51, s27, 0
    buffer_load_dwordx4 v[128:131], v0, s[4:7], s51 offen offset:0 sc1
    s_waitcnt lgkmcnt(12)
    v_mfma_f32_32x32x16_bf16 v[112:127], v[96:99], v[224:227], v[112:127]
    ds_read_b64_tr_b16 v[96:97], v6 offset:63488
    ds_read_b64_tr_b16 v[98:99], v6 offset:63744
    s_waitcnt lgkmcnt(8)
    v_add_f32 v52, v52, v53
    v_add_f32 v54, v54, v55
    v_add_f32 v52, v52, v54
    v_accvgpr_write_b32 a249, v52
    v_cvt_pk_bf16_f32 v44, v48, v48
    v_and_b32 v49, 0xffff0000, v44
    buffer_load_dwordx4 v[132:135], v0, s[4:7], s51 offen offset:1024 sc1
    v_mfma_f32_32x32x16_bf16 v[112:127], v[100:103], v[228:231], v[112:127]
    ds_read_b64_tr_b16 v[100:101], v6 offset:64000
    ds_read_b64_tr_b16 v[102:103], v6 offset:64256
    v_sub_f32 v48, v48, v49
    v_cvt_pk_bf16_f32 v45, v48, 0
    buffer_load_dwordx4 v[136:139], v0, s[4:7], s51 offen offset:2048 sc1
    s_waitcnt lgkmcnt(8)
    v_mfma_f32_32x32x16_bf16 v[112:127], v[104:107], v[232:235], v[112:127]
    buffer_load_dwordx4 v[140:143], v0, s[4:7], s51 offen offset:3072 sc1
    v_mfma_f32_32x32x16_bf16 v[112:127], v[108:111], v[236:239], v[112:127]
    v_accvgpr_read_b32 v50, a249
    v_cvt_pk_bf16_f32 v41, v50, 0
    v_lshlrev_b32 v51, 16, v41
    s_add_u32 s51, s27, 4096
    buffer_load_dwordx4 v[144:147], v0, s[4:7], s51 offen offset:0 sc1
    s_waitcnt lgkmcnt(4)
    v_mfma_f32_32x32x16_bf16 v[112:127], v[64:67], v[240:243], v[112:127]
    v_sub_f32 v51, v50, v51
    v_cvt_pk_bf16_f32 v40, v50, v51
    buffer_load_dwordx4 v[148:151], v0, s[4:7], s51 offen offset:1024 sc1
    v_mfma_f32_32x32x16_bf16 v[112:127], v[68:71], v[244:247], v[112:127]
    v_mfma_f32_32x32x16_bf16 v[112:127], v[40:43], v[44:47], v[112:127]
    buffer_load_dwordx4 v[152:155], v0, s[4:7], s51 offen offset:2048 sc1
    s_waitcnt lgkmcnt(0)
    v_mfma_f32_32x32x16_bf16 v[112:127], v[96:99], v[248:251], v[112:127]
    buffer_load_dwordx4 v[156:159], v0, s[4:7], s51 offen offset:3072 sc1
    v_mfma_f32_32x32x16_bf16 v[112:127], v[100:103], v[252:255], v[112:127]
    v_add_u32 v56, s23, v1
    v_add_u32 v57, s23, v0
    ds_read_b128 v[192:195], v56 offset:32768
    ds_read_b128 v[196:199], v56 offset:33792
    ds_read_b128 v[200:203], v56 offset:34816
    ds_read_b128 v[204:207], v56 offset:35840
    ds_read_b128 v[208:211], v56 offset:49152
    ds_read_b128 v[212:215], v56 offset:50176
    ds_read_b128 v[216:219], v56 offset:51200
    ds_read_b128 v[220:223], v56 offset:52224
    ds_read_b128 v[224:227], v57 offset:32768
    ds_read_b128 v[228:231], v57 offset:33792
    ds_read_b128 v[232:235], v57 offset:34816
    ds_read_b128 v[236:239], v57 offset:35840
    ds_read_b128 v[240:243], v57 offset:49152
    ds_read_b128 v[244:247], v57 offset:50176
    ds_read_b128 v[248:251], v57 offset:51200
    ds_read_b128 v[252:255], v57 offset:52224
    s_lshl_b32 s44, s16, 2
    s_add_u32 s44, s44, s3
    s_sub_u32 s44, s44, 4
    s_lshl_b32 s48, s44, 11
    s_add_u32 s48, s48, 262144
    s_lshl_b32 s44, s44, 6
    s_cmp_eq_u32 s16, 0
    s_cselect_b32 s44, 268435456, s44
    s_cselect_b32 s48, 268435456, s48
    s_mov_b64 s[12:13], s[86:87]
    s_mov_b32 s14, 2752
    v_and_b32 v182, 0xf8, v3
    v_lshrrev_b32 v182, 1, v182
    v_and_b32 v183, 0x400, v3
    v_or_b32 v182, v182, v183
    buffer_load_ushort v180, v32, s[12:15], s44 offen
    s_mov_b64 s[12:13], s[88:89]
    s_mov_b32 s14, 1024
    buffer_load_dword v172, v182, s[4:7], s48 offen offset:0 sc1
    buffer_load_dword v173, v182, s[4:7], s48 offen offset:128 sc1
    buffer_load_dword v174, v182, s[4:7], s48 offen offset:256 sc1
    buffer_load_dword v175, v182, s[4:7], s48 offen offset:384 sc1
    buffer_load_dword v176, v182, s[4:7], s48 offen offset:512 sc1
    buffer_load_dword v177, v182, s[4:7], s48 offen offset:640 sc1
    buffer_load_dword v178, v182, s[4:7], s48 offen offset:768 sc1
    buffer_load_dword v179, v182, s[4:7], s48 offen offset:896 sc1
    s_add_u32 s44, s97, 32768
    buffer_load_dwordx4 v[28:31], v35, s[8:11], s97 offen
    buffer_load_dwordx4 v[36:39], v35, s[8:11], s44 offen
    v_and_b32 v169, 0xf0, v0
    v_lshlrev_b32 v169, 2, v169
    s_lshl_b32 s44, s17, 10
    s_add_u32 s44, s44, 32768
    buffer_load_dword v168, v169, s[4:7], s44 offen sc1
    s_mov_b64 s[8:9], s[90:91]
    v_mul_f32 v60, 1069066811, v23
    s_lshl_b32 s44, s16, 5
    s_add_u32 s44, s44, 163584
    v_lshrrev_b32 v72, 8, v0
    v_lshl_add_u32 v72, v72, 3, s44
    buffer_load_dwordx4 v0, s[4:7], s49 offen offset:2048 sc1 lds
    v_cvt_pk_bf16_f32 v64, v112, v113
    v_cvt_pk_bf16_f32 v65, v114, v115
    v_cvt_pk_bf16_f32 v66, v116, v117
    v_cvt_pk_bf16_f32 v67, v118, v119
    v_cvt_pk_bf16_f32 v68, v120, v121
    v_cvt_pk_bf16_f32 v69, v122, v123
    v_mfma_f32_32x32x16_bf16 v[96:111], a[240:243], v[64:67], 0
    v_cvt_pk_bf16_f32 v70, v124, v125
    v_cvt_pk_bf16_f32 v71, v126, v127
    s_nop 1
    v_mfma_f32_32x32x16_bf16 v[96:111], a[244:247], v[68:71], v[96:111]
    s_waitcnt lgkmcnt(0)
    s_nop 10
    v_max3_f32 v56, v96, v97, v98
    v_min3_f32 v58, v96, v97, v98
    v_max3_f32 v56, v56, v99, v100
    v_min3_f32 v58, v58, v99, v100
    v_max3_f32 v56, v56, v101, v102
    buffer_load_dwordx4 v0, s[4:7], s49 offen offset:3072 sc1 lds
    v_min3_f32 v58, v58, v101, v102
    v_max3_f32 v56, v56, v103, v104
    v_min3_f32 v58, v58, v103, v104
    v_max3_f32 v56, v56, v105, v106
    v_min3_f32 v58, v58, v105, v106
    v_max3_f32 v56, v56, v107, v108
    v_min3_f32 v58, v58, v107, v108
    v_max3_f32 v56, v56, v109, v110
    v_min3_f32 v58, v58, v109, v110
    v_max_f32 v56, v56, v111
    v_min_f32 v58, v58, v111
    v_mul_f32 v56, v56, v60
    v_mul_f32 v58, v58, v60
    v_pk_fma_f32 v[112:113], v[96:97], v[60:61], v[56:57] op_sel_hi:[1,0,0] neg_lo:[0,0,1] neg_hi:[0,0,1]
    v_pk_fma_f32 v[114:115], v[98:99], v[60:61], v[56:57] op_sel_hi:[1,0,0] neg_lo:[0,0,1] neg_hi:[0,0,1]
    v_pk_fma_f32 v[116:117], v[100:101], v[60:61], v[56:57] op_sel_hi:[1,0,0] neg_lo:[0,0,1] neg_hi:[0,0,1]
    v_pk_fma_f32 v[118:119], v[102:103], v[60:61], v[56:57] op_sel_hi:[1,0,0] neg_lo:[0,0,1] neg_hi:[0,0,1]
    v_pk_fma_f32 v[120:121], v[104:105], v[60:61], v[56:57] op_sel_hi:[1,0,0] neg_lo:[0,0,1] neg_hi:[0,0,1]
    s_add_u32 m0, s23, 81920
    s_add_u32 s49, s42, 16384
    buffer_load_dwordx4 v0, s[4:7], s49 offen offset:0 sc1 lds
    v_pk_fma_f32 v[122:123], v[106:107], v[60:61], v[56:57] op_sel_hi:[1,0,0] neg_lo:[0,0,1] neg_hi:[0,0,1]
    v_pk_fma_f32 v[124:125], v[108:109], v[60:61], v[56:57] op_sel_hi:[1,0,0] neg_lo:[0,0,1] neg_hi:[0,0,1]
    v_pk_fma_f32 v[126:127], v[110:111], v[60:61], v[56:57] op_sel_hi:[1,0,0] neg_lo:[0,0,1] neg_hi:[0,0,1]
    v_pk_fma_f32 v[96:97], v[96:97], v[60:61], v[58:59] op_sel_hi:[1,0,0] neg_lo:[1,0,0] neg_hi:[1,0,0]
    v_pk_fma_f32 v[98:99], v[98:99], v[60:61], v[58:59] op_sel_hi:[1,0,0] neg_lo:[1,0,0] neg_hi:[1,0,0]
    v_pk_fma_f32 v[100:101], v[100:101], v[60:61], v[58:59] op_sel_hi:[1,0,0] neg_lo:[1,0,0] neg_hi:[1,0,0]
    v_pk_fma_f32 v[102:103], v[102:103], v[60:61], v[58:59] op_sel_hi:[1,0,0] neg_lo:[1,0,0] neg_hi:[1,0,0]
    v_pk_fma_f32 v[104:105], v[104:105], v[60:61], v[58:59] op_sel_hi:[1,0,0] neg_lo:[1,0,0] neg_hi:[1,0,0]
    v_pk_fma_f32 v[106:107], v[106:107], v[60:61], v[58:59] op_sel_hi:[1,0,0] neg_lo:[1,0,0] neg_hi:[1,0,0]
    v_pk_fma_f32 v[108:109], v[108:109], v[60:61], v[58:59] op_sel_hi:[1,0,0] neg_lo:[1,0,0] neg_hi:[1,0,0]
    v_pk_fma_f32 v[110:111], v[110:111], v[60:61], v[58:59] op_sel_hi:[1,0,0] neg_lo:[1,0,0] neg_hi:[1,0,0]
    v_exp_f32 v112, v112
    v_exp_f32 v113, v113
    v_exp_f32 v114, v114
    v_exp_f32 v115, v115
    buffer_load_dwordx4 v0, s[4:7], s49 offen offset:1024 sc1 lds
    v_exp_f32 v116, v116
    v_exp_f32 v117, v117
    v_exp_f32 v118, v118
    v_exp_f32 v119, v119
    v_exp_f32 v120, v120
    v_exp_f32 v121, v121
    v_exp_f32 v122, v122
    v_exp_f32 v123, v123
    v_exp_f32 v124, v124
    buffer_load_dwordx4 v0, s[4:7], s49 offen offset:2048 sc1 lds
    v_exp_f32 v125, v125
    v_exp_f32 v126, v126
    v_exp_f32 v127, v127
    v_exp_f32 v96, v96
    v_exp_f32 v97, v97
    v_pk_add_f32 v[56:57], v[112:113], v[114:115]
    v_pk_add_f32 v[56:57], v[56:57], v[116:117]
    v_pk_add_f32 v[56:57], v[56:57], v[118:119]
    v_pk_add_f32 v[56:57], v[56:57], v[120:121]
    v_pk_add_f32 v[56:57], v[56:57], v[122:123]
    v_pk_add_f32 v[56:57], v[56:57], v[124:125]
    v_pk_add_f32 v[56:57], v[56:57], v[126:127]
    v_add_f32 v22, v56, v57
    buffer_load_dwordx4 v0, s[4:7], s49 offen offset:3072 sc1 lds
    v_exp_f32 v98, v98
    v_exp_f32 v99, v99
    v_cvt_pk_bf16_f32 v40, v112, v113
    v_cvt_pk_bf16_f32 v41, v114, v115
    v_cvt_pk_bf16_f32 v42, v116, v117
    v_cvt_pk_bf16_f32 v43, v118, v119
    v_cvt_pk_bf16_f32 v44, v120, v121
    v_cvt_pk_bf16_f32 v45, v122, v123
    v_cvt_pk_bf16_f32 v46, v124, v125
    v_cvt_pk_bf16_f32 v47, v126, v127
    v_exp_f32 v100, v100
    v_exp_f32 v101, v101
    v_exp_f32 v102, v102
    s_add_u32 m0, s23, 98304
    s_add_u32 s49, s42, 131072
    buffer_load_dwordx4 v0, s[4:7], s49 offen offset:0 sc1 lds
    v_exp_f32 v103, v103
    v_exp_f32 v104, v104
    v_exp_f32 v105, v105
    v_exp_f32 v106, v106
    v_exp_f32 v107, v107
    v_exp_f32 v108, v108
    v_exp_f32 v109, v109
    v_exp_f32 v110, v110
    v_exp_f32 v111, v111
    buffer_load_dwordx4 v0, s[4:7], s49 offen offset:1024 sc1 lds
    v_pk_add_f32 v[58:59], v[96:97], v[98:99]
    v_pk_add_f32 v[58:59], v[58:59], v[100:101]
    v_pk_add_f32 v[58:59], v[58:59], v[102:103]
    v_pk_add_f32 v[58:59], v[58:59], v[104:105]
    v_pk_add_f32 v[58:59], v[58:59], v[106:107]
    v_pk_add_f32 v[58:59], v[58:59], v[108:109]
    v_pk_add_f32 v[58:59], v[58:59], v[110:111]
    v_add_f32 v58, v58, v59
    v_rcp_f32 v58, v58
    s_nop 0
    v_mul_f32 v58, v58, v22
    v_pk_mul_f32 v[96:97], v[96:97], v[58:59] op_sel_hi:[1,0]
    v_pk_mul_f32 v[98:99], v[98:99], v[58:59] op_sel_hi:[1,0]
    v_pk_mul_f32 v[100:101], v[100:101], v[58:59] op_sel_hi:[1,0]
    v_pk_mul_f32 v[102:103], v[102:103], v[58:59] op_sel_hi:[1,0]
    v_cvt_pk_bf16_f32 v48, v96, v97
    v_cvt_pk_bf16_f32 v49, v98, v99
    v_cvt_pk_bf16_f32 v50, v100, v101
    buffer_load_dwordx4 v0, s[4:7], s49 offen offset:2048 sc1 lds
    v_cvt_pk_bf16_f32 v51, v102, v103
    v_pk_mul_f32 v[104:105], v[104:105], v[58:59] op_sel_hi:[1,0]
    v_pk_mul_f32 v[106:107], v[106:107], v[58:59] op_sel_hi:[1,0]
    v_pk_mul_f32 v[108:109], v[108:109], v[58:59] op_sel_hi:[1,0]
    v_pk_mul_f32 v[110:111], v[110:111], v[58:59] op_sel_hi:[1,0]
    v_cvt_pk_bf16_f32 v52, v104, v105
    v_cvt_pk_bf16_f32 v53, v106, v107
    v_cvt_pk_bf16_f32 v54, v108, v109
    v_cvt_pk_bf16_f32 v55, v110, v111
    s_mov_b32 s50, 0
Lkvretry_6:
    s_waitcnt vmcnt(27)
    v_mfma_f32_16x16x32_bf16 v[64:67], v[76:79], v[128:131], 0
    v_add_f32_dpp v80, v160, v160 row_ror:8 row_mask:0xf bank_mask:0xf
    v_add_f32_dpp v81, v161, v161 row_ror:8 row_mask:0xf bank_mask:0xf
    v_mfma_f32_16x16x32_bf16 v[64:67], v[76:79], v[132:135], v[64:67]
    v_add_f32_dpp v82, v162, v162 row_ror:8 row_mask:0xf bank_mask:0xf
    v_add_f32_dpp v83, v163, v163 row_ror:8 row_mask:0xf bank_mask:0xf
    s_waitcnt vmcnt(25)
    v_mfma_f32_16x16x32_bf16 v[64:67], v[76:79], v[136:139], v[64:67]
    v_add_f32_dpp v80, v80, v80 row_ror:4 row_mask:0xf bank_mask:0xf
    v_add_f32_dpp v81, v81, v81 row_ror:4 row_mask:0xf bank_mask:0xf
    v_mfma_f32_16x16x32_bf16 v[64:67], v[76:79], v[140:143], v[64:67]
    v_add_f32_dpp v82, v82, v82 row_ror:4 row_mask:0xf bank_mask:0xf
    v_add_f32_dpp v83, v83, v83 row_ror:4 row_mask:0xf bank_mask:0xf
    s_waitcnt vmcnt(23)
    v_mfma_f32_16x16x32_bf16 v[64:67], v[76:79], v[144:147], v[64:67]
    v_add_f32_dpp v80, v80, v80 row_ror:2 row_mask:0xf bank_mask:0xf
    v_add_f32_dpp v81, v81, v81 row_ror:2 row_mask:0xf bank_mask:0xf
    v_mfma_f32_16x16x32_bf16 v[64:67], v[76:79], v[148:151], v[64:67]
    v_add_f32_dpp v82, v82, v82 row_ror:2 row_mask:0xf bank_mask:0xf
    v_add_f32_dpp v83, v83, v83 row_ror:2 row_mask:0xf bank_mask:0xf
    s_waitcnt vmcnt(21)
    v_mfma_f32_16x16x32_bf16 v[64:67], v[76:79], v[152:155], v[64:67]
    v_add_f32_dpp v80, v80, v80 row_ror:1 row_mask:0xf bank_mask:0xf
    v_add_f32_dpp v81, v81, v81 row_ror:1 row_mask:0xf bank_mask:0xf
    v_mfma_f32_16x16x32_bf16 v[64:67], v[76:79], v[156:159], v[64:67]
    v_add_f32_dpp v82, v82, v82 row_ror:1 row_mask:0xf bank_mask:0xf
    v_add_f32_dpp v83, v83, v83 row_ror:1 row_mask:0xf bank_mask:0xf
    v_cvt_pk_bf16_f32 v90, v80, v81
    v_cvt_pk_bf16_f32 v91, v82, v83
    v_add_f32 v84, v80, v81
    v_add_f32 v85, v82, v83
    v_add_f32 v84, v84, v85
    s_nop 0
    v_cmp_u_f32 vcc, v84, v64
    s_cbranch_vccnz Lkvslow_8
Lkvgo_7:
    v_cvt_pk_bf16_f32 v88, v64, v65
    v_cvt_pk_bf16_f32 v89, v66, v67
    ds_write_b64 v13, v[88:89]
    ds_write_b64 v72, v[90:91]
    s_waitcnt vmcnt(12)
    v_add_f32 v172, v172, v176
    v_add_f32 v173, v173, v177
    v_add_f32 v174, v174, v178
    v_add_f32 v175, v175, v179
    v_add_f32 v172, v172, v173
    v_add_f32 v174, v174, v175
    v_add_f32 v172, v172, v174
    v_lshlrev_b32 v180, 16, v180
    v_mov_b32 v173, v172
    s_nop 1
    v_permlane32_swap_b32 v172, v173
    v_add_f32 v172, v172, v173
    v_cndmask_b32 v172, v180, v172, s[58:59]
    ds_write_b32 v34, v172 offset:2048
    s_waitcnt vmcnt(9)
    v_cmp_ne_u32 vcc, s93, v168
    s_cmp_eq_u64 vcc, 0
    s_cselect_b32 s22, 1, 0
    s_cbranch_scc0 Lfork_s
Lfork:
    buffer_load_dwordx4 v0, s[4:7], s49 offen offset:3072 sc1 lds
    s_add_u32 m0, s23, 114688
    s_add_u32 s49, s42, 147456
    buffer_load_dwordx4 v0, s[4:7], s49 offen offset:0 sc1 lds
    buffer_load_dwordx4 v0, s[4:7], s49 offen offset:1024 sc1 lds
    buffer_load_dwordx4 v0, s[4:7], s49 offen offset:2048 sc1 lds
    s_waitcnt lgkmcnt(0)
    s_barrier
    ds_read_b32 a250, v2 offset:256
    ds_read_b32 a251, v2 offset:512
    ds_read_b32 a252, v2 offset:768
    ds_read_b128 v[128:131], v4 offset:3840
    ds_read_b128 v[132:135], v4 offset:3856
    ds_read_b128 v[136:139], v4 offset:3872
    ds_read_b128 v[140:143], v4 offset:3888
    ds_read_b128 v[64:67], v14 offset:0
    ds_read_b128 v[68:71], v14 offset:16
    ds_read_b128 v[72:75], v14 offset:32
    ds_read_b128 v[76:79], v14 offset:48
    v_mul_f32 v56, 897988541, v22
    v_mov_b32 v57, 0
    s_waitcnt lgkmcnt(6)
    v_dot2_f32_bf16 v56, v40, v128, v56
    v_dot2_f32_bf16 v57, v41, v129, v57
    v_dot2_f32_bf16 v56, v42, v130, v56
    v_dot2_f32_bf16 v57, v43, v131, v57
    v_dot2_f32_bf16 v56, v44, v132, v56
    v_dot2_f32_bf16 v57, v45, v133, v57
    v_dot2_f32_bf16 v56, v46, v134, v56
    v_dot2_f32_bf16 v57, v47, v135, v57
    s_waitcnt lgkmcnt(4)
    v_dot2_f32_bf16 v56, v48, v136, v56
    v_dot2_f32_bf16 v57, v49, v137, v57
    v_dot2_f32_bf16 v56, v50, v138, v56
    v_dot2_f32_bf16 v57, v51, v139, v57
    v_dot2_f32_bf16 v56, v52, v140, v56
    v_dot2_f32_bf16 v57, v53, v141, v57
    v_dot2_f32_bf16 v56, v54, v142, v56
    v_dot2_f32_bf16 v57, v55, v143, v57
    s_waitcnt lgkmcnt(0)
    v_mfma_f32_32x32x16_bf16 v[80:95], v[64:67], v[40:43], 0
    v_mfma_f32_32x32x16_bf16 v[80:95], v[68:71], v[44:47], v[80:95]
    v_mfma_f32_32x32x16_bf16 v[80:95], v[72:75], v[48:51], v[80:95]
    v_mfma_f32_32x32x16_bf16 v[80:95], v[76:79], v[52:55], v[80:95]
    v_add_f32 v56, v56, v57
    v_rcp_f32 v56, v56
    s_nop 9
    v_pk_mul_f32 v[80:81], v[80:81], v[56:57] op_sel_hi:[1,0]
    v_pk_mul_f32 v[82:83], v[82:83], v[56:57] op_sel_hi:[1,0]
    v_pk_mul_f32 v[84:85], v[84:85], v[56:57] op_sel_hi:[1,0]
    v_pk_mul_f32 v[86:87], v[86:87], v[56:57] op_sel_hi:[1,0]
    v_cvt_pk_bf16_f32 v64, v80, v81
    v_cvt_pk_bf16_f32 v65, v82, v83
    v_cvt_pk_bf16_f32 v66, v84, v85
    v_cvt_pk_bf16_f32 v67, v86, v87
    buffer_store_dwordx4 v[64:67], v5, s[4:7], s29 offen offset:0
    v_pk_mul_f32 v[88:89], v[88:89], v[56:57] op_sel_hi:[1,0]
    v_pk_mul_f32 v[90:91], v[90:91], v[56:57] op_sel_hi:[1,0]
    v_pk_mul_f32 v[92:93], v[92:93], v[56:57] op_sel_hi:[1,0]
    v_pk_mul_f32 v[94:95], v[94:95], v[56:57] op_sel_hi:[1,0]
    v_cvt_pk_bf16_f32 v68, v88, v89
    v_cvt_pk_bf16_f32 v69, v90, v91
    v_cvt_pk_bf16_f32 v70, v92, v93
    v_cvt_pk_bf16_f32 v71, v94, v95
    buffer_store_dwordx4 v[68:71], v5, s[4:7], s29 offen offset:256
    v_bfe_u32 v59, v0, 7, 3
    v_lshlrev_b32 v59, 4, v59
    s_lshl_b32 s47, s19, 7
    buffer_load_dwordx4 v0, s[4:7], s49 offen offset:3072 sc1 lds
    s_add_u32 m0, s23, 32768
    s_add_u32 s49, s43, 0
    buffer_load_dwordx4 v0, s[4:7], s49 offen offset:0 sc1 lds
    buffer_load_dwordx4 v0, s[4:7], s49 offen offset:1024 sc1 lds
    buffer_load_dwordx4 v0, s[4:7], s49 offen offset:2048 sc1 lds
    v_lshlrev_b32 v24, 16, v28
    v_and_b32 v25, 0xffff0000, v28
    v_lshlrev_b32 v26, 16, v29
    v_and_b32 v27, 0xffff0000, v29
    v_lshlrev_b32 v28, 16, v30
    v_and_b32 v29, 0xffff0000, v30
    v_lshlrev_b32 v30, 16, v31
    v_and_b32 v31, 0xffff0000, v31
    v_lshlrev_b32 v32, 16, v36
    v_and_b32 v33, 0xffff0000, v36
    v_lshlrev_b32 v34, 16, v37
    v_and_b32 v35, 0xffff0000, v37
    v_lshlrev_b32 v36, 16, v38
    v_and_b32 v37, 0xffff0000, v38
    v_lshlrev_b32 v38, 16, v39
    v_and_b32 v39, 0xffff0000, v39
    s_add_u32 s45, s98, 1
    s_mov_b64 exec, 1
    v_mov_b32 v56, s45
    s_waitcnt vmcnt(4)
    buffer_store_dword v56, off, s[4:7], s30 offset:0
    s_mov_b64 exec, -1
    s_add_u32 s45, s98, 1
    s_mov_b32 exec_hi, 0
    s_mov_b32 s50, 0
Lpoll_11:
    buffer_load_dword v56, v21, s[4:7], s32 offen sc1
    s_add_u32 s50, s50, 1
    s_cmp_gt_u32 s50, 0x40000
    s_cbranch_scc1 Labort
    s_waitcnt vmcnt(0)
    v_cmp_ne_u32 vcc, s45, v56
    s_cbranch_vccnz Lpoll_11
    s_mov_b64 exec, -1
    s_add_u32 s51, s31, 0
    buffer_load_dwordx4 v[128:131], v0, s[4:7], s51 offen offset:0 sc1
    buffer_load_dwordx4 v[132:135], v0, s[4:7], s51 offen offset:2048 sc1
    s_add_u32 s51, s31, 4096
    buffer_load_dwordx4 v[136:139], v0, s[4:7], s51 offen offset:0 sc1
    buffer_load_dwordx4 v[140:143], v0, s[4:7], s51 offen offset:2048 sc1
    s_add_u32 s51, s31, 1024
    buffer_load_dwordx4 v[144:147], v0, s[4:7], s51 offen offset:0 sc1
    buffer_load_dwordx4 v[148:151], v0, s[4:7], s51 offen offset:2048 sc1
    s_add_u32 s51, s31, 5120
    buffer_load_dwordx4 v[152:155], v0, s[4:7], s51 offen offset:0 sc1
    buffer_load_dwordx4 v[156:159], v0, s[4:7], s51 offen offset:2048 sc1
    s_add_u32 s51, s31, 32768
    buffer_load_dwordx4 v[160:163], v0, s[4:7], s51 offen offset:0 sc1
    s_barrier
    s_waitcnt vmcnt(8)
    v_mfma_f32_16x16x32_bf16 v[64:67], a[0:3], v[128:131], 0
    buffer_load_dwordx4 v[164:167], v0, s[4:7], s51 offen offset:2048 sc1
    v_mfma_f32_16x16x32_bf16 v[68:71], a[4:7], v[128:131], 0
    v_mfma_f32_16x16x32_bf16 v[72:75], a[8:11], v[128:131], 0
    v_mfma_f32_16x16x32_bf16 v[76:79], a[12:15], v[128:131], 0
    s_waitcnt vmcnt(8)
    v_mfma_f32_16x16x32_bf16 v[64:67], a[16:19], v[132:135], v[64:67]
    s_add_u32 s51, s31, 36864
    buffer_load_dwordx4 v[168:171], v0, s[4:7], s51 offen offset:0 sc1
    v_mfma_f32_16x16x32_bf16 v[68:71], a[20:23], v[132:135], v[68:71]
    v_mfma_f32_16x16x32_bf16 v[72:75], a[24:27], v[132:135], v[72:75]
    v_mfma_f32_16x16x32_bf16 v[76:79], a[28:31], v[132:135], v[76:79]
    s_waitcnt vmcnt(8)
    v_mfma_f32_16x16x32_bf16 v[64:67], a[32:35], v[136:139], v[64:67]
    buffer_load_dwordx4 v[172:175], v0, s[4:7], s51 offen offset:2048 sc1
    v_mfma_f32_16x16x32_bf16 v[68:71], a[36:39], v[136:139], v[68:71]
    v_mfma_f32_16x16x32_bf16 v[72:75], a[40:43], v[136:139], v[72:75]
    v_mfma_f32_16x16x32_bf16 v[76:79], a[44:47], v[136:139], v[76:79]
    s_waitcnt vmcnt(8)
    v_mfma_f32_16x16x32_bf16 v[64:67], a[48:51], v[140:143], v[64:67]
    s_add_u32 s51, s31, 33792
    buffer_load_dwordx4 v[176:179], v0, s[4:7], s51 offen offset:0 sc1
    v_mfma_f32_16x16x32_bf16 v[68:71], a[52:55], v[140:143], v[68:71]
    v_mfma_f32_16x16x32_bf16 v[72:75], a[56:59], v[140:143], v[72:75]
    v_mfma_f32_16x16x32_bf16 v[76:79], a[60:63], v[140:143], v[76:79]
    s_waitcnt vmcnt(8)
    v_mfma_f32_16x16x32_bf16 v[80:83], a[0:3], v[144:147], 0
    buffer_load_dwordx4 v[180:183], v0, s[4:7], s51 offen offset:2048 sc1
    v_mfma_f32_16x16x32_bf16 v[84:87], a[4:7], v[144:147], 0
    v_mfma_f32_16x16x32_bf16 v[88:91], a[8:11], v[144:147], 0
    v_mfma_f32_16x16x32_bf16 v[92:95], a[12:15], v[144:147], 0
    ds_write_b128 v17, v[64:67] offset:0
    s_waitcnt vmcnt(8)
    v_mfma_f32_16x16x32_bf16 v[80:83], a[16:19], v[148:151], v[80:83]
    s_add_u32 s51, s31, 37888
    buffer_load_dwordx4 v[184:187], v0, s[4:7], s51 offen offset:0 sc1
    v_mfma_f32_16x16x32_bf16 v[84:87], a[20:23], v[148:151], v[84:87]
    v_mfma_f32_16x16x32_bf16 v[88:91], a[24:27], v[148:151], v[88:91]
    v_mfma_f32_16x16x32_bf16 v[92:95], a[28:31], v[148:151], v[92:95]
    ds_write_b128 v17, v[68:71] offset:1024
    s_waitcnt vmcnt(8)
    v_mfma_f32_16x16x32_bf16 v[80:83], a[32:35], v[152:155], v[80:83]
    buffer_load_dwordx4 v[188:191], v0, s[4:7], s51 offen offset:2048 sc1
    v_mfma_f32_16x16x32_bf16 v[84:87], a[36:39], v[152:155], v[84:87]
    v_mfma_f32_16x16x32_bf16 v[88:91], a[40:43], v[152:155], v[88:91]
    v_mfma_f32_16x16x32_bf16 v[92:95], a[44:47], v[152:155], v[92:95]
    ds_write_b128 v17, v[72:75] offset:2048
    s_waitcnt vmcnt(8)
    v_mfma_f32_16x16x32_bf16 v[80:83], a[48:51], v[156:159], v[80:83]
    buffer_load_dwordx4 v0, s[4:7], s49 offen offset:3072 sc1 lds
    s_add_u32 m0, s23, 49152
    s_add_u32 s49, s43, 16384
    buffer_load_dwordx4 v0, s[4:7], s49 offen offset:0 sc1 lds
    v_mfma_f32_16x16x32_bf16 v[84:87], a[52:55], v[156:159], v[84:87]
    v_mfma_f32_16x16x32_bf16 v[88:91], a[56:59], v[156:159], v[88:91]
    v_mfma_f32_16x16x32_bf16 v[92:95], a[60:63], v[156:159], v[92:95]
    ds_write_b128 v17, v[76:79] offset:3072
    s_waitcnt vmcnt(9)
    v_mfma_f32_16x16x32_bf16 v[96:99], a[0:3], v[160:163], 0
    buffer_load_dwordx4 v0, s[4:7], s49 offen offset:1024 sc1 lds
    buffer_load_dwordx4 v0, s[4:7], s49 offen offset:2048 sc1 lds
    v_mfma_f32_16x16x32_bf16 v[100:103], a[4:7], v[160:163], 0
    v_mfma_f32_16x16x32_bf16 v[104:107], a[8:11], v[160:163], 0
    v_mfma_f32_16x16x32_bf16 v[108:111], a[12:15], v[160:163], 0
    ds_write_b128 v17, v[80:83] offset:4096
    s_waitcnt vmcnt(10)
    v_mfma_f32_16x16x32_bf16 v[96:99], a[16:19], v[164:167], v[96:99]
    buffer_load_dwordx4 v0, s[4:7], s49 offen offset:3072 sc1 lds
    s_add_u32 s49, s55, 0
    buffer_load_dwordx4 a[64:67], v0, s[4:7], s49 offen offset:0 sc1
    v_mfma_f32_16x16x32_bf16 v[100:103], a[20:23], v[164:167], v[100:103]
    v_mfma_f32_16x16x32_bf16 v[104:107], a[24:27], v[164:167], v[104:107]
    v_mfma_f32_16x16x32_bf16 v[108:111], a[28:31], v[164:167], v[108:111]
    ds_write_b128 v17, v[84:87] offset:5120
    buffer_load_dwordx4 v[60:63], v59, s[12:15], s47 offen
    s_waitcnt vmcnt(12)
    v_mfma_f32_16x16x32_bf16 v[96:99], a[32:35], v[168:171], v[96:99]
    v_mfma_f32_16x16x32_bf16 v[100:103], a[36:39], v[168:171], v[100:103]
    v_mfma_f32_16x16x32_bf16 v[104:107], a[40:43], v[168:171], v[104:107]
    v_mfma_f32_16x16x32_bf16 v[108:111], a[44:47], v[168:171], v[108:111]
    ds_write_b128 v17, v[88:91] offset:6144
    s_waitcnt vmcnt(11)
    v_mfma_f32_16x16x32_bf16 v[96:99], a[48:51], v[172:175], v[96:99]
    buffer_load_dwordx4 a[68:71], v0, s[4:7], s49 offen offset:1024 sc1
    v_mfma_f32_16x16x32_bf16 v[100:103], a[52:55], v[172:175], v[100:103]
    v_mfma_f32_16x16x32_bf16 v[104:107], a[56:59], v[172:175], v[104:107]
    v_mfma_f32_16x16x32_bf16 v[108:111], a[60:63], v[172:175], v[108:111]
    ds_write_b128 v17, v[92:95] offset:7168
    s_waitcnt vmcnt(11)
    v_mfma_f32_16x16x32_bf16 v[112:115], a[0:3], v[176:179], 0
    buffer_load_dwordx4 a[72:75], v0, s[4:7], s49 offen offset:2048 sc1
    v_mfma_f32_16x16x32_bf16 v[116:119], a[4:7], v[176:179], 0
    v_mfma_f32_16x16x32_bf16 v[120:123], a[8:11], v[176:179], 0
    v_mfma_f32_16x16x32_bf16 v[124:127], a[12:15], v[176:179], 0
    s_waitcnt vmcnt(11)
    v_mfma_f32_16x16x32_bf16 v[112:115], a[16:19], v[180:183], v[112:115]
    buffer_load_dwordx4 a[76:79], v0, s[4:7], s49 offen offset:3072 sc1
    v_mfma_f32_16x16x32_bf16 v[116:119], a[20:23], v[180:183], v[116:119]
    v_mfma_f32_16x16x32_bf16 v[120:123], a[24:27], v[180:183], v[120:123]
    v_mfma_f32_16x16x32_bf16 v[124:127], a[28:31], v[180:183], v[124:127]
    s_waitcnt lgkmcnt(0)
    s_barrier
    ds_read_b128 v[64:67], v18 offset:0
    ds_read_b128 v[68:71], v18 offset:256
    ds_read_b128 v[72:75], v18 offset:8192
    ds_read_b128 v[76:79], v18 offset:8448
    ds_read_b128 v[80:83], v18 offset:16384
    ds_read_b128 v[84:87], v18 offset:16640
    ds_read_b128 v[88:91], v18 offset:24576
    ds_read_b128 v[92:95], v18 offset:24832
    s_waitcnt vmcnt(11)
    v_mfma_f32_16x16x32_bf16 v[112:115], a[32:35], v[184:187], v[112:115]
    s_add_u32 s49, s55, 4096
    buffer_load_dwordx4 a[80:83], v0, s[4:7], s49 offen offset:0 sc1
    v_mfma_f32_16x16x32_bf16 v[116:119], a[36:39], v[184:187], v[116:119]
    v_mfma_f32_16x16x32_bf16 v[120:123], a[40:43], v[184:187], v[120:123]
    v_mfma_f32_16x16x32_bf16 v[124:127], a[44:47], v[184:187], v[124:127]
    s_waitcnt vmcnt(11)
    v_mfma_f32_16x16x32_bf16 v[112:115], a[48:51], v[188:191], v[112:115]
    buffer_load_dwordx4 a[84:87], v0, s[4:7], s49 offen offset:1024 sc1
    v_mfma_f32_16x16x32_bf16 v[116:119], a[52:55], v[188:191], v[116:119]
    v_mfma_f32_16x16x32_bf16 v[120:123], a[56:59], v[188:191], v[120:123]
    v_mfma_f32_16x16x32_bf16 v[124:127], a[60:63], v[188:191], v[124:127]
    s_waitcnt lgkmcnt(0)
    s_barrier
    ds_write_b128 v17, v[96:99] offset:0
    v_pk_add_f32 v[24:25], v[24:25], v[64:65]
    v_pk_add_f32 v[26:27], v[26:27], v[66:67]
    v_pk_add_f32 v[28:29], v[28:29], v[68:69]
    v_pk_add_f32 v[30:31], v[30:31], v[70:71]
    v_pk_add_f32 v[24:25], v[24:25], v[72:73]
    v_pk_add_f32 v[26:27], v[26:27], v[74:75]
    v_pk_add_f32 v[28:29], v[28:29], v[76:77]
    v_pk_add_f32 v[30:31], v[30:31], v[78:79]
    buffer_load_dwordx4 a[88:91], v0, s[4:7], s49 offen offset:2048 sc1
    ds_write_b128 v17, v[100:103] offset:1024
    v_pk_add_f32 v[24:25], v[24:25], v[80:81]
    v_pk_add_f32 v[26:27], v[26:27], v[82:83]
    v_pk_add_f32 v[28:29], v[28:29], v[84:85]
    v_pk_add_f32 v[30:31], v[30:31], v[86:87]
    v_pk_add_f32 v[24:25], v[24:25], v[88:89]
    v_pk_add_f32 v[26:27], v[26:27], v[90:91]
    v_pk_add_f32 v[28:29], v[28:29], v[92:93]
    v_pk_add_f32 v[30:31], v[30:31], v[94:95]
    buffer_load_dwordx4 a[92:95], v0, s[4:7], s49 offen offset:3072 sc1
    ds_write_b128 v17, v[104:107] offset:2048
    v_cvt_pk_bf16_f32 v40, v24, v25
    v_cvt_pk_bf16_f32 v41, v26, v27
    v_cvt_pk_bf16_f32 v42, v28, v29
    v_cvt_pk_bf16_f32 v43, v30, v31
    buffer_store_dwordx4 v[40:43], v19, s[8:11], s33 offen
    v_pk_add_f32 v[64:65], v[24:25], v[26:27]
    s_add_u32 s49, s55, 8192
    buffer_load_dwordx4 a[96:99], v0, s[4:7], s49 offen offset:0 sc1
    ds_write_b128 v17, v[108:111] offset:3072
    v_pk_mul_f32 v[66:67], v[24:25], v[24:25]
    v_pk_add_f32 v[64:65], v[64:65], v[28:29]
    v_pk_fma_f32 v[66:67], v[26:27], v[26:27], v[66:67]
    v_pk_add_f32 v[64:65], v[64:65], v[30:31]
    v_pk_fma_f32 v[66:67], v[28:29], v[28:29], v[66:67]
    v_add_f32 v64, v64, v65
    v_pk_fma_f32 v[66:67], v[30:31], v[30:31], v[66:67]
    v_add_f32 v65, v66, v67
    buffer_load_dwordx4 a[100:103], v0, s[4:7], s49 offen offset:1024 sc1
    ds_write_b128 v17, v[112:115] offset:4096
    v_permlane16_swap_b32 v64, v65
    v_add_f32 v64, v64, v65
    s_nop 1
    v_add_f32_dpp v65, v64, v64 row_ror:8 row_mask:0xf bank_mask:0xf
    v_add_f32_dpp v64, v64, v64 row_ror:8 row_mask:0xf bank_mask:0xf
    s_nop 1
    v_permlane32_swap_b32 v64, v65
    v_add_f32 v64, v64, v65
    s_mov_b64 exec, 0x00ff00ff
    buffer_store_dword v64, v20, s[4:7], s34 offen offset:0
    s_mov_b64 exec, -1
    buffer_load_dwordx4 a[104:107], v0, s[4:7], s49 offen offset:2048 sc1
    ds_write_b128 v17, v[116:119] offset:5120
    buffer_load_dwordx4 a[108:111], v0, s[4:7], s49 offen offset:3072 sc1
    ds_write_b128 v17, v[120:123] offset:6144
    s_add_u32 s49, s55, 12288
    buffer_load_dwordx4 a[112:115], v0, s[4:7], s49 offen offset:0 sc1
    ds_write_b128 v17, v[124:127] offset:7168
    buffer_load_dwordx4 a[116:119], v0, s[4:7], s49 offen offset:1024 sc1
    s_waitcnt lgkmcnt(0)
    s_barrier
    ds_read_b128 v[128:131], v18 offset:0
    ds_read_b128 v[132:135], v18 offset:256
    ds_read_b128 v[136:139], v18 offset:8192
    ds_read_b128 v[140:143], v18 offset:8448
    ds_read_b128 v[144:147], v18 offset:16384
    ds_read_b128 v[148:151], v18 offset:16640
    ds_read_b128 v[152:155], v18 offset:24576
    ds_read_b128 v[156:159], v18 offset:24832
    s_add_u32 s45, s98, 1
    s_mov_b64 exec, 1
    v_mov_b32 v56, s45
    s_waitcnt vmcnt(4)
    buffer_store_dword v56, off, s[4:7], s35 offset:0
    s_mov_b64 exec, -1
    s_waitcnt lgkmcnt(6)
    v_pk_add_f32 v[32:33], v[32:33], v[128:129]
    v_pk_add_f32 v[34:35], v[34:35], v[130:131]
    v_pk_add_f32 v[36:37], v[36:37], v[132:133]
    v_pk_add_f32 v[38:39], v[38:39], v[134:135]
    s_waitcnt lgkmcnt(4)
    v_pk_add_f32 v[32:33], v[32:33], v[136:137]
    v_pk_add_f32 v[34:35], v[34:35], v[138:139]
    v_pk_add_f32 v[36:37], v[36:37], v[140:141]
    v_pk_add_f32 v[38:39], v[38:39], v[142:143]
    s_waitcnt lgkmcnt(2)
    v_pk_add_f32 v[32:33], v[32:33], v[144:145]
    v_pk_add_f32 v[34:35], v[34:35], v[146:147]
    v_pk_add_f32 v[36:37], v[36:37], v[148:149]
    v_pk_add_f32 v[38:39], v[38:39], v[150:151]
    s_waitcnt lgkmcnt(0)
    v_pk_add_f32 v[32:33], v[32:33], v[152:153]
    v_pk_add_f32 v[34:35], v[34:35], v[154:155]
    v_pk_add_f32 v[36:37], v[36:37], v[156:157]
    v_pk_add_f32 v[38:39], v[38:39], v[158:159]
    v_cvt_pk_bf16_f32 v44, v32, v33
    v_cvt_pk_bf16_f32 v45, v34, v35
    v_cvt_pk_bf16_f32 v46, v36, v37
    v_cvt_pk_bf16_f32 v47, v38, v39
    buffer_store_dwordx4 v[44:47], v19, s[8:11], s96 offen
    v_pk_add_f32 v[128:129], v[32:33], v[34:35]
    v_pk_mul_f32 v[130:131], v[32:33], v[32:33]
    v_pk_add_f32 v[128:129], v[128:129], v[36:37]
    v_pk_fma_f32 v[130:131], v[34:35], v[34:35], v[130:131]
    v_pk_add_f32 v[128:129], v[128:129], v[38:39]
    v_pk_fma_f32 v[130:131], v[36:37], v[36:37], v[130:131]
    v_add_f32 v128, v128, v129
    v_pk_fma_f32 v[130:131], v[38:39], v[38:39], v[130:131]
    v_add_f32 v129, v130, v131
    s_nop 1
    v_permlane16_swap_b32 v128, v129
    v_add_f32 v128, v128, v129
    s_nop 1
    v_add_f32_dpp v129, v128, v128 row_ror:8 row_mask:0xf bank_mask:0xf
    v_add_f32_dpp v128, v128, v128 row_ror:8 row_mask:0xf bank_mask:0xf
    s_nop 1
    v_permlane32_swap_b32 v128, v129
    v_add_f32 v128, v128, v129
    s_mov_b64 exec, 0x00ff00ff
    buffer_store_dword v128, v20, s[4:7], s34 offen offset:2048
    s_mov_b64 exec, -1
    buffer_load_dword v22, v2, s[4:7], s26 offen sc1
    v_lshlrev_b32 v136, 16, v60
    v_and_b32 v137, 0xffff0000, v60
    v_lshlrev_b32 v138, 16, v61
    v_and_b32 v139, 0xffff0000, v61
    v_lshlrev_b32 v140, 16, v62
    v_and_b32 v141, 0xffff0000, v62
    v_lshlrev_b32 v142, 16, v63
    v_and_b32 v143, 0xffff0000, v63
    v_pk_add_f32 v[24:25], v[24:25], v[136:137]
    v_pk_add_f32 v[26:27], v[26:27], v[138:139]
    v_pk_add_f32 v[28:29], v[28:29], v[140:141]
    v_pk_add_f32 v[30:31], v[30:31], v[142:143]
    v_pk_add_f32 v[32:33], v[32:33], v[136:137]
    v_pk_add_f32 v[34:35], v[34:35], v[138:139]
    v_pk_add_f32 v[36:37], v[36:37], v[140:141]
    v_pk_add_f32 v[38:39], v[38:39], v[142:143]
    s_add_u32 s45, s98, 1
    s_mov_b64 exec, 1
    v_mov_b32 v56, s45
    s_waitcnt vmcnt(1)
    buffer_store_dword v56, off, s[4:7], s35 offset:128
    s_mov_b64 exec, -1
    s_barrier
    ds_read_b128 v[112:115], v1 offset:0
    ds_read_b128 v[116:119], v1 offset:32768
    ds_read_b128 v[120:123], v0 offset:32768
    ds_read_b128 v[124:127], v1 offset:1024
    s_add_u32 s45, s98, 1
    s_waitcnt vmcnt(1)
    v_cmp_ne_u32 vcc, s45, v22
    s_cmp_eq_u32 vcc_lo, 0
    s_cbranch_scc1 Lpolls_14
    s_add_u32 s45, s98, 1
    s_mov_b32 exec_hi, 0
    s_mov_b32 s50, 0
Lpoll_13:
    buffer_load_dword v56, v2, s[4:7], s26 offen sc1
    s_add_u32 s50, s50, 1
    s_cmp_gt_u32 s50, 0x40000
    s_cbranch_scc1 Labort
    s_waitcnt vmcnt(0)
    v_cmp_ne_u32 vcc, s45, v56
    s_cbranch_vccnz Lpoll_13
    s_mov_b64 exec, -1
Lpolls_14:
    s_add_u32 s51, s24, 0
    buffer_load_dwordx4 v[128:131], v0, s[8:11], s51 offen offset:0 sc1
    buffer_load_dwordx4 v[132:135], v0, s[8:11], s51 offen offset:1024 sc1
    buffer_load_dwordx4 v[136:139], v0, s[8:11], s51 offen offset:2048 sc1
    buffer_load_dwordx4 v[140:143], v0, s[8:11], s51 offen offset:3072 sc1
    s_add_u32 s51, s24, 4096
    buffer_load_dwordx4 v[144:147], v0, s[8:11], s51 offen offset:0 sc1
    buffer_load_dwordx4 v[148:151], v0, s[8:11], s51 offen offset:1024 sc1
    buffer_load_dwordx4 v[152:155], v0, s[8:11], s51 offen offset:2048 sc1
    buffer_load_dwordx4 v[156:159], v0, s[8:11], s51 offen offset:3072 sc1
    s_add_u32 s51, s24, 8192
    buffer_load_dwordx4 v[160:163], v0, s[8:11], s51 offen offset:0 sc1
    buffer_load_dwordx4 v[164:167], v0, s[8:11], s51 offen offset:1024 sc1
    s_waitcnt vmcnt(9) lgkmcnt(3)
    v_mfma_f32_32x32x16_bf16 v[64:79], v[112:115], v[128:131], 0
    ds_read_b128 v[112:115], v1 offset:33792
    buffer_load_dwordx4 v[168:171], v0, s[8:11], s51 offen offset:2048 sc1
    s_waitcnt lgkmcnt(3)
    v_mfma_f32_32x32x16_bf16 v[80:95], v[116:119], v[128:131], 0
    ds_read_b128 v[116:119], v0 offset:33792
    s_waitcnt lgkmcnt(3)
    v_mfma_f32_32x32x16_bf16 v[96:111], v[120:123], v[128:131], 0
    ds_read_b128 v[120:123], v1 offset:2048
    s_waitcnt vmcnt(9) lgkmcnt(3)
    v_mfma_f32_32x32x16_bf16 v[64:79], v[124:127], v[132:135], v[64:79]
    ds_read_b128 v[124:127], v1 offset:34816
    buffer_load_dwordx4 v[172:175], v0, s[8:11], s51 offen offset:3072 sc1
    s_waitcnt lgkmcnt(3)
    v_mfma_f32_32x32x16_bf16 v[80:95], v[112:115], v[132:135], v[80:95]
    ds_read_b128 v[112:115], v0 offset:34816
    s_waitcnt lgkmcnt(3)
    v_mfma_f32_32x32x16_bf16 v[96:111], v[116:119], v[132:135], v[96:111]
    ds_read_b128 v[116:119], v1 offset:3072
    s_waitcnt vmcnt(9) lgkmcnt(3)
    v_mfma_f32_32x32x16_bf16 v[64:79], v[120:123], v[136:139], v[64:79]
    ds_read_b128 v[120:123], v1 offset:35840
    buffer_load_dwordx2 v[56:57], v3, s[4:7], s25 offen offset:0 sc1
    s_waitcnt lgkmcnt(3)
    v_mfma_f32_32x32x16_bf16 v[80:95], v[124:127], v[136:139], v[80:95]
    ds_read_b128 v[124:127], v0 offset:35840
    s_waitcnt lgkmcnt(3)
    v_mfma_f32_32x32x16_bf16 v[96:111], v[112:115], v[136:139], v[96:111]
    ds_read_b128 v[112:115], v1 offset:4096
    buffer_load_dwordx4 a[120:123], v0, s[4:7], s49 offen offset:2048 sc1
    s_waitcnt vmcnt(10) lgkmcnt(3)
    v_mfma_f32_32x32x16_bf16 v[64:79], v[116:119], v[140:143], v[64:79]
    ds_read_b128 v[116:119], v1 offset:36864
    buffer_load_dwordx2 v[58:59], v3, s[4:7], s25 offen offset:256 sc1
    buffer_load_dwordx2 v[60:61], v3, s[4:7], s25 offen offset:512 sc1
    s_waitcnt lgkmcnt(3)
    v_mfma_f32_32x32x16_bf16 v[80:95], v[120:123], v[140:143], v[80:95]
    ds_read_b128 v[120:123], v0 offset:36864
    s_waitcnt lgkmcnt(3)
    v_mfma_f32_32x32x16_bf16 v[96:111], v[124:127], v[140:143], v[96:111]
    ds_read_b128 v[124:127], v1 offset:5120
    s_waitcnt vmcnt(11) lgkmcnt(3)
    v_mfma_f32_32x32x16_bf16 v[64:79], v[112:115], v[144:147], v[64:79]
    ds_read_b128 v[112:115], v1 offset:37888
    buffer_load_dwordx2 v[62:63], v3, s[4:7], s25 offen offset:768 sc1
    s_waitcnt lgkmcnt(3)
    v_mfma_f32_32x32x16_bf16 v[80:95], v[116:119], v[144:147], v[80:95]
    ds_read_b128 v[116:119], v0 offset:37888
    s_waitcnt lgkmcnt(3)
    v_mfma_f32_32x32x16_bf16 v[96:111], v[120:123], v[144:147], v[96:111]
    ds_read_b128 v[120:123], v1 offset:6144
    s_waitcnt vmcnt(11) lgkmcnt(3)
    v_mfma_f32_32x32x16_bf16 v[64:79], v[124:127], v[148:151], v[64:79]
    ds_read_b128 v[124:127], v1 offset:38912
    s_add_u32 s51, s24, 12288
    buffer_load_dwordx4 v[176:179], v0, s[8:11], s51 offen offset:0 sc1
    s_waitcnt lgkmcnt(3)
    v_mfma_f32_32x32x16_bf16 v[80:95], v[112:115], v[148:151], v[80:95]
    ds_read_b128 v[112:115], v0 offset:38912
    s_waitcnt lgkmcnt(3)
    v_mfma_f32_32x32x16_bf16 v[96:111], v[116:119], v[148:151], v[96:111]
    ds_read_b128 v[116:119], v1 offset:7168
    buffer_load_dwordx4 a[124:127], v0, s[4:7], s49 offen offset:3072 sc1
    s_waitcnt vmcnt(12) lgkmcnt(3)
    v_mfma_f32_32x32x16_bf16 v[64:79], v[120:123], v[152:155], v[64:79]
    ds_read_b128 v[120:123], v1 offset:39936
    buffer_load_dwordx4 v[180:183], v0, s[8:11], s51 offen offset:1024 sc1
    buffer_load_dwordx4 v[184:187], v0, s[8:11], s51 offen offset:2048 sc1
    s_waitcnt lgkmcnt(3)
    v_mfma_f32_32x32x16_bf16 v[80:95], v[124:127], v[152:155], v[80:95]
    ds_read_b128 v[124:127], v0 offset:39936
    s_waitcnt lgkmcnt(3)
    v_mfma_f32_32x32x16_bf16 v[96:111], v[112:115], v[152:155], v[96:111]
    ds_read_b128 v[112:115], v1 offset:8192
    s_waitcnt vmcnt(13) lgkmcnt(3)
    v_mfma_f32_32x32x16_bf16 v[64:79], v[116:119], v[156:159], v[64:79]
    ds_read_b128 v[116:119], v1 offset:40960
    buffer_load_dwordx4 v[188:191], v0, s[8:11], s51 offen offset:3072 sc1
    s_waitcnt lgkmcnt(3)
    v_mfma_f32_32x32x16_bf16 v[80:95], v[120:123], v[156:159], v[80:95]
    ds_read_b128 v[120:123], v0 offset:40960
    s_waitcnt lgkmcnt(3)
    v_mfma_f32_32x32x16_bf16 v[96:111], v[124:127], v[156:159], v[96:111]
    ds_read_b128 v[124:127], v1 offset:9216
    s_waitcnt vmcnt(13) lgkmcnt(3)
    v_mfma_f32_32x32x16_bf16 v[64:79], v[112:115], v[160:163], v[64:79]
    ds_read_b128 v[112:115], v1 offset:41984
    s_add_u32 s51, s24, 16384
    buffer_load_dwordx4 v[128:131], v0, s[8:11], s51 offen offset:0 sc1
    s_waitcnt lgkmcnt(3)
    v_mfma_f32_32x32x16_bf16 v[80:95], v[116:119], v[160:163], v[80:95]
    ds_read_b128 v[116:119], v0 offset:41984
    s_waitcnt lgkmcnt(3)
    v_mfma_f32_32x32x16_bf16 v[96:111], v[120:123], v[160:163], v[96:111]
    ds_read_b128 v[120:123], v1 offset:10240
    s_add_u32 s49, s55, 16384
    buffer_load_dwordx4 a[128:131], v0, s[4:7], s49 offen offset:0 sc1
    s_waitcnt vmcnt(14) lgkmcnt(3)
    v_mfma_f32_32x32x16_bf16 v[64:79], v[124:127], v[164:167], v[64:79]
    ds_read_b128 v[124:127], v1 offset:43008
    buffer_load_dwordx4 v[132:135], v0, s[8:11], s51 offen offset:1024 sc1
    buffer_load_dwordx4 v[136:139], v0, s[8:11], s51 offen offset:2048 sc1
    s_waitcnt lgkmcnt(3)
    v_mfma_f32_32x32x16_bf16 v[80:95], v[112:115], v[164:167], v[80:95]
    ds_read_b128 v[112:115], v0 offset:43008
    s_waitcnt lgkmcnt(3)
    v_mfma_f32_32x32x16_bf16 v[96:111], v[116:119], v[164:167], v[96:111]
    ds_read_b128 v[116:119], v1 offset:11264
    s_waitcnt vmcnt(15) lgkmcnt(3)
    v_mfma_f32_32x32x16_bf16 v[64:79], v[120:123], v[168:171], v[64:79]
    ds_read_b128 v[120:123], v1 offset:44032
    buffer_load_dwordx4 v[140:143], v0, s[8:11], s51 offen offset:3072 sc1
    s_waitcnt lgkmcnt(3)
    v_mfma_f32_32x32x16_bf16 v[80:95], v[124:127], v[168:171], v[80:95]
    ds_read_b128 v[124:127], v0 offset:44032
    s_waitcnt lgkmcnt(3)
    v_mfma_f32_32x32x16_bf16 v[96:111], v[112:115], v[168:171], v[96:111]
    ds_read_b128 v[112:115], v1 offset:12288
    s_waitcnt vmcnt(15) lgkmcnt(3)
    v_mfma_f32_32x32x16_bf16 v[64:79], v[116:119], v[172:175], v[64:79]
    ds_read_b128 v[116:119], v1 offset:45056
    s_add_u32 s51, s24, 20480
    buffer_load_dwordx4 v[144:147], v0, s[8:11], s51 offen offset:0 sc1
    s_waitcnt lgkmcnt(3)
    v_mfma_f32_32x32x16_bf16 v[80:95], v[120:123], v[172:175], v[80:95]
    ds_read_b128 v[120:123], v0 offset:45056
    s_waitcnt lgkmcnt(3)
    v_mfma_f32_32x32x16_bf16 v[96:111], v[124:127], v[172:175], v[96:111]
    ds_read_b128 v[124:127], v1 offset:13312
    buffer_load_dwordx4 a[132:135], v0, s[4:7], s49 offen offset:1024 sc1
    s_waitcnt vmcnt(11) lgkmcnt(3)
    v_mfma_f32_32x32x16_bf16 v[64:79], v[112:115], v[176:179], v[64:79]
    ds_read_b128 v[112:115], v1 offset:46080
    buffer_load_dwordx4 v[148:151], v0, s[8:11], s51 offen offset:1024 sc1
    s_waitcnt lgkmcnt(3)
    v_mfma_f32_32x32x16_bf16 v[80:95], v[116:119], v[176:179], v[80:95]
    ds_read_b128 v[116:119], v0 offset:46080
    s_waitcnt lgkmcnt(3)
    v_mfma_f32_32x32x16_bf16 v[96:111], v[120:123], v[176:179], v[96:111]
    ds_read_b128 v[120:123], v1 offset:14336
    s_waitcnt vmcnt(10) lgkmcnt(3)
    v_mfma_f32_32x32x16_bf16 v[64:79], v[124:127], v[180:183], v[64:79]
    ds_read_b128 v[124:127], v1 offset:47104
    buffer_load_dwordx4 v[152:155], v0, s[8:11], s51 offen offset:2048 sc1
    buffer_load_dwordx4 v[156:159], v0, s[8:11], s51 offen offset:3072 sc1
    s_waitcnt lgkmcnt(3)
    v_mfma_f32_32x32x16_bf16 v[80:95], v[112:115], v[180:183], v[80:95]
    ds_read_b128 v[112:115], v0 offset:47104
    s_waitcnt lgkmcnt(3)
    v_mfma_f32_32x32x16_bf16 v[96:111], v[116:119], v[180:183], v[96:111]
    ds_read_b128 v[116:119], v1 offset:15360
    s_waitcnt vmcnt(11) lgkmcnt(3)
    v_mfma_f32_32x32x16_bf16 v[64:79], v[120:123], v[184:187], v[64:79]
    ds_read_b128 v[120:123], v1 offset:48128
    s_add_u32 s51, s24, 24576
    buffer_load_dwordx4 v[160:163], v0, s[8:11], s51 offen offset:0 sc1
    s_waitcnt lgkmcnt(3)
    v_mfma_f32_32x32x16_bf16 v[80:95], v[124:127], v[184:187], v[80:95]
    ds_read_b128 v[124:127], v0 offset:48128
    v_add_f32 v56, v56, v58
    v_add_f32 v57, v57, v59
    v_add_f32 v60, v60, v62
    s_waitcnt lgkmcnt(3)
    v_mfma_f32_32x32x16_bf16 v[96:111], v[112:115], v[184:187], v[96:111]
    ds_read_b128 v[112:115], v1 offset:16384
    buffer_load_dwordx4 a[136:139], v0, s[4:7], s49 offen offset:2048 sc1
    v_add_f32 v61, v61, v63
    v_add_f32 v56, v56, v60
    s_waitcnt vmcnt(12) lgkmcnt(3)
    v_mfma_f32_32x32x16_bf16 v[64:79], v[116:119], v[188:191], v[64:79]
    ds_read_b128 v[116:119], v1 offset:49152
    buffer_load_dwordx4 v[164:167], v0, s[8:11], s51 offen offset:1024 sc1
    v_add_f32 v57, v57, v61
    s_nop 1
    v_permlane32_swap_b32 v56, v57
    s_waitcnt lgkmcnt(3)
    v_mfma_f32_32x32x16_bf16 v[80:95], v[120:123], v[188:191], v[80:95]
    ds_read_b128 v[120:123], v0 offset:49152
    v_add_f32 v56, v56, v57
    v_mov_b32 v57, v56
    s_waitcnt lgkmcnt(3)
    v_mfma_f32_32x32x16_bf16 v[96:111], v[124:127], v[188:191], v[96:111]
    ds_read_b128 v[124:127], v1 offset:17408
    v_permlane32_swap_b32 v56, v57
    v_mul_f32 v22, 989855744, v56
    s_waitcnt vmcnt(12) lgkmcnt(3)
    v_mfma_f32_32x32x16_bf16 v[64:79], v[112:115], v[128:131], v[64:79]
    ds_read_b128 v[112:115], v1 offset:50176
    buffer_load_dwordx4 v[168:171], v0, s[8:11], s51 offen offset:2048 sc1
    buffer_load_dwordx4 v[172:175], v0, s[8:11], s51 offen offset:3072 sc1
    s_waitcnt lgkmcnt(3)
    v_mfma_f32_32x32x16_bf16 v[80:95], v[116:119], v[128:131], v[80:95]
    ds_read_b128 v[116:119], v0 offset:50176
    v_mul_f32 v57, 989855744, v57
    v_fma_f32 v57, -v22, v22, v57
    v_max_f32 v57, 0, v57
    v_add_f32 v58, 925353388, v57
    s_waitcnt lgkmcnt(3)
    v_mfma_f32_32x32x16_bf16 v[96:111], v[120:123], v[128:131], v[96:111]
    ds_read_b128 v[120:123], v1 offset:18432
    v_rsq_f32 v23, v58
    s_waitcnt vmcnt(12) lgkmcnt(3)
    v_mfma_f32_32x32x16_bf16 v[64:79], v[124:127], v[132:135], v[64:79]
    ds_read_b128 v[124:127], v1 offset:51200
    s_add_u32 s51, s24, 28672
    buffer_load_dwordx4 v[176:179], v0, s[8:11], s51 offen offset:0 sc1
    s_waitcnt lgkmcnt(3)
    v_mfma_f32_32x32x16_bf16 v[80:95], v[112:115], v[132:135], v[80:95]
    ds_read_b128 v[112:115], v0 offset:51200
    v_mul_f32 v58, v23, v23
    v_mul_f32 v58, v58, v57
    v_add_f32 v58, 925353388, v58
    v_rsq_f32 v58, v58
    s_waitcnt lgkmcnt(3)
    v_mfma_f32_32x32x16_bf16 v[96:111], v[116:119], v[132:135], v[96:111]
    ds_read_b128 v[116:119], v1 offset:19456
    buffer_load_dwordx4 a[140:143], v0, s[4:7], s49 offen offset:3072 sc1
    v_mul_f32 v23, v23, v58
    s_waitcnt vmcnt(13) lgkmcnt(3)
    v_mfma_f32_32x32x16_bf16 v[64:79], v[120:123], v[136:139], v[64:79]
    ds_read_b128 v[120:123], v1 offset:52224
    buffer_load_dwordx4 v[180:183], v0, s[8:11], s51 offen offset:1024 sc1
    v_rcp_f32 v58, v23
    s_waitcnt lgkmcnt(3)
    v_mfma_f32_32x32x16_bf16 v[80:95], v[124:127], v[136:139], v[80:95]
    ds_read_b128 v[124:127], v0 offset:52224
    v_mul_f32 v56, 3222493025, v23
    v_mul_f32 v57, v23, v23
    s_waitcnt lgkmcnt(3)
    v_mfma_f32_32x32x16_bf16 v[96:111], v[112:115], v[136:139], v[96:111]
    ds_read_b128 v[112:115], v1 offset:20480
    v_mul_f32 v57, v57, v56
    v_mul_f32 v57, 1027024659, v57
    s_waitcnt vmcnt(13) lgkmcnt(3)
    v_mfma_f32_32x32x16_bf16 v[64:79], v[116:119], v[140:143], v[64:79]
    ds_read_b128 v[116:119], v1 offset:53248
    buffer_load_dwordx4 v[184:187], v0, s[8:11], s51 offen offset:2048 sc1
    buffer_load_dwordx4 v[188:191], v0, s[8:11], s51 offen offset:3072 sc1
    s_waitcnt lgkmcnt(3)
    v_mfma_f32_32x32x16_bf16 v[80:95], v[120:123], v[140:143], v[80:95]
    ds_read_b128 v[120:123], v0 offset:53248
    v_mov_b32 v42, 0
    v_mov_b32 v43, 0
    v_mov_b32 v46, 0
    v_mov_b32 v47, 0
    s_waitcnt lgkmcnt(3)
    v_mfma_f32_32x32x16_bf16 v[96:111], v[124:127], v[140:143], v[96:111]
    ds_read_b128 v[124:127], v1 offset:21504
    v_cndmask_b32 v48, v58, -v22, s[58:59]
    v_cvt_pk_bf16_f32 v44, v48, v48
    s_waitcnt vmcnt(14) lgkmcnt(3)
    v_mfma_f32_32x32x16_bf16 v[64:79], v[112:115], v[144:147], v[64:79]
    ds_read_b128 v[112:115], v1 offset:54272
    s_add_u32 s49, s55, 20480
    buffer_load_dwordx4 a[144:147], v0, s[4:7], s49 offen offset:0 sc1
    s_waitcnt lgkmcnt(3)
    v_mfma_f32_32x32x16_bf16 v[80:95], v[116:119], v[144:147], v[80:95]
    ds_read_b128 v[116:119], v0 offset:54272
    v_and_b32 v49, 0xffff0000, v44
    v_sub_f32 v48, v48, v49
    v_cvt_pk_bf16_f32 v45, v48, 0
    v_accvgpr_read_b32 v50, a250
    s_waitcnt lgkmcnt(3)
    v_mfma_f32_32x32x16_bf16 v[96:111], v[120:123], v[144:147], v[96:111]
    ds_read_b128 v[120:123], v1 offset:22528
    v_cvt_pk_bf16_f32 v41, v50, 0
    v_lshlrev_b32 v51, 16, v41
    s_waitcnt vmcnt(13) lgkmcnt(3)
    v_mfma_f32_32x32x16_bf16 v[64:79], v[124:127], v[148:151], v[64:79]
    ds_read_b128 v[124:127], v1 offset:55296
    buffer_load_dwordx4 a[148:151], v0, s[4:7], s49 offen offset:1024 sc1
    v_sub_f32 v51, v50, v51
    v_cvt_pk_bf16_f32 v40, v50, v51
    s_waitcnt lgkmcnt(3)
    v_mfma_f32_32x32x16_bf16 v[80:95], v[112:115], v[148:151], v[80:95]
    ds_read_b128 v[112:115], v0 offset:55296
    v_mfma_f32_32x32x16_bf16 v[64:79], v[40:43], v[44:47], v[64:79]
    v_accvgpr_read_b32 v50, a251
    s_waitcnt lgkmcnt(3)
    v_mfma_f32_32x32x16_bf16 v[96:111], v[116:119], v[148:151], v[96:111]
    ds_read_b128 v[116:119], v1 offset:23552
    v_cvt_pk_bf16_f32 v41, v50, 0
    v_lshlrev_b32 v51, 16, v41
    s_waitcnt vmcnt(13) lgkmcnt(3)
    v_mfma_f32_32x32x16_bf16 v[64:79], v[120:123], v[152:155], v[64:79]
    ds_read_b128 v[120:123], v1 offset:56320
    buffer_load_dwordx4 a[152:155], v0, s[4:7], s49 offen offset:2048 sc1
    v_sub_f32 v51, v50, v51
    v_cvt_pk_bf16_f32 v40, v50, v51
    s_waitcnt lgkmcnt(3)
    v_mfma_f32_32x32x16_bf16 v[80:95], v[124:127], v[152:155], v[80:95]
    ds_read_b128 v[124:127], v0 offset:56320
    v_mfma_f32_32x32x16_bf16 v[80:95], v[40:43], v[44:47], v[80:95]
    v_accvgpr_read_b32 v50, a252
    s_waitcnt lgkmcnt(3)
    v_mfma_f32_32x32x16_bf16 v[96:111], v[112:115], v[152:155], v[96:111]
    ds_read_b128 v[112:115], v1 offset:24576
    v_cvt_pk_bf16_f32 v41, v50, 0
    v_lshlrev_b32 v51, 16, v41
    s_waitcnt vmcnt(13) lgkmcnt(3)
    v_mfma_f32_32x32x16_bf16 v[64:79], v[116:119], v[156:159], v[64:79]
    ds_read_b128 v[116:119], v1 offset:57344
    buffer_load_dwordx4 a[156:159], v0, s[4:7], s49 offen offset:3072 sc1
    v_sub_f32 v51, v50, v51
    v_cvt_pk_bf16_f32 v40, v50, v51
    s_waitcnt lgkmcnt(3)
    v_mfma_f32_32x32x16_bf16 v[80:95], v[120:123], v[156:159], v[80:95]
    ds_read_b128 v[120:123], v0 offset:57344
    v_mfma_f32_32x32x16_bf16 v[96:111], v[40:43], v[44:47], v[96:111]
    s_waitcnt lgkmcnt(3)
    v_mfma_f32_32x32x16_bf16 v[96:111], v[124:127], v[156:159], v[96:111]
    ds_read_b128 v[124:127], v1 offset:25600
    s_waitcnt vmcnt(13) lgkmcnt(3)
    v_mfma_f32_32x32x16_bf16 v[64:79], v[112:115], v[160:163], v[64:79]
    ds_read_b128 v[112:115], v1 offset:58368
    s_add_u32 s49, s55, 24576
    buffer_load_dwordx4 a[160:163], v0, s[4:7], s49 offen offset:0 sc1
    s_waitcnt lgkmcnt(3)
    v_mfma_f32_32x32x16_bf16 v[80:95], v[116:119], v[160:163], v[80:95]
    ds_read_b128 v[116:119], v0 offset:58368
    s_waitcnt lgkmcnt(3)
    v_mfma_f32_32x32x16_bf16 v[96:111], v[120:123], v[160:163], v[96:111]
    ds_read_b128 v[120:123], v1 offset:26624
    s_waitcnt vmcnt(12) lgkmcnt(3)
    v_mfma_f32_32x32x16_bf16 v[64:79], v[124:127], v[164:167], v[64:79]
    ds_read_b128 v[124:127], v1 offset:59392
    buffer_load_dwordx4 a[164:167], v0, s[4:7], s49 offen offset:1024 sc1
    s_waitcnt lgkmcnt(3)
    v_mfma_f32_32x32x16_bf16 v[80:95], v[112:115], v[164:167], v[80:95]
    ds_read_b128 v[112:115], v0 offset:59392
    s_waitcnt lgkmcnt(3)
    v_mfma_f32_32x32x16_bf16 v[96:111], v[116:119], v[164:167], v[96:111]
    ds_read_b128 v[116:119], v1 offset:27648
    s_waitcnt vmcnt(12) lgkmcnt(3)
    v_mfma_f32_32x32x16_bf16 v[64:79], v[120:123], v[168:171], v[64:79]
    ds_read_b128 v[120:123], v1 offset:60416
    buffer_load_dwordx4 a[168:171], v0, s[4:7], s49 offen offset:2048 sc1
    s_waitcnt lgkmcnt(3)
    v_mfma_f32_32x32x16_bf16 v[80:95], v[124:127], v[168:171], v[80:95]
    ds_read_b128 v[124:127], v0 offset:60416
    s_waitcnt lgkmcnt(3)
    v_mfma_f32_32x32x16_bf16 v[96:111], v[112:115], v[168:171], v[96:111]
    ds_read_b128 v[112:115], v1 offset:28672
    s_waitcnt vmcnt(12) lgkmcnt(3)
    v_mfma_f32_32x32x16_bf16 v[64:79], v[116:119], v[172:175], v[64:79]
    ds_read_b128 v[116:119], v1 offset:61440
    buffer_load_dwordx4 a[172:175], v0, s[4:7], s49 offen offset:3072 sc1
    s_waitcnt lgkmcnt(3)
    v_mfma_f32_32x32x16_bf16 v[80:95], v[120:123], v[172:175], v[80:95]
    ds_read_b128 v[120:123], v0 offset:61440
    s_waitcnt lgkmcnt(3)
    v_mfma_f32_32x32x16_bf16 v[96:111], v[124:127], v[172:175], v[96:111]
    ds_read_b128 v[124:127], v1 offset:29696
    s_waitcnt vmcnt(12) lgkmcnt(3)
    v_mfma_f32_32x32x16_bf16 v[64:79], v[112:115], v[176:179], v[64:79]
    ds_read_b128 v[112:115], v1 offset:62464
    s_add_u32 s49, s55, 28672
    buffer_load_dwordx4 a[176:179], v0, s[4:7], s49 offen offset:0 sc1
    s_waitcnt lgkmcnt(3)
    v_mfma_f32_32x32x16_bf16 v[80:95], v[116:119], v[176:179], v[80:95]
    ds_read_b128 v[116:119], v0 offset:62464
    s_waitcnt lgkmcnt(3)
    v_mfma_f32_32x32x16_bf16 v[96:111], v[120:123], v[176:179], v[96:111]
    ds_read_b128 v[120:123], v1 offset:30720
    s_waitcnt vmcnt(11) lgkmcnt(3)
    v_mfma_f32_32x32x16_bf16 v[64:79], v[124:127], v[180:183], v[64:79]
    ds_read_b128 v[124:127], v1 offset:63488
    buffer_load_dwordx4 a[180:183], v0, s[4:7], s49 offen offset:1024 sc1
    s_waitcnt lgkmcnt(3)
    v_mfma_f32_32x32x16_bf16 v[80:95], v[112:115], v[180:183], v[80:95]
    ds_read_b128 v[112:115], v0 offset:63488
    s_waitcnt lgkmcnt(3)
    v_mfma_f32_32x32x16_bf16 v[96:111], v[116:119], v[180:183], v[96:111]
    ds_read_b128 v[116:119], v1 offset:31744
    s_waitcnt vmcnt(11) lgkmcnt(3)
    v_mfma_f32_32x32x16_bf16 v[64:79], v[120:123], v[184:187], v[64:79]
    ds_read_b128 v[120:123], v1 offset:64512
    buffer_load_dwordx4 a[184:187], v0, s[4:7], s49 offen offset:2048 sc1
    s_waitcnt lgkmcnt(3)
    v_mfma_f32_32x32x16_bf16 v[80:95], v[124:127], v[184:187], v[80:95]
    ds_read_b128 v[124:127], v0 offset:64512
    s_waitcnt lgkmcnt(3)
    v_mfma_f32_32x32x16_bf16 v[96:111], v[112:115], v[184:187], v[96:111]
    s_waitcnt vmcnt(11) lgkmcnt(2)
    v_mfma_f32_32x32x16_bf16 v[64:79], v[116:119], v[188:191], v[64:79]
    buffer_load_dwordx4 a[188:191], v0, s[4:7], s49 offen offset:3072 sc1
    s_waitcnt lgkmcnt(1)
    v_mfma_f32_32x32x16_bf16 v[80:95], v[120:123], v[188:191], v[80:95]
    s_waitcnt lgkmcnt(0)
    v_mfma_f32_32x32x16_bf16 v[96:111], v[124:127], v[188:191], v[96:111]
    s_nop 6
    v_pk_mul_f32 v[40:41], v[64:65], v[64:65]
    v_pk_mul_f32 v[42:43], v[66:67], v[66:67]
    v_pk_mul_f32 v[44:45], v[68:69], v[68:69]
    v_pk_mul_f32 v[46:47], v[70:71], v[70:71]
    v_pk_fma_f32 v[40:41], v[40:41], v[56:57], v[56:57] op_sel:[0,1,0] op_sel_hi:[1,1,0]
    s_add_u32 s49, s55, 32768
    buffer_load_dwordx4 a[192:195], v0, s[4:7], s49 offen offset:0 sc1
    v_pk_fma_f32 v[42:43], v[42:43], v[56:57], v[56:57] op_sel:[0,1,0] op_sel_hi:[1,1,0]
    v_pk_fma_f32 v[44:45], v[44:45], v[56:57], v[56:57] op_sel:[0,1,0] op_sel_hi:[1,1,0]
    v_pk_fma_f32 v[46:47], v[46:47], v[56:57], v[56:57] op_sel:[0,1,0] op_sel_hi:[1,1,0]
    v_pk_mul_f32 v[40:41], v[40:41], v[64:65]
    v_pk_mul_f32 v[42:43], v[42:43], v[66:67]
    v_pk_mul_f32 v[44:45], v[44:45], v[68:69]
    v_pk_mul_f32 v[46:47], v[46:47], v[70:71]
    v_exp_f32 v40, v40
    v_exp_f32 v41, v41
    v_exp_f32 v42, v42
    v_exp_f32 v43, v43
    buffer_load_dwordx4 a[196:199], v0, s[4:7], s49 offen offset:1024 sc1
    v_exp_f32 v44, v44
    v_exp_f32 v45, v45
    v_exp_f32 v46, v46
    v_exp_f32 v47, v47
    v_pk_fma_f32 v[40:41], v[40:41], v[58:59], v[58:59] op_sel_hi:[1,0,0]
    v_pk_fma_f32 v[42:43], v[42:43], v[58:59], v[58:59] op_sel_hi:[1,0,0]
    v_pk_fma_f32 v[44:45], v[44:45], v[58:59], v[58:59] op_sel_hi:[1,0,0]
    v_pk_fma_f32 v[46:47], v[46:47], v[58:59], v[58:59] op_sel_hi:[1,0,0]
    v_rcp_f32 v40, v40
    buffer_load_dwordx4 a[200:203], v0, s[4:7], s49 offen offset:2048 sc1
    v_rcp_f32 v41, v41
    v_rcp_f32 v42, v42
    v_rcp_f32 v43, v43
    v_rcp_f32 v44, v44
    v_rcp_f32 v45, v45
    v_rcp_f32 v46, v46
    v_rcp_f32 v47, v47
    buffer_load_dwordx4 a[204:207], v0, s[4:7], s49 offen offset:3072 sc1
    v_pk_mul_f32 v[64:65], v[64:65], v[40:41]
    v_pk_mul_f32 v[66:67], v[66:67], v[42:43]
    v_pk_mul_f32 v[68:69], v[68:69], v[44:45]
    v_pk_mul_f32 v[70:71], v[70:71], v[46:47]
    v_cvt_pk_bf16_f32 v64, v64, v65
    v_cvt_pk_bf16_f32 v65, v66, v67
    v_cvt_pk_bf16_f32 v66, v68, v69
    v_cvt_pk_bf16_f32 v67, v70, v71
    buffer_store_dwordx4 v[64:67], v5, s[4:7], s36 offen offset:0 sc1
    v_pk_mul_f32 v[48:49], v[72:73], v[72:73]
    v_pk_mul_f32 v[50:51], v[74:75], v[74:75]
    v_pk_mul_f32 v[52:53], v[76:77], v[76:77]
    v_pk_mul_f32 v[54:55], v[78:79], v[78:79]
    v_pk_fma_f32 v[48:49], v[48:49], v[56:57], v[56:57] op_sel:[0,1,0] op_sel_hi:[1,1,0]
    v_pk_fma_f32 v[50:51], v[50:51], v[56:57], v[56:57] op_sel:[0,1,0] op_sel_hi:[1,1,0]
    s_add_u32 s49, s55, 36864
    buffer_load_dwordx4 a[208:211], v0, s[4:7], s49 offen offset:0 sc1
    v_pk_fma_f32 v[52:53], v[52:53], v[56:57], v[56:57] op_sel:[0,1,0] op_sel_hi:[1,1,0]
    v_pk_fma_f32 v[54:55], v[54:55], v[56:57], v[56:57] op_sel:[0,1,0] op_sel_hi:[1,1,0]
    v_pk_mul_f32 v[48:49], v[48:49], v[72:73]
    v_pk_mul_f32 v[50:51], v[50:51], v[74:75]
    v_pk_mul_f32 v[52:53], v[52:53], v[76:77]
    v_pk_mul_f32 v[54:55], v[54:55], v[78:79]
    v_exp_f32 v48, v48
    v_exp_f32 v49, v49
    v_exp_f32 v50, v50
    v_exp_f32 v51, v51
    buffer_load_dwordx4 a[212:215], v0, s[4:7], s49 offen offset:1024 sc1
    v_exp_f32 v52, v52
    v_exp_f32 v53, v53
    v_exp_f32 v54, v54
    v_exp_f32 v55, v55
    v_pk_fma_f32 v[48:49], v[48:49], v[58:59], v[58:59] op_sel_hi:[1,0,0]
    v_pk_fma_f32 v[50:51], v[50:51], v[58:59], v[58:59] op_sel_hi:[1,0,0]
    v_pk_fma_f32 v[52:53], v[52:53], v[58:59], v[58:59] op_sel_hi:[1,0,0]
    v_pk_fma_f32 v[54:55], v[54:55], v[58:59], v[58:59] op_sel_hi:[1,0,0]
    v_rcp_f32 v48, v48
    buffer_load_dwordx4 a[216:219], v0, s[4:7], s49 offen offset:2048 sc1
    v_rcp_f32 v49, v49
    v_rcp_f32 v50, v50
    v_rcp_f32 v51, v51
    v_rcp_f32 v52, v52
    v_rcp_f32 v53, v53
    v_rcp_f32 v54, v54
    v_rcp_f32 v55, v55
    buffer_load_dwordx4 a[220:223], v0, s[4:7], s49 offen offset:3072 sc1
    v_pk_mul_f32 v[72:73], v[72:73], v[48:49]
    v_pk_mul_f32 v[74:75], v[74:75], v[50:51]
    v_pk_mul_f32 v[76:77], v[76:77], v[52:53]
    v_pk_mul_f32 v[78:79], v[78:79], v[54:55]
    v_cvt_pk_bf16_f32 v72, v72, v73
    v_cvt_pk_bf16_f32 v73, v74, v75
    v_cvt_pk_bf16_f32 v74, v76, v77
    v_cvt_pk_bf16_f32 v75, v78, v79
    buffer_store_dwordx4 v[72:75], v5, s[4:7], s36 offen offset:256 sc1
    v_pk_mul_f32 v[40:41], v[80:81], v[80:81]
    v_pk_mul_f32 v[42:43], v[82:83], v[82:83]
    v_pk_mul_f32 v[44:45], v[84:85], v[84:85]
    v_pk_mul_f32 v[46:47], v[86:87], v[86:87]
    v_pk_fma_f32 v[40:41], v[40:41], v[56:57], v[56:57] op_sel:[0,1,0] op_sel_hi:[1,1,0]
    v_pk_fma_f32 v[42:43], v[42:43], v[56:57], v[56:57] op_sel:[0,1,0] op_sel_hi:[1,1,0]
    s_add_u32 s49, s55, 40960
    s_cmp_eq_u32 s16, 3
    s_cselect_b32 s49, 268435456, s49
    buffer_load_dwordx4 a[224:227], v0, s[4:7], s49 offen offset:0 sc1
    v_pk_fma_f32 v[44:45], v[44:45], v[56:57], v[56:57] op_sel:[0,1,0] op_sel_hi:[1,1,0]
    v_pk_fma_f32 v[46:47], v[46:47], v[56:57], v[56:57] op_sel:[0,1,0] op_sel_hi:[1,1,0]
    v_pk_mul_f32 v[40:41], v[40:41], v[80:81]
    v_pk_mul_f32 v[42:43], v[42:43], v[82:83]
    v_pk_mul_f32 v[44:45], v[44:45], v[84:85]
    v_pk_mul_f32 v[46:47], v[46:47], v[86:87]
    v_exp_f32 v40, v40
    v_exp_f32 v41, v41
    v_exp_f32 v42, v42
    v_exp_f32 v43, v43
    buffer_load_dwordx4 a[228:231], v0, s[4:7], s49 offen offset:1024 sc1
    v_exp_f32 v44, v44
    v_exp_f32 v45, v45
    v_exp_f32 v46, v46
    v_exp_f32 v47, v47
    v_pk_fma_f32 v[40:41], v[40:41], v[58:59], v[58:59] op_sel_hi:[1,0,0]
    v_pk_fma_f32 v[42:43], v[42:43], v[58:59], v[58:59] op_sel_hi:[1,0,0]
    v_pk_fma_f32 v[44:45], v[44:45], v[58:59], v[58:59] op_sel_hi:[1,0,0]
    v_pk_fma_f32 v[46:47], v[46:47], v[58:59], v[58:59] op_sel_hi:[1,0,0]
    v_rcp_f32 v40, v40
    buffer_load_dwordx4 a[232:235], v0, s[4:7], s49 offen offset:2048 sc1
    v_rcp_f32 v41, v41
    v_rcp_f32 v42, v42
    v_rcp_f32 v43, v43
    v_rcp_f32 v44, v44
    v_rcp_f32 v45, v45
    v_rcp_f32 v46, v46
    v_rcp_f32 v47, v47
    buffer_load_dwordx4 a[236:239], v0, s[4:7], s49 offen offset:3072 sc1
    v_pk_mul_f32 v[80:81], v[80:81], v[40:41]
    v_pk_mul_f32 v[82:83], v[82:83], v[42:43]
    v_pk_mul_f32 v[84:85], v[84:85], v[44:45]
    v_pk_mul_f32 v[86:87], v[86:87], v[46:47]
    v_cvt_pk_bf16_f32 v80, v80, v81
    v_cvt_pk_bf16_f32 v81, v82, v83
    v_cvt_pk_bf16_f32 v82, v84, v85
    v_cvt_pk_bf16_f32 v83, v86, v87
    buffer_store_dwordx4 v[80:83], v5, s[4:7], s63 offen offset:0 sc1
    v_pk_mul_f32 v[48:49], v[88:89], v[88:89]
    v_pk_mul_f32 v[50:51], v[90:91], v[90:91]
    v_pk_mul_f32 v[52:53], v[92:93], v[92:93]
    v_pk_mul_f32 v[54:55], v[94:95], v[94:95]
    v_pk_fma_f32 v[48:49], v[48:49], v[56:57], v[56:57] op_sel:[0,1,0] op_sel_hi:[1,1,0]
    v_pk_fma_f32 v[50:51], v[50:51], v[56:57], v[56:57] op_sel:[0,1,0] op_sel_hi:[1,1,0]
    v_pk_fma_f32 v[52:53], v[52:53], v[56:57], v[56:57] op_sel:[0,1,0] op_sel_hi:[1,1,0]
    v_pk_fma_f32 v[54:55], v[54:55], v[56:57], v[56:57] op_sel:[0,1,0] op_sel_hi:[1,1,0]
    v_pk_mul_f32 v[48:49], v[48:49], v[88:89]
    v_pk_mul_f32 v[50:51], v[50:51], v[90:91]
    v_pk_mul_f32 v[52:53], v[52:53], v[92:93]
    v_pk_mul_f32 v[54:55], v[54:55], v[94:95]
    v_exp_f32 v48, v48
    v_exp_f32 v49, v49
    v_exp_f32 v50, v50
    v_exp_f32 v51, v51
    v_exp_f32 v52, v52
    v_exp_f32 v53, v53
    v_exp_f32 v54, v54
    v_exp_f32 v55, v55
    v_pk_fma_f32 v[48:49], v[48:49], v[58:59], v[58:59] op_sel_hi:[1,0,0]
    v_pk_fma_f32 v[50:51], v[50:51], v[58:59], v[58:59] op_sel_hi:[1,0,0]
    v_pk_fma_f32 v[52:53], v[52:53], v[58:59], v[58:59] op_sel_hi:[1,0,0]
    v_pk_fma_f32 v[54:55], v[54:55], v[58:59], v[58:59] op_sel_hi:[1,0,0]
    v_rcp_f32 v48, v48
    v_rcp_f32 v49, v49
    v_rcp_f32 v50, v50
    v_rcp_f32 v51, v51
    v_rcp_f32 v52, v52
    v_rcp_f32 v53, v53
    v_rcp_f32 v54, v54
    v_rcp_f32 v55, v55
    v_pk_mul_f32 v[88:89], v[88:89], v[48:49]
    v_pk_mul_f32 v[90:91], v[90:91], v[50:51]
    v_pk_mul_f32 v[92:93], v[92:93], v[52:53]
    v_pk_mul_f32 v[94:95], v[94:95], v[54:55]
    v_cvt_pk_bf16_f32 v88, v88, v89
    v_cvt_pk_bf16_f32 v89, v90, v91
    v_cvt_pk_bf16_f32 v90, v92, v93
    v_cvt_pk_bf16_f32 v91, v94, v95
    buffer_store_dwordx4 v[88:91], v5, s[4:7], s63 offen offset:256 sc1
    v_pk_mul_f32 v[40:41], v[96:97], v[96:97]
    v_pk_mul_f32 v[42:43], v[98:99], v[98:99]
    v_pk_mul_f32 v[44:45], v[100:101], v[100:101]
    v_pk_mul_f32 v[46:47], v[102:103], v[102:103]
    v_pk_fma_f32 v[40:41], v[40:41], v[56:57], v[56:57] op_sel:[0,1,0] op_sel_hi:[1,1,0]
    v_pk_fma_f32 v[42:43], v[42:43], v[56:57], v[56:57] op_sel:[0,1,0] op_sel_hi:[1,1,0]
    v_pk_fma_f32 v[44:45], v[44:45], v[56:57], v[56:57] op_sel:[0,1,0] op_sel_hi:[1,1,0]
    v_pk_fma_f32 v[46:47], v[46:47], v[56:57], v[56:57] op_sel:[0,1,0] op_sel_hi:[1,1,0]
    v_pk_mul_f32 v[40:41], v[40:41], v[96:97]
    v_pk_mul_f32 v[42:43], v[42:43], v[98:99]
    v_pk_mul_f32 v[44:45], v[44:45], v[100:101]
    v_pk_mul_f32 v[46:47], v[46:47], v[102:103]
    v_exp_f32 v40, v40
    v_exp_f32 v41, v41
    v_exp_f32 v42, v42
    v_exp_f32 v43, v43
    v_exp_f32 v44, v44
    v_exp_f32 v45, v45
    v_exp_f32 v46, v46
    v_exp_f32 v47, v47
    v_pk_fma_f32 v[40:41], v[40:41], v[58:59], v[58:59] op_sel_hi:[1,0,0]
    v_pk_fma_f32 v[42:43], v[42:43], v[58:59], v[58:59] op_sel_hi:[1,0,0]
    v_pk_fma_f32 v[44:45], v[44:45], v[58:59], v[58:59] op_sel_hi:[1,0,0]
    v_pk_fma_f32 v[46:47], v[46:47], v[58:59], v[58:59] op_sel_hi:[1,0,0]
    v_rcp_f32 v40, v40
    v_rcp_f32 v41, v41
    v_rcp_f32 v42, v42
    v_rcp_f32 v43, v43
    v_rcp_f32 v44, v44
    v_rcp_f32 v45, v45
    v_rcp_f32 v46, v46
    v_rcp_f32 v47, v47
    v_pk_mul_f32 v[96:97], v[96:97], v[40:41]
    v_pk_mul_f32 v[98:99], v[98:99], v[42:43]
    v_pk_mul_f32 v[100:101], v[100:101], v[44:45]
    v_pk_mul_f32 v[102:103], v[102:103], v[46:47]
    v_cvt_pk_bf16_f32 v96, v96, v97
    v_cvt_pk_bf16_f32 v97, v98, v99
    v_cvt_pk_bf16_f32 v98, v100, v101
    v_cvt_pk_bf16_f32 v99, v102, v103
    buffer_store_dwordx4 v[96:99], v5, s[4:7], s37 offen offset:0 sc1
    v_pk_mul_f32 v[48:49], v[104:105], v[104:105]
    v_pk_mul_f32 v[50:51], v[106:107], v[106:107]
    v_pk_mul_f32 v[52:53], v[108:109], v[108:109]
    v_pk_mul_f32 v[54:55], v[110:111], v[110:111]
    v_pk_fma_f32 v[48:49], v[48:49], v[56:57], v[56:57] op_sel:[0,1,0] op_sel_hi:[1,1,0]
    v_pk_fma_f32 v[50:51], v[50:51], v[56:57], v[56:57] op_sel:[0,1,0] op_sel_hi:[1,1,0]
    v_pk_fma_f32 v[52:53], v[52:53], v[56:57], v[56:57] op_sel:[0,1,0] op_sel_hi:[1,1,0]
    v_pk_fma_f32 v[54:55], v[54:55], v[56:57], v[56:57] op_sel:[0,1,0] op_sel_hi:[1,1,0]
    v_pk_mul_f32 v[48:49], v[48:49], v[104:105]
    v_pk_mul_f32 v[50:51], v[50:51], v[106:107]
    v_pk_mul_f32 v[52:53], v[52:53], v[108:109]
    v_pk_mul_f32 v[54:55], v[54:55], v[110:111]
    v_exp_f32 v48, v48
    v_exp_f32 v49, v49
    v_exp_f32 v50, v50
    v_exp_f32 v51, v51
    v_exp_f32 v52, v52
    v_exp_f32 v53, v53
    v_exp_f32 v54, v54
    v_exp_f32 v55, v55
    v_pk_fma_f32 v[48:49], v[48:49], v[58:59], v[58:59] op_sel_hi:[1,0,0]
    v_pk_fma_f32 v[50:51], v[50:51], v[58:59], v[58:59] op_sel_hi:[1,0,0]
    v_pk_fma_f32 v[52:53], v[52:53], v[58:59], v[58:59] op_sel_hi:[1,0,0]
    v_pk_fma_f32 v[54:55], v[54:55], v[58:59], v[58:59] op_sel_hi:[1,0,0]
    v_rcp_f32 v48, v48
    v_rcp_f32 v49, v49
    v_rcp_f32 v50, v50
    v_rcp_f32 v51, v51
    v_rcp_f32 v52, v52
    v_rcp_f32 v53, v53
    v_rcp_f32 v54, v54
    v_rcp_f32 v55, v55
    v_pk_mul_f32 v[104:105], v[104:105], v[48:49]
    v_pk_mul_f32 v[106:107], v[106:107], v[50:51]
    v_pk_mul_f32 v[108:109], v[108:109], v[52:53]
    v_pk_mul_f32 v[110:111], v[110:111], v[54:55]
    v_cvt_pk_bf16_f32 v104, v104, v105
    v_cvt_pk_bf16_f32 v105, v106, v107
    v_cvt_pk_bf16_f32 v106, v108, v109
    v_cvt_pk_bf16_f32 v107, v110, v111
    buffer_store_dwordx4 v[104:107], v5, s[4:7], s37 offen offset:256 sc1
    s_add_u32 s44, s101, 131072
    v_lshrrev_b32 v48, 2, v0
    v_add_u32 v48, s44, v48
    v_xor_b32 v49, 16, v48
    v_xor_b32 v50, 0x80, v48
    v_xor_b32 v51, 0x90, v48
    s_lshr_b32 s44, s16, 1
    s_lshl_b32 s44, s44, 12
    s_and_b32 s45, s16, 1
    s_lshl_b32 s45, s45, 7
    s_add_u32 s44, s44, s45
    s_add_u32 s44, s44, 131072
    v_bfe_u32 v52, v0, 8, 2
    v_lshl_add_u32 v57, v52, 10, s44
    v_bfe_u32 v52, v0, 4, 2
    v_lshl_add_u32 v57, v52, 8, v57
    v_and_b32 v52, 0x50, v0
    v_add_u32 v57, v57, v52
    v_bfe_u32 v52, v0, 7, 1
    v_lshl_add_u32 v57, v52, 5, v57
    v_and_b32 v52, 0x20, v0
    v_lshlrev_b32 v52, 2, v52
    v_xor_b32 v57, v57, v52
    v_xor_b32 v58, 16, v57
    v_subrev_u32 v52, 98304, v48
    v_subrev_u32 v53, 98304, v49
    v_subrev_u32 v54, 98304, v50
    v_subrev_u32 v55, 98304, v51
    s_add_u32 s45, s98, 3
    s_mov_b64 exec, 1
    v_mov_b32 v56, s45
    s_waitcnt vmcnt(0)
    buffer_store_dword v56, off, s[4:7], s38 offset:0
    s_mov_b64 exec, -1
    s_add_u32 s45, s98, 3
    s_mov_b32 exec_hi, 0
    s_mov_b32 exec_lo, s95
    s_mov_b32 s50, 0
Lpoll_15:
    buffer_load_dword v56, v21, s[4:7], s40 offen sc1
    s_add_u32 s50, s50, 1
    s_cmp_gt_u32 s50, 0x40000
    s_cbranch_scc1 Labort
    s_waitcnt vmcnt(0)
    v_cmp_ne_u32 vcc, s45, v56
    s_cbranch_vccnz Lpoll_15
    s_mov_b64 exec, -1
    v_add_u32 v60, s23, v1
    v_add_u32 v61, s23, v0
    s_add_u32 s51, s39, 0
    buffer_load_dwordx4 v[128:131], v0, s[4:7], s51 offen offset:0 sc1
    buffer_load_dwordx4 v[132:135], v0, s[4:7], s51 offen offset:2048 sc1
    s_add_u32 s51, s39, 4096
    buffer_load_dwordx4 v[136:139], v0, s[4:7], s51 offen offset:0 sc1
    buffer_load_dwordx4 v[140:143], v0, s[4:7], s51 offen offset:2048 sc1
    s_add_u32 s51, s39, 8192
    buffer_load_dwordx4 v[144:147], v0, s[4:7], s51 offen offset:0 sc1
    buffer_load_dwordx4 v[148:151], v0, s[4:7], s51 offen offset:2048 sc1
    s_add_u32 s51, s39, 12288
    buffer_load_dwordx4 v[152:155], v0, s[4:7], s51 offen offset:0 sc1
    buffer_load_dwordx4 v[156:159], v0, s[4:7], s51 offen offset:2048 sc1
    s_add_u32 s51, s39, 16384
    buffer_load_dwordx4 v[160:163], v0, s[4:7], s51 offen offset:0 sc1
    buffer_load_dwordx4 v[164:167], v0, s[4:7], s51 offen offset:2048 sc1
    s_barrier
    s_waitcnt vmcnt(9)
    v_mfma_f32_16x16x32_bf16 v[64:67], v[128:131], a[64:67], 0
    s_add_u32 s51, s39, 20480
    s_cmp_eq_u32 s16, 3
    s_cselect_b32 s51, 268435456, s51
    buffer_load_dwordx4 v[168:171], v0, s[4:7], s51 offen offset:0 sc1
    v_mfma_f32_16x16x32_bf16 v[68:71], v[128:131], a[68:71], 0
    v_mfma_f32_16x16x32_bf16 v[72:75], v[128:131], a[72:75], 0
    v_mfma_f32_16x16x32_bf16 v[76:79], v[128:131], a[76:79], 0
    s_waitcnt vmcnt(9)
    v_mfma_f32_16x16x32_bf16 v[64:67], v[132:135], a[80:83], v[64:67]
    s_add_u32 s51, s39, 1024
    buffer_load_dwordx4 v[172:175], v0, s[4:7], s51 offen offset:0 sc1
    v_mfma_f32_16x16x32_bf16 v[68:71], v[132:135], a[84:87], v[68:71]
    v_mfma_f32_16x16x32_bf16 v[72:75], v[132:135], a[88:91], v[72:75]
    v_mfma_f32_16x16x32_bf16 v[76:79], v[132:135], a[92:95], v[76:79]
    ds_write_b128 v60, v[192:195] offset:32768
    s_waitcnt vmcnt(9)
    v_mfma_f32_16x16x32_bf16 v[64:67], v[136:139], a[96:99], v[64:67]
    buffer_load_dwordx4 v[176:179], v0, s[4:7], s51 offen offset:2048 sc1
    v_mfma_f32_16x16x32_bf16 v[68:71], v[136:139], a[100:103], v[68:71]
    v_mfma_f32_16x16x32_bf16 v[72:75], v[136:139], a[104:107], v[72:75]
    v_mfma_f32_16x16x32_bf16 v[76:79], v[136:139], a[108:111], v[76:79]
    ds_write_b128 v60, v[196:199] offset:33792
    s_waitcnt vmcnt(9)
    v_mfma_f32_16x16x32_bf16 v[64:67], v[140:143], a[112:115], v[64:67]
    s_add_u32 s51, s39, 5120
    buffer_load_dwordx4 v[180:183], v0, s[4:7], s51 offen offset:0 sc1
    v_mfma_f32_16x16x32_bf16 v[68:71], v[140:143], a[116:119], v[68:71]
    v_mfma_f32_16x16x32_bf16 v[72:75], v[140:143], a[120:123], v[72:75]
    v_mfma_f32_16x16x32_bf16 v[76:79], v[140:143], a[124:127], v[76:79]
    ds_write_b128 v60, v[200:203] offset:34816
    s_waitcnt vmcnt(9)
    v_mfma_f32_16x16x32_bf16 v[64:67], v[144:147], a[128:131], v[64:67]
    buffer_load_dwordx4 v[184:187], v0, s[4:7], s51 offen offset:2048 sc1
    v_mfma_f32_16x16x32_bf16 v[68:71], v[144:147], a[132:135], v[68:71]
    v_mfma_f32_16x16x32_bf16 v[72:75], v[144:147], a[136:139], v[72:75]
    v_mfma_f32_16x16x32_bf16 v[76:79], v[144:147], a[140:143], v[76:79]
    ds_write_b128 v60, v[204:207] offset:35840
    s_waitcnt vmcnt(9)
    v_mfma_f32_16x16x32_bf16 v[64:67], v[148:151], a[144:147], v[64:67]
    s_add_u32 s51, s39, 9216
    buffer_load_dwordx4 v[188:191], v0, s[4:7], s51 offen offset:0 sc1
    v_mfma_f32_16x16x32_bf16 v[68:71], v[148:151], a[148:151], v[68:71]
    v_mfma_f32_16x16x32_bf16 v[72:75], v[148:151], a[152:155], v[72:75]
    v_mfma_f32_16x16x32_bf16 v[76:79], v[148:151], a[156:159], v[76:79]
    ds_write_b128 v60, v[208:211] offset:49152
    s_waitcnt vmcnt(9)
    v_mfma_f32_16x16x32_bf16 v[64:67], v[152:155], a[160:163], v[64:67]
    buffer_load_dwordx4 v[128:131], v0, s[4:7], s51 offen offset:2048 sc1
    v_mfma_f32_16x16x32_bf16 v[68:71], v[152:155], a[164:167], v[68:71]
    v_mfma_f32_16x16x32_bf16 v[72:75], v[152:155], a[168:171], v[72:75]
    v_mfma_f32_16x16x32_bf16 v[76:79], v[152:155], a[172:175], v[76:79]
    ds_write_b128 v60, v[212:215] offset:50176
    s_waitcnt vmcnt(9)
    v_mfma_f32_16x16x32_bf16 v[64:67], v[156:159], a[176:179], v[64:67]
    s_add_u32 s51, s39, 13312
    buffer_load_dwordx4 v[132:135], v0, s[4:7], s51 offen offset:0 sc1
    v_mfma_f32_16x16x32_bf16 v[68:71], v[156:159], a[180:183], v[68:71]
    v_mfma_f32_16x16x32_bf16 v[72:75], v[156:159], a[184:187], v[72:75]
    v_mfma_f32_16x16x32_bf16 v[76:79], v[156:159], a[188:191], v[76:79]
    ds_write_b128 v60, v[216:219] offset:51200
    s_waitcnt vmcnt(9)
    v_mfma_f32_16x16x32_bf16 v[64:67], v[160:163], a[192:195], v[64:67]
    buffer_load_dwordx4 v[136:139], v0, s[4:7], s51 offen offset:2048 sc1
    v_mfma_f32_16x16x32_bf16 v[68:71], v[160:163], a[196:199], v[68:71]
    v_mfma_f32_16x16x32_bf16 v[72:75], v[160:163], a[200:203], v[72:75]
    v_mfma_f32_16x16x32_bf16 v[76:79], v[160:163], a[204:207], v[76:79]
    ds_write_b128 v60, v[220:223] offset:52224
    s_waitcnt vmcnt(9)
    v_mfma_f32_16x16x32_bf16 v[64:67], v[164:167], a[208:211], v[64:67]
    s_add_u32 s51, s39, 17408
    buffer_load_dwordx4 v[140:143], v0, s[4:7], s51 offen offset:0 sc1
    v_mfma_f32_16x16x32_bf16 v[68:71], v[164:167], a[212:215], v[68:71]
    v_mfma_f32_16x16x32_bf16 v[72:75], v[164:167], a[216:219], v[72:75]
    v_mfma_f32_16x16x32_bf16 v[76:79], v[164:167], a[220:223], v[76:79]
    s_waitcnt vmcnt(9)
    v_mfma_f32_16x16x32_bf16 v[64:67], v[168:171], a[224:227], v[64:67]
    buffer_load_dwordx4 v[144:147], v0, s[4:7], s51 offen offset:2048 sc1
    v_mfma_f32_16x16x32_bf16 v[68:71], v[168:171], a[228:231], v[68:71]
    v_mfma_f32_16x16x32_bf16 v[72:75], v[168:171], a[232:235], v[72:75]
    v_mfma_f32_16x16x32_bf16 v[76:79], v[168:171], a[236:239], v[76:79]
    s_waitcnt vmcnt(9)
    v_mfma_f32_16x16x32_bf16 v[80:83], v[172:175], a[64:67], 0
    s_add_u32 s51, s39, 21504
    s_cmp_eq_u32 s16, 3
    s_cselect_b32 s51, 268435456, s51
    buffer_load_dwordx4 v[148:151], v0, s[4:7], s51 offen offset:0 sc1
    ds_write_b32 v48, v64 offset:0
    v_mfma_f32_16x16x32_bf16 v[84:87], v[172:175], a[68:71], 0
    ds_write_b32 v49, v65 offset:256
    v_mfma_f32_16x16x32_bf16 v[88:91], v[172:175], a[72:75], 0
    ds_write_b32 v50, v66 offset:512
    v_mfma_f32_16x16x32_bf16 v[92:95], v[172:175], a[76:79], 0
    ds_write_b32 v51, v67 offset:768
    s_waitcnt vmcnt(9)
    v_mfma_f32_16x16x32_bf16 v[80:83], v[176:179], a[80:83], v[80:83]
    s_add_u32 s51, s39, 88064
    buffer_load_dwordx4 v[152:155], v0, s[4:7], s51 offen offset:0 sc1
    ds_write_b32 v48, v68 offset:1024
    v_mfma_f32_16x16x32_bf16 v[84:87], v[176:179], a[84:87], v[84:87]
    ds_write_b32 v49, v69 offset:1280
    v_mfma_f32_16x16x32_bf16 v[88:91], v[176:179], a[88:91], v[88:91]
    ds_write_b32 v50, v70 offset:1536
    v_mfma_f32_16x16x32_bf16 v[92:95], v[176:179], a[92:95], v[92:95]
    ds_write_b32 v51, v71 offset:1792
    s_waitcnt vmcnt(9)
    v_mfma_f32_16x16x32_bf16 v[80:83], v[180:183], a[96:99], v[80:83]
    buffer_load_dwordx4 v[156:159], v0, s[4:7], s51 offen offset:2048 sc1
    ds_write_b32 v48, v72 offset:2048
    v_mfma_f32_16x16x32_bf16 v[84:87], v[180:183], a[100:103], v[84:87]
    ds_write_b32 v49, v73 offset:2304
    v_mfma_f32_16x16x32_bf16 v[88:91], v[180:183], a[104:107], v[88:91]
    ds_write_b32 v50, v74 offset:2560
    v_mfma_f32_16x16x32_bf16 v[92:95], v[180:183], a[108:111], v[92:95]
    ds_write_b32 v51, v75 offset:2816
    s_waitcnt vmcnt(9)
    v_mfma_f32_16x16x32_bf16 v[80:83], v[184:187], a[112:115], v[80:83]
    s_add_u32 s51, s39, 92160
    buffer_load_dwordx4 v[160:163], v0, s[4:7], s51 offen offset:0 sc1
    ds_write_b32 v48, v76 offset:3072
    v_mfma_f32_16x16x32_bf16 v[84:87], v[184:187], a[116:119], v[84:87]
    ds_write_b32 v49, v77 offset:3328
    v_mfma_f32_16x16x32_bf16 v[88:91], v[184:187], a[120:123], v[88:91]
    ds_write_b32 v50, v78 offset:3584
    v_mfma_f32_16x16x32_bf16 v[92:95], v[184:187], a[124:127], v[92:95]
    ds_write_b32 v51, v79 offset:3840
    s_waitcnt vmcnt(9)
    v_mfma_f32_16x16x32_bf16 v[80:83], v[188:191], a[128:131], v[80:83]
    buffer_load_dwordx4 v[164:167], v0, s[4:7], s51 offen offset:2048 sc1
    v_mfma_f32_16x16x32_bf16 v[84:87], v[188:191], a[132:135], v[84:87]
    v_mfma_f32_16x16x32_bf16 v[88:91], v[188:191], a[136:139], v[88:91]
    v_mfma_f32_16x16x32_bf16 v[92:95], v[188:191], a[140:143], v[92:95]
    s_waitcnt vmcnt(9)
    v_mfma_f32_16x16x32_bf16 v[80:83], v[128:131], a[144:147], v[80:83]
    s_add_u32 s51, s39, 96256
    buffer_load_dwordx4 v[168:171], v0, s[4:7], s51 offen offset:0 sc1
    v_mfma_f32_16x16x32_bf16 v[84:87], v[128:131], a[148:151], v[84:87]
    v_mfma_f32_16x16x32_bf16 v[88:91], v[128:131], a[152:155], v[88:91]
    v_mfma_f32_16x16x32_bf16 v[92:95], v[128:131], a[156:159], v[92:95]
    s_waitcnt vmcnt(9)
    v_mfma_f32_16x16x32_bf16 v[80:83], v[132:135], a[160:163], v[80:83]
    buffer_load_dwordx4 v[172:175], v0, s[4:7], s51 offen offset:2048 sc1
    v_mfma_f32_16x16x32_bf16 v[84:87], v[132:135], a[164:167], v[84:87]
    v_mfma_f32_16x16x32_bf16 v[88:91], v[132:135], a[168:171], v[88:91]
    v_mfma_f32_16x16x32_bf16 v[92:95], v[132:135], a[172:175], v[92:95]
    s_waitcnt vmcnt(9)
    v_mfma_f32_16x16x32_bf16 v[80:83], v[136:139], a[176:179], v[80:83]
    s_add_u32 s51, s39, 100352
    buffer_load_dwordx4 v[176:179], v0, s[4:7], s51 offen offset:0 sc1
    v_mfma_f32_16x16x32_bf16 v[84:87], v[136:139], a[180:183], v[84:87]
    v_mfma_f32_16x16x32_bf16 v[88:91], v[136:139], a[184:187], v[88:91]
    v_mfma_f32_16x16x32_bf16 v[92:95], v[136:139], a[188:191], v[92:95]
    s_waitcnt vmcnt(9)
    v_mfma_f32_16x16x32_bf16 v[80:83], v[140:143], a[192:195], v[80:83]
    buffer_load_dwordx4 v[180:183], v0, s[4:7], s51 offen offset:2048 sc1
    v_mfma_f32_16x16x32_bf16 v[84:87], v[140:143], a[196:199], v[84:87]
    v_mfma_f32_16x16x32_bf16 v[88:91], v[140:143], a[200:203], v[88:91]
    v_mfma_f32_16x16x32_bf16 v[92:95], v[140:143], a[204:207], v[92:95]
    s_waitcnt vmcnt(9)
    v_mfma_f32_16x16x32_bf16 v[80:83], v[144:147], a[208:211], v[80:83]
    s_add_u32 s51, s39, 104448
    buffer_load_dwordx4 v[184:187], v0, s[4:7], s51 offen offset:0 sc1
    v_mfma_f32_16x16x32_bf16 v[84:87], v[144:147], a[212:215], v[84:87]
    v_mfma_f32_16x16x32_bf16 v[88:91], v[144:147], a[216:219], v[88:91]
    v_mfma_f32_16x16x32_bf16 v[92:95], v[144:147], a[220:223], v[92:95]
    s_waitcnt vmcnt(9)
    v_mfma_f32_16x16x32_bf16 v[80:83], v[148:151], a[224:227], v[80:83]
    buffer_load_dwordx4 v[188:191], v0, s[4:7], s51 offen offset:2048 sc1
    v_mfma_f32_16x16x32_bf16 v[84:87], v[148:151], a[228:231], v[84:87]
    v_mfma_f32_16x16x32_bf16 v[88:91], v[148:151], a[232:235], v[88:91]
    v_mfma_f32_16x16x32_bf16 v[92:95], v[148:151], a[236:239], v[92:95]
    s_waitcnt vmcnt(9)
    v_mfma_f32_16x16x32_bf16 v[96:99], v[152:155], a[64:67], 0
    s_add_u32 s51, s39, 108544
    s_cmp_eq_u32 s16, 3
    s_cselect_b32 s51, 268435456, s51
    buffer_load_dwordx4 v[128:131], v0, s[4:7], s51 offen offset:0 sc1
    ds_write_b32 v48, v80 offset:4096
    v_mfma_f32_16x16x32_bf16 v[100:103], v[152:155], a[68:71], 0
    ds_write_b32 v49, v81 offset:4352
    v_mfma_f32_16x16x32_bf16 v[104:107], v[152:155], a[72:75], 0
    ds_write_b32 v50, v82 offset:4608
    v_mfma_f32_16x16x32_bf16 v[108:111], v[152:155], a[76:79], 0
    ds_write_b32 v51, v83 offset:4864
    s_waitcnt vmcnt(9)
    v_mfma_f32_16x16x32_bf16 v[96:99], v[156:159], a[80:83], v[96:99]
    s_add_u32 s51, s39, 89088
    buffer_load_dwordx4 v[132:135], v0, s[4:7], s51 offen offset:0 sc1
    ds_write_b32 v48, v84 offset:5120
    v_mfma_f32_16x16x32_bf16 v[100:103], v[156:159], a[84:87], v[100:103]
    ds_write_b32 v49, v85 offset:5376
    v_mfma_f32_16x16x32_bf16 v[104:107], v[156:159], a[88:91], v[104:107]
    ds_write_b32 v50, v86 offset:5632
    v_mfma_f32_16x16x32_bf16 v[108:111], v[156:159], a[92:95], v[108:111]
    ds_write_b32 v51, v87 offset:5888
    s_waitcnt vmcnt(9)
    v_mfma_f32_16x16x32_bf16 v[96:99], v[160:163], a[96:99], v[96:99]
    buffer_load_dwordx4 v[136:139], v0, s[4:7], s51 offen offset:2048 sc1
    ds_write_b32 v48, v88 offset:6144
    v_mfma_f32_16x16x32_bf16 v[100:103], v[160:163], a[100:103], v[100:103]
    ds_write_b32 v49, v89 offset:6400
    v_mfma_f32_16x16x32_bf16 v[104:107], v[160:163], a[104:107], v[104:107]
    ds_write_b32 v50, v90 offset:6656
    v_mfma_f32_16x16x32_bf16 v[108:111], v[160:163], a[108:111], v[108:111]
    ds_write_b32 v51, v91 offset:6912
    s_waitcnt vmcnt(9)
    v_mfma_f32_16x16x32_bf16 v[96:99], v[164:167], a[112:115], v[96:99]
    s_add_u32 s51, s39, 93184
    buffer_load_dwordx4 v[140:143], v0, s[4:7], s51 offen offset:0 sc1
    ds_write_b32 v48, v92 offset:7168
    v_mfma_f32_16x16x32_bf16 v[100:103], v[164:167], a[116:119], v[100:103]
    ds_write_b32 v49, v93 offset:7424
    v_mfma_f32_16x16x32_bf16 v[104:107], v[164:167], a[120:123], v[104:107]
    ds_write_b32 v50, v94 offset:7680
    v_mfma_f32_16x16x32_bf16 v[108:111], v[164:167], a[124:127], v[108:111]
    ds_write_b32 v51, v95 offset:7936
    s_waitcnt vmcnt(9)
    v_mfma_f32_16x16x32_bf16 v[96:99], v[168:171], a[128:131], v[96:99]
    buffer_load_dwordx4 v[144:147], v0, s[4:7], s51 offen offset:2048 sc1
    v_mfma_f32_16x16x32_bf16 v[100:103], v[168:171], a[132:135], v[100:103]
    v_mfma_f32_16x16x32_bf16 v[104:107], v[168:171], a[136:139], v[104:107]
    v_mfma_f32_16x16x32_bf16 v[108:111], v[168:171], a[140:143], v[108:111]
    s_waitcnt lgkmcnt(0)
    s_barrier
    s_waitcnt vmcnt(9)
    v_mfma_f32_16x16x32_bf16 v[96:99], v[172:175], a[144:147], v[96:99]
    s_add_u32 s51, s39, 97280
    buffer_load_dwordx4 v[148:151], v0, s[4:7], s51 offen offset:0 sc1
    v_mfma_f32_16x16x32_bf16 v[100:103], v[172:175], a[148:151], v[100:103]
    ds_read_b128 v[64:67], v57 offset:0
    ds_read_b128 v[68:71], v58 offset:0
    v_mfma_f32_16x16x32_bf16 v[104:107], v[172:175], a[152:155], v[104:107]
    ds_read_b128 v[72:75], v57 offset:8192
    ds_read_b128 v[76:79], v58 offset:8192
    v_mfma_f32_16x16x32_bf16 v[108:111], v[172:175], a[156:159], v[108:111]
    ds_read_b128 v[80:83], v57 offset:16384
    s_waitcnt vmcnt(9)
    v_mfma_f32_16x16x32_bf16 v[96:99], v[176:179], a[160:163], v[96:99]
    buffer_load_dwordx4 v[152:155], v0, s[4:7], s51 offen offset:2048 sc1
    ds_read_b128 v[84:87], v58 offset:16384
    v_mfma_f32_16x16x32_bf16 v[100:103], v[176:179], a[164:167], v[100:103]
    ds_read_b128 v[88:91], v57 offset:24576
    ds_read_b128 v[92:95], v58 offset:24576
    v_mfma_f32_16x16x32_bf16 v[104:107], v[176:179], a[168:171], v[104:107]
    v_subrev_u32 v57, 98304, v57
    v_subrev_u32 v58, 98304, v58
    v_mfma_f32_16x16x32_bf16 v[108:111], v[176:179], a[172:175], v[108:111]
    s_nop 0
    s_waitcnt vmcnt(9)
    v_mfma_f32_16x16x32_bf16 v[96:99], v[180:183], a[176:179], v[96:99]
    s_add_u32 s51, s39, 101376
    buffer_load_dwordx4 v[156:159], v0, s[4:7], s51 offen offset:0 sc1
    v_mfma_f32_16x16x32_bf16 v[100:103], v[180:183], a[180:183], v[100:103]
    s_nop 0
    s_nop 0
    v_mfma_f32_16x16x32_bf16 v[104:107], v[180:183], a[184:187], v[104:107]
    s_nop 0
    s_waitcnt lgkmcnt(0)
    v_mfma_f32_16x16x32_bf16 v[108:111], v[180:183], a[188:191], v[108:111]
    v_add_f32 v24, v24, v64
    s_waitcnt vmcnt(9)
    v_mfma_f32_16x16x32_bf16 v[96:99], v[184:187], a[192:195], v[96:99]
    buffer_load_dwordx4 v[160:163], v0, s[4:7], s51 offen offset:2048 sc1
    v_add_f32 v25, v25, v65
    v_mfma_f32_16x16x32_bf16 v[100:103], v[184:187], a[196:199], v[100:103]
    v_add_f32 v26, v26, v66
    v_add_f32 v27, v27, v67
    v_mfma_f32_16x16x32_bf16 v[104:107], v[184:187], a[200:203], v[104:107]
    v_add_f32 v28, v28, v68
    v_add_f32 v29, v29, v69
    v_mfma_f32_16x16x32_bf16 v[108:111], v[184:187], a[204:207], v[108:111]
    v_add_f32 v30, v30, v70
    s_waitcnt vmcnt(9)
    v_mfma_f32_16x16x32_bf16 v[96:99], v[188:191], a[208:211], v[96:99]
    s_add_u32 s51, s39, 105472
    buffer_load_dwordx4 v[164:167], v0, s[4:7], s51 offen offset:0 sc1
    v_mfma_f32_16x16x32_bf16 v[100:103], v[188:191], a[212:215], v[100:103]
    v_add_f32 v31, v31, v71
    v_add_f32 v24, v24, v72
    v_mfma_f32_16x16x32_bf16 v[104:107], v[188:191], a[216:219], v[104:107]
    v_add_f32 v25, v25, v73
    v_add_f32 v26, v26, v74
    v_mfma_f32_16x16x32_bf16 v[108:111], v[188:191], a[220:223], v[108:111]
    v_add_f32 v27, v27, v75
    s_waitcnt vmcnt(9)
    v_mfma_f32_16x16x32_bf16 v[96:99], v[128:131], a[224:227], v[96:99]
    buffer_load_dwordx4 v[168:171], v0, s[4:7], s51 offen offset:2048 sc1
    v_add_f32 v28, v28, v76
    v_mfma_f32_16x16x32_bf16 v[100:103], v[128:131], a[228:231], v[100:103]
    v_add_f32 v29, v29, v77
    v_add_f32 v30, v30, v78
    v_mfma_f32_16x16x32_bf16 v[104:107], v[128:131], a[232:235], v[104:107]
    v_add_f32 v31, v31, v79
    v_add_f32 v24, v24, v80
    v_mfma_f32_16x16x32_bf16 v[108:111], v[128:131], a[236:239], v[108:111]
    v_add_f32 v25, v25, v81
    s_waitcnt vmcnt(9)
    v_mfma_f32_16x16x32_bf16 v[112:115], v[132:135], a[64:67], 0
    s_add_u32 s51, s39, 109568
    s_cmp_eq_u32 s16, 3
    s_cselect_b32 s51, 268435456, s51
    buffer_load_dwordx4 v[172:175], v0, s[4:7], s51 offen offset:0 sc1
    ds_write_b32 v52, v96 offset:0
    v_mfma_f32_16x16x32_bf16 v[116:119], v[132:135], a[68:71], 0
    ds_write_b32 v53, v97 offset:256
    v_add_f32 v26, v26, v82
    v_mfma_f32_16x16x32_bf16 v[120:123], v[132:135], a[72:75], 0
    ds_write_b32 v54, v98 offset:512
    v_add_f32 v27, v27, v83
    v_mfma_f32_16x16x32_bf16 v[124:127], v[132:135], a[76:79], 0
    ds_write_b32 v55, v99 offset:768
    s_waitcnt vmcnt(9)
    v_mfma_f32_16x16x32_bf16 v[112:115], v[136:139], a[80:83], v[112:115]
    ds_write_b32 v52, v100 offset:1024
    v_add_f32 v28, v28, v84
    v_mfma_f32_16x16x32_bf16 v[116:119], v[136:139], a[84:87], v[116:119]
    ds_write_b32 v53, v101 offset:1280
    v_add_f32 v29, v29, v85
    v_mfma_f32_16x16x32_bf16 v[120:123], v[136:139], a[88:91], v[120:123]
    ds_write_b32 v54, v102 offset:1536
    v_add_f32 v30, v30, v86
    v_mfma_f32_16x16x32_bf16 v[124:127], v[136:139], a[92:95], v[124:127]
    ds_write_b32 v55, v103 offset:1792
    s_waitcnt vmcnt(8)
    v_mfma_f32_16x16x32_bf16 v[112:115], v[140:143], a[96:99], v[112:115]
    ds_write_b32 v52, v104 offset:2048
    v_add_f32 v31, v31, v87
    v_mfma_f32_16x16x32_bf16 v[116:119], v[140:143], a[100:103], v[116:119]
    ds_write_b32 v53, v105 offset:2304
    v_add_f32 v24, v24, v88
    v_mfma_f32_16x16x32_bf16 v[120:123], v[140:143], a[104:107], v[120:123]
    ds_write_b32 v54, v106 offset:2560
    v_add_f32 v25, v25, v89
    v_mfma_f32_16x16x32_bf16 v[124:127], v[140:143], a[108:111], v[124:127]
    ds_write_b32 v55, v107 offset:2816
    s_waitcnt vmcnt(7)
    v_mfma_f32_16x16x32_bf16 v[112:115], v[144:147], a[112:115], v[112:115]
    ds_write_b32 v52, v108 offset:3072
    v_add_f32 v26, v26, v90
    v_mfma_f32_16x16x32_bf16 v[116:119], v[144:147], a[116:119], v[116:119]
    ds_write_b32 v53, v109 offset:3328
    v_add_f32 v27, v27, v91
    v_mfma_f32_16x16x32_bf16 v[120:123], v[144:147], a[120:123], v[120:123]
    ds_write_b32 v54, v110 offset:3584
    v_add_f32 v28, v28, v92
    v_mfma_f32_16x16x32_bf16 v[124:127], v[144:147], a[124:127], v[124:127]
    ds_write_b32 v55, v111 offset:3840
    s_waitcnt vmcnt(6)
    v_mfma_f32_16x16x32_bf16 v[112:115], v[148:151], a[128:131], v[112:115]
    v_add_f32 v29, v29, v93
    v_add_f32 v30, v30, v94
    v_mfma_f32_16x16x32_bf16 v[116:119], v[148:151], a[132:135], v[116:119]
    v_add_f32 v31, v31, v95
    v_cvt_pk_bf16_f32 v40, v24, v25
    v_mfma_f32_16x16x32_bf16 v[120:123], v[148:151], a[136:139], v[120:123]
    v_cvt_pk_bf16_f32 v41, v26, v27
    v_cvt_pk_bf16_f32 v42, v28, v29
    v_mfma_f32_16x16x32_bf16 v[124:127], v[148:151], a[140:143], v[124:127]
    v_cvt_pk_bf16_f32 v43, v30, v31
    s_waitcnt vmcnt(5)
    v_mfma_f32_16x16x32_bf16 v[112:115], v[152:155], a[144:147], v[112:115]
    buffer_store_dwordx4 v[40:43], v19, s[8:11], s33 offen
    v_mfma_f32_16x16x32_bf16 v[116:119], v[152:155], a[148:151], v[116:119]
    v_add_f32 v64, v24, v25
    v_mul_f32 v65, v24, v24
    v_mfma_f32_16x16x32_bf16 v[120:123], v[152:155], a[152:155], v[120:123]
    v_fmac_f32 v65, v25, v25
    v_add_f32 v64, v64, v26
    v_mfma_f32_16x16x32_bf16 v[124:127], v[152:155], a[156:159], v[124:127]
    v_fmac_f32 v65, v26, v26
    s_waitcnt vmcnt(5)
    v_mfma_f32_16x16x32_bf16 v[112:115], v[156:159], a[160:163], v[112:115]
    v_add_f32 v64, v64, v27
    v_fmac_f32 v65, v27, v27
    v_mfma_f32_16x16x32_bf16 v[116:119], v[156:159], a[164:167], v[116:119]
    v_add_f32 v64, v64, v28
    v_fmac_f32 v65, v28, v28
    v_mfma_f32_16x16x32_bf16 v[120:123], v[156:159], a[168:171], v[120:123]
    v_add_f32 v64, v64, v29
    v_fmac_f32 v65, v29, v29
    v_mfma_f32_16x16x32_bf16 v[124:127], v[156:159], a[172:175], v[124:127]
    v_add_f32 v64, v64, v30
    s_waitcnt vmcnt(4)
    v_mfma_f32_16x16x32_bf16 v[112:115], v[160:163], a[176:179], v[112:115]
    v_fmac_f32 v65, v30, v30
    s_waitcnt vmcnt(3)
    v_mfma_f32_16x16x32_bf16 v[112:115], v[164:167], a[192:195], v[112:115]
    v_add_f32 v64, v64, v31
    s_waitcnt vmcnt(2)
    v_mfma_f32_16x16x32_bf16 v[112:115], v[168:171], a[208:211], v[112:115]
    v_fmac_f32 v65, v31, v31
    s_waitcnt vmcnt(1)
    v_mfma_f32_16x16x32_bf16 v[112:115], v[172:175], a[224:227], v[112:115]
    v_permlane16_swap_b32 v64, v65
    v_add_f32 v64, v64, v65
    v_mfma_f32_16x16x32_bf16 v[116:119], v[160:163], a[180:183], v[116:119]
    s_nop 0
    v_add_f32_dpp v65, v64, v64 row_ror:8 row_mask:0xf bank_mask:0xf
    v_add_f32_dpp v64, v64, v64 row_ror:8 row_mask:0xf bank_mask:0xf
    v_mfma_f32_16x16x32_bf16 v[116:119], v[164:167], a[196:199], v[116:119]
    s_nop 0
    v_permlane32_swap_b32 v64, v65
    v_add_f32 v64, v64, v65
    v_mfma_f32_16x16x32_bf16 v[116:119], v[168:171], a[212:215], v[116:119]
    s_mov_b64 exec, 0x00ff00ff
    buffer_store_dword v64, v20, s[4:7], s34 offen offset:0
    s_mov_b64 exec, -1
    v_mfma_f32_16x16x32_bf16 v[116:119], v[172:175], a[228:231], v[116:119]
    ds_write_b32 v52, v112 offset:4096
    v_mfma_f32_16x16x32_bf16 v[120:123], v[160:163], a[184:187], v[120:123]
    ds_write_b32 v53, v113 offset:4352
    v_mfma_f32_16x16x32_bf16 v[120:123], v[164:167], a[200:203], v[120:123]
    ds_write_b32 v54, v114 offset:4608
    v_mfma_f32_16x16x32_bf16 v[120:123], v[168:171], a[216:219], v[120:123]
    ds_write_b32 v55, v115 offset:4864
    v_mfma_f32_16x16x32_bf16 v[120:123], v[172:175], a[232:235], v[120:123]
    ds_write_b32 v52, v116 offset:5120
    v_mfma_f32_16x16x32_bf16 v[124:127], v[160:163], a[188:191], v[124:127]
    ds_write_b32 v53, v117 offset:5376
    v_mfma_f32_16x16x32_bf16 v[124:127], v[164:167], a[204:207], v[124:127]
    ds_write_b32 v54, v118 offset:5632
    v_mfma_f32_16x16x32_bf16 v[124:127], v[168:171], a[220:223], v[124:127]
    ds_write_b32 v55, v119 offset:5888
    v_mfma_f32_16x16x32_bf16 v[124:127], v[172:175], a[236:239], v[124:127]
    ds_write_b32 v52, v120 offset:6144
    ds_write_b32 v53, v121 offset:6400
    ds_write_b32 v54, v122 offset:6656
    ds_write_b32 v55, v123 offset:6912
    s_nop 3
    ds_write_b32 v52, v124 offset:7168
    ds_write_b32 v53, v125 offset:7424
    ds_write_b32 v54, v126 offset:7680
    ds_write_b32 v55, v127 offset:7936
    s_waitcnt lgkmcnt(0)
    s_barrier
    ds_read_b128 v[128:131], v57 offset:0
    ds_read_b128 v[132:135], v58 offset:0
    ds_read_b128 v[136:139], v57 offset:8192
    ds_read_b128 v[140:143], v58 offset:8192
    ds_read_b128 v[144:147], v57 offset:16384
    ds_read_b128 v[148:151], v58 offset:16384
    ds_read_b128 v[152:155], v57 offset:24576
    ds_read_b128 v[156:159], v58 offset:24576
    s_add_u32 s45, s98, 2
    s_mov_b64 exec, 1
    v_mov_b32 v56, s45
    s_waitcnt vmcnt(0)
    buffer_store_dword v56, off, s[4:7], s35 offset:0
    s_mov_b64 exec, -1
    s_waitcnt lgkmcnt(6)
    v_pk_add_f32 v[32:33], v[32:33], v[128:129]
    v_pk_add_f32 v[34:35], v[34:35], v[130:131]
    v_pk_add_f32 v[36:37], v[36:37], v[132:133]
    v_pk_add_f32 v[38:39], v[38:39], v[134:135]
    s_waitcnt lgkmcnt(4)
    v_pk_add_f32 v[32:33], v[32:33], v[136:137]
    v_pk_add_f32 v[34:35], v[34:35], v[138:139]
    v_pk_add_f32 v[36:37], v[36:37], v[140:141]
    v_pk_add_f32 v[38:39], v[38:39], v[142:143]
    s_waitcnt lgkmcnt(2)
    v_pk_add_f32 v[32:33], v[32:33], v[144:145]
    v_pk_add_f32 v[34:35], v[34:35], v[146:147]
    v_pk_add_f32 v[36:37], v[36:37], v[148:149]
    v_pk_add_f32 v[38:39], v[38:39], v[150:151]
    s_waitcnt lgkmcnt(0)
    v_pk_add_f32 v[32:33], v[32:33], v[152:153]
    v_pk_add_f32 v[34:35], v[34:35], v[154:155]
    v_pk_add_f32 v[36:37], v[36:37], v[156:157]
    v_pk_add_f32 v[38:39], v[38:39], v[158:159]
    v_cvt_pk_bf16_f32 v44, v32, v33
    v_cvt_pk_bf16_f32 v45, v34, v35
    v_cvt_pk_bf16_f32 v46, v36, v37
    v_cvt_pk_bf16_f32 v47, v38, v39
    buffer_store_dwordx4 v[44:47], v19, s[8:11], s96 offen
    v_pk_add_f32 v[128:129], v[32:33], v[34:35]
    v_pk_mul_f32 v[130:131], v[32:33], v[32:33]
    v_pk_add_f32 v[128:129], v[128:129], v[36:37]
    v_pk_fma_f32 v[130:131], v[34:35], v[34:35], v[130:131]
    v_pk_add_f32 v[128:129], v[128:129], v[38:39]
    v_pk_fma_f32 v[130:131], v[36:37], v[36:37], v[130:131]
    v_add_f32 v128, v128, v129
    v_pk_fma_f32 v[130:131], v[38:39], v[38:39], v[130:131]
    v_add_f32 v129, v130, v131
    s_nop 1
    v_permlane16_swap_b32 v128, v129
    v_add_f32 v128, v128, v129
    s_nop 1
    v_add_f32_dpp v129, v128, v128 row_ror:8 row_mask:0xf bank_mask:0xf
    v_add_f32_dpp v128, v128, v128 row_ror:8 row_mask:0xf bank_mask:0xf
    s_nop 1
    v_permlane32_swap_b32 v128, v129
    v_add_f32 v128, v128, v129
    s_mov_b64 exec, 0x00ff00ff
    buffer_store_dword v128, v20, s[4:7], s34 offen offset:2048
    s_mov_b64 exec, -1
    buffer_load_dword v22, v2, s[4:7], s26 offen sc1
    s_add_u32 s45, s98, 2
    s_mov_b64 exec, 1
    v_mov_b32 v56, s45
    s_waitcnt vmcnt(1)
    buffer_store_dword v56, off, s[4:7], s35 offset:128
    s_mov_b64 exec, -1
    s_barrier
    v_mov_b32 v55, v61
    v_mov_b32 v57, 0
    ds_write_b32 v2, v57
    s_add_u32 s27, s27, 524288
    s_add_u32 s28, s28, 65536
    ds_read_b64_tr_b16 v[96:97], v6 offset:0
    ds_read_b64_tr_b16 v[98:99], v6 offset:256
    ds_read_b64_tr_b16 v[100:101], v7 offset:0
    ds_read_b64_tr_b16 v[102:103], v7 offset:256
    ds_read_b64_tr_b16 v[104:105], v6 offset:512
    ds_read_b64_tr_b16 v[106:107], v6 offset:768
    ds_read_b64_tr_b16 v[108:109], v7 offset:512
    ds_read_b64_tr_b16 v[110:111], v7 offset:768
    s_add_u32 s45, s98, 2
    s_waitcnt vmcnt(1)
    v_cmp_ne_u32 vcc, s45, v22
    s_cmp_eq_u32 vcc_lo, 0
    s_cbranch_scc1 Lpolls_18
    s_add_u32 s45, s98, 2
    s_mov_b32 exec_hi, 0
    s_mov_b32 s50, 0
Lpoll_17:
    buffer_load_dword v56, v2, s[4:7], s26 offen sc1
    s_add_u32 s50, s50, 1
    s_cmp_gt_u32 s50, 0x40000
    s_cbranch_scc1 Labort
    s_waitcnt vmcnt(0)
    v_cmp_ne_u32 vcc, s45, v56
    s_cbranch_vccnz Lpoll_17
    s_mov_b64 exec, -1
Lpolls_18:
    s_add_u32 s51, s84, 0
    s_and_b32 s51, s51, 7
    s_lshl_b32 s51, s51, 12
    s_add_u32 s51, s51, s24
    buffer_load_dwordx4 v[128:131], v0, s[8:11], s51 offen offset:0 sc1
    buffer_load_dwordx4 v[132:135], v0, s[8:11], s51 offen offset:1024 sc1
    buffer_load_dwordx4 v[136:139], v0, s[8:11], s51 offen offset:2048 sc1
    buffer_load_dwordx4 v[140:143], v0, s[8:11], s51 offen offset:3072 sc1
    s_add_u32 s51, s84, 1
    s_and_b32 s51, s51, 7
    s_lshl_b32 s51, s51, 12
    s_add_u32 s51, s51, s24
    buffer_load_dwordx4 v[144:147], v0, s[8:11], s51 offen offset:0 sc1
    buffer_load_dwordx4 v[148:151], v0, s[8:11], s51 offen offset:1024 sc1
    ds_read_b64_tr_b16 v[112:113], v6 offset:2048
    ds_read_b64_tr_b16 v[114:115], v6 offset:2304
    ds_read_b64_tr_b16 v[116:117], v7 offset:2048
    ds_read_b64_tr_b16 v[118:119], v7 offset:2304
    s_waitcnt vmcnt(5) lgkmcnt(8)
    v_mfma_f32_32x32x16_bf16 v[64:79], v[96:99], v[128:131], 0
    ds_read_b64_tr_b16 v[96:97], v6 offset:2560
    ds_read_b64_tr_b16 v[98:99], v6 offset:2816
    buffer_load_dwordx4 v[152:155], v0, s[8:11], s51 offen offset:2048 sc1
    v_mfma_f32_32x32x16_bf16 v[80:95], v[100:103], v[128:131], 0
    ds_read_b64_tr_b16 v[100:101], v7 offset:2560
    ds_read_b64_tr_b16 v[102:103], v7 offset:2816
    ds_write_b128 v55, v[224:227] offset:32768
    s_waitcnt vmcnt(5) lgkmcnt(9)
    v_mfma_f32_32x32x16_bf16 v[64:79], v[104:107], v[132:135], v[64:79]
    ds_read_b64_tr_b16 v[104:105], v6 offset:4096
    ds_read_b64_tr_b16 v[106:107], v6 offset:4352
    buffer_load_dwordx4 v[156:159], v0, s[8:11], s51 offen offset:3072 sc1
    v_mfma_f32_32x32x16_bf16 v[80:95], v[108:111], v[132:135], v[80:95]
    ds_read_b64_tr_b16 v[108:109], v7 offset:4096
    ds_read_b64_tr_b16 v[110:111], v7 offset:4352
    ds_write_b128 v55, v[228:231] offset:33792
    s_waitcnt vmcnt(5) lgkmcnt(10)
    v_mfma_f32_32x32x16_bf16 v[64:79], v[112:115], v[136:139], v[64:79]
    ds_read_b64_tr_b16 v[112:113], v6 offset:4608
    ds_read_b64_tr_b16 v[114:115], v6 offset:4864
    s_add_u32 s51, s84, 2
    s_and_b32 s51, s51, 7
    s_lshl_b32 s51, s51, 12
    s_add_u32 s51, s51, s24
    buffer_load_dwordx4 v[160:163], v0, s[8:11], s51 offen offset:0 sc1
    v_mfma_f32_32x32x16_bf16 v[80:95], v[116:119], v[136:139], v[80:95]
    ds_read_b64_tr_b16 v[116:117], v7 offset:4608
    ds_read_b64_tr_b16 v[118:119], v7 offset:4864
    ds_write_b128 v55, v[232:235] offset:34816
    s_waitcnt vmcnt(5) lgkmcnt(11)
    v_mfma_f32_32x32x16_bf16 v[64:79], v[96:99], v[140:143], v[64:79]
    ds_read_b64_tr_b16 v[96:97], v6 offset:6144
    ds_read_b64_tr_b16 v[98:99], v6 offset:6400
    buffer_load_dwordx4 v[164:167], v0, s[8:11], s51 offen offset:1024 sc1
    buffer_load_dwordx4 v[168:171], v0, s[8:11], s51 offen offset:2048 sc1
    v_mfma_f32_32x32x16_bf16 v[80:95], v[100:103], v[140:143], v[80:95]
    ds_read_b64_tr_b16 v[100:101], v7 offset:6144
    ds_read_b64_tr_b16 v[102:103], v7 offset:6400
    ds_write_b128 v55, v[236:239] offset:35840
    s_waitcnt vmcnt(6) lgkmcnt(11)
    v_mfma_f32_32x32x16_bf16 v[64:79], v[104:107], v[144:147], v[64:79]
    ds_read_b64_tr_b16 v[104:105], v6 offset:6656
    ds_read_b64_tr_b16 v[106:107], v6 offset:6912
    buffer_load_dwordx4 v[172:175], v0, s[8:11], s51 offen offset:3072 sc1
    v_mfma_f32_32x32x16_bf16 v[80:95], v[108:111], v[144:147], v[80:95]
    ds_read_b64_tr_b16 v[108:109], v7 offset:6656
    ds_read_b64_tr_b16 v[110:111], v7 offset:6912
    ds_write_b128 v55, v[240:243] offset:49152
    s_waitcnt vmcnt(6) lgkmcnt(11)
    v_mfma_f32_32x32x16_bf16 v[64:79], v[112:115], v[148:151], v[64:79]
    ds_read_b64_tr_b16 v[112:113], v6 offset:8192
    ds_read_b64_tr_b16 v[114:115], v6 offset:8448
    s_add_u32 s51, s84, 3
    s_and_b32 s51, s51, 7
    s_lshl_b32 s51, s51, 12
    s_add_u32 s51, s51, s24
    buffer_load_dwordx4 v[176:179], v0, s[8:11], s51 offen offset:0 sc1
    v_mfma_f32_32x32x16_bf16 v[80:95], v[116:119], v[148:151], v[80:95]
    ds_read_b64_tr_b16 v[116:117], v7 offset:8192
    ds_read_b64_tr_b16 v[118:119], v7 offset:8448
    ds_write_b128 v55, v[244:247] offset:50176
    s_waitcnt vmcnt(6) lgkmcnt(11)
    v_mfma_f32_32x32x16_bf16 v[64:79], v[96:99], v[152:155], v[64:79]
    ds_read_b64_tr_b16 v[96:97], v6 offset:8704
    ds_read_b64_tr_b16 v[98:99], v6 offset:8960
    buffer_load_dwordx4 v[180:183], v0, s[8:11], s51 offen offset:1024 sc1
    buffer_load_dwordx4 v[184:187], v0, s[8:11], s51 offen offset:2048 sc1
    v_mfma_f32_32x32x16_bf16 v[80:95], v[100:103], v[152:155], v[80:95]
    ds_read_b64_tr_b16 v[100:101], v7 offset:8704
    ds_read_b64_tr_b16 v[102:103], v7 offset:8960
    ds_write_b128 v55, v[248:251] offset:51200
    s_waitcnt vmcnt(7) lgkmcnt(11)
    v_mfma_f32_32x32x16_bf16 v[64:79], v[104:107], v[156:159], v[64:79]
    ds_read_b64_tr_b16 v[104:105], v6 offset:10240
    ds_read_b64_tr_b16 v[106:107], v6 offset:10496
    buffer_load_dwordx4 v[188:191], v0, s[8:11], s51 offen offset:3072 sc1
    v_mfma_f32_32x32x16_bf16 v[80:95], v[108:111], v[156:159], v[80:95]
    ds_read_b64_tr_b16 v[108:109], v7 offset:10240
    ds_read_b64_tr_b16 v[110:111], v7 offset:10496
    ds_write_b128 v55, v[252:255] offset:52224
    s_waitcnt vmcnt(7) lgkmcnt(11)
    v_mfma_f32_32x32x16_bf16 v[64:79], v[112:115], v[160:163], v[64:79]
    ds_read_b64_tr_b16 v[112:113], v6 offset:10752
    ds_read_b64_tr_b16 v[114:115], v6 offset:11008
    s_add_u32 s51, s84, 4
    s_and_b32 s51, s51, 7
    s_lshl_b32 s51, s51, 12
    s_add_u32 s51, s51, s24
    buffer_load_dwordx4 v[192:195], v0, s[8:11], s51 offen offset:0 sc1
    v_mfma_f32_32x32x16_bf16 v[80:95], v[116:119], v[160:163], v[80:95]
    ds_read_b64_tr_b16 v[116:117], v7 offset:10752
    ds_read_b64_tr_b16 v[118:119], v7 offset:11008
    s_waitcnt vmcnt(7) lgkmcnt(10)
    v_mfma_f32_32x32x16_bf16 v[64:79], v[96:99], v[164:167], v[64:79]
    ds_read_b64_tr_b16 v[96:97], v6 offset:12288
    ds_read_b64_tr_b16 v[98:99], v6 offset:12544
    buffer_load_dwordx2 v[56:57], v3, s[4:7], s25 offen offset:0 sc1
    buffer_load_dwordx2 v[58:59], v3, s[4:7], s25 offen offset:256 sc1
    v_mfma_f32_32x32x16_bf16 v[80:95], v[100:103], v[164:167], v[80:95]
    ds_read_b64_tr_b16 v[100:101], v7 offset:12288
    ds_read_b64_tr_b16 v[102:103], v7 offset:12544
    s_waitcnt vmcnt(8) lgkmcnt(9)
    v_mfma_f32_32x32x16_bf16 v[64:79], v[104:107], v[168:171], v[64:79]
    ds_read_b64_tr_b16 v[104:105], v6 offset:12800
    ds_read_b64_tr_b16 v[106:107], v6 offset:13056
    buffer_load_dwordx2 v[60:61], v3, s[4:7], s25 offen offset:512 sc1
    v_mfma_f32_32x32x16_bf16 v[80:95], v[108:111], v[168:171], v[80:95]
    ds_read_b64_tr_b16 v[108:109], v7 offset:12800
    ds_read_b64_tr_b16 v[110:111], v7 offset:13056
    s_waitcnt vmcnt(8) lgkmcnt(8)
    v_mfma_f32_32x32x16_bf16 v[64:79], v[112:115], v[172:175], v[64:79]
    ds_read_b64_tr_b16 v[112:113], v6 offset:14336
    ds_read_b64_tr_b16 v[114:115], v6 offset:14592
    buffer_load_dwordx2 v[62:63], v3, s[4:7], s25 offen offset:768 sc1
    v_mfma_f32_32x32x16_bf16 v[80:95], v[116:119], v[172:175], v[80:95]
    ds_read_b64_tr_b16 v[116:117], v7 offset:14336
    ds_read_b64_tr_b16 v[118:119], v7 offset:14592
    s_waitcnt vmcnt(8) lgkmcnt(8)
    v_mfma_f32_32x32x16_bf16 v[64:79], v[96:99], v[176:179], v[64:79]
    ds_read_b64_tr_b16 v[96:97], v6 offset:14848
    ds_read_b64_tr_b16 v[98:99], v6 offset:15104
    buffer_load_dwordx4 v[196:199], v0, s[8:11], s51 offen offset:1024 sc1
    v_mfma_f32_32x32x16_bf16 v[80:95], v[100:103], v[176:179], v[80:95]
    ds_read_b64_tr_b16 v[100:101], v7 offset:14848
    ds_read_b64_tr_b16 v[102:103], v7 offset:15104
    s_waitcnt vmcnt(8) lgkmcnt(8)
    v_mfma_f32_32x32x16_bf16 v[64:79], v[104:107], v[180:183], v[64:79]
    ds_read_b64_tr_b16 v[104:105], v6 offset:16384
    ds_read_b64_tr_b16 v[106:107], v6 offset:16640
    buffer_load_dwordx4 v[200:203], v0, s[8:11], s51 offen offset:2048 sc1
    buffer_load_dwordx4 v[204:207], v0, s[8:11], s51 offen offset:3072 sc1
    v_mfma_f32_32x32x16_bf16 v[80:95], v[108:111], v[180:183], v[80:95]
    ds_read_b64_tr_b16 v[108:109], v7 offset:16384
    ds_read_b64_tr_b16 v[110:111], v7 offset:16640
    s_waitcnt vmcnt(9) lgkmcnt(8)
    v_mfma_f32_32x32x16_bf16 v[64:79], v[112:115], v[184:187], v[64:79]
    ds_read_b64_tr_b16 v[112:113], v6 offset:16896
    ds_read_b64_tr_b16 v[114:115], v6 offset:17152
    s_add_u32 s51, s84, 5
    s_and_b32 s51, s51, 7
    s_lshl_b32 s51, s51, 12
    s_add_u32 s51, s51, s24
    buffer_load_dwordx4 v[208:211], v0, s[8:11], s51 offen offset:0 sc1
    v_mfma_f32_32x32x16_bf16 v[80:95], v[116:119], v[184:187], v[80:95]
    ds_read_b64_tr_b16 v[116:117], v7 offset:16896
    ds_read_b64_tr_b16 v[118:119], v7 offset:17152
    s_waitcnt vmcnt(9) lgkmcnt(8)
    v_mfma_f32_32x32x16_bf16 v[64:79], v[96:99], v[188:191], v[64:79]
    ds_read_b64_tr_b16 v[96:97], v6 offset:18432
    ds_read_b64_tr_b16 v[98:99], v6 offset:18688
    buffer_load_dwordx4 v[212:215], v0, s[8:11], s51 offen offset:1024 sc1
    v_mfma_f32_32x32x16_bf16 v[80:95], v[100:103], v[188:191], v[80:95]
    ds_read_b64_tr_b16 v[100:101], v7 offset:18432
    ds_read_b64_tr_b16 v[102:103], v7 offset:18688
    s_waitcnt vmcnt(9) lgkmcnt(8)
    v_mfma_f32_32x32x16_bf16 v[64:79], v[104:107], v[192:195], v[64:79]
    ds_read_b64_tr_b16 v[104:105], v6 offset:18944
    ds_read_b64_tr_b16 v[106:107], v6 offset:19200
    buffer_load_dwordx4 v[216:219], v0, s[8:11], s51 offen offset:2048 sc1
    buffer_load_dwordx4 v[220:223], v0, s[8:11], s51 offen offset:3072 sc1
    v_mfma_f32_32x32x16_bf16 v[80:95], v[108:111], v[192:195], v[80:95]
    ds_read_b64_tr_b16 v[108:109], v7 offset:18944
    ds_read_b64_tr_b16 v[110:111], v7 offset:19200
    s_waitcnt vmcnt(6) lgkmcnt(8)
    v_mfma_f32_32x32x16_bf16 v[64:79], v[112:115], v[196:199], v[64:79]
    ds_read_b64_tr_b16 v[112:113], v6 offset:20480
    ds_read_b64_tr_b16 v[114:115], v6 offset:20736
    s_add_u32 s51, s84, 6
    s_and_b32 s51, s51, 7
    s_lshl_b32 s51, s51, 12
    s_add_u32 s51, s51, s24
    buffer_load_dwordx4 v[224:227], v0, s[8:11], s51 offen offset:0 sc1
    v_mfma_f32_32x32x16_bf16 v[80:95], v[116:119], v[196:199], v[80:95]
    ds_read_b64_tr_b16 v[116:117], v7 offset:20480
    ds_read_b64_tr_b16 v[118:119], v7 offset:20736
    s_waitcnt vmcnt(6) lgkmcnt(8)
    v_mfma_f32_32x32x16_bf16 v[64:79], v[96:99], v[200:203], v[64:79]
    ds_read_b64_tr_b16 v[96:97], v6 offset:20992
    ds_read_b64_tr_b16 v[98:99], v6 offset:21248
    buffer_load_dwordx4 v[228:231], v0, s[8:11], s51 offen offset:1024 sc1
    v_mfma_f32_32x32x16_bf16 v[80:95], v[100:103], v[200:203], v[80:95]
    ds_read_b64_tr_b16 v[100:101], v7 offset:20992
    ds_read_b64_tr_b16 v[102:103], v7 offset:21248
    s_waitcnt vmcnt(6) lgkmcnt(8)
    v_mfma_f32_32x32x16_bf16 v[64:79], v[104:107], v[204:207], v[64:79]
    ds_read_b64_tr_b16 v[104:105], v6 offset:22528
    ds_read_b64_tr_b16 v[106:107], v6 offset:22784
    buffer_load_dwordx4 v[232:235], v0, s[8:11], s51 offen offset:2048 sc1
    buffer_load_dwordx4 v[236:239], v0, s[8:11], s51 offen offset:3072 sc1
    v_mfma_f32_32x32x16_bf16 v[80:95], v[108:111], v[204:207], v[80:95]
    ds_read_b64_tr_b16 v[108:109], v7 offset:22528
    ds_read_b64_tr_b16 v[110:111], v7 offset:22784
    v_mov_b32 v42, 0
    v_mov_b32 v43, 0
    v_mov_b32 v46, 0
    v_mov_b32 v47, 0
    s_waitcnt vmcnt(7) lgkmcnt(8)
    v_mfma_f32_32x32x16_bf16 v[64:79], v[112:115], v[208:211], v[64:79]
    ds_read_b64_tr_b16 v[112:113], v6 offset:23040
    ds_read_b64_tr_b16 v[114:115], v6 offset:23296
    s_add_u32 s51, s84, 7
    s_and_b32 s51, s51, 7
    s_lshl_b32 s51, s51, 12
    s_add_u32 s51, s51, s24
    buffer_load_dwordx4 v[240:243], v0, s[8:11], s51 offen offset:0 sc1
    v_mfma_f32_32x32x16_bf16 v[80:95], v[116:119], v[208:211], v[80:95]
    ds_read_b64_tr_b16 v[116:117], v7 offset:23040
    ds_read_b64_tr_b16 v[118:119], v7 offset:23296
    v_accvgpr_read_b32 v50, a248
    v_cvt_pk_bf16_f32 v41, v50, 0
    v_lshlrev_b32 v51, 16, v41
    v_sub_f32 v51, v50, v51
    s_waitcnt vmcnt(7) lgkmcnt(8)
    v_mfma_f32_32x32x16_bf16 v[64:79], v[96:99], v[212:215], v[64:79]
    ds_read_b64_tr_b16 v[96:97], v6 offset:24576
    ds_read_b64_tr_b16 v[98:99], v6 offset:24832
    buffer_load_dwordx4 v[244:247], v0, s[8:11], s51 offen offset:1024 sc1
    v_cvt_pk_bf16_f32 v40, v50, v51
    v_mfma_f32_32x32x16_bf16 v[80:95], v[100:103], v[212:215], v[80:95]
    ds_read_b64_tr_b16 v[100:101], v7 offset:24576
    ds_read_b64_tr_b16 v[102:103], v7 offset:24832
    v_add_f32 v56, v56, v58
    v_add_f32 v57, v57, v59
    s_waitcnt vmcnt(7) lgkmcnt(8)
    v_mfma_f32_32x32x16_bf16 v[64:79], v[104:107], v[216:219], v[64:79]
    ds_read_b64_tr_b16 v[104:105], v6 offset:25088
    ds_read_b64_tr_b16 v[106:107], v6 offset:25344
    buffer_load_dwordx4 v[248:251], v0, s[8:11], s51 offen offset:2048 sc1
    v_add_f32 v60, v60, v62
    v_add_f32 v61, v61, v63
    v_mfma_f32_32x32x16_bf16 v[80:95], v[108:111], v[216:219], v[80:95]
    ds_read_b64_tr_b16 v[108:109], v7 offset:25088
    ds_read_b64_tr_b16 v[110:111], v7 offset:25344
    v_add_f32 v56, v56, v60
    v_add_f32 v57, v57, v61
    s_waitcnt vmcnt(7) lgkmcnt(8)
    v_mfma_f32_32x32x16_bf16 v[64:79], v[112:115], v[220:223], v[64:79]
    ds_read_b64_tr_b16 v[112:113], v6 offset:26624
    ds_read_b64_tr_b16 v[114:115], v6 offset:26880
    buffer_load_dwordx4 v[252:255], v0, s[8:11], s51 offen offset:3072 sc1
    v_permlane32_swap_b32 v56, v57
    v_add_f32 v56, v56, v57
    v_mfma_f32_32x32x16_bf16 v[80:95], v[116:119], v[220:223], v[80:95]
    ds_read_b64_tr_b16 v[116:117], v7 offset:26624
    ds_read_b64_tr_b16 v[118:119], v7 offset:26880
    v_mov_b32 v57, v56
    s_nop 1
    v_permlane32_swap_b32 v56, v57
    s_waitcnt vmcnt(7) lgkmcnt(8)
    v_mfma_f32_32x32x16_bf16 v[64:79], v[96:99], v[224:227], v[64:79]
    ds_read_b64_tr_b16 v[96:97], v6 offset:27136
    ds_read_b64_tr_b16 v[98:99], v6 offset:27392
    v_mul_f32 v22, 989855744, v56
    v_mul_f32 v57, 989855744, v57
    v_mfma_f32_32x32x16_bf16 v[80:95], v[100:103], v[224:227], v[80:95]
    ds_read_b64_tr_b16 v[100:101], v7 offset:27136
    ds_read_b64_tr_b16 v[102:103], v7 offset:27392
    v_fma_f32 v57, -v22, v22, v57
    v_max_f32 v57, 0, v57
    s_waitcnt vmcnt(6) lgkmcnt(8)
    v_mfma_f32_32x32x16_bf16 v[64:79], v[104:107], v[228:231], v[64:79]
    ds_read_b64_tr_b16 v[104:105], v6 offset:28672
    ds_read_b64_tr_b16 v[106:107], v6 offset:28928
    v_add_f32 v58, 925353388, v57
    v_rsq_f32 v23, v58
    v_mfma_f32_32x32x16_bf16 v[80:95], v[108:111], v[228:231], v[80:95]
    ds_read_b64_tr_b16 v[108:109], v7 offset:28672
    ds_read_b64_tr_b16 v[110:111], v7 offset:28928
    v_cndmask_b32 v48, 0, -v22, s[58:59]
    s_waitcnt vmcnt(5) lgkmcnt(8)
    v_mfma_f32_32x32x16_bf16 v[64:79], v[112:115], v[232:235], v[64:79]
    ds_read_b64_tr_b16 v[112:113], v6 offset:29184
    ds_read_b64_tr_b16 v[114:115], v6 offset:29440
    v_cvt_pk_bf16_f32 v44, v48, v48
    v_and_b32 v49, 0xffff0000, v44
    v_mfma_f32_32x32x16_bf16 v[80:95], v[116:119], v[232:235], v[80:95]
    ds_read_b64_tr_b16 v[116:117], v7 offset:29184
    ds_read_b64_tr_b16 v[118:119], v7 offset:29440
    v_sub_f32 v48, v48, v49
    v_cvt_pk_bf16_f32 v45, v48, 0
    s_waitcnt vmcnt(4) lgkmcnt(8)
    v_mfma_f32_32x32x16_bf16 v[64:79], v[96:99], v[236:239], v[64:79]
    ds_read_b64_tr_b16 v[96:97], v6 offset:30720
    ds_read_b64_tr_b16 v[98:99], v6 offset:30976
    v_mfma_f32_32x32x16_bf16 v[64:79], v[40:43], v[44:47], v[64:79]
    v_cndmask_b32 v48, -v22, 0, s[58:59]
    v_mfma_f32_32x32x16_bf16 v[80:95], v[100:103], v[236:239], v[80:95]
    ds_read_b64_tr_b16 v[100:101], v7 offset:30720
    ds_read_b64_tr_b16 v[102:103], v7 offset:30976
    v_cvt_pk_bf16_f32 v44, v48, v48
    v_and_b32 v49, 0xffff0000, v44
    s_waitcnt vmcnt(3) lgkmcnt(8)
    v_mfma_f32_32x32x16_bf16 v[64:79], v[104:107], v[240:243], v[64:79]
    ds_read_b64_tr_b16 v[104:105], v6 offset:31232
    ds_read_b64_tr_b16 v[106:107], v6 offset:31488
    v_sub_f32 v48, v48, v49
    v_cvt_pk_bf16_f32 v45, v48, 0
    v_mfma_f32_32x32x16_bf16 v[80:95], v[108:111], v[240:243], v[80:95]
    ds_read_b64_tr_b16 v[108:109], v7 offset:31232
    ds_read_b64_tr_b16 v[110:111], v7 offset:31488
    v_mfma_f32_32x32x16_bf16 v[80:95], v[40:43], v[44:47], v[80:95]
    v_mov_b32 v62, s98
    s_or_b32 s44, s2, s16
    s_cselect_b32 s44, 268435456, 0
    s_mov_b64 exec, 1
    buffer_store_dword v62, off, s[4:7], s44 sc1
    s_mov_b64 exec, -1
    s_waitcnt vmcnt(3) lgkmcnt(8)
    v_mfma_f32_32x32x16_bf16 v[64:79], v[112:115], v[244:247], v[64:79]
    v_mfma_f32_32x32x16_bf16 v[80:95], v[116:119], v[244:247], v[80:95]
    s_waitcnt vmcnt(2) lgkmcnt(4)
    v_mfma_f32_32x32x16_bf16 v[64:79], v[96:99], v[248:251], v[64:79]
    v_mfma_f32_32x32x16_bf16 v[80:95], v[100:103], v[248:251], v[80:95]
    s_waitcnt vmcnt(1) lgkmcnt(0)
    v_mfma_f32_32x32x16_bf16 v[64:79], v[104:107], v[252:255], v[64:79]
    v_mfma_f32_32x32x16_bf16 v[80:95], v[108:111], v[252:255], v[80:95]
    v_mul_f32 v60, 1069066811, v23
    s_lshl_b32 s46, s17, 9
    s_add_u32 s46, s46, s27
    s_lshl_b32 s48, s17, 6
    s_add_u32 s48, s48, s28
    s_mov_b32 s52, 0x00010001
    s_mov_b32 s53, 0x00010001
    v_lshrrev_b32 v116, 4, v0
    v_min_u32 v62, 240, v0
    v_lshlrev_b32 v62, 3, v62
    buffer_load_dword a253, v62, s[4:7], s29 offen sc1
    v_cvt_pk_bf16_f32 v40, v64, v65
    v_cvt_pk_bf16_f32 v41, v66, v67
    v_cvt_pk_bf16_f32 v42, v68, v69
    v_cvt_pk_bf16_f32 v43, v70, v71
    v_cvt_pk_bf16_f32 v44, v72, v73
    v_cvt_pk_bf16_f32 v45, v74, v75
    v_mfma_f32_32x32x16_bf16 v[96:111], a[240:243], v[40:43], 0
    v_cvt_pk_bf16_f32 v46, v76, v77
    v_cvt_pk_bf16_f32 v47, v78, v79
    v_mul_f32 v80, v80, v23
    v_mul_f32 v81, v81, v23
    v_mul_f32 v82, v82, v23
    v_mul_f32 v83, v83, v23
    v_mfma_f32_32x32x16_bf16 v[96:111], a[244:247], v[44:47], v[96:111]
    v_mul_f32 v84, v84, v23
    v_mul_f32 v85, v85, v23
    v_mul_f32 v86, v86, v23
    v_mul_f32 v87, v87, v23
    v_mul_f32 v88, v88, v23
    v_mul_f32 v89, v89, v23
    v_cvt_pk_bf16_f32 v48, v80, v81
    v_cvt_pk_bf16_f32 v49, v82, v83
    v_cvt_pk_bf16_f32 v50, v84, v85
    v_cvt_pk_bf16_f32 v51, v86, v87
    v_cvt_pk_bf16_f32 v52, v88, v89
    ds_write_b128 v10, v[48:51] offset:128
    v_pk_mul_f32 v[90:91], v[90:91], v[22:23] op_sel:[0,1]
    v_pk_mul_f32 v[92:93], v[92:93], v[22:23] op_sel:[0,1]
    v_pk_mul_f32 v[94:95], v[94:95], v[22:23] op_sel:[0,1]
    v_cvt_pk_bf16_f32 v53, v90, v91
    v_cvt_pk_bf16_f32 v54, v92, v93
    v_cvt_pk_bf16_f32 v55, v94, v95
    ds_write_b128 v10, v[52:55] offset:144
    v_max3_f32 v56, v96, v97, v98
    v_min3_f32 v58, v96, v97, v98
    v_max3_f32 v56, v56, v99, v100
    v_min3_f32 v58, v58, v99, v100
    v_max3_f32 v56, v56, v101, v102
    v_min3_f32 v58, v58, v101, v102
    v_max3_f32 v56, v56, v103, v104
    v_min3_f32 v58, v58, v103, v104
    v_max3_f32 v56, v56, v105, v106
    v_min3_f32 v58, v58, v105, v106
    v_max3_f32 v56, v56, v107, v108
    v_min3_f32 v58, v58, v107, v108
    v_max3_f32 v56, v56, v109, v110
    v_min3_f32 v58, v58, v109, v110
    v_max_f32 v56, v56, v111
    v_min_f32 v58, v58, v111
    v_mul_f32 v56, v56, v60
    v_mul_f32 v58, v58, v60
    v_pk_fma_f32 v[64:65], v[96:97], v[60:61], v[56:57] op_sel_hi:[1,0,0] neg_lo:[0,0,1] neg_hi:[0,0,1]
    v_pk_fma_f32 v[66:67], v[98:99], v[60:61], v[56:57] op_sel_hi:[1,0,0] neg_lo:[0,0,1] neg_hi:[0,0,1]
    v_pk_fma_f32 v[68:69], v[100:101], v[60:61], v[56:57] op_sel_hi:[1,0,0] neg_lo:[0,0,1] neg_hi:[0,0,1]
    v_pk_fma_f32 v[70:71], v[102:103], v[60:61], v[56:57] op_sel_hi:[1,0,0] neg_lo:[0,0,1] neg_hi:[0,0,1]
    v_pk_fma_f32 v[72:73], v[104:105], v[60:61], v[56:57] op_sel_hi:[1,0,0] neg_lo:[0,0,1] neg_hi:[0,0,1]
    v_pk_fma_f32 v[74:75], v[106:107], v[60:61], v[56:57] op_sel_hi:[1,0,0] neg_lo:[0,0,1] neg_hi:[0,0,1]
    v_pk_fma_f32 v[76:77], v[108:109], v[60:61], v[56:57] op_sel_hi:[1,0,0] neg_lo:[0,0,1] neg_hi:[0,0,1]
    v_pk_fma_f32 v[78:79], v[110:111], v[60:61], v[56:57] op_sel_hi:[1,0,0] neg_lo:[0,0,1] neg_hi:[0,0,1]
    v_pk_fma_f32 v[96:97], v[96:97], v[60:61], v[58:59] op_sel_hi:[1,0,0] neg_lo:[1,0,0] neg_hi:[1,0,0]
    v_pk_fma_f32 v[98:99], v[98:99], v[60:61], v[58:59] op_sel_hi:[1,0,0] neg_lo:[1,0,0] neg_hi:[1,0,0]
    v_pk_fma_f32 v[100:101], v[100:101], v[60:61], v[58:59] op_sel_hi:[1,0,0] neg_lo:[1,0,0] neg_hi:[1,0,0]
    v_pk_fma_f32 v[102:103], v[102:103], v[60:61], v[58:59] op_sel_hi:[1,0,0] neg_lo:[1,0,0] neg_hi:[1,0,0]
    v_pk_fma_f32 v[104:105], v[104:105], v[60:61], v[58:59] op_sel_hi:[1,0,0] neg_lo:[1,0,0] neg_hi:[1,0,0]
    v_pk_fma_f32 v[106:107], v[106:107], v[60:61], v[58:59] op_sel_hi:[1,0,0] neg_lo:[1,0,0] neg_hi:[1,0,0]
    v_pk_fma_f32 v[108:109], v[108:109], v[60:61], v[58:59] op_sel_hi:[1,0,0] neg_lo:[1,0,0] neg_hi:[1,0,0]
    v_pk_fma_f32 v[110:111], v[110:111], v[60:61], v[58:59] op_sel_hi:[1,0,0] neg_lo:[1,0,0] neg_hi:[1,0,0]
    v_exp_f32 v64, v64
    v_exp_f32 v65, v65
    v_exp_f32 v66, v66
    v_exp_f32 v67, v67
    v_exp_f32 v68, v68
    v_exp_f32 v69, v69
    v_exp_f32 v70, v70
    v_exp_f32 v71, v71
    v_exp_f32 v72, v72
    v_exp_f32 v73, v73
    v_exp_f32 v74, v74
    v_exp_f32 v75, v75
    v_exp_f32 v76, v76
    v_exp_f32 v77, v77
    v_exp_f32 v78, v78
    v_exp_f32 v79, v79
    v_exp_f32 v96, v96
    v_exp_f32 v97, v97
    v_pk_add_f32 v[56:57], v[64:65], v[66:67]
    v_pk_add_f32 v[56:57], v[56:57], v[68:69]
    v_pk_add_f32 v[56:57], v[56:57], v[70:71]
    v_pk_add_f32 v[56:57], v[56:57], v[72:73]
    v_pk_add_f32 v[56:57], v[56:57], v[74:75]
    v_pk_add_f32 v[56:57], v[56:57], v[76:77]
    v_pk_add_f32 v[56:57], v[56:57], v[78:79]
    v_add_f32 v56, v56, v57
    v_rcp_f32 v56, v56
    v_exp_f32 v98, v98
    v_exp_f32 v99, v99
    v_pk_mul_f32 v[64:65], v[64:65], v[56:57] op_sel_hi:[1,0]
    v_pk_mul_f32 v[66:67], v[66:67], v[56:57] op_sel_hi:[1,0]
    v_pk_mul_f32 v[68:69], v[68:69], v[56:57] op_sel_hi:[1,0]
    v_pk_mul_f32 v[70:71], v[70:71], v[56:57] op_sel_hi:[1,0]
    v_pk_mul_f32 v[72:73], v[72:73], v[56:57] op_sel_hi:[1,0]
    v_pk_mul_f32 v[74:75], v[74:75], v[56:57] op_sel_hi:[1,0]
    v_pk_mul_f32 v[76:77], v[76:77], v[56:57] op_sel_hi:[1,0]
    v_pk_mul_f32 v[78:79], v[78:79], v[56:57] op_sel_hi:[1,0]
    v_cvt_pk_bf16_f32 v80, v64, v65
    v_cvt_pk_bf16_f32 v81, v66, v67
    v_cvt_pk_bf16_f32 v82, v68, v69
    v_cvt_pk_bf16_f32 v83, v70, v71
    v_cvt_pk_bf16_f32 v84, v72, v73
    v_cvt_pk_bf16_f32 v85, v74, v75
    v_cvt_pk_bf16_f32 v86, v76, v77
    v_cvt_pk_bf16_f32 v87, v78, v79
    ds_write_b128 v9, v[80:83]
    ds_write_b128 v9, v[84:87] offset:16
    v_exp_f32 v100, v100
    v_exp_f32 v101, v101
    v_exp_f32 v102, v102
    v_exp_f32 v103, v103
    v_exp_f32 v104, v104
    v_exp_f32 v105, v105
    v_exp_f32 v106, v106
    v_exp_f32 v107, v107
    v_exp_f32 v108, v108
    v_exp_f32 v109, v109
    v_exp_f32 v110, v110
    v_exp_f32 v111, v111
    v_pk_add_f32 v[58:59], v[96:97], v[98:99]
    v_pk_add_f32 v[58:59], v[58:59], v[100:101]
    v_pk_add_f32 v[58:59], v[58:59], v[102:103]
    v_pk_add_f32 v[58:59], v[58:59], v[104:105]
    v_pk_add_f32 v[58:59], v[58:59], v[106:107]
    v_pk_add_f32 v[58:59], v[58:59], v[108:109]
    v_pk_add_f32 v[58:59], v[58:59], v[110:111]
    v_add_f32 v58, v58, v59
    v_rcp_f32 v58, v58
    s_nop 0
    v_pk_mul_f32 v[96:97], v[96:97], v[58:59] op_sel_hi:[1,0]
    v_pk_mul_f32 v[98:99], v[98:99], v[58:59] op_sel_hi:[1,0]
    v_pk_mul_f32 v[100:101], v[100:101], v[58:59] op_sel_hi:[1,0]
    v_pk_mul_f32 v[102:103], v[102:103], v[58:59] op_sel_hi:[1,0]
    v_cvt_pk_bf16_f32 v88, v96, v97
    v_cvt_pk_bf16_f32 v89, v98, v99
    v_cvt_pk_bf16_f32 v90, v100, v101
    v_cvt_pk_bf16_f32 v91, v102, v103
    ds_write_b128 v9, v[88:91] offset:32
    v_pk_mul_f32 v[104:105], v[104:105], v[58:59] op_sel_hi:[1,0]
    v_pk_mul_f32 v[106:107], v[106:107], v[58:59] op_sel_hi:[1,0]
    v_pk_mul_f32 v[108:109], v[108:109], v[58:59] op_sel_hi:[1,0]
    v_pk_mul_f32 v[110:111], v[110:111], v[58:59] op_sel_hi:[1,0]
    v_cvt_pk_bf16_f32 v92, v104, v105
    v_cvt_pk_bf16_f32 v93, v106, v107
    v_cvt_pk_bf16_f32 v94, v108, v109
    v_cvt_pk_bf16_f32 v95, v110, v111
    ds_write_b128 v9, v[92:95] offset:48
    v_mov_b32 v56, 0x3f803f80
    v_mov_b32 v57, 0x3f803f80
    v_mov_b32 v58, 0x3f803f80
    v_mov_b32 v59, 0x3f803f80
    s_waitcnt lgkmcnt(0)
    s_barrier
    ds_read_b64_tr_b16 v[64:65], v11 offset:0
    ds_read_b64_tr_b16 v[80:81], v12 offset:0
    ds_read_b64_tr_b16 v[66:67], v11 offset:3584
    ds_read_b64_tr_b16 v[82:83], v12 offset:3584
    ds_read_b64_tr_b16 v[68:69], v11 offset:7168
    ds_read_b64_tr_b16 v[84:85], v12 offset:7168
    ds_read_b64_tr_b16 v[70:71], v11 offset:10752
    ds_read_b64_tr_b16 v[86:87], v12 offset:10752
    ds_read_b64_tr_b16 v[72:73], v11 offset:14336
    ds_read_b64_tr_b16 v[88:89], v12 offset:14336
    ds_read_b64_tr_b16 v[74:75], v11 offset:17920
    ds_read_b64_tr_b16 v[90:91], v12 offset:17920
    ds_read_b64_tr_b16 v[76:77], v11 offset:21504
    ds_read_b64_tr_b16 v[92:93], v12 offset:21504
    ds_read_b64_tr_b16 v[78:79], v11 offset:25088
    ds_read_b64_tr_b16 v[94:95], v12 offset:25088
    s_waitcnt lgkmcnt(12)
    v_mfma_f32_16x16x32_bf16 v[60:63], v[64:67], v[80:83], 0
    v_mfma_f32_16x16x32_bf16 v[40:43], v[64:67], v[56:59], 0
    s_waitcnt lgkmcnt(8)
    v_mfma_f32_16x16x32_bf16 v[60:63], v[68:71], v[84:87], v[60:63]
    v_mfma_f32_16x16x32_bf16 v[40:43], v[68:71], v[56:59], v[40:43]
    s_waitcnt lgkmcnt(4)
    v_mfma_f32_16x16x32_bf16 v[60:63], v[72:75], v[88:91], v[60:63]
    v_mfma_f32_16x16x32_bf16 v[40:43], v[72:75], v[56:59], v[40:43]
    s_waitcnt lgkmcnt(0)
    v_mfma_f32_16x16x32_bf16 v[60:63], v[76:79], v[92:95], v[60:63]
    v_mfma_f32_16x16x32_bf16 v[40:43], v[76:79], v[56:59], v[40:43]
    ds_read_b64_tr_b16 v[96:97], v6 offset:32768
    ds_read_b64_tr_b16 v[98:99], v6 offset:33024
    ds_read_b64_tr_b16 v[100:101], v6 offset:33280
    ds_read_b64_tr_b16 v[102:103], v6 offset:33536
    ds_read_b64_tr_b16 v[104:105], v6 offset:34816
    ds_read_b64_tr_b16 v[106:107], v6 offset:35072
    s_nop 0
    v_cvt_pk_bf16_f32 v48, v60, v61
    v_cvt_pk_bf16_f32 v49, v62, v63
    v_cvt_pk_bf16_f32 v50, v60, v61
    v_cvt_pk_bf16_f32 v51, v62, v63
    s_nop 0
    v_permlane16_swap_b32 v48, v50
    v_permlane16_swap_b32 v49, v51
    s_mov_b32 exec_lo, 0xffff
    s_mov_b32 exec_hi, 0xffff
    buffer_store_dwordx4 v[48:51], v16, s[4:7], s46 offen sc1
    s_mov_b64 exec, s[52:53]
    buffer_store_dwordx4 v[40:43], v116, s[4:7], s48 offen sc1
    s_mov_b64 exec, -1
    ds_read_b64_tr_b16 v[108:109], v6 offset:35328
    ds_read_b64_tr_b16 v[110:111], v6 offset:35584
    ds_read_b64_tr_b16 v[64:65], v6 offset:36864
    ds_read_b64_tr_b16 v[66:67], v6 offset:37120
    ds_read_b64_tr_b16 v[68:69], v6 offset:37376
    ds_read_b64_tr_b16 v[70:71], v6 offset:37632
    s_add_u32 m0, s23, 98304
    s_add_u32 s49, s42, 131072
    buffer_load_dwordx4 v0, s[4:7], s49 offen offset:0 sc1 lds
    s_waitcnt lgkmcnt(8)
    v_mfma_f32_32x32x16_bf16 v[112:127], v[96:99], v[128:131], 0
    ds_read_b64_tr_b16 v[96:97], v6 offset:38912
    ds_read_b64_tr_b16 v[98:99], v6 offset:39168
    v_mfma_f32_32x32x16_bf16 v[112:127], v[100:103], v[132:135], v[112:127]
    ds_read_b64_tr_b16 v[100:101], v6 offset:39424
    ds_read_b64_tr_b16 v[102:103], v6 offset:39680
    buffer_load_dwordx4 v0, s[4:7], s49 offen offset:1024 sc1 lds
    s_waitcnt lgkmcnt(8)
    v_mfma_f32_32x32x16_bf16 v[112:127], v[104:107], v[136:139], v[112:127]
    ds_read_b64_tr_b16 v[104:105], v6 offset:40960
    ds_read_b64_tr_b16 v[106:107], v6 offset:41216
    v_bfe_u32 v58, v0, 4, 4
    v_bfe_u32 v56, v0, 8, 1
    v_mfma_f32_32x32x16_bf16 v[112:127], v[108:111], v[140:143], v[112:127]
    ds_read_b64_tr_b16 v[108:109], v6 offset:41472
    ds_read_b64_tr_b16 v[110:111], v6 offset:41728
    v_lshlrev_b32 v56, 3, v56
    v_xor_b32 v58, v58, v56
    buffer_load_dwordx4 v0, s[4:7], s49 offen offset:2048 sc1 lds
    s_waitcnt lgkmcnt(8)
    v_mfma_f32_32x32x16_bf16 v[112:127], v[64:67], v[144:147], v[112:127]
    ds_read_b64_tr_b16 v[64:65], v6 offset:43008
    ds_read_b64_tr_b16 v[66:67], v6 offset:43264
    v_mov_b32 v56, 0x3f80
    v_mov_b32 v57, 0x3f800000
    v_mfma_f32_32x32x16_bf16 v[112:127], v[68:71], v[148:151], v[112:127]
    ds_read_b64_tr_b16 v[68:69], v6 offset:43520
    ds_read_b64_tr_b16 v[70:71], v6 offset:43776
    v_cmp_eq_u32 vcc, 0, v58
    v_cmp_eq_u32 s[60:61], 1, v58
    s_nop 0
    v_cndmask_b32 v76, 0, v56, vcc
    v_cndmask_b32 v76, v76, v57, s[60:61]
    buffer_load_dwordx4 v0, s[4:7], s49 offen offset:3072 sc1 lds
    s_waitcnt lgkmcnt(8)
    v_mfma_f32_32x32x16_bf16 v[112:127], v[96:99], v[152:155], v[112:127]
    ds_read_b64_tr_b16 v[96:97], v6 offset:45056
    ds_read_b64_tr_b16 v[98:99], v6 offset:45312
    v_cmp_eq_u32 vcc, 2, v58
    v_cmp_eq_u32 s[60:61], 3, v58
    s_nop 0
    v_cndmask_b32 v77, 0, v56, vcc
    v_cndmask_b32 v77, v77, v57, s[60:61]
    v_mfma_f32_32x32x16_bf16 v[112:127], v[100:103], v[156:159], v[112:127]
    ds_read_b64_tr_b16 v[100:101], v6 offset:45568
    ds_read_b64_tr_b16 v[102:103], v6 offset:45824
    s_add_u32 m0, s23, 114688
    s_add_u32 s49, s42, 147456
    buffer_load_dwordx4 v0, s[4:7], s49 offen offset:0 sc1 lds
    s_waitcnt lgkmcnt(8)
    v_mfma_f32_32x32x16_bf16 v[112:127], v[104:107], v[160:163], v[112:127]
    ds_read_b64_tr_b16 v[104:105], v6 offset:47104
    ds_read_b64_tr_b16 v[106:107], v6 offset:47360
    v_cmp_eq_u32 vcc, 4, v58
    v_cmp_eq_u32 s[60:61], 5, v58
    s_nop 0
    v_cndmask_b32 v78, 0, v56, vcc
    v_cndmask_b32 v78, v78, v57, s[60:61]
    v_mfma_f32_32x32x16_bf16 v[112:127], v[108:111], v[164:167], v[112:127]
    ds_read_b64_tr_b16 v[108:109], v6 offset:47616
    ds_read_b64_tr_b16 v[110:111], v6 offset:47872
    v_cmp_eq_u32 vcc, 6, v58
    v_cmp_eq_u32 s[60:61], 7, v58
    s_nop 0
    v_cndmask_b32 v79, 0, v56, vcc
    v_cndmask_b32 v79, v79, v57, s[60:61]
    buffer_load_dwordx4 v0, s[4:7], s49 offen offset:1024 sc1 lds
    s_waitcnt lgkmcnt(8)
    v_mfma_f32_32x32x16_bf16 v[112:127], v[64:67], v[168:171], v[112:127]
    ds_read_b64_tr_b16 v[64:65], v6 offset:49152
    ds_read_b64_tr_b16 v[66:67], v6 offset:49408
    v_mfma_f32_32x32x16_bf16 v[112:127], v[68:71], v[172:175], v[112:127]
    ds_read_b64_tr_b16 v[68:69], v6 offset:49664
    ds_read_b64_tr_b16 v[70:71], v6 offset:49920
    buffer_load_dwordx4 v0, s[4:7], s49 offen offset:2048 sc1 lds
    s_waitcnt lgkmcnt(8)
    v_mfma_f32_32x32x16_bf16 v[112:127], v[96:99], v[176:179], v[112:127]
    ds_read_b64_tr_b16 v[96:97], v6 offset:51200
    ds_read_b64_tr_b16 v[98:99], v6 offset:51456
    v_mfma_f32_32x32x16_bf16 v[112:127], v[100:103], v[180:183], v[112:127]
    ds_read_b64_tr_b16 v[100:101], v6 offset:51712
    ds_read_b64_tr_b16 v[102:103], v6 offset:51968
    buffer_load_dwordx4 v0, s[4:7], s49 offen offset:3072 sc1 lds
    s_waitcnt lgkmcnt(8)
    v_mfma_f32_32x32x16_bf16 v[112:127], v[104:107], v[184:187], v[112:127]
    ds_read_b64_tr_b16 v[104:105], v6 offset:53248
    ds_read_b64_tr_b16 v[106:107], v6 offset:53504
    v_mov_b32 v42, 0
    v_mov_b32 v43, 0
    v_mfma_f32_32x32x16_bf16 v[112:127], v[108:111], v[188:191], v[112:127]
    ds_read_b64_tr_b16 v[108:109], v6 offset:53760
    ds_read_b64_tr_b16 v[110:111], v6 offset:54016
    v_mov_b32 v46, 0
    v_mov_b32 v47, 0
    v_cndmask_b32 v48, 0, -v22, s[58:59]
    s_waitcnt lgkmcnt(8)
    v_mfma_f32_32x32x16_bf16 v[112:127], v[64:67], v[192:195], v[112:127]
    ds_read_b64_tr_b16 v[64:65], v6 offset:55296
    ds_read_b64_tr_b16 v[66:67], v6 offset:55552
    v_cvt_pk_bf16_f32 v44, v48, v48
    v_and_b32 v49, 0xffff0000, v44
    v_mfma_f32_32x32x16_bf16 v[112:127], v[68:71], v[196:199], v[112:127]
    ds_read_b64_tr_b16 v[68:69], v6 offset:55808
    ds_read_b64_tr_b16 v[70:71], v6 offset:56064
    v_sub_f32 v48, v48, v49
    v_cvt_pk_bf16_f32 v45, v48, 0
    s_waitcnt lgkmcnt(8)
    v_mfma_f32_32x32x16_bf16 v[112:127], v[96:99], v[200:203], v[112:127]
    ds_read_b64_tr_b16 v[96:97], v6 offset:57344
    ds_read_b64_tr_b16 v[98:99], v6 offset:57600
    buffer_load_dwordx4 v[160:163], v15, s[4:7], s28 offen sc1
    v_mfma_f32_32x32x16_bf16 v[112:127], v[100:103], v[204:207], v[112:127]
    ds_read_b64_tr_b16 v[100:101], v6 offset:57856
    ds_read_b64_tr_b16 v[102:103], v6 offset:58112
    v_accvgpr_read_b32 v50, a249
    v_cvt_pk_bf16_f32 v41, v50, 0
    v_lshlrev_b32 v51, 16, v41
    s_add_u32 s51, s27, 0
    buffer_load_dwordx4 v[128:131], v0, s[4:7], s51 offen offset:0 sc1
    s_waitcnt lgkmcnt(8)
    v_mfma_f32_32x32x16_bf16 v[112:127], v[104:107], v[208:211], v[112:127]
    ds_read_b64_tr_b16 v[104:105], v6 offset:59392
    ds_read_b64_tr_b16 v[106:107], v6 offset:59648
    v_sub_f32 v51, v50, v51
    v_cvt_pk_bf16_f32 v40, v50, v51
    buffer_load_dwordx4 v[132:135], v0, s[4:7], s51 offen offset:1024 sc1
    v_mfma_f32_32x32x16_bf16 v[112:127], v[108:111], v[212:215], v[112:127]
    ds_read_b64_tr_b16 v[108:109], v6 offset:59904
    ds_read_b64_tr_b16 v[110:111], v6 offset:60160
    v_mfma_f32_32x32x16_bf16 v[112:127], v[40:43], v[44:47], v[112:127]
    buffer_load_dwordx4 v[136:139], v0, s[4:7], s51 offen offset:2048 sc1
    s_waitcnt lgkmcnt(8)
    v_mfma_f32_32x32x16_bf16 v[112:127], v[64:67], v[216:219], v[112:127]
    ds_read_b64_tr_b16 v[64:65], v6 offset:61440
    ds_read_b64_tr_b16 v[66:67], v6 offset:61696
    buffer_load_dwordx4 v[140:143], v0, s[4:7], s51 offen offset:3072 sc1
    v_mfma_f32_32x32x16_bf16 v[112:127], v[68:71], v[220:223], v[112:127]
    ds_read_b64_tr_b16 v[68:69], v6 offset:61952
    ds_read_b64_tr_b16 v[70:71], v6 offset:62208
    s_add_u32 s51, s27, 4096
    buffer_load_dwordx4 v[144:147], v0, s[4:7], s51 offen offset:0 sc1
    s_waitcnt lgkmcnt(8)
    v_mfma_f32_32x32x16_bf16 v[112:127], v[96:99], v[224:227], v[112:127]
    ds_read_b64_tr_b16 v[96:97], v6 offset:63488
    ds_read_b64_tr_b16 v[98:99], v6 offset:63744
    buffer_load_dwordx4 v[148:151], v0, s[4:7], s51 offen offset:1024 sc1
    v_mfma_f32_32x32x16_bf16 v[112:127], v[100:103], v[228:231], v[112:127]
    ds_read_b64_tr_b16 v[100:101], v6 offset:64000
    ds_read_b64_tr_b16 v[102:103], v6 offset:64256
    buffer_load_dwordx4 v[152:155], v0, s[4:7], s51 offen offset:2048 sc1
    s_waitcnt lgkmcnt(8)
    v_mfma_f32_32x32x16_bf16 v[112:127], v[104:107], v[232:235], v[112:127]
    buffer_load_dwordx4 v[156:159], v0, s[4:7], s51 offen offset:3072 sc1
    v_mfma_f32_32x32x16_bf16 v[112:127], v[108:111], v[236:239], v[112:127]
    s_waitcnt lgkmcnt(4)
    v_mfma_f32_32x32x16_bf16 v[112:127], v[64:67], v[240:243], v[112:127]
    v_mfma_f32_32x32x16_bf16 v[112:127], v[68:71], v[244:247], v[112:127]
    s_waitcnt lgkmcnt(0)
    v_mfma_f32_32x32x16_bf16 v[112:127], v[96:99], v[248:251], v[112:127]
    v_mfma_f32_32x32x16_bf16 v[112:127], v[100:103], v[252:255], v[112:127]
    v_mul_f32 v60, 1069066811, v23
    s_lshl_b32 s44, s16, 5
    s_add_u32 s44, s44, 163584
    v_lshrrev_b32 v72, 8, v0
    v_lshl_add_u32 v72, v72, 3, s44
    s_nop 6
    v_cvt_pk_bf16_f32 v64, v112, v113
    v_cvt_pk_bf16_f32 v65, v114, v115
    v_cvt_pk_bf16_f32 v66, v116, v117
    v_cvt_pk_bf16_f32 v67, v118, v119
    v_cvt_pk_bf16_f32 v68, v120, v121
    v_cvt_pk_bf16_f32 v69, v122, v123
    v_mfma_f32_32x32x16_bf16 v[96:111], a[240:243], v[64:67], 0
    v_cvt_pk_bf16_f32 v70, v124, v125
    v_cvt_pk_bf16_f32 v71, v126, v127
    s_nop 1
    v_mfma_f32_32x32x16_bf16 v[96:111], a[244:247], v[68:71], v[96:111]
    s_nop 11
    v_max3_f32 v56, v96, v97, v98
    v_min3_f32 v58, v96, v97, v98
    v_max3_f32 v56, v56, v99, v100
    v_min3_f32 v58, v58, v99, v100
    v_max3_f32 v56, v56, v101, v102
    v_min3_f32 v58, v58, v101, v102
    v_max3_f32 v56, v56, v103, v104
    v_min3_f32 v58, v58, v103, v104
    v_max3_f32 v56, v56, v105, v106
    v_min3_f32 v58, v58, v105, v106
    v_max3_f32 v56, v56, v107, v108
    v_min3_f32 v58, v58, v107, v108
    v_max3_f32 v56, v56, v109, v110
    v_min3_f32 v58, v58, v109, v110
    v_max_f32 v56, v56, v111
    v_min_f32 v58, v58, v111
    v_mul_f32 v56, v56, v60
    v_mul_f32 v58, v58, v60
    v_pk_fma_f32 v[112:113], v[96:97], v[60:61], v[56:57] op_sel_hi:[1,0,0] neg_lo:[0,0,1] neg_hi:[0,0,1]
    v_pk_fma_f32 v[114:115], v[98:99], v[60:61], v[56:57] op_sel_hi:[1,0,0] neg_lo:[0,0,1] neg_hi:[0,0,1]
    v_pk_fma_f32 v[116:117], v[100:101], v[60:61], v[56:57] op_sel_hi:[1,0,0] neg_lo:[0,0,1] neg_hi:[0,0,1]
    v_pk_fma_f32 v[118:119], v[102:103], v[60:61], v[56:57] op_sel_hi:[1,0,0] neg_lo:[0,0,1] neg_hi:[0,0,1]
    v_pk_fma_f32 v[120:121], v[104:105], v[60:61], v[56:57] op_sel_hi:[1,0,0] neg_lo:[0,0,1] neg_hi:[0,0,1]
    v_pk_fma_f32 v[122:123], v[106:107], v[60:61], v[56:57] op_sel_hi:[1,0,0] neg_lo:[0,0,1] neg_hi:[0,0,1]
    v_pk_fma_f32 v[124:125], v[108:109], v[60:61], v[56:57] op_sel_hi:[1,0,0] neg_lo:[0,0,1] neg_hi:[0,0,1]
    v_pk_fma_f32 v[126:127], v[110:111], v[60:61], v[56:57] op_sel_hi:[1,0,0] neg_lo:[0,0,1] neg_hi:[0,0,1]
    v_pk_fma_f32 v[96:97], v[96:97], v[60:61], v[58:59] op_sel_hi:[1,0,0] neg_lo:[1,0,0] neg_hi:[1,0,0]
    v_pk_fma_f32 v[98:99], v[98:99], v[60:61], v[58:59] op_sel_hi:[1,0,0] neg_lo:[1,0,0] neg_hi:[1,0,0]
    v_pk_fma_f32 v[100:101], v[100:101], v[60:61], v[58:59] op_sel_hi:[1,0,0] neg_lo:[1,0,0] neg_hi:[1,0,0]
    v_pk_fma_f32 v[102:103], v[102:103], v[60:61], v[58:59] op_sel_hi:[1,0,0] neg_lo:[1,0,0] neg_hi:[1,0,0]
    v_pk_fma_f32 v[104:105], v[104:105], v[60:61], v[58:59] op_sel_hi:[1,0,0] neg_lo:[1,0,0] neg_hi:[1,0,0]
    v_pk_fma_f32 v[106:107], v[106:107], v[60:61], v[58:59] op_sel_hi:[1,0,0] neg_lo:[1,0,0] neg_hi:[1,0,0]
    v_pk_fma_f32 v[108:109], v[108:109], v[60:61], v[58:59] op_sel_hi:[1,0,0] neg_lo:[1,0,0] neg_hi:[1,0,0]
    v_pk_fma_f32 v[110:111], v[110:111], v[60:61], v[58:59] op_sel_hi:[1,0,0] neg_lo:[1,0,0] neg_hi:[1,0,0]
    s_waitcnt vmcnt(8)
    v_cmp_eq_u32 vcc, -1, v160
    s_cbranch_vccz Lzb_20
    buffer_load_dwordx4 v[160:163], v15, s[4:7], s28 offen sc1
    s_add_u32 s51, s27, 0
    buffer_load_dwordx4 v[128:131], v0, s[4:7], s51 offen offset:0 sc1
    buffer_load_dwordx4 v[132:135], v0, s[4:7], s51 offen offset:1024 sc1
    buffer_load_dwordx4 v[136:139], v0, s[4:7], s51 offen offset:2048 sc1
    buffer_load_dwordx4 v[140:143], v0, s[4:7], s51 offen offset:3072 sc1
    s_add_u32 s51, s27, 4096
    buffer_load_dwordx4 v[144:147], v0, s[4:7], s51 offen offset:0 sc1
    buffer_load_dwordx4 v[148:151], v0, s[4:7], s51 offen offset:1024 sc1
    buffer_load_dwordx4 v[152:155], v0, s[4:7], s51 offen offset:2048 sc1
    buffer_load_dwordx4 v[156:159], v0, s[4:7], s51 offen offset:3072 sc1
Lzb_20:
    v_exp_f32 v112, v112
    v_exp_f32 v113, v113
    v_exp_f32 v114, v114
    v_exp_f32 v115, v115
    v_exp_f32 v116, v116
    v_exp_f32 v117, v117
    v_exp_f32 v118, v118
    v_exp_f32 v119, v119
    v_exp_f32 v120, v120
    v_exp_f32 v121, v121
    v_exp_f32 v122, v122
    v_exp_f32 v123, v123
    v_exp_f32 v124, v124
    v_exp_f32 v125, v125
    v_exp_f32 v126, v126
    v_exp_f32 v127, v127
    v_exp_f32 v96, v96
    v_exp_f32 v97, v97
    v_pk_add_f32 v[56:57], v[112:113], v[114:115]
    v_pk_add_f32 v[56:57], v[56:57], v[116:117]
    v_pk_add_f32 v[56:57], v[56:57], v[118:119]
    v_pk_add_f32 v[56:57], v[56:57], v[120:121]
    v_pk_add_f32 v[56:57], v[56:57], v[122:123]
    v_pk_add_f32 v[56:57], v[56:57], v[124:125]
    v_pk_add_f32 v[56:57], v[56:57], v[126:127]
    v_add_f32 v22, v56, v57
    v_exp_f32 v98, v98
    v_exp_f32 v99, v99
    v_cvt_pk_bf16_f32 v40, v112, v113
    v_cvt_pk_bf16_f32 v41, v114, v115
    v_cvt_pk_bf16_f32 v42, v116, v117
    v_cvt_pk_bf16_f32 v43, v118, v119
    v_cvt_pk_bf16_f32 v44, v120, v121
    v_cvt_pk_bf16_f32 v45, v122, v123
    v_cvt_pk_bf16_f32 v46, v124, v125
    v_cvt_pk_bf16_f32 v47, v126, v127
    v_exp_f32 v100, v100
    v_exp_f32 v101, v101
    v_exp_f32 v102, v102
    v_exp_f32 v103, v103
    v_exp_f32 v104, v104
    v_exp_f32 v105, v105
    v_exp_f32 v106, v106
    v_exp_f32 v107, v107
    v_exp_f32 v108, v108
    v_exp_f32 v109, v109
    v_exp_f32 v110, v110
    v_exp_f32 v111, v111
    v_pk_add_f32 v[58:59], v[96:97], v[98:99]
    v_pk_add_f32 v[58:59], v[58:59], v[100:101]
    v_pk_add_f32 v[58:59], v[58:59], v[102:103]
    v_pk_add_f32 v[58:59], v[58:59], v[104:105]
    v_pk_add_f32 v[58:59], v[58:59], v[106:107]
    v_pk_add_f32 v[58:59], v[58:59], v[108:109]
    v_pk_add_f32 v[58:59], v[58:59], v[110:111]
    v_add_f32 v58, v58, v59
    v_rcp_f32 v58, v58
    s_nop 0
    v_mul_f32 v58, v58, v22
    v_pk_mul_f32 v[96:97], v[96:97], v[58:59] op_sel_hi:[1,0]
    v_pk_mul_f32 v[98:99], v[98:99], v[58:59] op_sel_hi:[1,0]
    v_pk_mul_f32 v[100:101], v[100:101], v[58:59] op_sel_hi:[1,0]
    v_pk_mul_f32 v[102:103], v[102:103], v[58:59] op_sel_hi:[1,0]
    v_cvt_pk_bf16_f32 v48, v96, v97
    v_cvt_pk_bf16_f32 v49, v98, v99
    v_cvt_pk_bf16_f32 v50, v100, v101
    v_cvt_pk_bf16_f32 v51, v102, v103
    v_pk_mul_f32 v[104:105], v[104:105], v[58:59] op_sel_hi:[1,0]
    v_pk_mul_f32 v[106:107], v[106:107], v[58:59] op_sel_hi:[1,0]
    v_pk_mul_f32 v[108:109], v[108:109], v[58:59] op_sel_hi:[1,0]
    v_pk_mul_f32 v[110:111], v[110:111], v[58:59] op_sel_hi:[1,0]
    v_cvt_pk_bf16_f32 v52, v104, v105
    v_cvt_pk_bf16_f32 v53, v106, v107
    v_cvt_pk_bf16_f32 v54, v108, v109
    v_cvt_pk_bf16_f32 v55, v110, v111
    s_mov_b32 s50, 0
Lkvretry_21:
    s_waitcnt vmcnt(6)
    v_mfma_f32_16x16x32_bf16 v[64:67], v[76:79], v[128:131], 0
    v_add_f32_dpp v80, v160, v160 row_ror:8 row_mask:0xf bank_mask:0xf
    v_add_f32_dpp v81, v161, v161 row_ror:8 row_mask:0xf bank_mask:0xf
    v_mfma_f32_16x16x32_bf16 v[64:67], v[76:79], v[132:135], v[64:67]
    v_add_f32_dpp v82, v162, v162 row_ror:8 row_mask:0xf bank_mask:0xf
    v_add_f32_dpp v83, v163, v163 row_ror:8 row_mask:0xf bank_mask:0xf
    s_waitcnt vmcnt(4)
    v_mfma_f32_16x16x32_bf16 v[64:67], v[76:79], v[136:139], v[64:67]
    v_add_f32_dpp v80, v80, v80 row_ror:4 row_mask:0xf bank_mask:0xf
    v_add_f32_dpp v81, v81, v81 row_ror:4 row_mask:0xf bank_mask:0xf
    v_mfma_f32_16x16x32_bf16 v[64:67], v[76:79], v[140:143], v[64:67]
    v_add_f32_dpp v82, v82, v82 row_ror:4 row_mask:0xf bank_mask:0xf
    v_add_f32_dpp v83, v83, v83 row_ror:4 row_mask:0xf bank_mask:0xf
    s_waitcnt vmcnt(2)
    v_mfma_f32_16x16x32_bf16 v[64:67], v[76:79], v[144:147], v[64:67]
    v_add_f32_dpp v80, v80, v80 row_ror:2 row_mask:0xf bank_mask:0xf
    v_add_f32_dpp v81, v81, v81 row_ror:2 row_mask:0xf bank_mask:0xf
    v_mfma_f32_16x16x32_bf16 v[64:67], v[76:79], v[148:151], v[64:67]
    v_add_f32_dpp v82, v82, v82 row_ror:2 row_mask:0xf bank_mask:0xf
    v_add_f32_dpp v83, v83, v83 row_ror:2 row_mask:0xf bank_mask:0xf
    s_waitcnt vmcnt(0)
    v_mfma_f32_16x16x32_bf16 v[64:67], v[76:79], v[152:155], v[64:67]
    v_add_f32_dpp v80, v80, v80 row_ror:1 row_mask:0xf bank_mask:0xf
    v_add_f32_dpp v81, v81, v81 row_ror:1 row_mask:0xf bank_mask:0xf
    v_mfma_f32_16x16x32_bf16 v[64:67], v[76:79], v[156:159], v[64:67]
    v_add_f32_dpp v82, v82, v82 row_ror:1 row_mask:0xf bank_mask:0xf
    v_add_f32_dpp v83, v83, v83 row_ror:1 row_mask:0xf bank_mask:0xf
    v_cvt_pk_bf16_f32 v90, v80, v81
    v_cvt_pk_bf16_f32 v91, v82, v83
    v_add_f32 v84, v80, v81
    v_add_f32 v85, v82, v83
    v_add_f32 v84, v84, v85
    s_nop 0
    v_cmp_u_f32 vcc, v84, v64
    s_cbranch_vccnz Lkvslow_23
Lkvgo_22:
    v_cvt_pk_bf16_f32 v88, v64, v65
    v_cvt_pk_bf16_f32 v89, v66, v67
    ds_write_b64 v13, v[88:89]
    ds_write_b64 v72, v[90:91]
    s_waitcnt lgkmcnt(0)
    s_barrier
    ds_read_b128 v[128:131], v4 offset:3840
    ds_read_b128 v[132:135], v4 offset:3856
    ds_read_b128 v[136:139], v4 offset:3872
    ds_read_b128 v[140:143], v4 offset:3888
    ds_read_b128 v[64:67], v14 offset:0
    ds_read_b128 v[68:71], v14 offset:16
    ds_read_b128 v[72:75], v14 offset:32
    ds_read_b128 v[76:79], v14 offset:48
    v_mul_f32 v56, 897988541, v22
    v_mov_b32 v57, 0
    s_waitcnt lgkmcnt(6)
    v_dot2_f32_bf16 v56, v40, v128, v56
    v_dot2_f32_bf16 v57, v41, v129, v57
    v_dot2_f32_bf16 v56, v42, v130, v56
    v_dot2_f32_bf16 v57, v43, v131, v57
    v_dot2_f32_bf16 v56, v44, v132, v56
    v_dot2_f32_bf16 v57, v45, v133, v57
    v_dot2_f32_bf16 v56, v46, v134, v56
    v_dot2_f32_bf16 v57, v47, v135, v57
    s_waitcnt lgkmcnt(4)
    v_dot2_f32_bf16 v56, v48, v136, v56
    v_dot2_f32_bf16 v57, v49, v137, v57
    v_dot2_f32_bf16 v56, v50, v138, v56
    v_dot2_f32_bf16 v57, v51, v139, v57
    v_dot2_f32_bf16 v56, v52, v140, v56
    v_dot2_f32_bf16 v57, v53, v141, v57
    v_dot2_f32_bf16 v56, v54, v142, v56
    v_dot2_f32_bf16 v57, v55, v143, v57
    s_waitcnt lgkmcnt(0)
    v_mfma_f32_32x32x16_bf16 v[80:95], v[64:67], v[40:43], 0
    v_mfma_f32_32x32x16_bf16 v[80:95], v[68:71], v[44:47], v[80:95]
    v_mfma_f32_32x32x16_bf16 v[80:95], v[72:75], v[48:51], v[80:95]
    v_mfma_f32_32x32x16_bf16 v[80:95], v[76:79], v[52:55], v[80:95]
    v_add_f32 v56, v56, v57
    v_rcp_f32 v56, v56
    s_nop 9
    v_pk_mul_f32 v[80:81], v[80:81], v[56:57] op_sel_hi:[1,0]
    v_pk_mul_f32 v[82:83], v[82:83], v[56:57] op_sel_hi:[1,0]
    v_pk_mul_f32 v[84:85], v[84:85], v[56:57] op_sel_hi:[1,0]
    v_pk_mul_f32 v[86:87], v[86:87], v[56:57] op_sel_hi:[1,0]
    v_cvt_pk_bf16_f32 v64, v80, v81
    v_cvt_pk_bf16_f32 v65, v82, v83
    v_cvt_pk_bf16_f32 v66, v84, v85
    v_cvt_pk_bf16_f32 v67, v86, v87
    buffer_store_dwordx4 v[64:67], v5, s[4:7], s29 offen offset:0
    v_pk_mul_f32 v[88:89], v[88:89], v[56:57] op_sel_hi:[1,0]
    v_pk_mul_f32 v[90:91], v[90:91], v[56:57] op_sel_hi:[1,0]
    v_pk_mul_f32 v[92:93], v[92:93], v[56:57] op_sel_hi:[1,0]
    v_pk_mul_f32 v[94:95], v[94:95], v[56:57] op_sel_hi:[1,0]
    v_cvt_pk_bf16_f32 v68, v88, v89
    v_cvt_pk_bf16_f32 v69, v90, v91
    v_cvt_pk_bf16_f32 v70, v92, v93
    v_cvt_pk_bf16_f32 v71, v94, v95
    buffer_store_dwordx4 v[68:71], v5, s[4:7], s29 offen offset:256
    v_bfe_u32 v59, v0, 7, 3
    v_lshlrev_b32 v59, 4, v59
    s_lshl_b32 s47, s19, 7
    s_add_u32 s45, s98, 2
    s_mov_b64 exec, 1
    v_mov_b32 v56, s45
    s_waitcnt vmcnt(0)
    buffer_store_dword v56, off, s[4:7], s30 offset:0
    s_mov_b64 exec, -1
    s_add_u32 s45, s98, 2
    s_mov_b32 exec_hi, 0
    s_mov_b32 s50, 0
Lpoll_26:
    buffer_load_dword v56, v21, s[4:7], s32 offen sc1
    s_add_u32 s50, s50, 1
    s_cmp_gt_u32 s50, 0x40000
    s_cbranch_scc1 Labort
    s_waitcnt vmcnt(0)
    v_cmp_ne_u32 vcc, s45, v56
    s_cbranch_vccnz Lpoll_26
    s_mov_b64 exec, -1
    s_add_u32 s51, s31, 0
    buffer_load_dwordx4 v[128:131], v0, s[4:7], s51 offen offset:0 sc1
    buffer_load_dwordx4 v[132:135], v0, s[4:7], s51 offen offset:2048 sc1
    s_add_u32 s51, s31, 4096
    buffer_load_dwordx4 v[136:139], v0, s[4:7], s51 offen offset:0 sc1
    buffer_load_dwordx4 v[140:143], v0, s[4:7], s51 offen offset:2048 sc1
    s_add_u32 s51, s31, 1024
    buffer_load_dwordx4 v[144:147], v0, s[4:7], s51 offen offset:0 sc1
    buffer_load_dwordx4 v[148:151], v0, s[4:7], s51 offen offset:2048 sc1
    s_add_u32 s51, s31, 5120
    buffer_load_dwordx4 v[152:155], v0, s[4:7], s51 offen offset:0 sc1
    s_barrier
    s_waitcnt vmcnt(6)
    v_mfma_f32_16x16x32_bf16 v[64:67], a[0:3], v[128:131], 0
    buffer_load_dwordx4 v[156:159], v0, s[4:7], s51 offen offset:2048 sc1
    v_mfma_f32_16x16x32_bf16 v[68:71], a[4:7], v[128:131], 0
    v_mfma_f32_16x16x32_bf16 v[72:75], a[8:11], v[128:131], 0
    v_mfma_f32_16x16x32_bf16 v[76:79], a[12:15], v[128:131], 0
    s_waitcnt vmcnt(6)
    v_mfma_f32_16x16x32_bf16 v[64:67], a[16:19], v[132:135], v[64:67]
    s_add_u32 s51, s31, 32768
    buffer_load_dwordx4 v[160:163], v0, s[4:7], s51 offen offset:0 sc1
    v_mfma_f32_16x16x32_bf16 v[68:71], a[20:23], v[132:135], v[68:71]
    v_mfma_f32_16x16x32_bf16 v[72:75], a[24:27], v[132:135], v[72:75]
    v_mfma_f32_16x16x32_bf16 v[76:79], a[28:31], v[132:135], v[76:79]
    s_waitcnt vmcnt(6)
    v_mfma_f32_16x16x32_bf16 v[64:67], a[32:35], v[136:139], v[64:67]
    buffer_load_dwordx4 v[164:167], v0, s[4:7], s51 offen offset:2048 sc1
    v_mfma_f32_16x16x32_bf16 v[68:71], a[36:39], v[136:139], v[68:71]
    v_mfma_f32_16x16x32_bf16 v[72:75], a[40:43], v[136:139], v[72:75]
    v_mfma_f32_16x16x32_bf16 v[76:79], a[44:47], v[136:139], v[76:79]
    s_waitcnt vmcnt(6)
    v_mfma_f32_16x16x32_bf16 v[64:67], a[48:51], v[140:143], v[64:67]
    s_add_u32 s51, s31, 36864
    buffer_load_dwordx4 v[168:171], v0, s[4:7], s51 offen offset:0 sc1
    v_mfma_f32_16x16x32_bf16 v[68:71], a[52:55], v[140:143], v[68:71]
    v_mfma_f32_16x16x32_bf16 v[72:75], a[56:59], v[140:143], v[72:75]
    v_mfma_f32_16x16x32_bf16 v[76:79], a[60:63], v[140:143], v[76:79]
    s_waitcnt vmcnt(6)
    v_mfma_f32_16x16x32_bf16 v[80:83], a[0:3], v[144:147], 0
    buffer_load_dwordx4 v[172:175], v0, s[4:7], s51 offen offset:2048 sc1
    v_mfma_f32_16x16x32_bf16 v[84:87], a[4:7], v[144:147], 0
    v_mfma_f32_16x16x32_bf16 v[88:91], a[8:11], v[144:147], 0
    v_mfma_f32_16x16x32_bf16 v[92:95], a[12:15], v[144:147], 0
    ds_write_b128 v17, v[64:67] offset:0
    s_waitcnt vmcnt(6)
    v_mfma_f32_16x16x32_bf16 v[80:83], a[16:19], v[148:151], v[80:83]
    s_add_u32 s51, s31, 33792
    buffer_load_dwordx4 v[176:179], v0, s[4:7], s51 offen offset:0 sc1
    v_mfma_f32_16x16x32_bf16 v[84:87], a[20:23], v[148:151], v[84:87]
    v_mfma_f32_16x16x32_bf16 v[88:91], a[24:27], v[148:151], v[88:91]
    v_mfma_f32_16x16x32_bf16 v[92:95], a[28:31], v[148:151], v[92:95]
    ds_write_b128 v17, v[68:71] offset:1024
    s_waitcnt vmcnt(6)
    v_mfma_f32_16x16x32_bf16 v[80:83], a[32:35], v[152:155], v[80:83]
    buffer_load_dwordx4 v[180:183], v0, s[4:7], s51 offen offset:2048 sc1
    v_mfma_f32_16x16x32_bf16 v[84:87], a[36:39], v[152:155], v[84:87]
    v_mfma_f32_16x16x32_bf16 v[88:91], a[40:43], v[152:155], v[88:91]
    v_mfma_f32_16x16x32_bf16 v[92:95], a[44:47], v[152:155], v[92:95]
    ds_write_b128 v17, v[72:75] offset:2048
    s_waitcnt vmcnt(6)
    v_mfma_f32_16x16x32_bf16 v[80:83], a[48:51], v[156:159], v[80:83]
    s_add_u32 s51, s31, 37888
    buffer_load_dwordx4 v[184:187], v0, s[4:7], s51 offen offset:0 sc1
    v_mfma_f32_16x16x32_bf16 v[84:87], a[52:55], v[156:159], v[84:87]
    v_mfma_f32_16x16x32_bf16 v[88:91], a[56:59], v[156:159], v[88:91]
    v_mfma_f32_16x16x32_bf16 v[92:95], a[60:63], v[156:159], v[92:95]
    ds_write_b128 v17, v[76:79] offset:3072
    s_waitcnt vmcnt(6)
    v_mfma_f32_16x16x32_bf16 v[96:99], a[0:3], v[160:163], 0
    buffer_load_dwordx4 v[188:191], v0, s[4:7], s51 offen offset:2048 sc1
    v_mfma_f32_16x16x32_bf16 v[100:103], a[4:7], v[160:163], 0
    v_mfma_f32_16x16x32_bf16 v[104:107], a[8:11], v[160:163], 0
    v_mfma_f32_16x16x32_bf16 v[108:111], a[12:15], v[160:163], 0
    ds_write_b128 v17, v[80:83] offset:4096
    s_waitcnt vmcnt(6)
    v_mfma_f32_16x16x32_bf16 v[96:99], a[16:19], v[164:167], v[96:99]
    s_add_u32 m0, s23, 32768
    s_add_u32 s49, s43, 0
    buffer_load_dwordx4 v0, s[4:7], s49 offen offset:0 sc1 lds
    buffer_load_dwordx4 v0, s[4:7], s49 offen offset:1024 sc1 lds
    v_mfma_f32_16x16x32_bf16 v[100:103], a[20:23], v[164:167], v[100:103]
    v_mfma_f32_16x16x32_bf16 v[104:107], a[24:27], v[164:167], v[104:107]
    v_mfma_f32_16x16x32_bf16 v[108:111], a[28:31], v[164:167], v[108:111]
    ds_write_b128 v17, v[84:87] offset:5120
    buffer_load_dwordx4 v[60:63], v59, s[12:15], s47 offen
    s_waitcnt vmcnt(8)
    v_mfma_f32_16x16x32_bf16 v[96:99], a[32:35], v[168:171], v[96:99]
    v_mfma_f32_16x16x32_bf16 v[100:103], a[36:39], v[168:171], v[100:103]
    v_mfma_f32_16x16x32_bf16 v[104:107], a[40:43], v[168:171], v[104:107]
    v_mfma_f32_16x16x32_bf16 v[108:111], a[44:47], v[168:171], v[108:111]
    ds_write_b128 v17, v[88:91] offset:6144
    s_waitcnt vmcnt(7)
    v_mfma_f32_16x16x32_bf16 v[96:99], a[48:51], v[172:175], v[96:99]
    buffer_load_dwordx4 v0, s[4:7], s49 offen offset:2048 sc1 lds
    v_mfma_f32_16x16x32_bf16 v[100:103], a[52:55], v[172:175], v[100:103]
    v_mfma_f32_16x16x32_bf16 v[104:107], a[56:59], v[172:175], v[104:107]
    v_mfma_f32_16x16x32_bf16 v[108:111], a[60:63], v[172:175], v[108:111]
    ds_write_b128 v17, v[92:95] offset:7168
    s_waitcnt vmcnt(7)
    v_mfma_f32_16x16x32_bf16 v[112:115], a[0:3], v[176:179], 0
    buffer_load_dwordx4 v0, s[4:7], s49 offen offset:3072 sc1 lds
    v_mfma_f32_16x16x32_bf16 v[116:119], a[4:7], v[176:179], 0
    v_mfma_f32_16x16x32_bf16 v[120:123], a[8:11], v[176:179], 0
    v_mfma_f32_16x16x32_bf16 v[124:127], a[12:15], v[176:179], 0
    s_waitcnt vmcnt(7)
    v_mfma_f32_16x16x32_bf16 v[112:115], a[16:19], v[180:183], v[112:115]
    s_add_u32 m0, s23, 49152
    s_add_u32 s49, s43, 16384
    buffer_load_dwordx4 v0, s[4:7], s49 offen offset:0 sc1 lds
    v_mfma_f32_16x16x32_bf16 v[116:119], a[20:23], v[180:183], v[116:119]
    v_mfma_f32_16x16x32_bf16 v[120:123], a[24:27], v[180:183], v[120:123]
    v_mfma_f32_16x16x32_bf16 v[124:127], a[28:31], v[180:183], v[124:127]
    s_waitcnt lgkmcnt(0)
    s_barrier
    ds_read_b128 v[64:67], v18 offset:0
    ds_read_b128 v[68:71], v18 offset:256
    ds_read_b128 v[72:75], v18 offset:8192
    ds_read_b128 v[76:79], v18 offset:8448
    ds_read_b128 v[80:83], v18 offset:16384
    ds_read_b128 v[84:87], v18 offset:16640
    ds_read_b128 v[88:91], v18 offset:24576
    ds_read_b128 v[92:95], v18 offset:24832
    s_waitcnt vmcnt(7)
    v_mfma_f32_16x16x32_bf16 v[112:115], a[32:35], v[184:187], v[112:115]
    buffer_load_dwordx4 v0, s[4:7], s49 offen offset:1024 sc1 lds
    v_mfma_f32_16x16x32_bf16 v[116:119], a[36:39], v[184:187], v[116:119]
    v_mfma_f32_16x16x32_bf16 v[120:123], a[40:43], v[184:187], v[120:123]
    v_mfma_f32_16x16x32_bf16 v[124:127], a[44:47], v[184:187], v[124:127]
    s_waitcnt vmcnt(7)
    v_mfma_f32_16x16x32_bf16 v[112:115], a[48:51], v[188:191], v[112:115]
    buffer_load_dwordx4 v0, s[4:7], s49 offen offset:2048 sc1 lds
    v_mfma_f32_16x16x32_bf16 v[116:119], a[52:55], v[188:191], v[116:119]
    v_mfma_f32_16x16x32_bf16 v[120:123], a[56:59], v[188:191], v[120:123]
    v_mfma_f32_16x16x32_bf16 v[124:127], a[60:63], v[188:191], v[124:127]
    s_waitcnt lgkmcnt(0)
    s_barrier
    ds_write_b128 v17, v[96:99] offset:0
    v_pk_add_f32 v[24:25], v[24:25], v[64:65]
    v_pk_add_f32 v[26:27], v[26:27], v[66:67]
    v_pk_add_f32 v[28:29], v[28:29], v[68:69]
    v_pk_add_f32 v[30:31], v[30:31], v[70:71]
    v_pk_add_f32 v[24:25], v[24:25], v[72:73]
    v_pk_add_f32 v[26:27], v[26:27], v[74:75]
    v_pk_add_f32 v[28:29], v[28:29], v[76:77]
    v_pk_add_f32 v[30:31], v[30:31], v[78:79]
    buffer_load_dwordx4 v0, s[4:7], s49 offen offset:3072 sc1 lds
    ds_write_b128 v17, v[100:103] offset:1024
    v_pk_add_f32 v[24:25], v[24:25], v[80:81]
    v_pk_add_f32 v[26:27], v[26:27], v[82:83]
    v_pk_add_f32 v[28:29], v[28:29], v[84:85]
    v_pk_add_f32 v[30:31], v[30:31], v[86:87]
    v_pk_add_f32 v[24:25], v[24:25], v[88:89]
    v_pk_add_f32 v[26:27], v[26:27], v[90:91]
    v_pk_add_f32 v[28:29], v[28:29], v[92:93]
    v_pk_add_f32 v[30:31], v[30:31], v[94:95]
    ds_write_b128 v17, v[104:107] offset:2048
    v_cvt_pk_bf16_f32 v40, v24, v25
    v_cvt_pk_bf16_f32 v41, v26, v27
    v_cvt_pk_bf16_f32 v42, v28, v29
    v_cvt_pk_bf16_f32 v43, v30, v31
    buffer_store_dwordx4 v[40:43], v19, s[8:11], s33 offen
    v_pk_add_f32 v[64:65], v[24:25], v[26:27]
    ds_write_b128 v17, v[108:111] offset:3072
    v_pk_mul_f32 v[66:67], v[24:25], v[24:25]
    v_pk_add_f32 v[64:65], v[64:65], v[28:29]
    v_pk_fma_f32 v[66:67], v[26:27], v[26:27], v[66:67]
    v_pk_add_f32 v[64:65], v[64:65], v[30:31]
    v_pk_fma_f32 v[66:67], v[28:29], v[28:29], v[66:67]
    v_add_f32 v64, v64, v65
    v_pk_fma_f32 v[66:67], v[30:31], v[30:31], v[66:67]
    v_add_f32 v65, v66, v67
    ds_write_b128 v17, v[112:115] offset:4096
    s_nop 0
    v_permlane16_swap_b32 v64, v65
    v_add_f32 v64, v64, v65
    s_nop 1
    v_add_f32_dpp v65, v64, v64 row_ror:8 row_mask:0xf bank_mask:0xf
    v_add_f32_dpp v64, v64, v64 row_ror:8 row_mask:0xf bank_mask:0xf
    s_nop 1
    v_permlane32_swap_b32 v64, v65
    v_add_f32 v64, v64, v65
    s_mov_b64 exec, 0x00ff00ff
    buffer_store_dword v64, v20, s[4:7], s34 offen offset:0
    s_mov_b64 exec, -1
    ds_write_b128 v17, v[116:119] offset:5120
    ds_write_b128 v17, v[120:123] offset:6144
    ds_write_b128 v17, v[124:127] offset:7168
    s_waitcnt vmcnt(2)
    s_waitcnt lgkmcnt(0)
    s_barrier
    ds_read_b128 v[192:195], v18 offset:0
    ds_read_b128 v[196:199], v18 offset:256
    ds_read_b128 v[200:203], v18 offset:8192
    ds_read_b128 v[204:207], v18 offset:8448
    ds_read_b128 v[208:211], v18 offset:16384
    ds_read_b128 v[212:215], v18 offset:16640
    ds_read_b128 v[216:219], v18 offset:24576
    ds_read_b128 v[220:223], v18 offset:24832
    s_add_u32 s45, s98, 3
    s_mov_b64 exec, 1
    v_mov_b32 v56, s45
    s_waitcnt vmcnt(0)
    buffer_store_dword v56, off, s[4:7], s35 offset:0
    s_mov_b64 exec, -1
    s_waitcnt lgkmcnt(6)
    v_pk_add_f32 v[32:33], v[32:33], v[192:193]
    v_pk_add_f32 v[34:35], v[34:35], v[194:195]
    v_pk_add_f32 v[36:37], v[36:37], v[196:197]
    v_pk_add_f32 v[38:39], v[38:39], v[198:199]
    s_waitcnt lgkmcnt(4)
    v_pk_add_f32 v[32:33], v[32:33], v[200:201]
    v_pk_add_f32 v[34:35], v[34:35], v[202:203]
    v_pk_add_f32 v[36:37], v[36:37], v[204:205]
    v_pk_add_f32 v[38:39], v[38:39], v[206:207]
    s_waitcnt lgkmcnt(2)
    v_pk_add_f32 v[32:33], v[32:33], v[208:209]
    v_pk_add_f32 v[34:35], v[34:35], v[210:211]
    v_pk_add_f32 v[36:37], v[36:37], v[212:213]
    v_pk_add_f32 v[38:39], v[38:39], v[214:215]
    s_waitcnt lgkmcnt(0)
    v_pk_add_f32 v[32:33], v[32:33], v[216:217]
    v_pk_add_f32 v[34:35], v[34:35], v[218:219]
    v_pk_add_f32 v[36:37], v[36:37], v[220:221]
    v_pk_add_f32 v[38:39], v[38:39], v[222:223]
    v_cvt_pk_bf16_f32 v44, v32, v33
    v_cvt_pk_bf16_f32 v45, v34, v35
    v_cvt_pk_bf16_f32 v46, v36, v37
    v_cvt_pk_bf16_f32 v47, v38, v39
    buffer_store_dwordx4 v[44:47], v19, s[8:11], s96 offen
    v_pk_add_f32 v[192:193], v[32:33], v[34:35]
    v_pk_mul_f32 v[194:195], v[32:33], v[32:33]
    v_pk_add_f32 v[192:193], v[192:193], v[36:37]
    v_pk_fma_f32 v[194:195], v[34:35], v[34:35], v[194:195]
    v_pk_add_f32 v[192:193], v[192:193], v[38:39]
    v_pk_fma_f32 v[194:195], v[36:37], v[36:37], v[194:195]
    v_add_f32 v192, v192, v193
    v_pk_fma_f32 v[194:195], v[38:39], v[38:39], v[194:195]
    v_add_f32 v193, v194, v195
    s_nop 1
    v_permlane16_swap_b32 v192, v193
    v_add_f32 v192, v192, v193
    s_nop 1
    v_add_f32_dpp v193, v192, v192 row_ror:8 row_mask:0xf bank_mask:0xf
    v_add_f32_dpp v192, v192, v192 row_ror:8 row_mask:0xf bank_mask:0xf
    s_nop 1
    v_permlane32_swap_b32 v192, v193
    v_add_f32 v192, v192, v193
    s_mov_b64 exec, 0x00ff00ff
    buffer_store_dword v192, v20, s[4:7], s34 offen offset:2048
    s_mov_b64 exec, -1
    buffer_load_dword v22, v2, s[4:7], s26 offen sc1
    v_lshlrev_b32 v200, 16, v60
    v_and_b32 v201, 0xffff0000, v60
    v_lshlrev_b32 v202, 16, v61
    v_and_b32 v203, 0xffff0000, v61
    v_lshlrev_b32 v204, 16, v62
    v_and_b32 v205, 0xffff0000, v62
    v_lshlrev_b32 v206, 16, v63
    v_and_b32 v207, 0xffff0000, v63
    v_pk_add_f32 v[24:25], v[24:25], v[200:201]
    v_pk_add_f32 v[26:27], v[26:27], v[202:203]
    v_pk_add_f32 v[28:29], v[28:29], v[204:205]
    v_pk_add_f32 v[30:31], v[30:31], v[206:207]
    v_pk_add_f32 v[32:33], v[32:33], v[200:201]
    v_pk_add_f32 v[34:35], v[34:35], v[202:203]
    v_pk_add_f32 v[36:37], v[36:37], v[204:205]
    v_pk_add_f32 v[38:39], v[38:39], v[206:207]
    s_add_u32 s45, s98, 3
    s_mov_b64 exec, 1
    v_mov_b32 v56, s45
    s_waitcnt vmcnt(1)
    buffer_store_dword v56, off, s[4:7], s35 offset:128
    s_mov_b64 exec, -1
    ds_read_b128 v[112:115], v1 offset:0
    ds_read_b128 v[116:119], v1 offset:32768
    ds_read_b128 v[120:123], v0 offset:32768
    ds_read_b128 v[124:127], v1 offset:1024
    s_add_u32 s45, s98, 3
    s_waitcnt vmcnt(1)
    v_cmp_ne_u32 vcc, s45, v22
    s_cmp_eq_u32 vcc_lo, 0
    s_cbranch_scc1 Lpolls_29
    s_add_u32 s45, s98, 3
    s_mov_b32 exec_hi, 0
    s_mov_b32 s50, 0
Lpoll_28:
    buffer_load_dword v56, v2, s[4:7], s26 offen sc1
    s_add_u32 s50, s50, 1
    s_cmp_gt_u32 s50, 0x40000
    s_cbranch_scc1 Labort
    s_waitcnt vmcnt(0)
    v_cmp_ne_u32 vcc, s45, v56
    s_cbranch_vccnz Lpoll_28
    s_mov_b64 exec, -1
Lpolls_29:
    s_add_u32 s51, s24, 0
    buffer_load_dwordx4 v[128:131], v0, s[8:11], s51 offen offset:0 sc1
    buffer_load_dwordx4 v[132:135], v0, s[8:11], s51 offen offset:1024 sc1
    buffer_load_dwordx4 v[136:139], v0, s[8:11], s51 offen offset:2048 sc1
    buffer_load_dwordx4 v[140:143], v0, s[8:11], s51 offen offset:3072 sc1
    s_waitcnt vmcnt(3) lgkmcnt(3)
    v_mfma_f32_32x32x16_bf16 v[64:79], v[112:115], v[128:131], 0
    ds_read_b128 v[112:115], v1 offset:33792
    s_add_u32 s51, s24, 4096
    buffer_load_dwordx4 v[144:147], v0, s[8:11], s51 offen offset:0 sc1
    s_waitcnt lgkmcnt(3)
    v_mfma_f32_32x32x16_bf16 v[80:95], v[116:119], v[128:131], 0
    ds_read_b128 v[116:119], v0 offset:33792
    s_waitcnt lgkmcnt(3)
    v_mfma_f32_32x32x16_bf16 v[96:111], v[120:123], v[128:131], 0
    ds_read_b128 v[120:123], v1 offset:2048
    s_waitcnt vmcnt(3) lgkmcnt(3)
    v_mfma_f32_32x32x16_bf16 v[64:79], v[124:127], v[132:135], v[64:79]
    ds_read_b128 v[124:127], v1 offset:34816
    buffer_load_dwordx4 v[148:151], v0, s[8:11], s51 offen offset:1024 sc1
    s_waitcnt lgkmcnt(3)
    v_mfma_f32_32x32x16_bf16 v[80:95], v[112:115], v[132:135], v[80:95]
    ds_read_b128 v[112:115], v0 offset:34816
    s_waitcnt lgkmcnt(3)
    v_mfma_f32_32x32x16_bf16 v[96:111], v[116:119], v[132:135], v[96:111]
    ds_read_b128 v[116:119], v1 offset:3072
    s_waitcnt vmcnt(3) lgkmcnt(3)
    v_mfma_f32_32x32x16_bf16 v[64:79], v[120:123], v[136:139], v[64:79]
    ds_read_b128 v[120:123], v1 offset:35840
    buffer_load_dwordx4 v[152:155], v0, s[8:11], s51 offen offset:2048 sc1
    s_waitcnt lgkmcnt(3)
    v_mfma_f32_32x32x16_bf16 v[80:95], v[124:127], v[136:139], v[80:95]
    ds_read_b128 v[124:127], v0 offset:35840
    s_waitcnt lgkmcnt(3)
    v_mfma_f32_32x32x16_bf16 v[96:111], v[112:115], v[136:139], v[96:111]
    ds_read_b128 v[112:115], v1 offset:4096
    s_waitcnt vmcnt(3) lgkmcnt(3)
    v_mfma_f32_32x32x16_bf16 v[64:79], v[116:119], v[140:143], v[64:79]
    ds_read_b128 v[116:119], v1 offset:36864
    buffer_load_dwordx4 v[156:159], v0, s[8:11], s51 offen offset:3072 sc1
    s_add_u32 s51, s24, 8192
    buffer_load_dwordx4 v[160:163], v0, s[8:11], s51 offen offset:0 sc1
    s_waitcnt lgkmcnt(3)
    v_mfma_f32_32x32x16_bf16 v[80:95], v[120:123], v[140:143], v[80:95]
    ds_read_b128 v[120:123], v0 offset:36864
    s_waitcnt lgkmcnt(3)
    v_mfma_f32_32x32x16_bf16 v[96:111], v[124:127], v[140:143], v[96:111]
    ds_read_b128 v[124:127], v1 offset:5120
    s_waitcnt vmcnt(4) lgkmcnt(3)
    v_mfma_f32_32x32x16_bf16 v[64:79], v[112:115], v[144:147], v[64:79]
    ds_read_b128 v[112:115], v1 offset:37888
    buffer_load_dwordx4 v[164:167], v0, s[8:11], s51 offen offset:1024 sc1
    s_waitcnt lgkmcnt(3)
    v_mfma_f32_32x32x16_bf16 v[80:95], v[116:119], v[144:147], v[80:95]
    ds_read_b128 v[116:119], v0 offset:37888
    s_waitcnt lgkmcnt(3)
    v_mfma_f32_32x32x16_bf16 v[96:111], v[120:123], v[144:147], v[96:111]
    ds_read_b128 v[120:123], v1 offset:6144
    s_waitcnt vmcnt(4) lgkmcnt(3)
    v_mfma_f32_32x32x16_bf16 v[64:79], v[124:127], v[148:151], v[64:79]
    ds_read_b128 v[124:127], v1 offset:38912
    buffer_load_dwordx4 v[168:171], v0, s[8:11], s51 offen offset:2048 sc1
    s_waitcnt lgkmcnt(3)
    v_mfma_f32_32x32x16_bf16 v[80:95], v[112:115], v[148:151], v[80:95]
    ds_read_b128 v[112:115], v0 offset:38912
    s_waitcnt lgkmcnt(3)
    v_mfma_f32_32x32x16_bf16 v[96:111], v[116:119], v[148:151], v[96:111]
    ds_read_b128 v[116:119], v1 offset:7168
    s_waitcnt vmcnt(4) lgkmcnt(3)
    v_mfma_f32_32x32x16_bf16 v[64:79], v[120:123], v[152:155], v[64:79]
    ds_read_b128 v[120:123], v1 offset:39936
    buffer_load_dwordx4 v[172:175], v0, s[8:11], s51 offen offset:3072 sc1
    buffer_load_dwordx2 v[56:57], v3, s[4:7], s25 offen offset:0 sc1
    s_waitcnt lgkmcnt(3)
    v_mfma_f32_32x32x16_bf16 v[80:95], v[124:127], v[152:155], v[80:95]
    ds_read_b128 v[124:127], v0 offset:39936
    s_waitcnt lgkmcnt(3)
    v_mfma_f32_32x32x16_bf16 v[96:111], v[112:115], v[152:155], v[96:111]
    ds_read_b128 v[112:115], v1 offset:8192
    s_waitcnt vmcnt(5) lgkmcnt(3)
    v_mfma_f32_32x32x16_bf16 v[64:79], v[116:119], v[156:159], v[64:79]
    ds_read_b128 v[116:119], v1 offset:40960
    buffer_load_dwordx2 v[58:59], v3, s[4:7], s25 offen offset:256 sc1
    s_waitcnt lgkmcnt(3)
    v_mfma_f32_32x32x16_bf16 v[80:95], v[120:123], v[156:159], v[80:95]
    ds_read_b128 v[120:123], v0 offset:40960
    s_waitcnt lgkmcnt(3)
    v_mfma_f32_32x32x16_bf16 v[96:111], v[124:127], v[156:159], v[96:111]
    ds_read_b128 v[124:127], v1 offset:9216
    s_waitcnt vmcnt(5) lgkmcnt(3)
    v_mfma_f32_32x32x16_bf16 v[64:79], v[112:115], v[160:163], v[64:79]
    ds_read_b128 v[112:115], v1 offset:41984
    buffer_load_dwordx2 v[60:61], v3, s[4:7], s25 offen offset:512 sc1
    s_waitcnt lgkmcnt(3)
    v_mfma_f32_32x32x16_bf16 v[80:95], v[116:119], v[160:163], v[80:95]
    ds_read_b128 v[116:119], v0 offset:41984
    s_waitcnt lgkmcnt(3)
    v_mfma_f32_32x32x16_bf16 v[96:111], v[120:123], v[160:163], v[96:111]
    ds_read_b128 v[120:123], v1 offset:10240
    s_waitcnt vmcnt(5) lgkmcnt(3)
    v_mfma_f32_32x32x16_bf16 v[64:79], v[124:127], v[164:167], v[64:79]
    ds_read_b128 v[124:127], v1 offset:43008
    buffer_load_dwordx2 v[62:63], v3, s[4:7], s25 offen offset:768 sc1
    s_add_u32 s51, s24, 12288
    buffer_load_dwordx4 v[176:179], v0, s[8:11], s51 offen offset:0 sc1
    s_waitcnt lgkmcnt(3)
    v_mfma_f32_32x32x16_bf16 v[80:95], v[112:115], v[164:167], v[80:95]
    ds_read_b128 v[112:115], v0 offset:43008
    s_waitcnt lgkmcnt(3)
    v_mfma_f32_32x32x16_bf16 v[96:111], v[116:119], v[164:167], v[96:111]
    ds_read_b128 v[116:119], v1 offset:11264
    s_waitcnt vmcnt(6) lgkmcnt(3)
    v_mfma_f32_32x32x16_bf16 v[64:79], v[120:123], v[168:171], v[64:79]
    ds_read_b128 v[120:123], v1 offset:44032
    buffer_load_dwordx4 v[180:183], v0, s[8:11], s51 offen offset:1024 sc1
    s_waitcnt lgkmcnt(3)
    v_mfma_f32_32x32x16_bf16 v[80:95], v[124:127], v[168:171], v[80:95]
    ds_read_b128 v[124:127], v0 offset:44032
    s_waitcnt lgkmcnt(3)
    v_mfma_f32_32x32x16_bf16 v[96:111], v[112:115], v[168:171], v[96:111]
    ds_read_b128 v[112:115], v1 offset:12288
    s_waitcnt vmcnt(6) lgkmcnt(3)
    v_mfma_f32_32x32x16_bf16 v[64:79], v[116:119], v[172:175], v[64:79]
    ds_read_b128 v[116:119], v1 offset:45056
    buffer_load_dwordx4 v[184:187], v0, s[8:11], s51 offen offset:2048 sc1
    s_waitcnt lgkmcnt(3)
    v_mfma_f32_32x32x16_bf16 v[80:95], v[120:123], v[172:175], v[80:95]
    ds_read_b128 v[120:123], v0 offset:45056
    s_waitcnt lgkmcnt(3)
    v_mfma_f32_32x32x16_bf16 v[96:111], v[124:127], v[172:175], v[96:111]
    ds_read_b128 v[124:127], v1 offset:13312
    s_waitcnt vmcnt(2) lgkmcnt(3)
    v_mfma_f32_32x32x16_bf16 v[64:79], v[112:115], v[176:179], v[64:79]
    ds_read_b128 v[112:115], v1 offset:46080
    buffer_load_dwordx4 v[188:191], v0, s[8:11], s51 offen offset:3072 sc1
    s_waitcnt lgkmcnt(3)
    v_mfma_f32_32x32x16_bf16 v[80:95], v[116:119], v[176:179], v[80:95]
    ds_read_b128 v[116:119], v0 offset:46080
    s_waitcnt lgkmcnt(3)
    v_mfma_f32_32x32x16_bf16 v[96:111], v[120:123], v[176:179], v[96:111]
    ds_read_b128 v[120:123], v1 offset:14336
    s_waitcnt vmcnt(2) lgkmcnt(3)
    v_mfma_f32_32x32x16_bf16 v[64:79], v[124:127], v[180:183], v[64:79]
    ds_read_b128 v[124:127], v1 offset:47104
    s_add_u32 s51, s24, 16384
    buffer_load_dwordx4 v[192:195], v0, s[8:11], s51 offen offset:0 sc1
    buffer_load_dwordx4 v[196:199], v0, s[8:11], s51 offen offset:1024 sc1
    s_waitcnt lgkmcnt(3)
    v_mfma_f32_32x32x16_bf16 v[80:95], v[112:115], v[180:183], v[80:95]
    ds_read_b128 v[112:115], v0 offset:47104
    s_waitcnt lgkmcnt(3)
    v_mfma_f32_32x32x16_bf16 v[96:111], v[116:119], v[180:183], v[96:111]
    ds_read_b128 v[116:119], v1 offset:15360
    s_waitcnt vmcnt(3) lgkmcnt(3)
    v_mfma_f32_32x32x16_bf16 v[64:79], v[120:123], v[184:187], v[64:79]
    ds_read_b128 v[120:123], v1 offset:48128
    buffer_load_dwordx4 v[200:203], v0, s[8:11], s51 offen offset:2048 sc1
    v_add_f32 v56, v56, v58
    s_waitcnt lgkmcnt(3)
    v_mfma_f32_32x32x16_bf16 v[80:95], v[124:127], v[184:187], v[80:95]
    ds_read_b128 v[124:127], v0 offset:48128
    v_add_f32 v57, v57, v59
    v_add_f32 v60, v60, v62
    s_waitcnt lgkmcnt(3)
    v_mfma_f32_32x32x16_bf16 v[96:111], v[112:115], v[184:187], v[96:111]
    ds_read_b128 v[112:115], v1 offset:16384
    v_add_f32 v61, v61, v63
    v_add_f32 v56, v56, v60
    s_waitcnt vmcnt(3) lgkmcnt(3)
    v_mfma_f32_32x32x16_bf16 v[64:79], v[116:119], v[188:191], v[64:79]
    ds_read_b128 v[116:119], v1 offset:49152
    buffer_load_dwordx4 v[204:207], v0, s[8:11], s51 offen offset:3072 sc1
    v_add_f32 v57, v57, v61
    s_nop 1
    v_permlane32_swap_b32 v56, v57
    s_waitcnt lgkmcnt(3)
    v_mfma_f32_32x32x16_bf16 v[80:95], v[120:123], v[188:191], v[80:95]
    ds_read_b128 v[120:123], v0 offset:49152
    v_add_f32 v56, v56, v57
    v_mov_b32 v57, v56
    s_waitcnt lgkmcnt(3)
    v_mfma_f32_32x32x16_bf16 v[96:111], v[124:127], v[188:191], v[96:111]
    ds_read_b128 v[124:127], v1 offset:17408
    v_permlane32_swap_b32 v56, v57
    v_mul_f32 v22, 989855744, v56
    s_waitcnt vmcnt(3) lgkmcnt(3)
    v_mfma_f32_32x32x16_bf16 v[64:79], v[112:115], v[192:195], v[64:79]
    ds_read_b128 v[112:115], v1 offset:50176
    s_add_u32 s51, s24, 20480
    buffer_load_dwordx4 v[208:211], v0, s[8:11], s51 offen offset:0 sc1
    buffer_load_dwordx4 v[212:215], v0, s[8:11], s51 offen offset:1024 sc1
    s_waitcnt lgkmcnt(3)
    v_mfma_f32_32x32x16_bf16 v[80:95], v[116:119], v[192:195], v[80:95]
    ds_read_b128 v[116:119], v0 offset:50176
    v_mul_f32 v57, 989855744, v57
    v_fma_f32 v57, -v22, v22, v57
    v_max_f32 v57, 0, v57
    v_add_f32 v58, 925353388, v57
    s_waitcnt lgkmcnt(3)
    v_mfma_f32_32x32x16_bf16 v[96:111], v[120:123], v[192:195], v[96:111]
    ds_read_b128 v[120:123], v1 offset:18432
    v_rsq_f32 v23, v58
    s_waitcnt vmcnt(4) lgkmcnt(3)
    v_mfma_f32_32x32x16_bf16 v[64:79], v[124:127], v[196:199], v[64:79]
    ds_read_b128 v[124:127], v1 offset:51200
    buffer_load_dwordx4 v[216:219], v0, s[8:11], s51 offen offset:2048 sc1
    v_mul_f32 v58, v23, v23
    v_mul_f32 v58, v58, v57
    s_waitcnt lgkmcnt(3)
    v_mfma_f32_32x32x16_bf16 v[80:95], v[112:115], v[196:199], v[80:95]
    ds_read_b128 v[112:115], v0 offset:51200
    v_add_f32 v58, 925353388, v58
    v_rsq_f32 v58, v58
    s_waitcnt lgkmcnt(3)
    v_mfma_f32_32x32x16_bf16 v[96:111], v[116:119], v[196:199], v[96:111]
    ds_read_b128 v[116:119], v1 offset:19456
    v_mul_f32 v23, v23, v58
    s_waitcnt vmcnt(4) lgkmcnt(3)
    v_mfma_f32_32x32x16_bf16 v[64:79], v[120:123], v[200:203], v[64:79]
    ds_read_b128 v[120:123], v1 offset:52224
    buffer_load_dwordx4 v[220:223], v0, s[8:11], s51 offen offset:3072 sc1
    v_rcp_f32 v58, v23
    s_waitcnt lgkmcnt(3)
    v_mfma_f32_32x32x16_bf16 v[80:95], v[124:127], v[200:203], v[80:95]
    ds_read_b128 v[124:127], v0 offset:52224
    v_mul_f32 v56, 3222493025, v23
    v_mul_f32 v57, v23, v23
    s_waitcnt lgkmcnt(3)
    v_mfma_f32_32x32x16_bf16 v[96:111], v[112:115], v[200:203], v[96:111]
    ds_read_b128 v[112:115], v1 offset:20480
    v_mul_f32 v57, v57, v56
    v_mul_f32 v57, 1027024659, v57
    s_waitcnt vmcnt(4) lgkmcnt(3)
    v_mfma_f32_32x32x16_bf16 v[64:79], v[116:119], v[204:207], v[64:79]
    ds_read_b128 v[116:119], v1 offset:53248
    s_add_u32 s51, s24, 24576
    buffer_load_dwordx4 v[224:227], v0, s[8:11], s51 offen offset:0 sc1
    buffer_load_dwordx4 v[228:231], v0, s[8:11], s51 offen offset:1024 sc1
    s_waitcnt lgkmcnt(3)
    v_mfma_f32_32x32x16_bf16 v[80:95], v[120:123], v[204:207], v[80:95]
    ds_read_b128 v[120:123], v0 offset:53248
    v_mov_b32 v42, 0
    v_mov_b32 v43, 0
    v_mov_b32 v46, 0
    v_mov_b32 v47, 0
    s_waitcnt lgkmcnt(3)
    v_mfma_f32_32x32x16_bf16 v[96:111], v[124:127], v[204:207], v[96:111]
    ds_read_b128 v[124:127], v1 offset:21504
    v_cndmask_b32 v48, v58, -v22, s[58:59]
    v_cvt_pk_bf16_f32 v44, v48, v48
    s_waitcnt vmcnt(5) lgkmcnt(3)
    v_mfma_f32_32x32x16_bf16 v[64:79], v[112:115], v[208:211], v[64:79]
    ds_read_b128 v[112:115], v1 offset:54272
    buffer_load_dwordx4 v[232:235], v0, s[8:11], s51 offen offset:2048 sc1
    v_and_b32 v49, 0xffff0000, v44
    v_sub_f32 v48, v48, v49
    s_waitcnt lgkmcnt(3)
    v_mfma_f32_32x32x16_bf16 v[80:95], v[116:119], v[208:211], v[80:95]
    ds_read_b128 v[116:119], v0 offset:54272
    v_cvt_pk_bf16_f32 v45, v48, 0
    v_accvgpr_read_b32 v50, a250
    s_waitcnt lgkmcnt(3)
    v_mfma_f32_32x32x16_bf16 v[96:111], v[120:123], v[208:211], v[96:111]
    ds_read_b128 v[120:123], v1 offset:22528
    v_cvt_pk_bf16_f32 v41, v50, 0
    v_lshlrev_b32 v51, 16, v41
    s_waitcnt vmcnt(5) lgkmcnt(3)
    v_mfma_f32_32x32x16_bf16 v[64:79], v[124:127], v[212:215], v[64:79]
    ds_read_b128 v[124:127], v1 offset:55296
    buffer_load_dwordx4 v[236:239], v0, s[8:11], s51 offen offset:3072 sc1
    v_sub_f32 v51, v50, v51
    v_cvt_pk_bf16_f32 v40, v50, v51
    s_waitcnt lgkmcnt(3)
    v_mfma_f32_32x32x16_bf16 v[80:95], v[112:115], v[212:215], v[80:95]
    ds_read_b128 v[112:115], v0 offset:55296
    v_mfma_f32_32x32x16_bf16 v[64:79], v[40:43], v[44:47], v[64:79]
    v_accvgpr_read_b32 v50, a251
    s_waitcnt lgkmcnt(3)
    v_mfma_f32_32x32x16_bf16 v[96:111], v[116:119], v[212:215], v[96:111]
    ds_read_b128 v[116:119], v1 offset:23552
    v_cvt_pk_bf16_f32 v41, v50, 0
    v_lshlrev_b32 v51, 16, v41
    s_waitcnt vmcnt(5) lgkmcnt(3)
    v_mfma_f32_32x32x16_bf16 v[64:79], v[120:123], v[216:219], v[64:79]
    ds_read_b128 v[120:123], v1 offset:56320
    s_add_u32 s51, s24, 28672
    buffer_load_dwordx4 v[240:243], v0, s[8:11], s51 offen offset:0 sc1
    s_waitcnt lgkmcnt(3)
    v_mfma_f32_32x32x16_bf16 v[80:95], v[124:127], v[216:219], v[80:95]
    ds_read_b128 v[124:127], v0 offset:56320
    v_sub_f32 v51, v50, v51
    v_cvt_pk_bf16_f32 v40, v50, v51
    s_nop 1
    v_mfma_f32_32x32x16_bf16 v[80:95], v[40:43], v[44:47], v[80:95]
    v_accvgpr_read_b32 v50, a252
    s_waitcnt lgkmcnt(3)
    v_mfma_f32_32x32x16_bf16 v[96:111], v[112:115], v[216:219], v[96:111]
    ds_read_b128 v[112:115], v1 offset:24576
    v_cvt_pk_bf16_f32 v41, v50, 0
    v_lshlrev_b32 v51, 16, v41
    s_waitcnt vmcnt(5) lgkmcnt(3)
    v_mfma_f32_32x32x16_bf16 v[64:79], v[116:119], v[220:223], v[64:79]
    ds_read_b128 v[116:119], v1 offset:57344
    buffer_load_dwordx4 v[244:247], v0, s[8:11], s51 offen offset:1024 sc1
    buffer_load_dwordx4 v[248:251], v0, s[8:11], s51 offen offset:2048 sc1
    s_waitcnt lgkmcnt(3)
    v_mfma_f32_32x32x16_bf16 v[80:95], v[120:123], v[220:223], v[80:95]
    ds_read_b128 v[120:123], v0 offset:57344
    v_sub_f32 v51, v50, v51
    v_cvt_pk_bf16_f32 v40, v50, v51
    s_nop 1
    v_mfma_f32_32x32x16_bf16 v[96:111], v[40:43], v[44:47], v[96:111]
    s_waitcnt lgkmcnt(3)
    v_mfma_f32_32x32x16_bf16 v[96:111], v[124:127], v[220:223], v[96:111]
    ds_read_b128 v[124:127], v1 offset:25600
    s_waitcnt vmcnt(6) lgkmcnt(3)
    v_mfma_f32_32x32x16_bf16 v[64:79], v[112:115], v[224:227], v[64:79]
    ds_read_b128 v[112:115], v1 offset:58368
    buffer_load_dwordx4 v[252:255], v0, s[8:11], s51 offen offset:3072 sc1
    s_waitcnt lgkmcnt(3)
    v_mfma_f32_32x32x16_bf16 v[80:95], v[116:119], v[224:227], v[80:95]
    ds_read_b128 v[116:119], v0 offset:58368
    s_waitcnt lgkmcnt(3)
    v_mfma_f32_32x32x16_bf16 v[96:111], v[120:123], v[224:227], v[96:111]
    ds_read_b128 v[120:123], v1 offset:26624
    s_waitcnt vmcnt(6) lgkmcnt(3)
    v_mfma_f32_32x32x16_bf16 v[64:79], v[124:127], v[228:231], v[64:79]
    ds_read_b128 v[124:127], v1 offset:59392
    s_waitcnt lgkmcnt(3)
    v_mfma_f32_32x32x16_bf16 v[80:95], v[112:115], v[228:231], v[80:95]
    ds_read_b128 v[112:115], v0 offset:59392
    s_waitcnt lgkmcnt(3)
    v_mfma_f32_32x32x16_bf16 v[96:111], v[116:119], v[228:231], v[96:111]
    ds_read_b128 v[116:119], v1 offset:27648
    s_waitcnt vmcnt(5) lgkmcnt(3)
    v_mfma_f32_32x32x16_bf16 v[64:79], v[120:123], v[232:235], v[64:79]
    ds_read_b128 v[120:123], v1 offset:60416
    s_waitcnt lgkmcnt(3)
    v_mfma_f32_32x32x16_bf16 v[80:95], v[124:127], v[232:235], v[80:95]
    ds_read_b128 v[124:127], v0 offset:60416
    s_waitcnt lgkmcnt(3)
    v_mfma_f32_32x32x16_bf16 v[96:111], v[112:115], v[232:235], v[96:111]
    ds_read_b128 v[112:115], v1 offset:28672
    s_waitcnt vmcnt(4) lgkmcnt(3)
    v_mfma_f32_32x32x16_bf16 v[64:79], v[116:119], v[236:239], v[64:79]
    ds_read_b128 v[116:119], v1 offset:61440
    s_waitcnt lgkmcnt(3)
    v_mfma_f32_32x32x16_bf16 v[80:95], v[120:123], v[236:239], v[80:95]
    ds_read_b128 v[120:123], v0 offset:61440
    s_waitcnt lgkmcnt(3)
    v_mfma_f32_32x32x16_bf16 v[96:111], v[124:127], v[236:239], v[96:111]
    ds_read_b128 v[124:127], v1 offset:29696
    s_waitcnt vmcnt(3) lgkmcnt(3)
    v_mfma_f32_32x32x16_bf16 v[64:79], v[112:115], v[240:243], v[64:79]
    ds_read_b128 v[112:115], v1 offset:62464
    s_waitcnt lgkmcnt(3)
    v_mfma_f32_32x32x16_bf16 v[80:95], v[116:119], v[240:243], v[80:95]
    ds_read_b128 v[116:119], v0 offset:62464
    s_waitcnt lgkmcnt(3)
    v_mfma_f32_32x32x16_bf16 v[96:111], v[120:123], v[240:243], v[96:111]
    ds_read_b128 v[120:123], v1 offset:30720
    s_waitcnt vmcnt(2) lgkmcnt(3)
    v_mfma_f32_32x32x16_bf16 v[64:79], v[124:127], v[244:247], v[64:79]
    ds_read_b128 v[124:127], v1 offset:63488
    s_waitcnt lgkmcnt(3)
    v_mfma_f32_32x32x16_bf16 v[80:95], v[112:115], v[244:247], v[80:95]
    ds_read_b128 v[112:115], v0 offset:63488
    s_waitcnt lgkmcnt(3)
    v_mfma_f32_32x32x16_bf16 v[96:111], v[116:119], v[244:247], v[96:111]
    ds_read_b128 v[116:119], v1 offset:31744
    s_waitcnt vmcnt(1) lgkmcnt(3)
    v_mfma_f32_32x32x16_bf16 v[64:79], v[120:123], v[248:251], v[64:79]
    ds_read_b128 v[120:123], v1 offset:64512
    s_waitcnt lgkmcnt(3)
    v_mfma_f32_32x32x16_bf16 v[80:95], v[124:127], v[248:251], v[80:95]
    ds_read_b128 v[124:127], v0 offset:64512
    s_waitcnt lgkmcnt(3)
    v_mfma_f32_32x32x16_bf16 v[96:111], v[112:115], v[248:251], v[96:111]
    s_waitcnt vmcnt(0) lgkmcnt(2)
    v_mfma_f32_32x32x16_bf16 v[64:79], v[116:119], v[252:255], v[64:79]
    s_waitcnt lgkmcnt(1)
    v_mfma_f32_32x32x16_bf16 v[80:95], v[120:123], v[252:255], v[80:95]
    s_waitcnt lgkmcnt(0)
    v_mfma_f32_32x32x16_bf16 v[96:111], v[124:127], v[252:255], v[96:111]
    s_nop 7
    v_pk_mul_f32 v[40:41], v[64:65], v[64:65]
    v_pk_mul_f32 v[42:43], v[66:67], v[66:67]
    v_pk_mul_f32 v[44:45], v[68:69], v[68:69]
    v_pk_mul_f32 v[46:47], v[70:71], v[70:71]
    v_pk_fma_f32 v[40:41], v[40:41], v[56:57], v[56:57] op_sel:[0,1,0] op_sel_hi:[1,1,0]
    v_pk_fma_f32 v[42:43], v[42:43], v[56:57], v[56:57] op_sel:[0,1,0] op_sel_hi:[1,1,0]
    v_pk_fma_f32 v[44:45], v[44:45], v[56:57], v[56:57] op_sel:[0,1,0] op_sel_hi:[1,1,0]
    v_pk_fma_f32 v[46:47], v[46:47], v[56:57], v[56:57] op_sel:[0,1,0] op_sel_hi:[1,1,0]
    v_pk_mul_f32 v[40:41], v[40:41], v[64:65]
    v_pk_mul_f32 v[42:43], v[42:43], v[66:67]
    v_pk_mul_f32 v[44:45], v[44:45], v[68:69]
    v_pk_mul_f32 v[46:47], v[46:47], v[70:71]
    v_exp_f32 v40, v40
    v_exp_f32 v41, v41
    v_exp_f32 v42, v42
    v_exp_f32 v43, v43
    v_exp_f32 v44, v44
    v_exp_f32 v45, v45
    v_exp_f32 v46, v46
    v_exp_f32 v47, v47
    v_pk_fma_f32 v[40:41], v[40:41], v[58:59], v[58:59] op_sel_hi:[1,0,0]
    v_pk_fma_f32 v[42:43], v[42:43], v[58:59], v[58:59] op_sel_hi:[1,0,0]
    v_pk_fma_f32 v[44:45], v[44:45], v[58:59], v[58:59] op_sel_hi:[1,0,0]
    v_pk_fma_f32 v[46:47], v[46:47], v[58:59], v[58:59] op_sel_hi:[1,0,0]
    v_rcp_f32 v40, v40
    v_rcp_f32 v41, v41
    v_rcp_f32 v42, v42
    v_rcp_f32 v43, v43
    v_rcp_f32 v44, v44
    v_rcp_f32 v45, v45
    v_rcp_f32 v46, v46
    v_rcp_f32 v47, v47
    v_pk_mul_f32 v[64:65], v[64:65], v[40:41]
    v_pk_mul_f32 v[66:67], v[66:67], v[42:43]
    v_pk_mul_f32 v[68:69], v[68:69], v[44:45]
    v_pk_mul_f32 v[70:71], v[70:71], v[46:47]
    v_cvt_pk_bf16_f32 v64, v64, v65
    v_cvt_pk_bf16_f32 v65, v66, v67
    v_cvt_pk_bf16_f32 v66, v68, v69
    v_cvt_pk_bf16_f32 v67, v70, v71
    buffer_store_dwordx4 v[64:67], v5, s[4:7], s36 offen offset:0 sc1
    v_pk_mul_f32 v[48:49], v[72:73], v[72:73]
    v_pk_mul_f32 v[50:51], v[74:75], v[74:75]
    v_pk_mul_f32 v[52:53], v[76:77], v[76:77]
    v_pk_mul_f32 v[54:55], v[78:79], v[78:79]
    v_pk_fma_f32 v[48:49], v[48:49], v[56:57], v[56:57] op_sel:[0,1,0] op_sel_hi:[1,1,0]
    v_pk_fma_f32 v[50:51], v[50:51], v[56:57], v[56:57] op_sel:[0,1,0] op_sel_hi:[1,1,0]
    v_pk_fma_f32 v[52:53], v[52:53], v[56:57], v[56:57] op_sel:[0,1,0] op_sel_hi:[1,1,0]
    v_pk_fma_f32 v[54:55], v[54:55], v[56:57], v[56:57] op_sel:[0,1,0] op_sel_hi:[1,1,0]
    v_pk_mul_f32 v[48:49], v[48:49], v[72:73]
    v_pk_mul_f32 v[50:51], v[50:51], v[74:75]
    v_pk_mul_f32 v[52:53], v[52:53], v[76:77]
    v_pk_mul_f32 v[54:55], v[54:55], v[78:79]
    v_exp_f32 v48, v48
    v_exp_f32 v49, v49
    v_exp_f32 v50, v50
    v_exp_f32 v51, v51
    v_exp_f32 v52, v52
    v_exp_f32 v53, v53
    v_exp_f32 v54, v54
    v_exp_f32 v55, v55
    v_pk_fma_f32 v[48:49], v[48:49], v[58:59], v[58:59] op_sel_hi:[1,0,0]
    v_pk_fma_f32 v[50:51], v[50:51], v[58:59], v[58:59] op_sel_hi:[1,0,0]
    v_pk_fma_f32 v[52:53], v[52:53], v[58:59], v[58:59] op_sel_hi:[1,0,0]
    v_pk_fma_f32 v[54:55], v[54:55], v[58:59], v[58:59] op_sel_hi:[1,0,0]
    v_rcp_f32 v48, v48
    v_rcp_f32 v49, v49
    v_rcp_f32 v50, v50
    v_rcp_f32 v51, v51
    v_rcp_f32 v52, v52
    v_rcp_f32 v53, v53
    v_rcp_f32 v54, v54
    v_rcp_f32 v55, v55
    v_pk_mul_f32 v[72:73], v[72:73], v[48:49]
    v_pk_mul_f32 v[74:75], v[74:75], v[50:51]
    v_pk_mul_f32 v[76:77], v[76:77], v[52:53]
    v_pk_mul_f32 v[78:79], v[78:79], v[54:55]
    v_cvt_pk_bf16_f32 v72, v72, v73
    v_cvt_pk_bf16_f32 v73, v74, v75
    v_cvt_pk_bf16_f32 v74, v76, v77
    v_cvt_pk_bf16_f32 v75, v78, v79
    buffer_store_dwordx4 v[72:75], v5, s[4:7], s36 offen offset:256 sc1
    v_pk_mul_f32 v[40:41], v[80:81], v[80:81]
    v_pk_mul_f32 v[42:43], v[82:83], v[82:83]
    v_pk_mul_f32 v[44:45], v[84:85], v[84:85]
    v_pk_mul_f32 v[46:47], v[86:87], v[86:87]
    v_pk_fma_f32 v[40:41], v[40:41], v[56:57], v[56:57] op_sel:[0,1,0] op_sel_hi:[1,1,0]
    v_pk_fma_f32 v[42:43], v[42:43], v[56:57], v[56:57] op_sel:[0,1,0] op_sel_hi:[1,1,0]
    v_pk_fma_f32 v[44:45], v[44:45], v[56:57], v[56:57] op_sel:[0,1,0] op_sel_hi:[1,1,0]
    v_pk_fma_f32 v[46:47], v[46:47], v[56:57], v[56:57] op_sel:[0,1,0] op_sel_hi:[1,1,0]
    v_pk_mul_f32 v[40:41], v[40:41], v[80:81]
    v_pk_mul_f32 v[42:43], v[42:43], v[82:83]
    v_pk_mul_f32 v[44:45], v[44:45], v[84:85]
    v_pk_mul_f32 v[46:47], v[46:47], v[86:87]
    v_exp_f32 v40, v40
    v_exp_f32 v41, v41
    v_exp_f32 v42, v42
    v_exp_f32 v43, v43
    v_exp_f32 v44, v44
    v_exp_f32 v45, v45
    v_exp_f32 v46, v46
    v_exp_f32 v47, v47
    v_pk_fma_f32 v[40:41], v[40:41], v[58:59], v[58:59] op_sel_hi:[1,0,0]
    v_pk_fma_f32 v[42:43], v[42:43], v[58:59], v[58:59] op_sel_hi:[1,0,0]
    v_pk_fma_f32 v[44:45], v[44:45], v[58:59], v[58:59] op_sel_hi:[1,0,0]
    v_pk_fma_f32 v[46:47], v[46:47], v[58:59], v[58:59] op_sel_hi:[1,0,0]
    v_rcp_f32 v40, v40
    v_rcp_f32 v41, v41
    v_rcp_f32 v42, v42
    v_rcp_f32 v43, v43
    v_rcp_f32 v44, v44
    v_rcp_f32 v45, v45
    v_rcp_f32 v46, v46
    v_rcp_f32 v47, v47
    v_pk_mul_f32 v[80:81], v[80:81], v[40:41]
    v_pk_mul_f32 v[82:83], v[82:83], v[42:43]
    v_pk_mul_f32 v[84:85], v[84:85], v[44:45]
    v_pk_mul_f32 v[86:87], v[86:87], v[46:47]
    v_cvt_pk_bf16_f32 v80, v80, v81
    v_cvt_pk_bf16_f32 v81, v82, v83
    v_cvt_pk_bf16_f32 v82, v84, v85
    v_cvt_pk_bf16_f32 v83, v86, v87
    buffer_store_dwordx4 v[80:83], v5, s[4:7], s63 offen offset:0 sc1
    v_pk_mul_f32 v[48:49], v[88:89], v[88:89]
    v_pk_mul_f32 v[50:51], v[90:91], v[90:91]
    v_pk_mul_f32 v[52:53], v[92:93], v[92:93]
    v_pk_mul_f32 v[54:55], v[94:95], v[94:95]
    v_pk_fma_f32 v[48:49], v[48:49], v[56:57], v[56:57] op_sel:[0,1,0] op_sel_hi:[1,1,0]
    v_pk_fma_f32 v[50:51], v[50:51], v[56:57], v[56:57] op_sel:[0,1,0] op_sel_hi:[1,1,0]
    v_pk_fma_f32 v[52:53], v[52:53], v[56:57], v[56:57] op_sel:[0,1,0] op_sel_hi:[1,1,0]
    v_pk_fma_f32 v[54:55], v[54:55], v[56:57], v[56:57] op_sel:[0,1,0] op_sel_hi:[1,1,0]
    v_pk_mul_f32 v[48:49], v[48:49], v[88:89]
    v_pk_mul_f32 v[50:51], v[50:51], v[90:91]
    v_pk_mul_f32 v[52:53], v[52:53], v[92:93]
    v_pk_mul_f32 v[54:55], v[54:55], v[94:95]
    v_exp_f32 v48, v48
    v_exp_f32 v49, v49
    v_exp_f32 v50, v50
    v_exp_f32 v51, v51
    v_exp_f32 v52, v52
    v_exp_f32 v53, v53
    v_exp_f32 v54, v54
    v_exp_f32 v55, v55
    v_pk_fma_f32 v[48:49], v[48:49], v[58:59], v[58:59] op_sel_hi:[1,0,0]
    v_pk_fma_f32 v[50:51], v[50:51], v[58:59], v[58:59] op_sel_hi:[1,0,0]
    v_pk_fma_f32 v[52:53], v[52:53], v[58:59], v[58:59] op_sel_hi:[1,0,0]
    v_pk_fma_f32 v[54:55], v[54:55], v[58:59], v[58:59] op_sel_hi:[1,0,0]
    v_rcp_f32 v48, v48
    v_rcp_f32 v49, v49
    v_rcp_f32 v50, v50
    v_rcp_f32 v51, v51
    v_rcp_f32 v52, v52
    v_rcp_f32 v53, v53
    v_rcp_f32 v54, v54
    v_rcp_f32 v55, v55
    v_pk_mul_f32 v[88:89], v[88:89], v[48:49]
    v_pk_mul_f32 v[90:91], v[90:91], v[50:51]
    v_pk_mul_f32 v[92:93], v[92:93], v[52:53]
    v_pk_mul_f32 v[94:95], v[94:95], v[54:55]
    v_cvt_pk_bf16_f32 v88, v88, v89
    v_cvt_pk_bf16_f32 v89, v90, v91
    v_cvt_pk_bf16_f32 v90, v92, v93
    v_cvt_pk_bf16_f32 v91, v94, v95
    buffer_store_dwordx4 v[88:91], v5, s[4:7], s63 offen offset:256 sc1
    v_pk_mul_f32 v[40:41], v[96:97], v[96:97]
    v_pk_mul_f32 v[42:43], v[98:99], v[98:99]
    v_pk_mul_f32 v[44:45], v[100:101], v[100:101]
    v_pk_mul_f32 v[46:47], v[102:103], v[102:103]
    v_pk_fma_f32 v[40:41], v[40:41], v[56:57], v[56:57] op_sel:[0,1,0] op_sel_hi:[1,1,0]
    v_pk_fma_f32 v[42:43], v[42:43], v[56:57], v[56:57] op_sel:[0,1,0] op_sel_hi:[1,1,0]
    v_pk_fma_f32 v[44:45], v[44:45], v[56:57], v[56:57] op_sel:[0,1,0] op_sel_hi:[1,1,0]
    v_pk_fma_f32 v[46:47], v[46:47], v[56:57], v[56:57] op_sel:[0,1,0] op_sel_hi:[1,1,0]
    v_pk_mul_f32 v[40:41], v[40:41], v[96:97]
    v_pk_mul_f32 v[42:43], v[42:43], v[98:99]
    v_pk_mul_f32 v[44:45], v[44:45], v[100:101]
    v_pk_mul_f32 v[46:47], v[46:47], v[102:103]
    v_exp_f32 v40, v40
    v_exp_f32 v41, v41
    v_exp_f32 v42, v42
    v_exp_f32 v43, v43
    v_exp_f32 v44, v44
    v_exp_f32 v45, v45
    v_exp_f32 v46, v46
    v_exp_f32 v47, v47
    v_pk_fma_f32 v[40:41], v[40:41], v[58:59], v[58:59] op_sel_hi:[1,0,0]
    v_pk_fma_f32 v[42:43], v[42:43], v[58:59], v[58:59] op_sel_hi:[1,0,0]
    v_pk_fma_f32 v[44:45], v[44:45], v[58:59], v[58:59] op_sel_hi:[1,0,0]
    v_pk_fma_f32 v[46:47], v[46:47], v[58:59], v[58:59] op_sel_hi:[1,0,0]
    v_rcp_f32 v40, v40
    v_rcp_f32 v41, v41
    v_rcp_f32 v42, v42
    v_rcp_f32 v43, v43
    v_rcp_f32 v44, v44
    v_rcp_f32 v45, v45
    v_rcp_f32 v46, v46
    v_rcp_f32 v47, v47
    v_pk_mul_f32 v[96:97], v[96:97], v[40:41]
    v_pk_mul_f32 v[98:99], v[98:99], v[42:43]
    v_pk_mul_f32 v[100:101], v[100:101], v[44:45]
    v_pk_mul_f32 v[102:103], v[102:103], v[46:47]
    v_cvt_pk_bf16_f32 v96, v96, v97
    v_cvt_pk_bf16_f32 v97, v98, v99
    v_cvt_pk_bf16_f32 v98, v100, v101
    v_cvt_pk_bf16_f32 v99, v102, v103
    buffer_store_dwordx4 v[96:99], v5, s[4:7], s37 offen offset:0 sc1
    v_pk_mul_f32 v[48:49], v[104:105], v[104:105]
    v_pk_mul_f32 v[50:51], v[106:107], v[106:107]
    v_pk_mul_f32 v[52:53], v[108:109], v[108:109]
    v_pk_mul_f32 v[54:55], v[110:111], v[110:111]
    v_pk_fma_f32 v[48:49], v[48:49], v[56:57], v[56:57] op_sel:[0,1,0] op_sel_hi:[1,1,0]
    v_pk_fma_f32 v[50:51], v[50:51], v[56:57], v[56:57] op_sel:[0,1,0] op_sel_hi:[1,1,0]
    v_pk_fma_f32 v[52:53], v[52:53], v[56:57], v[56:57] op_sel:[0,1,0] op_sel_hi:[1,1,0]
    v_pk_fma_f32 v[54:55], v[54:55], v[56:57], v[56:57] op_sel:[0,1,0] op_sel_hi:[1,1,0]
    v_pk_mul_f32 v[48:49], v[48:49], v[104:105]
    v_pk_mul_f32 v[50:51], v[50:51], v[106:107]
    v_pk_mul_f32 v[52:53], v[52:53], v[108:109]
    v_pk_mul_f32 v[54:55], v[54:55], v[110:111]
    v_exp_f32 v48, v48
    v_exp_f32 v49, v49
    v_exp_f32 v50, v50
    v_exp_f32 v51, v51
    v_exp_f32 v52, v52
    v_exp_f32 v53, v53
    v_exp_f32 v54, v54
    v_exp_f32 v55, v55
    v_pk_fma_f32 v[48:49], v[48:49], v[58:59], v[58:59] op_sel_hi:[1,0,0]
    v_pk_fma_f32 v[50:51], v[50:51], v[58:59], v[58:59] op_sel_hi:[1,0,0]
    v_pk_fma_f32 v[52:53], v[52:53], v[58:59], v[58:59] op_sel_hi:[1,0,0]
    v_pk_fma_f32 v[54:55], v[54:55], v[58:59], v[58:59] op_sel_hi:[1,0,0]
    v_rcp_f32 v48, v48
    v_rcp_f32 v49, v49
    v_rcp_f32 v50, v50
    v_rcp_f32 v51, v51
    v_rcp_f32 v52, v52
    v_rcp_f32 v53, v53
    v_rcp_f32 v54, v54
    v_rcp_f32 v55, v55
    v_pk_mul_f32 v[104:105], v[104:105], v[48:49]
    v_pk_mul_f32 v[106:107], v[106:107], v[50:51]
    v_pk_mul_f32 v[108:109], v[108:109], v[52:53]
    v_pk_mul_f32 v[110:111], v[110:111], v[54:55]
    v_cvt_pk_bf16_f32 v104, v104, v105
    v_cvt_pk_bf16_f32 v105, v106, v107
    v_cvt_pk_bf16_f32 v106, v108, v109
    v_cvt_pk_bf16_f32 v107, v110, v111
    buffer_store_dwordx4 v[104:107], v5, s[4:7], s37 offen offset:256 sc1
    s_add_u32 s44, s101, 131072
    v_lshrrev_b32 v48, 2, v0
    v_add_u32 v48, s44, v48
    v_xor_b32 v49, 16, v48
    v_xor_b32 v50, 0x80, v48
    v_xor_b32 v51, 0x90, v48
    s_lshr_b32 s44, s16, 1
    s_lshl_b32 s44, s44, 12
    s_and_b32 s45, s16, 1
    s_lshl_b32 s45, s45, 7
    s_add_u32 s44, s44, s45
    s_add_u32 s44, s44, 131072
    v_bfe_u32 v52, v0, 8, 2
    v_lshl_add_u32 v57, v52, 10, s44
    v_bfe_u32 v52, v0, 4, 2
    v_lshl_add_u32 v57, v52, 8, v57
    v_and_b32 v52, 0x50, v0
    v_add_u32 v57, v57, v52
    v_bfe_u32 v52, v0, 7, 1
    v_lshl_add_u32 v57, v52, 5, v57
    v_and_b32 v52, 0x20, v0
    v_lshlrev_b32 v52, 2, v52
    v_xor_b32 v57, v57, v52
    v_xor_b32 v58, 16, v57
    v_subrev_u32 v52, 98304, v48
    v_subrev_u32 v53, 98304, v49
    v_subrev_u32 v54, 98304, v50
    v_subrev_u32 v55, 98304, v51
    v_bfe_u32 v60, v0, 7, 3
    v_bfe_u32 v61, v0, 4, 3
    v_lshlrev_b32 v19, 10, v61
    v_lshl_add_u32 v19, v60, 4, v19
    s_mov_b32 s33, s97
    s_add_u32 s96, s97, 32768
    s_add_u32 s45, s98, 6
    s_mov_b64 exec, 1
    v_mov_b32 v56, s45
    s_waitcnt vmcnt(0)
    buffer_store_dword v56, off, s[4:7], s38 offset:0
    s_mov_b64 exec, -1
    s_add_u32 s45, s98, 6
    s_mov_b32 exec_hi, 0
    s_mov_b32 exec_lo, s95
    s_mov_b32 s50, 0
Lpoll_30:
    buffer_load_dword v56, v21, s[4:7], s40 offen sc1
    s_add_u32 s50, s50, 1
    s_cmp_gt_u32 s50, 0x40000
    s_cbranch_scc1 Labort
    s_waitcnt vmcnt(0)
    v_cmp_ne_u32 vcc, s45, v56
    s_cbranch_vccnz Lpoll_30
    s_mov_b64 exec, -1
    s_add_u32 s51, s39, 0
    buffer_load_dwordx4 v[128:131], v0, s[4:7], s51 offen offset:0 sc1
    buffer_load_dwordx4 v[132:135], v0, s[4:7], s51 offen offset:2048 sc1
    s_add_u32 s51, s39, 4096
    buffer_load_dwordx4 v[136:139], v0, s[4:7], s51 offen offset:0 sc1
    buffer_load_dwordx4 v[140:143], v0, s[4:7], s51 offen offset:2048 sc1
    s_add_u32 s51, s39, 8192
    buffer_load_dwordx4 v[144:147], v0, s[4:7], s51 offen offset:0 sc1
    buffer_load_dwordx4 v[148:151], v0, s[4:7], s51 offen offset:2048 sc1
    s_add_u32 s51, s39, 12288
    buffer_load_dwordx4 v[152:155], v0, s[4:7], s51 offen offset:0 sc1
    buffer_load_dwordx4 v[156:159], v0, s[4:7], s51 offen offset:2048 sc1
    s_add_u32 s51, s39, 16384
    buffer_load_dwordx4 v[160:163], v0, s[4:7], s51 offen offset:0 sc1
    buffer_load_dwordx4 v[164:167], v0, s[4:7], s51 offen offset:2048 sc1
    s_barrier
    s_waitcnt vmcnt(9)
    v_mfma_f32_16x16x32_bf16 v[64:67], v[128:131], a[64:67], 0
    s_add_u32 s51, s39, 20480
    s_cmp_eq_u32 s16, 3
    s_cselect_b32 s51, 268435456, s51
    buffer_load_dwordx4 v[168:171], v0, s[4:7], s51 offen offset:0 sc1
    v_mfma_f32_16x16x32_bf16 v[68:71], v[128:131], a[68:71], 0
    v_mfma_f32_16x16x32_bf16 v[72:75], v[128:131], a[72:75], 0
    v_mfma_f32_16x16x32_bf16 v[76:79], v[128:131], a[76:79], 0
    s_waitcnt vmcnt(9)
    v_mfma_f32_16x16x32_bf16 v[64:67], v[132:135], a[80:83], v[64:67]
    s_add_u32 s51, s39, 1024
    buffer_load_dwordx4 v[172:175], v0, s[4:7], s51 offen offset:0 sc1
    v_mfma_f32_16x16x32_bf16 v[68:71], v[132:135], a[84:87], v[68:71]
    v_mfma_f32_16x16x32_bf16 v[72:75], v[132:135], a[88:91], v[72:75]
    v_mfma_f32_16x16x32_bf16 v[76:79], v[132:135], a[92:95], v[76:79]
    s_waitcnt vmcnt(9)
    v_mfma_f32_16x16x32_bf16 v[64:67], v[136:139], a[96:99], v[64:67]
    buffer_load_dwordx4 v[176:179], v0, s[4:7], s51 offen offset:2048 sc1
    v_mfma_f32_16x16x32_bf16 v[68:71], v[136:139], a[100:103], v[68:71]
    v_mfma_f32_16x16x32_bf16 v[72:75], v[136:139], a[104:107], v[72:75]
    v_mfma_f32_16x16x32_bf16 v[76:79], v[136:139], a[108:111], v[76:79]
    s_waitcnt vmcnt(9)
    v_mfma_f32_16x16x32_bf16 v[64:67], v[140:143], a[112:115], v[64:67]
    s_add_u32 s51, s39, 5120
    buffer_load_dwordx4 v[180:183], v0, s[4:7], s51 offen offset:0 sc1
    v_mfma_f32_16x16x32_bf16 v[68:71], v[140:143], a[116:119], v[68:71]
    v_mfma_f32_16x16x32_bf16 v[72:75], v[140:143], a[120:123], v[72:75]
    v_mfma_f32_16x16x32_bf16 v[76:79], v[140:143], a[124:127], v[76:79]
    s_waitcnt vmcnt(9)
    v_mfma_f32_16x16x32_bf16 v[64:67], v[144:147], a[128:131], v[64:67]
    buffer_load_dwordx4 v[184:187], v0, s[4:7], s51 offen offset:2048 sc1
    v_mfma_f32_16x16x32_bf16 v[68:71], v[144:147], a[132:135], v[68:71]
    v_mfma_f32_16x16x32_bf16 v[72:75], v[144:147], a[136:139], v[72:75]
    v_mfma_f32_16x16x32_bf16 v[76:79], v[144:147], a[140:143], v[76:79]
    s_waitcnt vmcnt(9)
    v_mfma_f32_16x16x32_bf16 v[64:67], v[148:151], a[144:147], v[64:67]
    s_add_u32 s51, s39, 9216
    buffer_load_dwordx4 v[188:191], v0, s[4:7], s51 offen offset:0 sc1
    v_mfma_f32_16x16x32_bf16 v[68:71], v[148:151], a[148:151], v[68:71]
    v_mfma_f32_16x16x32_bf16 v[72:75], v[148:151], a[152:155], v[72:75]
    v_mfma_f32_16x16x32_bf16 v[76:79], v[148:151], a[156:159], v[76:79]
    s_waitcnt vmcnt(9)
    v_mfma_f32_16x16x32_bf16 v[64:67], v[152:155], a[160:163], v[64:67]
    buffer_load_dwordx4 v[192:195], v0, s[4:7], s51 offen offset:2048 sc1
    v_mfma_f32_16x16x32_bf16 v[68:71], v[152:155], a[164:167], v[68:71]
    v_mfma_f32_16x16x32_bf16 v[72:75], v[152:155], a[168:171], v[72:75]
    v_mfma_f32_16x16x32_bf16 v[76:79], v[152:155], a[172:175], v[76:79]
    s_waitcnt vmcnt(9)
    v_mfma_f32_16x16x32_bf16 v[64:67], v[156:159], a[176:179], v[64:67]
    s_add_u32 s51, s39, 13312
    buffer_load_dwordx4 v[196:199], v0, s[4:7], s51 offen offset:0 sc1
    v_mfma_f32_16x16x32_bf16 v[68:71], v[156:159], a[180:183], v[68:71]
    v_mfma_f32_16x16x32_bf16 v[72:75], v[156:159], a[184:187], v[72:75]
    v_mfma_f32_16x16x32_bf16 v[76:79], v[156:159], a[188:191], v[76:79]
    s_waitcnt vmcnt(9)
    v_mfma_f32_16x16x32_bf16 v[64:67], v[160:163], a[192:195], v[64:67]
    buffer_load_dwordx4 v[200:203], v0, s[4:7], s51 offen offset:2048 sc1
    v_mfma_f32_16x16x32_bf16 v[68:71], v[160:163], a[196:199], v[68:71]
    v_mfma_f32_16x16x32_bf16 v[72:75], v[160:163], a[200:203], v[72:75]
    v_mfma_f32_16x16x32_bf16 v[76:79], v[160:163], a[204:207], v[76:79]
    s_waitcnt vmcnt(9)
    v_mfma_f32_16x16x32_bf16 v[64:67], v[164:167], a[208:211], v[64:67]
    s_add_u32 s51, s39, 17408
    buffer_load_dwordx4 v[204:207], v0, s[4:7], s51 offen offset:0 sc1
    v_mfma_f32_16x16x32_bf16 v[68:71], v[164:167], a[212:215], v[68:71]
    v_mfma_f32_16x16x32_bf16 v[72:75], v[164:167], a[216:219], v[72:75]
    v_mfma_f32_16x16x32_bf16 v[76:79], v[164:167], a[220:223], v[76:79]
    s_waitcnt vmcnt(9)
    v_mfma_f32_16x16x32_bf16 v[64:67], v[168:171], a[224:227], v[64:67]
    buffer_load_dwordx4 v[208:211], v0, s[4:7], s51 offen offset:2048 sc1
    v_mfma_f32_16x16x32_bf16 v[68:71], v[168:171], a[228:231], v[68:71]
    v_mfma_f32_16x16x32_bf16 v[72:75], v[168:171], a[232:235], v[72:75]
    v_mfma_f32_16x16x32_bf16 v[76:79], v[168:171], a[236:239], v[76:79]
    s_waitcnt vmcnt(9)
    v_mfma_f32_16x16x32_bf16 v[80:83], v[172:175], a[64:67], 0
    s_add_u32 s51, s39, 21504
    s_cmp_eq_u32 s16, 3
    s_cselect_b32 s51, 268435456, s51
    buffer_load_dwordx4 v[212:215], v0, s[4:7], s51 offen offset:0 sc1
    ds_write_b32 v48, v64 offset:0
    v_mfma_f32_16x16x32_bf16 v[84:87], v[172:175], a[68:71], 0
    ds_write_b32 v49, v65 offset:256
    v_mfma_f32_16x16x32_bf16 v[88:91], v[172:175], a[72:75], 0
    ds_write_b32 v50, v66 offset:512
    v_mfma_f32_16x16x32_bf16 v[92:95], v[172:175], a[76:79], 0
    ds_write_b32 v51, v67 offset:768
    s_waitcnt vmcnt(9)
    v_mfma_f32_16x16x32_bf16 v[80:83], v[176:179], a[80:83], v[80:83]
    s_add_u32 s51, s39, 88064
    buffer_load_dwordx4 v[216:219], v0, s[4:7], s51 offen offset:0 sc1
    ds_write_b32 v48, v68 offset:1024
    v_mfma_f32_16x16x32_bf16 v[84:87], v[176:179], a[84:87], v[84:87]
    ds_write_b32 v49, v69 offset:1280
    v_mfma_f32_16x16x32_bf16 v[88:91], v[176:179], a[88:91], v[88:91]
    ds_write_b32 v50, v70 offset:1536
    v_mfma_f32_16x16x32_bf16 v[92:95], v[176:179], a[92:95], v[92:95]
    ds_write_b32 v51, v71 offset:1792
    s_waitcnt vmcnt(9)
    v_mfma_f32_16x16x32_bf16 v[80:83], v[180:183], a[96:99], v[80:83]
    buffer_load_dwordx4 v[220:223], v0, s[4:7], s51 offen offset:2048 sc1
    ds_write_b32 v48, v72 offset:2048
    v_mfma_f32_16x16x32_bf16 v[84:87], v[180:183], a[100:103], v[84:87]
    ds_write_b32 v49, v73 offset:2304
    v_mfma_f32_16x16x32_bf16 v[88:91], v[180:183], a[104:107], v[88:91]
    ds_write_b32 v50, v74 offset:2560
    v_mfma_f32_16x16x32_bf16 v[92:95], v[180:183], a[108:111], v[92:95]
    ds_write_b32 v51, v75 offset:2816
    s_waitcnt vmcnt(9)
    v_mfma_f32_16x16x32_bf16 v[80:83], v[184:187], a[112:115], v[80:83]
    s_add_u32 s51, s39, 92160
    buffer_load_dwordx4 v[224:227], v0, s[4:7], s51 offen offset:0 sc1
    ds_write_b32 v48, v76 offset:3072
    v_mfma_f32_16x16x32_bf16 v[84:87], v[184:187], a[116:119], v[84:87]
    ds_write_b32 v49, v77 offset:3328
    v_mfma_f32_16x16x32_bf16 v[88:91], v[184:187], a[120:123], v[88:91]
    ds_write_b32 v50, v78 offset:3584
    v_mfma_f32_16x16x32_bf16 v[92:95], v[184:187], a[124:127], v[92:95]
    ds_write_b32 v51, v79 offset:3840
    s_waitcnt vmcnt(9)
    v_mfma_f32_16x16x32_bf16 v[80:83], v[188:191], a[128:131], v[80:83]
    buffer_load_dwordx4 v[228:231], v0, s[4:7], s51 offen offset:2048 sc1
    v_mfma_f32_16x16x32_bf16 v[84:87], v[188:191], a[132:135], v[84:87]
    v_mfma_f32_16x16x32_bf16 v[88:91], v[188:191], a[136:139], v[88:91]
    v_mfma_f32_16x16x32_bf16 v[92:95], v[188:191], a[140:143], v[92:95]
    s_waitcnt vmcnt(9)
    v_mfma_f32_16x16x32_bf16 v[80:83], v[192:195], a[144:147], v[80:83]
    s_add_u32 s51, s39, 96256
    buffer_load_dwordx4 v[232:235], v0, s[4:7], s51 offen offset:0 sc1
    v_mfma_f32_16x16x32_bf16 v[84:87], v[192:195], a[148:151], v[84:87]
    v_mfma_f32_16x16x32_bf16 v[88:91], v[192:195], a[152:155], v[88:91]
    v_mfma_f32_16x16x32_bf16 v[92:95], v[192:195], a[156:159], v[92:95]
    s_waitcnt vmcnt(9)
    v_mfma_f32_16x16x32_bf16 v[80:83], v[196:199], a[160:163], v[80:83]
    buffer_load_dwordx4 v[236:239], v0, s[4:7], s51 offen offset:2048 sc1
    v_mfma_f32_16x16x32_bf16 v[84:87], v[196:199], a[164:167], v[84:87]
    v_mfma_f32_16x16x32_bf16 v[88:91], v[196:199], a[168:171], v[88:91]
    v_mfma_f32_16x16x32_bf16 v[92:95], v[196:199], a[172:175], v[92:95]
    s_waitcnt vmcnt(9)
    v_mfma_f32_16x16x32_bf16 v[80:83], v[200:203], a[176:179], v[80:83]
    s_add_u32 s51, s39, 100352
    buffer_load_dwordx4 v[240:243], v0, s[4:7], s51 offen offset:0 sc1
    v_mfma_f32_16x16x32_bf16 v[84:87], v[200:203], a[180:183], v[84:87]
    v_mfma_f32_16x16x32_bf16 v[88:91], v[200:203], a[184:187], v[88:91]
    v_mfma_f32_16x16x32_bf16 v[92:95], v[200:203], a[188:191], v[92:95]
    s_waitcnt vmcnt(9)
    v_mfma_f32_16x16x32_bf16 v[80:83], v[204:207], a[192:195], v[80:83]
    buffer_load_dwordx4 v[244:247], v0, s[4:7], s51 offen offset:2048 sc1
    v_mfma_f32_16x16x32_bf16 v[84:87], v[204:207], a[196:199], v[84:87]
    v_mfma_f32_16x16x32_bf16 v[88:91], v[204:207], a[200:203], v[88:91]
    v_mfma_f32_16x16x32_bf16 v[92:95], v[204:207], a[204:207], v[92:95]
    s_waitcnt vmcnt(9)
    v_mfma_f32_16x16x32_bf16 v[80:83], v[208:211], a[208:211], v[80:83]
    s_add_u32 s51, s39, 104448
    buffer_load_dwordx4 v[248:251], v0, s[4:7], s51 offen offset:0 sc1
    v_mfma_f32_16x16x32_bf16 v[84:87], v[208:211], a[212:215], v[84:87]
    v_mfma_f32_16x16x32_bf16 v[88:91], v[208:211], a[216:219], v[88:91]
    v_mfma_f32_16x16x32_bf16 v[92:95], v[208:211], a[220:223], v[92:95]
    s_waitcnt vmcnt(9)
    v_mfma_f32_16x16x32_bf16 v[80:83], v[212:215], a[224:227], v[80:83]
    buffer_load_dwordx4 v[252:255], v0, s[4:7], s51 offen offset:2048 sc1
    v_mfma_f32_16x16x32_bf16 v[84:87], v[212:215], a[228:231], v[84:87]
    v_mfma_f32_16x16x32_bf16 v[88:91], v[212:215], a[232:235], v[88:91]
    v_mfma_f32_16x16x32_bf16 v[92:95], v[212:215], a[236:239], v[92:95]
    s_waitcnt vmcnt(9)
    v_mfma_f32_16x16x32_bf16 v[96:99], v[216:219], a[64:67], 0
    s_add_u32 s51, s39, 108544
    s_cmp_eq_u32 s16, 3
    s_cselect_b32 s51, 268435456, s51
    buffer_load_dwordx4 v[128:131], v0, s[4:7], s51 offen offset:0 sc1
    ds_write_b32 v48, v80 offset:4096
    v_mfma_f32_16x16x32_bf16 v[100:103], v[216:219], a[68:71], 0
    ds_write_b32 v49, v81 offset:4352
    v_mfma_f32_16x16x32_bf16 v[104:107], v[216:219], a[72:75], 0
    ds_write_b32 v50, v82 offset:4608
    v_mfma_f32_16x16x32_bf16 v[108:111], v[216:219], a[76:79], 0
    ds_write_b32 v51, v83 offset:4864
    s_waitcnt vmcnt(9)
    v_mfma_f32_16x16x32_bf16 v[96:99], v[220:223], a[80:83], v[96:99]
    s_add_u32 s51, s39, 89088
    buffer_load_dwordx4 v[132:135], v0, s[4:7], s51 offen offset:0 sc1
    ds_write_b32 v48, v84 offset:5120
    v_mfma_f32_16x16x32_bf16 v[100:103], v[220:223], a[84:87], v[100:103]
    ds_write_b32 v49, v85 offset:5376
    v_mfma_f32_16x16x32_bf16 v[104:107], v[220:223], a[88:91], v[104:107]
    ds_write_b32 v50, v86 offset:5632
    v_mfma_f32_16x16x32_bf16 v[108:111], v[220:223], a[92:95], v[108:111]
    ds_write_b32 v51, v87 offset:5888
    s_waitcnt vmcnt(9)
    v_mfma_f32_16x16x32_bf16 v[96:99], v[224:227], a[96:99], v[96:99]
    buffer_load_dwordx4 v[136:139], v0, s[4:7], s51 offen offset:2048 sc1
    ds_write_b32 v48, v88 offset:6144
    v_mfma_f32_16x16x32_bf16 v[100:103], v[224:227], a[100:103], v[100:103]
    ds_write_b32 v49, v89 offset:6400
    v_mfma_f32_16x16x32_bf16 v[104:107], v[224:227], a[104:107], v[104:107]
    ds_write_b32 v50, v90 offset:6656
    v_mfma_f32_16x16x32_bf16 v[108:111], v[224:227], a[108:111], v[108:111]
    ds_write_b32 v51, v91 offset:6912
    s_waitcnt vmcnt(9)
    v_mfma_f32_16x16x32_bf16 v[96:99], v[228:231], a[112:115], v[96:99]
    s_add_u32 s51, s39, 93184
    buffer_load_dwordx4 v[140:143], v0, s[4:7], s51 offen offset:0 sc1
    ds_write_b32 v48, v92 offset:7168
    v_mfma_f32_16x16x32_bf16 v[100:103], v[228:231], a[116:119], v[100:103]
    ds_write_b32 v49, v93 offset:7424
    v_mfma_f32_16x16x32_bf16 v[104:107], v[228:231], a[120:123], v[104:107]
    ds_write_b32 v50, v94 offset:7680
    v_mfma_f32_16x16x32_bf16 v[108:111], v[228:231], a[124:127], v[108:111]
    ds_write_b32 v51, v95 offset:7936
    s_waitcnt vmcnt(9)
    v_mfma_f32_16x16x32_bf16 v[96:99], v[232:235], a[128:131], v[96:99]
    buffer_load_dwordx4 v[144:147], v0, s[4:7], s51 offen offset:2048 sc1
    v_mfma_f32_16x16x32_bf16 v[100:103], v[232:235], a[132:135], v[100:103]
    v_mfma_f32_16x16x32_bf16 v[104:107], v[232:235], a[136:139], v[104:107]
    v_mfma_f32_16x16x32_bf16 v[108:111], v[232:235], a[140:143], v[108:111]
    s_waitcnt lgkmcnt(0)
    s_barrier
    s_waitcnt vmcnt(9)
    v_mfma_f32_16x16x32_bf16 v[96:99], v[236:239], a[144:147], v[96:99]
    s_add_u32 s51, s39, 97280
    buffer_load_dwordx4 v[148:151], v0, s[4:7], s51 offen offset:0 sc1
    v_mfma_f32_16x16x32_bf16 v[100:103], v[236:239], a[148:151], v[100:103]
    ds_read_b128 v[64:67], v57 offset:0
    ds_read_b128 v[68:71], v58 offset:0
    v_mfma_f32_16x16x32_bf16 v[104:107], v[236:239], a[152:155], v[104:107]
    ds_read_b128 v[72:75], v57 offset:8192
    ds_read_b128 v[76:79], v58 offset:8192
    v_mfma_f32_16x16x32_bf16 v[108:111], v[236:239], a[156:159], v[108:111]
    ds_read_b128 v[80:83], v57 offset:16384
    s_waitcnt vmcnt(9)
    v_mfma_f32_16x16x32_bf16 v[96:99], v[240:243], a[160:163], v[96:99]
    buffer_load_dwordx4 v[152:155], v0, s[4:7], s51 offen offset:2048 sc1
    ds_read_b128 v[84:87], v58 offset:16384
    v_mfma_f32_16x16x32_bf16 v[100:103], v[240:243], a[164:167], v[100:103]
    ds_read_b128 v[88:91], v57 offset:24576
    ds_read_b128 v[92:95], v58 offset:24576
    v_mfma_f32_16x16x32_bf16 v[104:107], v[240:243], a[168:171], v[104:107]
    v_subrev_u32 v57, 98304, v57
    v_subrev_u32 v58, 98304, v58
    v_mfma_f32_16x16x32_bf16 v[108:111], v[240:243], a[172:175], v[108:111]
    s_nop 0
    s_waitcnt vmcnt(9)
    v_mfma_f32_16x16x32_bf16 v[96:99], v[244:247], a[176:179], v[96:99]
    s_add_u32 s51, s39, 101376
    buffer_load_dwordx4 v[156:159], v0, s[4:7], s51 offen offset:0 sc1
    v_mfma_f32_16x16x32_bf16 v[100:103], v[244:247], a[180:183], v[100:103]
    s_nop 0
    s_nop 0
    v_mfma_f32_16x16x32_bf16 v[104:107], v[244:247], a[184:187], v[104:107]
    s_nop 0
    s_waitcnt lgkmcnt(0)
    v_mfma_f32_16x16x32_bf16 v[108:111], v[244:247], a[188:191], v[108:111]
    v_add_f32 v24, v24, v64
    s_waitcnt vmcnt(9)
    v_mfma_f32_16x16x32_bf16 v[96:99], v[248:251], a[192:195], v[96:99]
    buffer_load_dwordx4 v[160:163], v0, s[4:7], s51 offen offset:2048 sc1
    v_add_f32 v25, v25, v65
    v_mfma_f32_16x16x32_bf16 v[100:103], v[248:251], a[196:199], v[100:103]
    v_add_f32 v26, v26, v66
    v_add_f32 v27, v27, v67
    v_mfma_f32_16x16x32_bf16 v[104:107], v[248:251], a[200:203], v[104:107]
    v_add_f32 v28, v28, v68
    v_add_f32 v29, v29, v69
    v_mfma_f32_16x16x32_bf16 v[108:111], v[248:251], a[204:207], v[108:111]
    v_add_f32 v30, v30, v70
    s_waitcnt vmcnt(9)
    v_mfma_f32_16x16x32_bf16 v[96:99], v[252:255], a[208:211], v[96:99]
    s_add_u32 s51, s39, 105472
    buffer_load_dwordx4 v[164:167], v0, s[4:7], s51 offen offset:0 sc1
    v_mfma_f32_16x16x32_bf16 v[100:103], v[252:255], a[212:215], v[100:103]
    v_add_f32 v31, v31, v71
    v_add_f32 v24, v24, v72
    v_mfma_f32_16x16x32_bf16 v[104:107], v[252:255], a[216:219], v[104:107]
    v_add_f32 v25, v25, v73
    v_add_f32 v26, v26, v74
    v_mfma_f32_16x16x32_bf16 v[108:111], v[252:255], a[220:223], v[108:111]
    v_add_f32 v27, v27, v75
    s_waitcnt vmcnt(9)
    v_mfma_f32_16x16x32_bf16 v[96:99], v[128:131], a[224:227], v[96:99]
    buffer_load_dwordx4 v[168:171], v0, s[4:7], s51 offen offset:2048 sc1
    v_add_f32 v28, v28, v76
    v_mfma_f32_16x16x32_bf16 v[100:103], v[128:131], a[228:231], v[100:103]
    v_add_f32 v29, v29, v77
    v_add_f32 v30, v30, v78
    v_mfma_f32_16x16x32_bf16 v[104:107], v[128:131], a[232:235], v[104:107]
    v_add_f32 v31, v31, v79
    v_add_f32 v24, v24, v80
    v_mfma_f32_16x16x32_bf16 v[108:111], v[128:131], a[236:239], v[108:111]
    v_add_f32 v25, v25, v81
    s_waitcnt vmcnt(9)
    v_mfma_f32_16x16x32_bf16 v[112:115], v[132:135], a[64:67], 0
    s_add_u32 s51, s39, 109568
    s_cmp_eq_u32 s16, 3
    s_cselect_b32 s51, 268435456, s51
    buffer_load_dwordx4 v[172:175], v0, s[4:7], s51 offen offset:0 sc1
    ds_write_b32 v52, v96 offset:0
    v_mfma_f32_16x16x32_bf16 v[116:119], v[132:135], a[68:71], 0
    ds_write_b32 v53, v97 offset:256
    v_add_f32 v26, v26, v82
    v_mfma_f32_16x16x32_bf16 v[120:123], v[132:135], a[72:75], 0
    ds_write_b32 v54, v98 offset:512
    v_add_f32 v27, v27, v83
    v_mfma_f32_16x16x32_bf16 v[124:127], v[132:135], a[76:79], 0
    ds_write_b32 v55, v99 offset:768
    s_waitcnt vmcnt(9)
    v_mfma_f32_16x16x32_bf16 v[112:115], v[136:139], a[80:83], v[112:115]
    ds_write_b32 v52, v100 offset:1024
    v_add_f32 v28, v28, v84
    v_mfma_f32_16x16x32_bf16 v[116:119], v[136:139], a[84:87], v[116:119]
    ds_write_b32 v53, v101 offset:1280
    v_add_f32 v29, v29, v85
    v_mfma_f32_16x16x32_bf16 v[120:123], v[136:139], a[88:91], v[120:123]
    ds_write_b32 v54, v102 offset:1536
    v_add_f32 v30, v30, v86
    v_mfma_f32_16x16x32_bf16 v[124:127], v[136:139], a[92:95], v[124:127]
    ds_write_b32 v55, v103 offset:1792
    s_waitcnt vmcnt(8)
    v_mfma_f32_16x16x32_bf16 v[112:115], v[140:143], a[96:99], v[112:115]
    ds_write_b32 v52, v104 offset:2048
    v_add_f32 v31, v31, v87
    v_mfma_f32_16x16x32_bf16 v[116:119], v[140:143], a[100:103], v[116:119]
    ds_write_b32 v53, v105 offset:2304
    v_add_f32 v24, v24, v88
    v_mfma_f32_16x16x32_bf16 v[120:123], v[140:143], a[104:107], v[120:123]
    ds_write_b32 v54, v106 offset:2560
    v_add_f32 v25, v25, v89
    v_mfma_f32_16x16x32_bf16 v[124:127], v[140:143], a[108:111], v[124:127]
    ds_write_b32 v55, v107 offset:2816
    s_waitcnt vmcnt(7)
    v_mfma_f32_16x16x32_bf16 v[112:115], v[144:147], a[112:115], v[112:115]
    ds_write_b32 v52, v108 offset:3072
    v_add_f32 v26, v26, v90
    v_mfma_f32_16x16x32_bf16 v[116:119], v[144:147], a[116:119], v[116:119]
    ds_write_b32 v53, v109 offset:3328
    v_add_f32 v27, v27, v91
    v_mfma_f32_16x16x32_bf16 v[120:123], v[144:147], a[120:123], v[120:123]
    ds_write_b32 v54, v110 offset:3584
    v_add_f32 v28, v28, v92
    v_mfma_f32_16x16x32_bf16 v[124:127], v[144:147], a[124:127], v[124:127]
    ds_write_b32 v55, v111 offset:3840
    s_waitcnt vmcnt(6)
    v_mfma_f32_16x16x32_bf16 v[112:115], v[148:151], a[128:131], v[112:115]
    v_add_f32 v29, v29, v93
    v_add_f32 v30, v30, v94
    v_mfma_f32_16x16x32_bf16 v[116:119], v[148:151], a[132:135], v[116:119]
    v_add_f32 v31, v31, v95
    v_cvt_pk_bf16_f32 v40, v24, v25
    v_mfma_f32_16x16x32_bf16 v[120:123], v[148:151], a[136:139], v[120:123]
    v_cvt_pk_bf16_f32 v41, v26, v27
    v_cvt_pk_bf16_f32 v42, v28, v29
    v_mfma_f32_16x16x32_bf16 v[124:127], v[148:151], a[140:143], v[124:127]
    v_cvt_pk_bf16_f32 v43, v30, v31
    s_waitcnt vmcnt(5)
    v_mfma_f32_16x16x32_bf16 v[112:115], v[152:155], a[144:147], v[112:115]
    buffer_store_dwordx4 v[40:43], v19, s[8:11], s33 offen
    v_mfma_f32_16x16x32_bf16 v[116:119], v[152:155], a[148:151], v[116:119]
    v_mfma_f32_16x16x32_bf16 v[120:123], v[152:155], a[152:155], v[120:123]
    v_mfma_f32_16x16x32_bf16 v[124:127], v[152:155], a[156:159], v[124:127]
    s_waitcnt vmcnt(5)
    v_mfma_f32_16x16x32_bf16 v[112:115], v[156:159], a[160:163], v[112:115]
    s_nop 0
    v_mfma_f32_16x16x32_bf16 v[116:119], v[156:159], a[164:167], v[116:119]
    s_nop 0
    v_mfma_f32_16x16x32_bf16 v[120:123], v[156:159], a[168:171], v[120:123]
    s_nop 0
    v_mfma_f32_16x16x32_bf16 v[124:127], v[156:159], a[172:175], v[124:127]
    s_nop 0
    s_waitcnt vmcnt(4)
    v_mfma_f32_16x16x32_bf16 v[112:115], v[160:163], a[176:179], v[112:115]
    s_nop 0
    s_waitcnt vmcnt(3)
    v_mfma_f32_16x16x32_bf16 v[112:115], v[164:167], a[192:195], v[112:115]
    s_nop 0
    s_waitcnt vmcnt(2)
    v_mfma_f32_16x16x32_bf16 v[112:115], v[168:171], a[208:211], v[112:115]
    s_nop 0
    s_waitcnt vmcnt(1)
    v_mfma_f32_16x16x32_bf16 v[112:115], v[172:175], a[224:227], v[112:115]
    s_nop 0
    v_mfma_f32_16x16x32_bf16 v[116:119], v[160:163], a[180:183], v[116:119]
    s_nop 0
    v_mfma_f32_16x16x32_bf16 v[116:119], v[164:167], a[196:199], v[116:119]
    s_nop 0
    v_mfma_f32_16x16x32_bf16 v[116:119], v[168:171], a[212:215], v[116:119]
    s_nop 0
    v_mfma_f32_16x16x32_bf16 v[116:119], v[172:175], a[228:231], v[116:119]
    ds_write_b32 v52, v112 offset:4096
    v_mfma_f32_16x16x32_bf16 v[120:123], v[160:163], a[184:187], v[120:123]
    ds_write_b32 v53, v113 offset:4352
    v_mfma_f32_16x16x32_bf16 v[120:123], v[164:167], a[200:203], v[120:123]
    ds_write_b32 v54, v114 offset:4608
    v_mfma_f32_16x16x32_bf16 v[120:123], v[168:171], a[216:219], v[120:123]
    ds_write_b32 v55, v115 offset:4864
    v_mfma_f32_16x16x32_bf16 v[120:123], v[172:175], a[232:235], v[120:123]
    ds_write_b32 v52, v116 offset:5120
    v_mfma_f32_16x16x32_bf16 v[124:127], v[160:163], a[188:191], v[124:127]
    ds_write_b32 v53, v117 offset:5376
    v_mfma_f32_16x16x32_bf16 v[124:127], v[164:167], a[204:207], v[124:127]
    ds_write_b32 v54, v118 offset:5632
    v_mfma_f32_16x16x32_bf16 v[124:127], v[168:171], a[220:223], v[124:127]
    ds_write_b32 v55, v119 offset:5888
    v_mfma_f32_16x16x32_bf16 v[124:127], v[172:175], a[236:239], v[124:127]
    ds_write_b32 v52, v120 offset:6144
    ds_write_b32 v53, v121 offset:6400
    ds_write_b32 v54, v122 offset:6656
    ds_write_b32 v55, v123 offset:6912
    s_nop 3
    ds_write_b32 v52, v124 offset:7168
    ds_write_b32 v53, v125 offset:7424
    ds_write_b32 v54, v126 offset:7680
    ds_write_b32 v55, v127 offset:7936
    s_waitcnt lgkmcnt(0)
    s_barrier
    ds_read_b128 v[192:195], v57 offset:0
    ds_read_b128 v[196:199], v58 offset:0
    ds_read_b128 v[200:203], v57 offset:8192
    ds_read_b128 v[204:207], v58 offset:8192
    ds_read_b128 v[208:211], v57 offset:16384
    ds_read_b128 v[212:215], v58 offset:16384
    ds_read_b128 v[216:219], v57 offset:24576
    ds_read_b128 v[220:223], v58 offset:24576
    s_waitcnt lgkmcnt(6)
    v_pk_add_f32 v[32:33], v[32:33], v[192:193]
    v_pk_add_f32 v[34:35], v[34:35], v[194:195]
    v_pk_add_f32 v[36:37], v[36:37], v[196:197]
    v_pk_add_f32 v[38:39], v[38:39], v[198:199]
    s_waitcnt lgkmcnt(4)
    v_pk_add_f32 v[32:33], v[32:33], v[200:201]
    v_pk_add_f32 v[34:35], v[34:35], v[202:203]
    v_pk_add_f32 v[36:37], v[36:37], v[204:205]
    v_pk_add_f32 v[38:39], v[38:39], v[206:207]
    s_waitcnt lgkmcnt(2)
    v_pk_add_f32 v[32:33], v[32:33], v[208:209]
    v_pk_add_f32 v[34:35], v[34:35], v[210:211]
    v_pk_add_f32 v[36:37], v[36:37], v[212:213]
    v_pk_add_f32 v[38:39], v[38:39], v[214:215]
    s_waitcnt lgkmcnt(0)
    v_pk_add_f32 v[32:33], v[32:33], v[216:217]
    v_pk_add_f32 v[34:35], v[34:35], v[218:219]
    v_pk_add_f32 v[36:37], v[36:37], v[220:221]
    v_pk_add_f32 v[38:39], v[38:39], v[222:223]
    v_cvt_pk_bf16_f32 v44, v32, v33
    v_cvt_pk_bf16_f32 v45, v34, v35
    v_cvt_pk_bf16_f32 v46, v36, v37
    v_cvt_pk_bf16_f32 v47, v38, v39
    buffer_store_dwordx4 v[44:47], v19, s[8:11], s96 offen
Labort:
Lend:
    s_endpgm
Lst0_1:
    s_sleep 4
    buffer_load_dwordx4 v[56:59], v46, s[4:7], s85 offen sc1
    s_add_u32 s50, s50, 1
    s_cmp_gt_u32 s50, 0x20000
    s_cbranch_scc1 Labort
    s_waitcnt vmcnt(0)
    s_branch Lst0b_2
Lkvslow_8:
    v_max3_u32 v85, v128, v129, v129
    v_max3_u32 v85, v85, v130, v131
    v_max3_u32 v85, v85, v132, v133
    v_max3_u32 v85, v85, v134, v135
    v_max3_u32 v85, v85, v136, v137
    v_max3_u32 v85, v85, v138, v139
    v_max3_u32 v85, v85, v140, v141
    v_max3_u32 v85, v85, v142, v143
    v_max3_u32 v85, v85, v144, v145
    v_max3_u32 v85, v85, v146, v147
    v_max3_u32 v85, v85, v148, v149
    v_max3_u32 v85, v85, v150, v151
    v_max3_u32 v85, v85, v152, v153
    v_max3_u32 v85, v85, v154, v155
    v_max3_u32 v85, v85, v156, v157
    v_max3_u32 v85, v85, v158, v159
    v_max3_u32 v85, v85, v160, v161
    v_max3_u32 v85, v85, v162, v163
    v_cmp_eq_u32 vcc, -1, v85
    s_cbranch_vccz Lkvgo_7
Lkvz_9:
    s_add_u32 s50, s50, 1
    s_cmp_gt_u32 s50, 0x20000
    s_cbranch_scc1 Labort
    s_cmp_le_u32 s50, 1
    s_cbranch_scc1 Lkvz_10
    v_cmp_eq_u32 vcc, -1, v160
    s_cbranch_vccz Lkvz_10
    s_mov_b64 exec, vcc
    s_sleep 2
    buffer_load_dword v160, v15, s[4:7], s28 offen sc1
    s_waitcnt vmcnt(0)
    s_mov_b64 exec, -1
    s_branch Lkvz_9
Lkvz_10:
    s_add_u32 s51, s27, 0
    buffer_load_dwordx4 v[128:131], v0, s[4:7], s51 offen offset:0 sc1
    buffer_load_dwordx4 v[132:135], v0, s[4:7], s51 offen offset:1024 sc1
    buffer_load_dwordx4 v[136:139], v0, s[4:7], s51 offen offset:2048 sc1
    buffer_load_dwordx4 v[140:143], v0, s[4:7], s51 offen offset:3072 sc1
    s_add_u32 s51, s27, 4096
    buffer_load_dwordx4 v[144:147], v0, s[4:7], s51 offen offset:0 sc1
    buffer_load_dwordx4 v[148:151], v0, s[4:7], s51 offen offset:1024 sc1
    buffer_load_dwordx4 v[152:155], v0, s[4:7], s51 offen offset:2048 sc1
    buffer_load_dwordx4 v[156:159], v0, s[4:7], s51 offen offset:3072 sc1
    buffer_load_dwordx4 v[160:163], v15, s[4:7], s28 offen sc1
    s_waitcnt vmcnt(0)
    s_branch Lkvretry_6
Lkvslow_23:
    v_max3_u32 v85, v128, v129, v129
    v_max3_u32 v85, v85, v130, v131
    v_max3_u32 v85, v85, v132, v133
    v_max3_u32 v85, v85, v134, v135
    v_max3_u32 v85, v85, v136, v137
    v_max3_u32 v85, v85, v138, v139
    v_max3_u32 v85, v85, v140, v141
    v_max3_u32 v85, v85, v142, v143
    v_max3_u32 v85, v85, v144, v145
    v_max3_u32 v85, v85, v146, v147
    v_max3_u32 v85, v85, v148, v149
    v_max3_u32 v85, v85, v150, v151
    v_max3_u32 v85, v85, v152, v153
    v_max3_u32 v85, v85, v154, v155
    v_max3_u32 v85, v85, v156, v157
    v_max3_u32 v85, v85, v158, v159
    v_max3_u32 v85, v85, v160, v161
    v_max3_u32 v85, v85, v162, v163
    v_cmp_eq_u32 vcc, -1, v85
    s_cbranch_vccz Lkvgo_22
Lkvz_24:
    s_add_u32 s50, s50, 1
    s_cmp_gt_u32 s50, 0x20000
    s_cbranch_scc1 Labort
    s_cmp_le_u32 s50, 1
    s_cbranch_scc1 Lkvz_25
    v_cmp_eq_u32 vcc, -1, v160
    s_cbranch_vccz Lkvz_25
    s_mov_b64 exec, vcc
    s_sleep 2
    buffer_load_dword v160, v15, s[4:7], s28 offen sc1
    s_waitcnt vmcnt(0)
    s_mov_b64 exec, -1
    s_branch Lkvz_24
Lkvz_25:
    s_add_u32 s51, s27, 0
    buffer_load_dwordx4 v[128:131], v0, s[4:7], s51 offen offset:0 sc1
    buffer_load_dwordx4 v[132:135], v0, s[4:7], s51 offen offset:1024 sc1
    buffer_load_dwordx4 v[136:139], v0, s[4:7], s51 offen offset:2048 sc1
    buffer_load_dwordx4 v[140:143], v0, s[4:7], s51 offen offset:3072 sc1
    s_add_u32 s51, s27, 4096
    buffer_load_dwordx4 v[144:147], v0, s[4:7], s51 offen offset:0 sc1
    buffer_load_dwordx4 v[148:151], v0, s[4:7], s51 offen offset:1024 sc1
    buffer_load_dwordx4 v[152:155], v0, s[4:7], s51 offen offset:2048 sc1
    buffer_load_dwordx4 v[156:159], v0, s[4:7], s51 offen offset:3072 sc1
    buffer_load_dwordx4 v[160:163], v15, s[4:7], s28 offen sc1
    s_waitcnt vmcnt(0)
    s_branch Lkvretry_21
Lcode_end:
Lfork_s:
    buffer_load_dwordx4 v0, s[4:7], s49 offen offset:3072 sc1 lds
    s_add_u32 m0, s23, 114688
    s_add_u32 s49, s42, 147456
    buffer_load_dwordx4 v0, s[4:7], s49 offen offset:0 sc1 lds
    buffer_load_dwordx4 v0, s[4:7], s49 offen offset:1024 sc1 lds
    buffer_load_dwordx4 v0, s[4:7], s49 offen offset:2048 sc1 lds
    s_waitcnt lgkmcnt(0)
    s_barrier
    ds_read_b32 a250, v2 offset:256
    ds_read_b32 a251, v2 offset:512
    ds_read_b32 a252, v2 offset:768
    ds_read_b128 v[128:131], v4 offset:3840
    ds_read_b128 v[132:135], v4 offset:3856
    ds_read_b128 v[136:139], v4 offset:3872
    ds_read_b128 v[140:143], v4 offset:3888
    ds_read_b128 v[64:67], v14 offset:0
    ds_read_b128 v[68:71], v14 offset:16
    ds_read_b128 v[72:75], v14 offset:32
    ds_read_b128 v[76:79], v14 offset:48
    v_mul_f32 v56, 897988541, v22
    v_mov_b32 v57, 0
    s_waitcnt lgkmcnt(6)
    v_dot2_f32_bf16 v56, v40, v128, v56
    v_dot2_f32_bf16 v57, v41, v129, v57
    v_dot2_f32_bf16 v56, v42, v130, v56
    v_dot2_f32_bf16 v57, v43, v131, v57
    v_dot2_f32_bf16 v56, v44, v132, v56
    v_dot2_f32_bf16 v57, v45, v133, v57
    v_dot2_f32_bf16 v56, v46, v134, v56
    v_dot2_f32_bf16 v57, v47, v135, v57
    s_waitcnt lgkmcnt(4)
    v_dot2_f32_bf16 v56, v48, v136, v56
    v_dot2_f32_bf16 v57, v49, v137, v57
    v_dot2_f32_bf16 v56, v50, v138, v56
    v_dot2_f32_bf16 v57, v51, v139, v57
    v_dot2_f32_bf16 v56, v52, v140, v56
    v_dot2_f32_bf16 v57, v53, v141, v57
    v_dot2_f32_bf16 v56, v54, v142, v56
    v_dot2_f32_bf16 v57, v55, v143, v57
    s_waitcnt lgkmcnt(0)
    v_mfma_f32_32x32x16_bf16 v[80:95], v[64:67], v[40:43], 0
    v_mfma_f32_32x32x16_bf16 v[80:95], v[68:71], v[44:47], v[80:95]
    v_mfma_f32_32x32x16_bf16 v[80:95], v[72:75], v[48:51], v[80:95]
    v_mfma_f32_32x32x16_bf16 v[80:95], v[76:79], v[52:55], v[80:95]
    v_add_f32 v56, v56, v57
    v_rcp_f32 v56, v56
    s_nop 9
    v_pk_mul_f32 v[80:81], v[80:81], v[56:57] op_sel_hi:[1,0]
    v_pk_mul_f32 v[82:83], v[82:83], v[56:57] op_sel_hi:[1,0]
    v_pk_mul_f32 v[84:85], v[84:85], v[56:57] op_sel_hi:[1,0]
    v_pk_mul_f32 v[86:87], v[86:87], v[56:57] op_sel_hi:[1,0]
    v_cvt_pk_bf16_f32 v64, v80, v81
    v_cvt_pk_bf16_f32 v65, v82, v83
    v_cvt_pk_bf16_f32 v66, v84, v85
    v_cvt_pk_bf16_f32 v67, v86, v87
    buffer_store_dwordx4 v[64:67], v5, s[4:7], s29 offen offset:0 sc1
    v_pk_mul_f32 v[88:89], v[88:89], v[56:57] op_sel_hi:[1,0]
    v_pk_mul_f32 v[90:91], v[90:91], v[56:57] op_sel_hi:[1,0]
    v_pk_mul_f32 v[92:93], v[92:93], v[56:57] op_sel_hi:[1,0]
    v_pk_mul_f32 v[94:95], v[94:95], v[56:57] op_sel_hi:[1,0]
    v_cvt_pk_bf16_f32 v68, v88, v89
    v_cvt_pk_bf16_f32 v69, v90, v91
    v_cvt_pk_bf16_f32 v70, v92, v93
    v_cvt_pk_bf16_f32 v71, v94, v95
    buffer_store_dwordx4 v[68:71], v5, s[4:7], s29 offen offset:256 sc1
    v_bfe_u32 v59, v0, 7, 3
    v_lshlrev_b32 v59, 4, v59
    s_lshl_b32 s47, s19, 7
    buffer_load_dwordx4 v0, s[4:7], s49 offen offset:3072 sc1 lds
    s_add_u32 m0, s23, 32768
    s_add_u32 s49, s43, 0
    buffer_load_dwordx4 v0, s[4:7], s49 offen offset:0 sc1 lds
    buffer_load_dwordx4 v0, s[4:7], s49 offen offset:1024 sc1 lds
    buffer_load_dwordx4 v0, s[4:7], s49 offen offset:2048 sc1 lds
    v_lshlrev_b32 v24, 16, v28
    v_and_b32 v25, 0xffff0000, v28
    v_lshlrev_b32 v26, 16, v29
    v_and_b32 v27, 0xffff0000, v29
    v_lshlrev_b32 v28, 16, v30
    v_and_b32 v29, 0xffff0000, v30
    v_lshlrev_b32 v30, 16, v31
    v_and_b32 v31, 0xffff0000, v31
    v_lshlrev_b32 v32, 16, v36
    v_and_b32 v33, 0xffff0000, v36
    v_lshlrev_b32 v34, 16, v37
    v_and_b32 v35, 0xffff0000, v37
    v_lshlrev_b32 v36, 16, v38
    v_and_b32 v37, 0xffff0000, v38
    v_lshlrev_b32 v38, 16, v39
    v_and_b32 v39, 0xffff0000, v39
    s_add_u32 s45, s98, 1
    s_mov_b64 exec, 1
    v_mov_b32 v56, s45
    s_waitcnt vmcnt(4)
    buffer_store_dword v56, off, s[4:7], s30 offset:0 sc1
    s_mov_b64 exec, -1
    s_add_u32 s45, s98, 1
    s_mov_b32 exec_hi, 0
    s_mov_b32 s50, 0
Lpoll_11_s:
    buffer_load_dword v56, v21, s[4:7], s32 offen sc1
    s_add_u32 s50, s50, 1
    s_cmp_gt_u32 s50, 0x40000
    s_cbranch_scc1 Labort
    s_waitcnt vmcnt(0)
    v_cmp_ne_u32 vcc, s45, v56
    s_cbranch_vccnz Lpoll_11_s
    s_mov_b64 exec, -1
    s_add_u32 s51, s31, 0
    buffer_load_dwordx4 v[128:131], v0, s[4:7], s51 offen offset:0 sc1
    buffer_load_dwordx4 v[132:135], v0, s[4:7], s51 offen offset:2048 sc1
    s_add_u32 s51, s31, 4096
    buffer_load_dwordx4 v[136:139], v0, s[4:7], s51 offen offset:0 sc1
    buffer_load_dwordx4 v[140:143], v0, s[4:7], s51 offen offset:2048 sc1
    s_add_u32 s51, s31, 1024
    buffer_load_dwordx4 v[144:147], v0, s[4:7], s51 offen offset:0 sc1
    buffer_load_dwordx4 v[148:151], v0, s[4:7], s51 offen offset:2048 sc1
    s_add_u32 s51, s31, 5120
    buffer_load_dwordx4 v[152:155], v0, s[4:7], s51 offen offset:0 sc1
    buffer_load_dwordx4 v[156:159], v0, s[4:7], s51 offen offset:2048 sc1
    s_add_u32 s51, s31, 32768
    buffer_load_dwordx4 v[160:163], v0, s[4:7], s51 offen offset:0 sc1
    s_barrier
    s_waitcnt vmcnt(8)
    v_mfma_f32_16x16x32_bf16 v[64:67], a[0:3], v[128:131], 0
    buffer_load_dwordx4 v[164:167], v0, s[4:7], s51 offen offset:2048 sc1
    v_mfma_f32_16x16x32_bf16 v[68:71], a[4:7], v[128:131], 0
    v_mfma_f32_16x16x32_bf16 v[72:75], a[8:11], v[128:131], 0
    v_mfma_f32_16x16x32_bf16 v[76:79], a[12:15], v[128:131], 0
    s_waitcnt vmcnt(8)
    v_mfma_f32_16x16x32_bf16 v[64:67], a[16:19], v[132:135], v[64:67]
    s_add_u32 s51, s31, 36864
    buffer_load_dwordx4 v[168:171], v0, s[4:7], s51 offen offset:0 sc1
    v_mfma_f32_16x16x32_bf16 v[68:71], a[20:23], v[132:135], v[68:71]
    v_mfma_f32_16x16x32_bf16 v[72:75], a[24:27], v[132:135], v[72:75]
    v_mfma_f32_16x16x32_bf16 v[76:79], a[28:31], v[132:135], v[76:79]
    s_waitcnt vmcnt(8)
    v_mfma_f32_16x16x32_bf16 v[64:67], a[32:35], v[136:139], v[64:67]
    buffer_load_dwordx4 v[172:175], v0, s[4:7], s51 offen offset:2048 sc1
    v_mfma_f32_16x16x32_bf16 v[68:71], a[36:39], v[136:139], v[68:71]
    v_mfma_f32_16x16x32_bf16 v[72:75], a[40:43], v[136:139], v[72:75]
    v_mfma_f32_16x16x32_bf16 v[76:79], a[44:47], v[136:139], v[76:79]
    s_waitcnt vmcnt(8)
    v_mfma_f32_16x16x32_bf16 v[64:67], a[48:51], v[140:143], v[64:67]
    s_add_u32 s51, s31, 33792
    buffer_load_dwordx4 v[176:179], v0, s[4:7], s51 offen offset:0 sc1
    v_mfma_f32_16x16x32_bf16 v[68:71], a[52:55], v[140:143], v[68:71]
    v_mfma_f32_16x16x32_bf16 v[72:75], a[56:59], v[140:143], v[72:75]
    v_mfma_f32_16x16x32_bf16 v[76:79], a[60:63], v[140:143], v[76:79]
    s_waitcnt vmcnt(8)
    v_mfma_f32_16x16x32_bf16 v[80:83], a[0:3], v[144:147], 0
    buffer_load_dwordx4 v[180:183], v0, s[4:7], s51 offen offset:2048 sc1
    v_mfma_f32_16x16x32_bf16 v[84:87], a[4:7], v[144:147], 0
    v_mfma_f32_16x16x32_bf16 v[88:91], a[8:11], v[144:147], 0
    v_mfma_f32_16x16x32_bf16 v[92:95], a[12:15], v[144:147], 0
    ds_write_b128 v17, v[64:67] offset:0
    s_waitcnt vmcnt(8)
    v_mfma_f32_16x16x32_bf16 v[80:83], a[16:19], v[148:151], v[80:83]
    s_add_u32 s51, s31, 37888
    buffer_load_dwordx4 v[184:187], v0, s[4:7], s51 offen offset:0 sc1
    v_mfma_f32_16x16x32_bf16 v[84:87], a[20:23], v[148:151], v[84:87]
    v_mfma_f32_16x16x32_bf16 v[88:91], a[24:27], v[148:151], v[88:91]
    v_mfma_f32_16x16x32_bf16 v[92:95], a[28:31], v[148:151], v[92:95]
    ds_write_b128 v17, v[68:71] offset:1024
    s_waitcnt vmcnt(8)
    v_mfma_f32_16x16x32_bf16 v[80:83], a[32:35], v[152:155], v[80:83]
    buffer_load_dwordx4 v[188:191], v0, s[4:7], s51 offen offset:2048 sc1
    v_mfma_f32_16x16x32_bf16 v[84:87], a[36:39], v[152:155], v[84:87]
    v_mfma_f32_16x16x32_bf16 v[88:91], a[40:43], v[152:155], v[88:91]
    v_mfma_f32_16x16x32_bf16 v[92:95], a[44:47], v[152:155], v[92:95]
    ds_write_b128 v17, v[72:75] offset:2048
    s_waitcnt vmcnt(8)
    v_mfma_f32_16x16x32_bf16 v[80:83], a[48:51], v[156:159], v[80:83]
    buffer_load_dwordx4 v0, s[4:7], s49 offen offset:3072 sc1 lds
    s_add_u32 m0, s23, 49152
    s_add_u32 s49, s43, 16384
    buffer_load_dwordx4 v0, s[4:7], s49 offen offset:0 sc1 lds
    v_mfma_f32_16x16x32_bf16 v[84:87], a[52:55], v[156:159], v[84:87]
    v_mfma_f32_16x16x32_bf16 v[88:91], a[56:59], v[156:159], v[88:91]
    v_mfma_f32_16x16x32_bf16 v[92:95], a[60:63], v[156:159], v[92:95]
    ds_write_b128 v17, v[76:79] offset:3072
    s_waitcnt vmcnt(9)
    v_mfma_f32_16x16x32_bf16 v[96:99], a[0:3], v[160:163], 0
    buffer_load_dwordx4 v0, s[4:7], s49 offen offset:1024 sc1 lds
    buffer_load_dwordx4 v0, s[4:7], s49 offen offset:2048 sc1 lds
    v_mfma_f32_16x16x32_bf16 v[100:103], a[4:7], v[160:163], 0
    v_mfma_f32_16x16x32_bf16 v[104:107], a[8:11], v[160:163], 0
    v_mfma_f32_16x16x32_bf16 v[108:111], a[12:15], v[160:163], 0
    ds_write_b128 v17, v[80:83] offset:4096
    s_waitcnt vmcnt(10)
    v_mfma_f32_16x16x32_bf16 v[96:99], a[16:19], v[164:167], v[96:99]
    buffer_load_dwordx4 v0, s[4:7], s49 offen offset:3072 sc1 lds
    s_add_u32 s49, s55, 0
    buffer_load_dwordx4 a[64:67], v0, s[4:7], s49 offen offset:0 sc1
    v_mfma_f32_16x16x32_bf16 v[100:103], a[20:23], v[164:167], v[100:103]
    v_mfma_f32_16x16x32_bf16 v[104:107], a[24:27], v[164:167], v[104:107]
    v_mfma_f32_16x16x32_bf16 v[108:111], a[28:31], v[164:167], v[108:111]
    ds_write_b128 v17, v[84:87] offset:5120
    buffer_load_dwordx4 v[60:63], v59, s[12:15], s47 offen
    s_waitcnt vmcnt(12)
    v_mfma_f32_16x16x32_bf16 v[96:99], a[32:35], v[168:171], v[96:99]
    v_mfma_f32_16x16x32_bf16 v[100:103], a[36:39], v[168:171], v[100:103]
    v_mfma_f32_16x16x32_bf16 v[104:107], a[40:43], v[168:171], v[104:107]
    v_mfma_f32_16x16x32_bf16 v[108:111], a[44:47], v[168:171], v[108:111]
    ds_write_b128 v17, v[88:91] offset:6144
    s_waitcnt vmcnt(11)
    v_mfma_f32_16x16x32_bf16 v[96:99], a[48:51], v[172:175], v[96:99]
    buffer_load_dwordx4 a[68:71], v0, s[4:7], s49 offen offset:1024 sc1
    v_mfma_f32_16x16x32_bf16 v[100:103], a[52:55], v[172:175], v[100:103]
    v_mfma_f32_16x16x32_bf16 v[104:107], a[56:59], v[172:175], v[104:107]
    v_mfma_f32_16x16x32_bf16 v[108:111], a[60:63], v[172:175], v[108:111]
    ds_write_b128 v17, v[92:95] offset:7168
    s_waitcnt vmcnt(11)
    v_mfma_f32_16x16x32_bf16 v[112:115], a[0:3], v[176:179], 0
    buffer_load_dwordx4 a[72:75], v0, s[4:7], s49 offen offset:2048 sc1
    v_mfma_f32_16x16x32_bf16 v[116:119], a[4:7], v[176:179], 0
    v_mfma_f32_16x16x32_bf16 v[120:123], a[8:11], v[176:179], 0
    v_mfma_f32_16x16x32_bf16 v[124:127], a[12:15], v[176:179], 0
    s_waitcnt vmcnt(11)
    v_mfma_f32_16x16x32_bf16 v[112:115], a[16:19], v[180:183], v[112:115]
    buffer_load_dwordx4 a[76:79], v0, s[4:7], s49 offen offset:3072 sc1
    v_mfma_f32_16x16x32_bf16 v[116:119], a[20:23], v[180:183], v[116:119]
    v_mfma_f32_16x16x32_bf16 v[120:123], a[24:27], v[180:183], v[120:123]
    v_mfma_f32_16x16x32_bf16 v[124:127], a[28:31], v[180:183], v[124:127]
    s_waitcnt lgkmcnt(0)
    s_barrier
    ds_read_b128 v[64:67], v18 offset:0
    ds_read_b128 v[68:71], v18 offset:256
    ds_read_b128 v[72:75], v18 offset:8192
    ds_read_b128 v[76:79], v18 offset:8448
    ds_read_b128 v[80:83], v18 offset:16384
    ds_read_b128 v[84:87], v18 offset:16640
    ds_read_b128 v[88:91], v18 offset:24576
    ds_read_b128 v[92:95], v18 offset:24832
    s_waitcnt vmcnt(11)
    v_mfma_f32_16x16x32_bf16 v[112:115], a[32:35], v[184:187], v[112:115]
    s_add_u32 s49, s55, 4096
    buffer_load_dwordx4 a[80:83], v0, s[4:7], s49 offen offset:0 sc1
    v_mfma_f32_16x16x32_bf16 v[116:119], a[36:39], v[184:187], v[116:119]
    v_mfma_f32_16x16x32_bf16 v[120:123], a[40:43], v[184:187], v[120:123]
    v_mfma_f32_16x16x32_bf16 v[124:127], a[44:47], v[184:187], v[124:127]
    s_waitcnt vmcnt(11)
    v_mfma_f32_16x16x32_bf16 v[112:115], a[48:51], v[188:191], v[112:115]
    buffer_load_dwordx4 a[84:87], v0, s[4:7], s49 offen offset:1024 sc1
    v_mfma_f32_16x16x32_bf16 v[116:119], a[52:55], v[188:191], v[116:119]
    v_mfma_f32_16x16x32_bf16 v[120:123], a[56:59], v[188:191], v[120:123]
    v_mfma_f32_16x16x32_bf16 v[124:127], a[60:63], v[188:191], v[124:127]
    s_waitcnt lgkmcnt(0)
    s_barrier
    ds_write_b128 v17, v[96:99] offset:0
    v_pk_add_f32 v[24:25], v[24:25], v[64:65]
    v_pk_add_f32 v[26:27], v[26:27], v[66:67]
    v_pk_add_f32 v[28:29], v[28:29], v[68:69]
    v_pk_add_f32 v[30:31], v[30:31], v[70:71]
    v_pk_add_f32 v[24:25], v[24:25], v[72:73]
    v_pk_add_f32 v[26:27], v[26:27], v[74:75]
    v_pk_add_f32 v[28:29], v[28:29], v[76:77]
    v_pk_add_f32 v[30:31], v[30:31], v[78:79]
    buffer_load_dwordx4 a[88:91], v0, s[4:7], s49 offen offset:2048 sc1
    ds_write_b128 v17, v[100:103] offset:1024
    v_pk_add_f32 v[24:25], v[24:25], v[80:81]
    v_pk_add_f32 v[26:27], v[26:27], v[82:83]
    v_pk_add_f32 v[28:29], v[28:29], v[84:85]
    v_pk_add_f32 v[30:31], v[30:31], v[86:87]
    v_pk_add_f32 v[24:25], v[24:25], v[88:89]
    v_pk_add_f32 v[26:27], v[26:27], v[90:91]
    v_pk_add_f32 v[28:29], v[28:29], v[92:93]
    v_pk_add_f32 v[30:31], v[30:31], v[94:95]
    buffer_load_dwordx4 a[92:95], v0, s[4:7], s49 offen offset:3072 sc1
    ds_write_b128 v17, v[104:107] offset:2048
    v_cvt_pk_bf16_f32 v40, v24, v25
    v_cvt_pk_bf16_f32 v41, v26, v27
    v_cvt_pk_bf16_f32 v42, v28, v29
    v_cvt_pk_bf16_f32 v43, v30, v31
    buffer_store_dwordx4 v[40:43], v19, s[8:11], s33 offen sc1
    v_pk_add_f32 v[64:65], v[24:25], v[26:27]
    s_add_u32 s49, s55, 8192
    buffer_load_dwordx4 a[96:99], v0, s[4:7], s49 offen offset:0 sc1
    ds_write_b128 v17, v[108:111] offset:3072
    v_pk_mul_f32 v[66:67], v[24:25], v[24:25]
    v_pk_add_f32 v[64:65], v[64:65], v[28:29]
    v_pk_fma_f32 v[66:67], v[26:27], v[26:27], v[66:67]
    v_pk_add_f32 v[64:65], v[64:65], v[30:31]
    v_pk_fma_f32 v[66:67], v[28:29], v[28:29], v[66:67]
    v_add_f32 v64, v64, v65
    v_pk_fma_f32 v[66:67], v[30:31], v[30:31], v[66:67]
    v_add_f32 v65, v66, v67
    buffer_load_dwordx4 a[100:103], v0, s[4:7], s49 offen offset:1024 sc1
    ds_write_b128 v17, v[112:115] offset:4096
    v_permlane16_swap_b32 v64, v65
    v_add_f32 v64, v64, v65
    s_nop 1
    v_add_f32_dpp v65, v64, v64 row_ror:8 row_mask:0xf bank_mask:0xf
    v_add_f32_dpp v64, v64, v64 row_ror:8 row_mask:0xf bank_mask:0xf
    s_nop 1
    v_permlane32_swap_b32 v64, v65
    v_add_f32 v64, v64, v65
    s_mov_b64 exec, 0x00ff00ff
    buffer_store_dword v64, v20, s[4:7], s34 offen offset:0 sc1
    s_mov_b64 exec, -1
    buffer_load_dwordx4 a[104:107], v0, s[4:7], s49 offen offset:2048 sc1
    ds_write_b128 v17, v[116:119] offset:5120
    buffer_load_dwordx4 a[108:111], v0, s[4:7], s49 offen offset:3072 sc1
    ds_write_b128 v17, v[120:123] offset:6144
    s_add_u32 s49, s55, 12288
    buffer_load_dwordx4 a[112:115], v0, s[4:7], s49 offen offset:0 sc1
    ds_write_b128 v17, v[124:127] offset:7168
    buffer_load_dwordx4 a[116:119], v0, s[4:7], s49 offen offset:1024 sc1
    s_waitcnt lgkmcnt(0)
    s_barrier
    ds_read_b128 v[128:131], v18 offset:0
    ds_read_b128 v[132:135], v18 offset:256
    ds_read_b128 v[136:139], v18 offset:8192
    ds_read_b128 v[140:143], v18 offset:8448
    ds_read_b128 v[144:147], v18 offset:16384
    ds_read_b128 v[148:151], v18 offset:16640
    ds_read_b128 v[152:155], v18 offset:24576
    ds_read_b128 v[156:159], v18 offset:24832
    s_add_u32 s45, s98, 1
    s_mov_b64 exec, 1
    v_mov_b32 v56, s45
    s_waitcnt vmcnt(4)
    buffer_store_dword v56, off, s[4:7], s35 offset:0 sc1
    s_mov_b64 exec, -1
    s_waitcnt lgkmcnt(6)
    v_pk_add_f32 v[32:33], v[32:33], v[128:129]
    v_pk_add_f32 v[34:35], v[34:35], v[130:131]
    v_pk_add_f32 v[36:37], v[36:37], v[132:133]
    v_pk_add_f32 v[38:39], v[38:39], v[134:135]
    s_waitcnt lgkmcnt(4)
    v_pk_add_f32 v[32:33], v[32:33], v[136:137]
    v_pk_add_f32 v[34:35], v[34:35], v[138:139]
    v_pk_add_f32 v[36:37], v[36:37], v[140:141]
    v_pk_add_f32 v[38:39], v[38:39], v[142:143]
    s_waitcnt lgkmcnt(2)
    v_pk_add_f32 v[32:33], v[32:33], v[144:145]
    v_pk_add_f32 v[34:35], v[34:35], v[146:147]
    v_pk_add_f32 v[36:37], v[36:37], v[148:149]
    v_pk_add_f32 v[38:39], v[38:39], v[150:151]
    s_waitcnt lgkmcnt(0)
    v_pk_add_f32 v[32:33], v[32:33], v[152:153]
    v_pk_add_f32 v[34:35], v[34:35], v[154:155]
    v_pk_add_f32 v[36:37], v[36:37], v[156:157]
    v_pk_add_f32 v[38:39], v[38:39], v[158:159]
    v_cvt_pk_bf16_f32 v44, v32, v33
    v_cvt_pk_bf16_f32 v45, v34, v35
    v_cvt_pk_bf16_f32 v46, v36, v37
    v_cvt_pk_bf16_f32 v47, v38, v39
    buffer_store_dwordx4 v[44:47], v19, s[8:11], s96 offen sc1
    v_pk_add_f32 v[128:129], v[32:33], v[34:35]
    v_pk_mul_f32 v[130:131], v[32:33], v[32:33]
    v_pk_add_f32 v[128:129], v[128:129], v[36:37]
    v_pk_fma_f32 v[130:131], v[34:35], v[34:35], v[130:131]
    v_pk_add_f32 v[128:129], v[128:129], v[38:39]
    v_pk_fma_f32 v[130:131], v[36:37], v[36:37], v[130:131]
    v_add_f32 v128, v128, v129
    v_pk_fma_f32 v[130:131], v[38:39], v[38:39], v[130:131]
    v_add_f32 v129, v130, v131
    s_nop 1
    v_permlane16_swap_b32 v128, v129
    v_add_f32 v128, v128, v129
    s_nop 1
    v_add_f32_dpp v129, v128, v128 row_ror:8 row_mask:0xf bank_mask:0xf
    v_add_f32_dpp v128, v128, v128 row_ror:8 row_mask:0xf bank_mask:0xf
    s_nop 1
    v_permlane32_swap_b32 v128, v129
    v_add_f32 v128, v128, v129
    s_mov_b64 exec, 0x00ff00ff
    buffer_store_dword v128, v20, s[4:7], s34 offen offset:2048 sc1
    s_mov_b64 exec, -1
    buffer_load_dword v22, v2, s[4:7], s26 offen sc1
    v_lshlrev_b32 v136, 16, v60
    v_and_b32 v137, 0xffff0000, v60
    v_lshlrev_b32 v138, 16, v61
    v_and_b32 v139, 0xffff0000, v61
    v_lshlrev_b32 v140, 16, v62
    v_and_b32 v141, 0xffff0000, v62
    v_lshlrev_b32 v142, 16, v63
    v_and_b32 v143, 0xffff0000, v63
    v_pk_add_f32 v[24:25], v[24:25], v[136:137]
    v_pk_add_f32 v[26:27], v[26:27], v[138:139]
    v_pk_add_f32 v[28:29], v[28:29], v[140:141]
    v_pk_add_f32 v[30:31], v[30:31], v[142:143]
    v_pk_add_f32 v[32:33], v[32:33], v[136:137]
    v_pk_add_f32 v[34:35], v[34:35], v[138:139]
    v_pk_add_f32 v[36:37], v[36:37], v[140:141]
    v_pk_add_f32 v[38:39], v[38:39], v[142:143]
    s_add_u32 s45, s98, 1
    s_mov_b64 exec, 1
    v_mov_b32 v56, s45
    s_waitcnt vmcnt(1)
    buffer_store_dword v56, off, s[4:7], s35 offset:128 sc1
    s_mov_b64 exec, -1
    s_barrier
    ds_read_b128 v[112:115], v1 offset:0
    ds_read_b128 v[116:119], v1 offset:32768
    ds_read_b128 v[120:123], v0 offset:32768
    ds_read_b128 v[124:127], v1 offset:1024
    s_add_u32 s45, s98, 1
    s_waitcnt vmcnt(1)
    v_cmp_ne_u32 vcc, s45, v22
    s_cmp_eq_u32 vcc_lo, 0
    s_cbranch_scc1 Lpolls_14_s
    s_add_u32 s45, s98, 1
    s_mov_b32 exec_hi, 0
    s_mov_b32 s50, 0
Lpoll_13_s:
    buffer_load_dword v56, v2, s[4:7], s26 offen sc1
    s_add_u32 s50, s50, 1
    s_cmp_gt_u32 s50, 0x40000
    s_cbranch_scc1 Labort
    s_waitcnt vmcnt(0)
    v_cmp_ne_u32 vcc, s45, v56
    s_cbranch_vccnz Lpoll_13_s
    s_mov_b64 exec, -1
Lpolls_14_s:
    s_add_u32 s51, s24, 0
    buffer_load_dwordx4 v[128:131], v0, s[8:11], s51 offen offset:0 sc1
    buffer_load_dwordx4 v[132:135], v0, s[8:11], s51 offen offset:1024 sc1
    buffer_load_dwordx4 v[136:139], v0, s[8:11], s51 offen offset:2048 sc1
    buffer_load_dwordx4 v[140:143], v0, s[8:11], s51 offen offset:3072 sc1
    s_add_u32 s51, s24, 4096
    buffer_load_dwordx4 v[144:147], v0, s[8:11], s51 offen offset:0 sc1
    buffer_load_dwordx4 v[148:151], v0, s[8:11], s51 offen offset:1024 sc1
    buffer_load_dwordx4 v[152:155], v0, s[8:11], s51 offen offset:2048 sc1
    buffer_load_dwordx4 v[156:159], v0, s[8:11], s51 offen offset:3072 sc1
    s_add_u32 s51, s24, 8192
    buffer_load_dwordx4 v[160:163], v0, s[8:11], s51 offen offset:0 sc1
    buffer_load_dwordx4 v[164:167], v0, s[8:11], s51 offen offset:1024 sc1
    s_waitcnt vmcnt(9) lgkmcnt(3)
    v_mfma_f32_32x32x16_bf16 v[64:79], v[112:115], v[128:131], 0
    ds_read_b128 v[112:115], v1 offset:33792
    buffer_load_dwordx4 v[168:171], v0, s[8:11], s51 offen offset:2048 sc1
    s_waitcnt lgkmcnt(3)
    v_mfma_f32_32x32x16_bf16 v[80:95], v[116:119], v[128:131], 0
    ds_read_b128 v[116:119], v0 offset:33792
    s_waitcnt lgkmcnt(3)
    v_mfma_f32_32x32x16_bf16 v[96:111], v[120:123], v[128:131], 0
    ds_read_b128 v[120:123], v1 offset:2048
    s_waitcnt vmcnt(9) lgkmcnt(3)
    v_mfma_f32_32x32x16_bf16 v[64:79], v[124:127], v[132:135], v[64:79]
    ds_read_b128 v[124:127], v1 offset:34816
    buffer_load_dwordx4 v[172:175], v0, s[8:11], s51 offen offset:3072 sc1
    s_waitcnt lgkmcnt(3)
    v_mfma_f32_32x32x16_bf16 v[80:95], v[112:115], v[132:135], v[80:95]
    ds_read_b128 v[112:115], v0 offset:34816
    s_waitcnt lgkmcnt(3)
    v_mfma_f32_32x32x16_bf16 v[96:111], v[116:119], v[132:135], v[96:111]
    ds_read_b128 v[116:119], v1 offset:3072
    s_waitcnt vmcnt(9) lgkmcnt(3)
    v_mfma_f32_32x32x16_bf16 v[64:79], v[120:123], v[136:139], v[64:79]
    ds_read_b128 v[120:123], v1 offset:35840
    buffer_load_dwordx2 v[56:57], v3, s[4:7], s25 offen offset:0 sc1
    s_waitcnt lgkmcnt(3)
    v_mfma_f32_32x32x16_bf16 v[80:95], v[124:127], v[136:139], v[80:95]
    ds_read_b128 v[124:127], v0 offset:35840
    s_waitcnt lgkmcnt(3)
    v_mfma_f32_32x32x16_bf16 v[96:111], v[112:115], v[136:139], v[96:111]
    ds_read_b128 v[112:115], v1 offset:4096
    buffer_load_dwordx4 a[120:123], v0, s[4:7], s49 offen offset:2048 sc1
    s_waitcnt vmcnt(10) lgkmcnt(3)
    v_mfma_f32_32x32x16_bf16 v[64:79], v[116:119], v[140:143], v[64:79]
    ds_read_b128 v[116:119], v1 offset:36864
    buffer_load_dwordx2 v[58:59], v3, s[4:7], s25 offen offset:256 sc1
    buffer_load_dwordx2 v[60:61], v3, s[4:7], s25 offen offset:512 sc1
    s_waitcnt lgkmcnt(3)
    v_mfma_f32_32x32x16_bf16 v[80:95], v[120:123], v[140:143], v[80:95]
    ds_read_b128 v[120:123], v0 offset:36864
    s_waitcnt lgkmcnt(3)
    v_mfma_f32_32x32x16_bf16 v[96:111], v[124:127], v[140:143], v[96:111]
    ds_read_b128 v[124:127], v1 offset:5120
    s_waitcnt vmcnt(11) lgkmcnt(3)
    v_mfma_f32_32x32x16_bf16 v[64:79], v[112:115], v[144:147], v[64:79]
    ds_read_b128 v[112:115], v1 offset:37888
    buffer_load_dwordx2 v[62:63], v3, s[4:7], s25 offen offset:768 sc1
    s_waitcnt lgkmcnt(3)
    v_mfma_f32_32x32x16_bf16 v[80:95], v[116:119], v[144:147], v[80:95]
    ds_read_b128 v[116:119], v0 offset:37888
    s_waitcnt lgkmcnt(3)
    v_mfma_f32_32x32x16_bf16 v[96:111], v[120:123], v[144:147], v[96:111]
    ds_read_b128 v[120:123], v1 offset:6144
    s_waitcnt vmcnt(11) lgkmcnt(3)
    v_mfma_f32_32x32x16_bf16 v[64:79], v[124:127], v[148:151], v[64:79]
    ds_read_b128 v[124:127], v1 offset:38912
    s_add_u32 s51, s24, 12288
    buffer_load_dwordx4 v[176:179], v0, s[8:11], s51 offen offset:0 sc1
    s_waitcnt lgkmcnt(3)
    v_mfma_f32_32x32x16_bf16 v[80:95], v[112:115], v[148:151], v[80:95]
    ds_read_b128 v[112:115], v0 offset:38912
    s_waitcnt lgkmcnt(3)
    v_mfma_f32_32x32x16_bf16 v[96:111], v[116:119], v[148:151], v[96:111]
    ds_read_b128 v[116:119], v1 offset:7168
    buffer_load_dwordx4 a[124:127], v0, s[4:7], s49 offen offset:3072 sc1
    s_waitcnt vmcnt(12) lgkmcnt(3)
    v_mfma_f32_32x32x16_bf16 v[64:79], v[120:123], v[152:155], v[64:79]
    ds_read_b128 v[120:123], v1 offset:39936
    buffer_load_dwordx4 v[180:183], v0, s[8:11], s51 offen offset:1024 sc1
    buffer_load_dwordx4 v[184:187], v0, s[8:11], s51 offen offset:2048 sc1
    s_waitcnt lgkmcnt(3)
    v_mfma_f32_32x32x16_bf16 v[80:95], v[124:127], v[152:155], v[80:95]
    ds_read_b128 v[124:127], v0 offset:39936
    s_waitcnt lgkmcnt(3)
    v_mfma_f32_32x32x16_bf16 v[96:111], v[112:115], v[152:155], v[96:111]
    ds_read_b128 v[112:115], v1 offset:8192
    s_waitcnt vmcnt(13) lgkmcnt(3)
    v_mfma_f32_32x32x16_bf16 v[64:79], v[116:119], v[156:159], v[64:79]
    ds_read_b128 v[116:119], v1 offset:40960
    buffer_load_dwordx4 v[188:191], v0, s[8:11], s51 offen offset:3072 sc1
    s_waitcnt lgkmcnt(3)
    v_mfma_f32_32x32x16_bf16 v[80:95], v[120:123], v[156:159], v[80:95]
    ds_read_b128 v[120:123], v0 offset:40960
    s_waitcnt lgkmcnt(3)
    v_mfma_f32_32x32x16_bf16 v[96:111], v[124:127], v[156:159], v[96:111]
    ds_read_b128 v[124:127], v1 offset:9216
    s_waitcnt vmcnt(13) lgkmcnt(3)
    v_mfma_f32_32x32x16_bf16 v[64:79], v[112:115], v[160:163], v[64:79]
    ds_read_b128 v[112:115], v1 offset:41984
    s_add_u32 s51, s24, 16384
    buffer_load_dwordx4 v[128:131], v0, s[8:11], s51 offen offset:0 sc1
    s_waitcnt lgkmcnt(3)
    v_mfma_f32_32x32x16_bf16 v[80:95], v[116:119], v[160:163], v[80:95]
    ds_read_b128 v[116:119], v0 offset:41984
    s_waitcnt lgkmcnt(3)
    v_mfma_f32_32x32x16_bf16 v[96:111], v[120:123], v[160:163], v[96:111]
    ds_read_b128 v[120:123], v1 offset:10240
    s_add_u32 s49, s55, 16384
    buffer_load_dwordx4 a[128:131], v0, s[4:7], s49 offen offset:0 sc1
    s_waitcnt vmcnt(14) lgkmcnt(3)
    v_mfma_f32_32x32x16_bf16 v[64:79], v[124:127], v[164:167], v[64:79]
    ds_read_b128 v[124:127], v1 offset:43008
    buffer_load_dwordx4 v[132:135], v0, s[8:11], s51 offen offset:1024 sc1
    buffer_load_dwordx4 v[136:139], v0, s[8:11], s51 offen offset:2048 sc1
    s_waitcnt lgkmcnt(3)
    v_mfma_f32_32x32x16_bf16 v[80:95], v[112:115], v[164:167], v[80:95]
    ds_read_b128 v[112:115], v0 offset:43008
    s_waitcnt lgkmcnt(3)
    v_mfma_f32_32x32x16_bf16 v[96:111], v[116:119], v[164:167], v[96:111]
    ds_read_b128 v[116:119], v1 offset:11264
    s_waitcnt vmcnt(15) lgkmcnt(3)
    v_mfma_f32_32x32x16_bf16 v[64:79], v[120:123], v[168:171], v[64:79]
    ds_read_b128 v[120:123], v1 offset:44032
    buffer_load_dwordx4 v[140:143], v0, s[8:11], s51 offen offset:3072 sc1
    s_waitcnt lgkmcnt(3)
    v_mfma_f32_32x32x16_bf16 v[80:95], v[124:127], v[168:171], v[80:95]
    ds_read_b128 v[124:127], v0 offset:44032
    s_waitcnt lgkmcnt(3)
    v_mfma_f32_32x32x16_bf16 v[96:111], v[112:115], v[168:171], v[96:111]
    ds_read_b128 v[112:115], v1 offset:12288
    s_waitcnt vmcnt(15) lgkmcnt(3)
    v_mfma_f32_32x32x16_bf16 v[64:79], v[116:119], v[172:175], v[64:79]
    ds_read_b128 v[116:119], v1 offset:45056
    s_add_u32 s51, s24, 20480
    buffer_load_dwordx4 v[144:147], v0, s[8:11], s51 offen offset:0 sc1
    s_waitcnt lgkmcnt(3)
    v_mfma_f32_32x32x16_bf16 v[80:95], v[120:123], v[172:175], v[80:95]
    ds_read_b128 v[120:123], v0 offset:45056
    s_waitcnt lgkmcnt(3)
    v_mfma_f32_32x32x16_bf16 v[96:111], v[124:127], v[172:175], v[96:111]
    ds_read_b128 v[124:127], v1 offset:13312
    buffer_load_dwordx4 a[132:135], v0, s[4:7], s49 offen offset:1024 sc1
    s_waitcnt vmcnt(11) lgkmcnt(3)
    v_mfma_f32_32x32x16_bf16 v[64:79], v[112:115], v[176:179], v[64:79]
    ds_read_b128 v[112:115], v1 offset:46080
    buffer_load_dwordx4 v[148:151], v0, s[8:11], s51 offen offset:1024 sc1
    s_waitcnt lgkmcnt(3)
    v_mfma_f32_32x32x16_bf16 v[80:95], v[116:119], v[176:179], v[80:95]
    ds_read_b128 v[116:119], v0 offset:46080
    s_waitcnt lgkmcnt(3)
    v_mfma_f32_32x32x16_bf16 v[96:111], v[120:123], v[176:179], v[96:111]
    ds_read_b128 v[120:123], v1 offset:14336
    s_waitcnt vmcnt(10) lgkmcnt(3)
    v_mfma_f32_32x32x16_bf16 v[64:79], v[124:127], v[180:183], v[64:79]
    ds_read_b128 v[124:127], v1 offset:47104
    buffer_load_dwordx4 v[152:155], v0, s[8:11], s51 offen offset:2048 sc1
    buffer_load_dwordx4 v[156:159], v0, s[8:11], s51 offen offset:3072 sc1
    s_waitcnt lgkmcnt(3)
    v_mfma_f32_32x32x16_bf16 v[80:95], v[112:115], v[180:183], v[80:95]
    ds_read_b128 v[112:115], v0 offset:47104
    s_waitcnt lgkmcnt(3)
    v_mfma_f32_32x32x16_bf16 v[96:111], v[116:119], v[180:183], v[96:111]
    ds_read_b128 v[116:119], v1 offset:15360
    s_waitcnt vmcnt(11) lgkmcnt(3)
    v_mfma_f32_32x32x16_bf16 v[64:79], v[120:123], v[184:187], v[64:79]
    ds_read_b128 v[120:123], v1 offset:48128
    s_add_u32 s51, s24, 24576
    buffer_load_dwordx4 v[160:163], v0, s[8:11], s51 offen offset:0 sc1
    s_waitcnt lgkmcnt(3)
    v_mfma_f32_32x32x16_bf16 v[80:95], v[124:127], v[184:187], v[80:95]
    ds_read_b128 v[124:127], v0 offset:48128
    v_add_f32 v56, v56, v58
    v_add_f32 v57, v57, v59
    v_add_f32 v60, v60, v62
    s_waitcnt lgkmcnt(3)
    v_mfma_f32_32x32x16_bf16 v[96:111], v[112:115], v[184:187], v[96:111]
    ds_read_b128 v[112:115], v1 offset:16384
    buffer_load_dwordx4 a[136:139], v0, s[4:7], s49 offen offset:2048 sc1
    v_add_f32 v61, v61, v63
    v_add_f32 v56, v56, v60
    s_waitcnt vmcnt(12) lgkmcnt(3)
    v_mfma_f32_32x32x16_bf16 v[64:79], v[116:119], v[188:191], v[64:79]
    ds_read_b128 v[116:119], v1 offset:49152
    buffer_load_dwordx4 v[164:167], v0, s[8:11], s51 offen offset:1024 sc1
    v_add_f32 v57, v57, v61
    s_nop 1
    v_permlane32_swap_b32 v56, v57
    s_waitcnt lgkmcnt(3)
    v_mfma_f32_32x32x16_bf16 v[80:95], v[120:123], v[188:191], v[80:95]
    ds_read_b128 v[120:123], v0 offset:49152
    v_add_f32 v56, v56, v57
    v_mov_b32 v57, v56
    s_waitcnt lgkmcnt(3)
    v_mfma_f32_32x32x16_bf16 v[96:111], v[124:127], v[188:191], v[96:111]
    ds_read_b128 v[124:127], v1 offset:17408
    v_permlane32_swap_b32 v56, v57
    v_mul_f32 v22, 989855744, v56
    s_waitcnt vmcnt(12) lgkmcnt(3)
    v_mfma_f32_32x32x16_bf16 v[64:79], v[112:115], v[128:131], v[64:79]
    ds_read_b128 v[112:115], v1 offset:50176
    buffer_load_dwordx4 v[168:171], v0, s[8:11], s51 offen offset:2048 sc1
    buffer_load_dwordx4 v[172:175], v0, s[8:11], s51 offen offset:3072 sc1
    s_waitcnt lgkmcnt(3)
    v_mfma_f32_32x32x16_bf16 v[80:95], v[116:119], v[128:131], v[80:95]
    ds_read_b128 v[116:119], v0 offset:50176
    v_mul_f32 v57, 989855744, v57
    v_fma_f32 v57, -v22, v22, v57
    v_max_f32 v57, 0, v57
    v_add_f32 v58, 925353388, v57
    s_waitcnt lgkmcnt(3)
    v_mfma_f32_32x32x16_bf16 v[96:111], v[120:123], v[128:131], v[96:111]
    ds_read_b128 v[120:123], v1 offset:18432
    v_rsq_f32 v23, v58
    s_waitcnt vmcnt(12) lgkmcnt(3)
    v_mfma_f32_32x32x16_bf16 v[64:79], v[124:127], v[132:135], v[64:79]
    ds_read_b128 v[124:127], v1 offset:51200
    s_add_u32 s51, s24, 28672
    buffer_load_dwordx4 v[176:179], v0, s[8:11], s51 offen offset:0 sc1
    s_waitcnt lgkmcnt(3)
    v_mfma_f32_32x32x16_bf16 v[80:95], v[112:115], v[132:135], v[80:95]
    ds_read_b128 v[112:115], v0 offset:51200
    v_mul_f32 v58, v23, v23
    v_mul_f32 v58, v58, v57
    v_add_f32 v58, 925353388, v58
    v_rsq_f32 v58, v58
    s_waitcnt lgkmcnt(3)
    v_mfma_f32_32x32x16_bf16 v[96:111], v[116:119], v[132:135], v[96:111]
    ds_read_b128 v[116:119], v1 offset:19456
    buffer_load_dwordx4 a[140:143], v0, s[4:7], s49 offen offset:3072 sc1
    v_mul_f32 v23, v23, v58
    s_waitcnt vmcnt(13) lgkmcnt(3)
    v_mfma_f32_32x32x16_bf16 v[64:79], v[120:123], v[136:139], v[64:79]
    ds_read_b128 v[120:123], v1 offset:52224
    buffer_load_dwordx4 v[180:183], v0, s[8:11], s51 offen offset:1024 sc1
    v_rcp_f32 v58, v23
    s_waitcnt lgkmcnt(3)
    v_mfma_f32_32x32x16_bf16 v[80:95], v[124:127], v[136:139], v[80:95]
    ds_read_b128 v[124:127], v0 offset:52224
    v_mul_f32 v56, 3222493025, v23
    v_mul_f32 v57, v23, v23
    s_waitcnt lgkmcnt(3)
    v_mfma_f32_32x32x16_bf16 v[96:111], v[112:115], v[136:139], v[96:111]
    ds_read_b128 v[112:115], v1 offset:20480
    v_mul_f32 v57, v57, v56
    v_mul_f32 v57, 1027024659, v57
    s_waitcnt vmcnt(13) lgkmcnt(3)
    v_mfma_f32_32x32x16_bf16 v[64:79], v[116:119], v[140:143], v[64:79]
    ds_read_b128 v[116:119], v1 offset:53248
    buffer_load_dwordx4 v[184:187], v0, s[8:11], s51 offen offset:2048 sc1
    buffer_load_dwordx4 v[188:191], v0, s[8:11], s51 offen offset:3072 sc1
    s_waitcnt lgkmcnt(3)
    v_mfma_f32_32x32x16_bf16 v[80:95], v[120:123], v[140:143], v[80:95]
    ds_read_b128 v[120:123], v0 offset:53248
    v_mov_b32 v42, 0
    v_mov_b32 v43, 0
    v_mov_b32 v46, 0
    v_mov_b32 v47, 0
    s_waitcnt lgkmcnt(3)
    v_mfma_f32_32x32x16_bf16 v[96:111], v[124:127], v[140:143], v[96:111]
    ds_read_b128 v[124:127], v1 offset:21504
    v_cndmask_b32 v48, v58, -v22, s[58:59]
    v_cvt_pk_bf16_f32 v44, v48, v48
    s_waitcnt vmcnt(14) lgkmcnt(3)
    v_mfma_f32_32x32x16_bf16 v[64:79], v[112:115], v[144:147], v[64:79]
    ds_read_b128 v[112:115], v1 offset:54272
    s_add_u32 s49, s55, 20480
    buffer_load_dwordx4 a[144:147], v0, s[4:7], s49 offen offset:0 sc1
    s_waitcnt lgkmcnt(3)
    v_mfma_f32_32x32x16_bf16 v[80:95], v[116:119], v[144:147], v[80:95]
    ds_read_b128 v[116:119], v0 offset:54272
    v_and_b32 v49, 0xffff0000, v44
    v_sub_f32 v48, v48, v49
    v_cvt_pk_bf16_f32 v45, v48, 0
    v_accvgpr_read_b32 v50, a250
    s_waitcnt lgkmcnt(3)
    v_mfma_f32_32x32x16_bf16 v[96:111], v[120:123], v[144:147], v[96:111]
    ds_read_b128 v[120:123], v1 offset:22528
    v_cvt_pk_bf16_f32 v41, v50, 0
    v_lshlrev_b32 v51, 16, v41
    s_waitcnt vmcnt(13) lgkmcnt(3)
    v_mfma_f32_32x32x16_bf16 v[64:79], v[124:127], v[148:151], v[64:79]
    ds_read_b128 v[124:127], v1 offset:55296
    buffer_load_dwordx4 a[148:151], v0, s[4:7], s49 offen offset:1024 sc1
    v_sub_f32 v51, v50, v51
    v_cvt_pk_bf16_f32 v40, v50, v51
    s_waitcnt lgkmcnt(3)
    v_mfma_f32_32x32x16_bf16 v[80:95], v[112:115], v[148:151], v[80:95]
    ds_read_b128 v[112:115], v0 offset:55296
    v_mfma_f32_32x32x16_bf16 v[64:79], v[40:43], v[44:47], v[64:79]
    v_accvgpr_read_b32 v50, a251
    s_waitcnt lgkmcnt(3)
    v_mfma_f32_32x32x16_bf16 v[96:111], v[116:119], v[148:151], v[96:111]
    ds_read_b128 v[116:119], v1 offset:23552
    v_cvt_pk_bf16_f32 v41, v50, 0
    v_lshlrev_b32 v51, 16, v41
    s_waitcnt vmcnt(13) lgkmcnt(3)
    v_mfma_f32_32x32x16_bf16 v[64:79], v[120:123], v[152:155], v[64:79]
    ds_read_b128 v[120:123], v1 offset:56320
    buffer_load_dwordx4 a[152:155], v0, s[4:7], s49 offen offset:2048 sc1
    v_sub_f32 v51, v50, v51
    v_cvt_pk_bf16_f32 v40, v50, v51
    s_waitcnt lgkmcnt(3)
    v_mfma_f32_32x32x16_bf16 v[80:95], v[124:127], v[152:155], v[80:95]
    ds_read_b128 v[124:127], v0 offset:56320
    v_mfma_f32_32x32x16_bf16 v[80:95], v[40:43], v[44:47], v[80:95]
    v_accvgpr_read_b32 v50, a252
    s_waitcnt lgkmcnt(3)
    v_mfma_f32_32x32x16_bf16 v[96:111], v[112:115], v[152:155], v[96:111]
    ds_read_b128 v[112:115], v1 offset:24576
    v_cvt_pk_bf16_f32 v41, v50, 0
    v_lshlrev_b32 v51, 16, v41
    s_waitcnt vmcnt(13) lgkmcnt(3)
    v_mfma_f32_32x32x16_bf16 v[64:79], v[116:119], v[156:159], v[64:79]
    ds_read_b128 v[116:119], v1 offset:57344
    buffer_load_dwordx4 a[156:159], v0, s[4:7], s49 offen offset:3072 sc1
    v_sub_f32 v51, v50, v51
    v_cvt_pk_bf16_f32 v40, v50, v51
    s_waitcnt lgkmcnt(3)
    v_mfma_f32_32x32x16_bf16 v[80:95], v[120:123], v[156:159], v[80:95]
    ds_read_b128 v[120:123], v0 offset:57344
    v_mfma_f32_32x32x16_bf16 v[96:111], v[40:43], v[44:47], v[96:111]
    s_waitcnt lgkmcnt(3)
    v_mfma_f32_32x32x16_bf16 v[96:111], v[124:127], v[156:159], v[96:111]
    ds_read_b128 v[124:127], v1 offset:25600
    s_waitcnt vmcnt(13) lgkmcnt(3)
    v_mfma_f32_32x32x16_bf16 v[64:79], v[112:115], v[160:163], v[64:79]
    ds_read_b128 v[112:115], v1 offset:58368
    s_add_u32 s49, s55, 24576
    buffer_load_dwordx4 a[160:163], v0, s[4:7], s49 offen offset:0 sc1
    s_waitcnt lgkmcnt(3)
    v_mfma_f32_32x32x16_bf16 v[80:95], v[116:119], v[160:163], v[80:95]
    ds_read_b128 v[116:119], v0 offset:58368
    s_waitcnt lgkmcnt(3)
    v_mfma_f32_32x32x16_bf16 v[96:111], v[120:123], v[160:163], v[96:111]
    ds_read_b128 v[120:123], v1 offset:26624
    s_waitcnt vmcnt(12) lgkmcnt(3)
    v_mfma_f32_32x32x16_bf16 v[64:79], v[124:127], v[164:167], v[64:79]
    ds_read_b128 v[124:127], v1 offset:59392
    buffer_load_dwordx4 a[164:167], v0, s[4:7], s49 offen offset:1024 sc1
    s_waitcnt lgkmcnt(3)
    v_mfma_f32_32x32x16_bf16 v[80:95], v[112:115], v[164:167], v[80:95]
    ds_read_b128 v[112:115], v0 offset:59392
    s_waitcnt lgkmcnt(3)
    v_mfma_f32_32x32x16_bf16 v[96:111], v[116:119], v[164:167], v[96:111]
    ds_read_b128 v[116:119], v1 offset:27648
    s_waitcnt vmcnt(12) lgkmcnt(3)
    v_mfma_f32_32x32x16_bf16 v[64:79], v[120:123], v[168:171], v[64:79]
    ds_read_b128 v[120:123], v1 offset:60416
    buffer_load_dwordx4 a[168:171], v0, s[4:7], s49 offen offset:2048 sc1
    s_waitcnt lgkmcnt(3)
    v_mfma_f32_32x32x16_bf16 v[80:95], v[124:127], v[168:171], v[80:95]
    ds_read_b128 v[124:127], v0 offset:60416
    s_waitcnt lgkmcnt(3)
    v_mfma_f32_32x32x16_bf16 v[96:111], v[112:115], v[168:171], v[96:111]
    ds_read_b128 v[112:115], v1 offset:28672
    s_waitcnt vmcnt(12) lgkmcnt(3)
    v_mfma_f32_32x32x16_bf16 v[64:79], v[116:119], v[172:175], v[64:79]
    ds_read_b128 v[116:119], v1 offset:61440
    buffer_load_dwordx4 a[172:175], v0, s[4:7], s49 offen offset:3072 sc1
    s_waitcnt lgkmcnt(3)
    v_mfma_f32_32x32x16_bf16 v[80:95], v[120:123], v[172:175], v[80:95]
    ds_read_b128 v[120:123], v0 offset:61440
    s_waitcnt lgkmcnt(3)
    v_mfma_f32_32x32x16_bf16 v[96:111], v[124:127], v[172:175], v[96:111]
    ds_read_b128 v[124:127], v1 offset:29696
    s_waitcnt vmcnt(12) lgkmcnt(3)
    v_mfma_f32_32x32x16_bf16 v[64:79], v[112:115], v[176:179], v[64:79]
    ds_read_b128 v[112:115], v1 offset:62464
    s_add_u32 s49, s55, 28672
    buffer_load_dwordx4 a[176:179], v0, s[4:7], s49 offen offset:0 sc1
    s_waitcnt lgkmcnt(3)
    v_mfma_f32_32x32x16_bf16 v[80:95], v[116:119], v[176:179], v[80:95]
    ds_read_b128 v[116:119], v0 offset:62464
    s_waitcnt lgkmcnt(3)
    v_mfma_f32_32x32x16_bf16 v[96:111], v[120:123], v[176:179], v[96:111]
    ds_read_b128 v[120:123], v1 offset:30720
    s_waitcnt vmcnt(11) lgkmcnt(3)
    v_mfma_f32_32x32x16_bf16 v[64:79], v[124:127], v[180:183], v[64:79]
    ds_read_b128 v[124:127], v1 offset:63488
    buffer_load_dwordx4 a[180:183], v0, s[4:7], s49 offen offset:1024 sc1
    s_waitcnt lgkmcnt(3)
    v_mfma_f32_32x32x16_bf16 v[80:95], v[112:115], v[180:183], v[80:95]
    ds_read_b128 v[112:115], v0 offset:63488
    s_waitcnt lgkmcnt(3)
    v_mfma_f32_32x32x16_bf16 v[96:111], v[116:119], v[180:183], v[96:111]
    ds_read_b128 v[116:119], v1 offset:31744
    s_waitcnt vmcnt(11) lgkmcnt(3)
    v_mfma_f32_32x32x16_bf16 v[64:79], v[120:123], v[184:187], v[64:79]
    ds_read_b128 v[120:123], v1 offset:64512
    buffer_load_dwordx4 a[184:187], v0, s[4:7], s49 offen offset:2048 sc1
    s_waitcnt lgkmcnt(3)
    v_mfma_f32_32x32x16_bf16 v[80:95], v[124:127], v[184:187], v[80:95]
    ds_read_b128 v[124:127], v0 offset:64512
    s_waitcnt lgkmcnt(3)
    v_mfma_f32_32x32x16_bf16 v[96:111], v[112:115], v[184:187], v[96:111]
    s_waitcnt vmcnt(11) lgkmcnt(2)
    v_mfma_f32_32x32x16_bf16 v[64:79], v[116:119], v[188:191], v[64:79]
    buffer_load_dwordx4 a[188:191], v0, s[4:7], s49 offen offset:3072 sc1
    s_waitcnt lgkmcnt(1)
    v_mfma_f32_32x32x16_bf16 v[80:95], v[120:123], v[188:191], v[80:95]
    s_waitcnt lgkmcnt(0)
    v_mfma_f32_32x32x16_bf16 v[96:111], v[124:127], v[188:191], v[96:111]
    s_nop 6
    v_pk_mul_f32 v[40:41], v[64:65], v[64:65]
    v_pk_mul_f32 v[42:43], v[66:67], v[66:67]
    v_pk_mul_f32 v[44:45], v[68:69], v[68:69]
    v_pk_mul_f32 v[46:47], v[70:71], v[70:71]
    v_pk_fma_f32 v[40:41], v[40:41], v[56:57], v[56:57] op_sel:[0,1,0] op_sel_hi:[1,1,0]
    s_add_u32 s49, s55, 32768
    buffer_load_dwordx4 a[192:195], v0, s[4:7], s49 offen offset:0 sc1
    v_pk_fma_f32 v[42:43], v[42:43], v[56:57], v[56:57] op_sel:[0,1,0] op_sel_hi:[1,1,0]
    v_pk_fma_f32 v[44:45], v[44:45], v[56:57], v[56:57] op_sel:[0,1,0] op_sel_hi:[1,1,0]
    v_pk_fma_f32 v[46:47], v[46:47], v[56:57], v[56:57] op_sel:[0,1,0] op_sel_hi:[1,1,0]
    v_pk_mul_f32 v[40:41], v[40:41], v[64:65]
    v_pk_mul_f32 v[42:43], v[42:43], v[66:67]
    v_pk_mul_f32 v[44:45], v[44:45], v[68:69]
    v_pk_mul_f32 v[46:47], v[46:47], v[70:71]
    v_exp_f32 v40, v40
    v_exp_f32 v41, v41
    v_exp_f32 v42, v42
    v_exp_f32 v43, v43
    buffer_load_dwordx4 a[196:199], v0, s[4:7], s49 offen offset:1024 sc1
    v_exp_f32 v44, v44
    v_exp_f32 v45, v45
    v_exp_f32 v46, v46
    v_exp_f32 v47, v47
    v_pk_fma_f32 v[40:41], v[40:41], v[58:59], v[58:59] op_sel_hi:[1,0,0]
    v_pk_fma_f32 v[42:43], v[42:43], v[58:59], v[58:59] op_sel_hi:[1,0,0]
    v_pk_fma_f32 v[44:45], v[44:45], v[58:59], v[58:59] op_sel_hi:[1,0,0]
    v_pk_fma_f32 v[46:47], v[46:47], v[58:59], v[58:59] op_sel_hi:[1,0,0]
    v_rcp_f32 v40, v40
    buffer_load_dwordx4 a[200:203], v0, s[4:7], s49 offen offset:2048 sc1
    v_rcp_f32 v41, v41
    v_rcp_f32 v42, v42
    v_rcp_f32 v43, v43
    v_rcp_f32 v44, v44
    v_rcp_f32 v45, v45
    v_rcp_f32 v46, v46
    v_rcp_f32 v47, v47
    buffer_load_dwordx4 a[204:207], v0, s[4:7], s49 offen offset:3072 sc1
    v_pk_mul_f32 v[64:65], v[64:65], v[40:41]
    v_pk_mul_f32 v[66:67], v[66:67], v[42:43]
    v_pk_mul_f32 v[68:69], v[68:69], v[44:45]
    v_pk_mul_f32 v[70:71], v[70:71], v[46:47]
    v_cvt_pk_bf16_f32 v64, v64, v65
    v_cvt_pk_bf16_f32 v65, v66, v67
    v_cvt_pk_bf16_f32 v66, v68, v69
    v_cvt_pk_bf16_f32 v67, v70, v71
    buffer_store_dwordx4 v[64:67], v5, s[4:7], s36 offen offset:0 sc1
    v_pk_mul_f32 v[48:49], v[72:73], v[72:73]
    v_pk_mul_f32 v[50:51], v[74:75], v[74:75]
    v_pk_mul_f32 v[52:53], v[76:77], v[76:77]
    v_pk_mul_f32 v[54:55], v[78:79], v[78:79]
    v_pk_fma_f32 v[48:49], v[48:49], v[56:57], v[56:57] op_sel:[0,1,0] op_sel_hi:[1,1,0]
    v_pk_fma_f32 v[50:51], v[50:51], v[56:57], v[56:57] op_sel:[0,1,0] op_sel_hi:[1,1,0]
    s_add_u32 s49, s55, 36864
    buffer_load_dwordx4 a[208:211], v0, s[4:7], s49 offen offset:0 sc1
    v_pk_fma_f32 v[52:53], v[52:53], v[56:57], v[56:57] op_sel:[0,1,0] op_sel_hi:[1,1,0]
    v_pk_fma_f32 v[54:55], v[54:55], v[56:57], v[56:57] op_sel:[0,1,0] op_sel_hi:[1,1,0]
    v_pk_mul_f32 v[48:49], v[48:49], v[72:73]
    v_pk_mul_f32 v[50:51], v[50:51], v[74:75]
    v_pk_mul_f32 v[52:53], v[52:53], v[76:77]
    v_pk_mul_f32 v[54:55], v[54:55], v[78:79]
    v_exp_f32 v48, v48
    v_exp_f32 v49, v49
    v_exp_f32 v50, v50
    v_exp_f32 v51, v51
    buffer_load_dwordx4 a[212:215], v0, s[4:7], s49 offen offset:1024 sc1
    v_exp_f32 v52, v52
    v_exp_f32 v53, v53
    v_exp_f32 v54, v54
    v_exp_f32 v55, v55
    v_pk_fma_f32 v[48:49], v[48:49], v[58:59], v[58:59] op_sel_hi:[1,0,0]
    v_pk_fma_f32 v[50:51], v[50:51], v[58:59], v[58:59] op_sel_hi:[1,0,0]
    v_pk_fma_f32 v[52:53], v[52:53], v[58:59], v[58:59] op_sel_hi:[1,0,0]
    v_pk_fma_f32 v[54:55], v[54:55], v[58:59], v[58:59] op_sel_hi:[1,0,0]
    v_rcp_f32 v48, v48
    buffer_load_dwordx4 a[216:219], v0, s[4:7], s49 offen offset:2048 sc1
    v_rcp_f32 v49, v49
    v_rcp_f32 v50, v50
    v_rcp_f32 v51, v51
    v_rcp_f32 v52, v52
    v_rcp_f32 v53, v53
    v_rcp_f32 v54, v54
    v_rcp_f32 v55, v55
    buffer_load_dwordx4 a[220:223], v0, s[4:7], s49 offen offset:3072 sc1
    v_pk_mul_f32 v[72:73], v[72:73], v[48:49]
    v_pk_mul_f32 v[74:75], v[74:75], v[50:51]
    v_pk_mul_f32 v[76:77], v[76:77], v[52:53]
    v_pk_mul_f32 v[78:79], v[78:79], v[54:55]
    v_cvt_pk_bf16_f32 v72, v72, v73
    v_cvt_pk_bf16_f32 v73, v74, v75
    v_cvt_pk_bf16_f32 v74, v76, v77
    v_cvt_pk_bf16_f32 v75, v78, v79
    buffer_store_dwordx4 v[72:75], v5, s[4:7], s36 offen offset:256 sc1
    v_pk_mul_f32 v[40:41], v[80:81], v[80:81]
    v_pk_mul_f32 v[42:43], v[82:83], v[82:83]
    v_pk_mul_f32 v[44:45], v[84:85], v[84:85]
    v_pk_mul_f32 v[46:47], v[86:87], v[86:87]
    v_pk_fma_f32 v[40:41], v[40:41], v[56:57], v[56:57] op_sel:[0,1,0] op_sel_hi:[1,1,0]
    v_pk_fma_f32 v[42:43], v[42:43], v[56:57], v[56:57] op_sel:[0,1,0] op_sel_hi:[1,1,0]
    s_add_u32 s49, s55, 40960
    s_cmp_eq_u32 s16, 3
    s_cselect_b32 s49, 268435456, s49
    buffer_load_dwordx4 a[224:227], v0, s[4:7], s49 offen offset:0 sc1
    v_pk_fma_f32 v[44:45], v[44:45], v[56:57], v[56:57] op_sel:[0,1,0] op_sel_hi:[1,1,0]
    v_pk_fma_f32 v[46:47], v[46:47], v[56:57], v[56:57] op_sel:[0,1,0] op_sel_hi:[1,1,0]
    v_pk_mul_f32 v[40:41], v[40:41], v[80:81]
    v_pk_mul_f32 v[42:43], v[42:43], v[82:83]
    v_pk_mul_f32 v[44:45], v[44:45], v[84:85]
    v_pk_mul_f32 v[46:47], v[46:47], v[86:87]
    v_exp_f32 v40, v40
    v_exp_f32 v41, v41
    v_exp_f32 v42, v42
    v_exp_f32 v43, v43
    buffer_load_dwordx4 a[228:231], v0, s[4:7], s49 offen offset:1024 sc1
    v_exp_f32 v44, v44
    v_exp_f32 v45, v45
    v_exp_f32 v46, v46
    v_exp_f32 v47, v47
    v_pk_fma_f32 v[40:41], v[40:41], v[58:59], v[58:59] op_sel_hi:[1,0,0]
    v_pk_fma_f32 v[42:43], v[42:43], v[58:59], v[58:59] op_sel_hi:[1,0,0]
    v_pk_fma_f32 v[44:45], v[44:45], v[58:59], v[58:59] op_sel_hi:[1,0,0]
    v_pk_fma_f32 v[46:47], v[46:47], v[58:59], v[58:59] op_sel_hi:[1,0,0]
    v_rcp_f32 v40, v40
    buffer_load_dwordx4 a[232:235], v0, s[4:7], s49 offen offset:2048 sc1
    v_rcp_f32 v41, v41
    v_rcp_f32 v42, v42
    v_rcp_f32 v43, v43
    v_rcp_f32 v44, v44
    v_rcp_f32 v45, v45
    v_rcp_f32 v46, v46
    v_rcp_f32 v47, v47
    buffer_load_dwordx4 a[236:239], v0, s[4:7], s49 offen offset:3072 sc1
    v_pk_mul_f32 v[80:81], v[80:81], v[40:41]
    v_pk_mul_f32 v[82:83], v[82:83], v[42:43]
    v_pk_mul_f32 v[84:85], v[84:85], v[44:45]
    v_pk_mul_f32 v[86:87], v[86:87], v[46:47]
    v_cvt_pk_bf16_f32 v80, v80, v81
    v_cvt_pk_bf16_f32 v81, v82, v83
    v_cvt_pk_bf16_f32 v82, v84, v85
    v_cvt_pk_bf16_f32 v83, v86, v87
    buffer_store_dwordx4 v[80:83], v5, s[4:7], s63 offen offset:0 sc1
    v_pk_mul_f32 v[48:49], v[88:89], v[88:89]
    v_pk_mul_f32 v[50:51], v[90:91], v[90:91]
    v_pk_mul_f32 v[52:53], v[92:93], v[92:93]
    v_pk_mul_f32 v[54:55], v[94:95], v[94:95]
    v_pk_fma_f32 v[48:49], v[48:49], v[56:57], v[56:57] op_sel:[0,1,0] op_sel_hi:[1,1,0]
    v_pk_fma_f32 v[50:51], v[50:51], v[56:57], v[56:57] op_sel:[0,1,0] op_sel_hi:[1,1,0]
    v_pk_fma_f32 v[52:53], v[52:53], v[56:57], v[56:57] op_sel:[0,1,0] op_sel_hi:[1,1,0]
    v_pk_fma_f32 v[54:55], v[54:55], v[56:57], v[56:57] op_sel:[0,1,0] op_sel_hi:[1,1,0]
    v_pk_mul_f32 v[48:49], v[48:49], v[88:89]
    v_pk_mul_f32 v[50:51], v[50:51], v[90:91]
    v_pk_mul_f32 v[52:53], v[52:53], v[92:93]
    v_pk_mul_f32 v[54:55], v[54:55], v[94:95]
    v_exp_f32 v48, v48
    v_exp_f32 v49, v49
    v_exp_f32 v50, v50
    v_exp_f32 v51, v51
    v_exp_f32 v52, v52
    v_exp_f32 v53, v53
    v_exp_f32 v54, v54
    v_exp_f32 v55, v55
    v_pk_fma_f32 v[48:49], v[48:49], v[58:59], v[58:59] op_sel_hi:[1,0,0]
    v_pk_fma_f32 v[50:51], v[50:51], v[58:59], v[58:59] op_sel_hi:[1,0,0]
    v_pk_fma_f32 v[52:53], v[52:53], v[58:59], v[58:59] op_sel_hi:[1,0,0]
    v_pk_fma_f32 v[54:55], v[54:55], v[58:59], v[58:59] op_sel_hi:[1,0,0]
    v_rcp_f32 v48, v48
    v_rcp_f32 v49, v49
    v_rcp_f32 v50, v50
    v_rcp_f32 v51, v51
    v_rcp_f32 v52, v52
    v_rcp_f32 v53, v53
    v_rcp_f32 v54, v54
    v_rcp_f32 v55, v55
    v_pk_mul_f32 v[88:89], v[88:89], v[48:49]
    v_pk_mul_f32 v[90:91], v[90:91], v[50:51]
    v_pk_mul_f32 v[92:93], v[92:93], v[52:53]
    v_pk_mul_f32 v[94:95], v[94:95], v[54:55]
    v_cvt_pk_bf16_f32 v88, v88, v89
    v_cvt_pk_bf16_f32 v89, v90, v91
    v_cvt_pk_bf16_f32 v90, v92, v93
    v_cvt_pk_bf16_f32 v91, v94, v95
    buffer_store_dwordx4 v[88:91], v5, s[4:7], s63 offen offset:256 sc1
    v_pk_mul_f32 v[40:41], v[96:97], v[96:97]
    v_pk_mul_f32 v[42:43], v[98:99], v[98:99]
    v_pk_mul_f32 v[44:45], v[100:101], v[100:101]
    v_pk_mul_f32 v[46:47], v[102:103], v[102:103]
    v_pk_fma_f32 v[40:41], v[40:41], v[56:57], v[56:57] op_sel:[0,1,0] op_sel_hi:[1,1,0]
    v_pk_fma_f32 v[42:43], v[42:43], v[56:57], v[56:57] op_sel:[0,1,0] op_sel_hi:[1,1,0]
    v_pk_fma_f32 v[44:45], v[44:45], v[56:57], v[56:57] op_sel:[0,1,0] op_sel_hi:[1,1,0]
    v_pk_fma_f32 v[46:47], v[46:47], v[56:57], v[56:57] op_sel:[0,1,0] op_sel_hi:[1,1,0]
    v_pk_mul_f32 v[40:41], v[40:41], v[96:97]
    v_pk_mul_f32 v[42:43], v[42:43], v[98:99]
    v_pk_mul_f32 v[44:45], v[44:45], v[100:101]
    v_pk_mul_f32 v[46:47], v[46:47], v[102:103]
    v_exp_f32 v40, v40
    v_exp_f32 v41, v41
    v_exp_f32 v42, v42
    v_exp_f32 v43, v43
    v_exp_f32 v44, v44
    v_exp_f32 v45, v45
    v_exp_f32 v46, v46
    v_exp_f32 v47, v47
    v_pk_fma_f32 v[40:41], v[40:41], v[58:59], v[58:59] op_sel_hi:[1,0,0]
    v_pk_fma_f32 v[42:43], v[42:43], v[58:59], v[58:59] op_sel_hi:[1,0,0]
    v_pk_fma_f32 v[44:45], v[44:45], v[58:59], v[58:59] op_sel_hi:[1,0,0]
    v_pk_fma_f32 v[46:47], v[46:47], v[58:59], v[58:59] op_sel_hi:[1,0,0]
    v_rcp_f32 v40, v40
    v_rcp_f32 v41, v41
    v_rcp_f32 v42, v42
    v_rcp_f32 v43, v43
    v_rcp_f32 v44, v44
    v_rcp_f32 v45, v45
    v_rcp_f32 v46, v46
    v_rcp_f32 v47, v47
    v_pk_mul_f32 v[96:97], v[96:97], v[40:41]
    v_pk_mul_f32 v[98:99], v[98:99], v[42:43]
    v_pk_mul_f32 v[100:101], v[100:101], v[44:45]
    v_pk_mul_f32 v[102:103], v[102:103], v[46:47]
    v_cvt_pk_bf16_f32 v96, v96, v97
    v_cvt_pk_bf16_f32 v97, v98, v99
    v_cvt_pk_bf16_f32 v98, v100, v101
    v_cvt_pk_bf16_f32 v99, v102, v103
    buffer_store_dwordx4 v[96:99], v5, s[4:7], s37 offen offset:0 sc1
    v_pk_mul_f32 v[48:49], v[104:105], v[104:105]
    v_pk_mul_f32 v[50:51], v[106:107], v[106:107]
    v_pk_mul_f32 v[52:53], v[108:109], v[108:109]
    v_pk_mul_f32 v[54:55], v[110:111], v[110:111]
    v_pk_fma_f32 v[48:49], v[48:49], v[56:57], v[56:57] op_sel:[0,1,0] op_sel_hi:[1,1,0]
    v_pk_fma_f32 v[50:51], v[50:51], v[56:57], v[56:57] op_sel:[0,1,0] op_sel_hi:[1,1,0]
    v_pk_fma_f32 v[52:53], v[52:53], v[56:57], v[56:57] op_sel:[0,1,0] op_sel_hi:[1,1,0]
    v_pk_fma_f32 v[54:55], v[54:55], v[56:57], v[56:57] op_sel:[0,1,0] op_sel_hi:[1,1,0]
    v_pk_mul_f32 v[48:49], v[48:49], v[104:105]
    v_pk_mul_f32 v[50:51], v[50:51], v[106:107]
    v_pk_mul_f32 v[52:53], v[52:53], v[108:109]
    v_pk_mul_f32 v[54:55], v[54:55], v[110:111]
    v_exp_f32 v48, v48
    v_exp_f32 v49, v49
    v_exp_f32 v50, v50
    v_exp_f32 v51, v51
    v_exp_f32 v52, v52
    v_exp_f32 v53, v53
    v_exp_f32 v54, v54
    v_exp_f32 v55, v55
    v_pk_fma_f32 v[48:49], v[48:49], v[58:59], v[58:59] op_sel_hi:[1,0,0]
    v_pk_fma_f32 v[50:51], v[50:51], v[58:59], v[58:59] op_sel_hi:[1,0,0]
    v_pk_fma_f32 v[52:53], v[52:53], v[58:59], v[58:59] op_sel_hi:[1,0,0]
    v_pk_fma_f32 v[54:55], v[54:55], v[58:59], v[58:59] op_sel_hi:[1,0,0]
    v_rcp_f32 v48, v48
    v_rcp_f32 v49, v49
    v_rcp_f32 v50, v50
    v_rcp_f32 v51, v51
    v_rcp_f32 v52, v52
    v_rcp_f32 v53, v53
    v_rcp_f32 v54, v54
    v_rcp_f32 v55, v55
    v_pk_mul_f32 v[104:105], v[104:105], v[48:49]
    v_pk_mul_f32 v[106:107], v[106:107], v[50:51]
    v_pk_mul_f32 v[108:109], v[108:109], v[52:53]
    v_pk_mul_f32 v[110:111], v[110:111], v[54:55]
    v_cvt_pk_bf16_f32 v104, v104, v105
    v_cvt_pk_bf16_f32 v105, v106, v107
    v_cvt_pk_bf16_f32 v106, v108, v109
    v_cvt_pk_bf16_f32 v107, v110, v111
    buffer_store_dwordx4 v[104:107], v5, s[4:7], s37 offen offset:256 sc1
    s_add_u32 s44, s101, 131072
    v_lshrrev_b32 v48, 2, v0
    v_add_u32 v48, s44, v48
    v_xor_b32 v49, 16, v48
    v_xor_b32 v50, 0x80, v48
    v_xor_b32 v51, 0x90, v48
    s_lshr_b32 s44, s16, 1
    s_lshl_b32 s44, s44, 12
    s_and_b32 s45, s16, 1
    s_lshl_b32 s45, s45, 7
    s_add_u32 s44, s44, s45
    s_add_u32 s44, s44, 131072
    v_bfe_u32 v52, v0, 8, 2
    v_lshl_add_u32 v57, v52, 10, s44
    v_bfe_u32 v52, v0, 4, 2
    v_lshl_add_u32 v57, v52, 8, v57
    v_and_b32 v52, 0x50, v0
    v_add_u32 v57, v57, v52
    v_bfe_u32 v52, v0, 7, 1
    v_lshl_add_u32 v57, v52, 5, v57
    v_and_b32 v52, 0x20, v0
    v_lshlrev_b32 v52, 2, v52
    v_xor_b32 v57, v57, v52
    v_xor_b32 v58, 16, v57
    v_subrev_u32 v52, 98304, v48
    v_subrev_u32 v53, 98304, v49
    v_subrev_u32 v54, 98304, v50
    v_subrev_u32 v55, 98304, v51
    s_add_u32 s45, s98, 3
    s_mov_b64 exec, 1
    v_mov_b32 v56, s45
    s_waitcnt vmcnt(0)
    buffer_store_dword v56, off, s[4:7], s38 offset:0 sc1
    s_mov_b64 exec, -1
    s_add_u32 s45, s98, 3
    s_mov_b32 exec_hi, 0
    s_mov_b32 exec_lo, s95
    s_mov_b32 s50, 0
Lpoll_15_s:
    buffer_load_dword v56, v21, s[4:7], s40 offen sc1
    s_add_u32 s50, s50, 1
    s_cmp_gt_u32 s50, 0x40000
    s_cbranch_scc1 Labort
    s_waitcnt vmcnt(0)
    v_cmp_ne_u32 vcc, s45, v56
    s_cbranch_vccnz Lpoll_15_s
    s_mov_b64 exec, -1
    v_add_u32 v60, s23, v1
    v_add_u32 v61, s23, v0
    s_add_u32 s51, s39, 0
    buffer_load_dwordx4 v[128:131], v0, s[4:7], s51 offen offset:0 sc1
    buffer_load_dwordx4 v[132:135], v0, s[4:7], s51 offen offset:2048 sc1
    s_add_u32 s51, s39, 4096
    buffer_load_dwordx4 v[136:139], v0, s[4:7], s51 offen offset:0 sc1
    buffer_load_dwordx4 v[140:143], v0, s[4:7], s51 offen offset:2048 sc1
    s_add_u32 s51, s39, 8192
    buffer_load_dwordx4 v[144:147], v0, s[4:7], s51 offen offset:0 sc1
    buffer_load_dwordx4 v[148:151], v0, s[4:7], s51 offen offset:2048 sc1
    s_add_u32 s51, s39, 12288
    buffer_load_dwordx4 v[152:155], v0, s[4:7], s51 offen offset:0 sc1
    buffer_load_dwordx4 v[156:159], v0, s[4:7], s51 offen offset:2048 sc1
    s_add_u32 s51, s39, 16384
    buffer_load_dwordx4 v[160:163], v0, s[4:7], s51 offen offset:0 sc1
    buffer_load_dwordx4 v[164:167], v0, s[4:7], s51 offen offset:2048 sc1
    s_barrier
    s_waitcnt vmcnt(9)
    v_mfma_f32_16x16x32_bf16 v[64:67], v[128:131], a[64:67], 0
    s_add_u32 s51, s39, 20480
    s_cmp_eq_u32 s16, 3
    s_cselect_b32 s51, 268435456, s51
    buffer_load_dwordx4 v[168:171], v0, s[4:7], s51 offen offset:0 sc1
    v_mfma_f32_16x16x32_bf16 v[68:71], v[128:131], a[68:71], 0
    v_mfma_f32_16x16x32_bf16 v[72:75], v[128:131], a[72:75], 0
    v_mfma_f32_16x16x32_bf16 v[76:79], v[128:131], a[76:79], 0
    s_waitcnt vmcnt(9)
    v_mfma_f32_16x16x32_bf16 v[64:67], v[132:135], a[80:83], v[64:67]
    s_add_u32 s51, s39, 1024
    buffer_load_dwordx4 v[172:175], v0, s[4:7], s51 offen offset:0 sc1
    v_mfma_f32_16x16x32_bf16 v[68:71], v[132:135], a[84:87], v[68:71]
    v_mfma_f32_16x16x32_bf16 v[72:75], v[132:135], a[88:91], v[72:75]
    v_mfma_f32_16x16x32_bf16 v[76:79], v[132:135], a[92:95], v[76:79]
    ds_write_b128 v60, v[192:195] offset:32768
    s_waitcnt vmcnt(9)
    v_mfma_f32_16x16x32_bf16 v[64:67], v[136:139], a[96:99], v[64:67]
    buffer_load_dwordx4 v[176:179], v0, s[4:7], s51 offen offset:2048 sc1
    v_mfma_f32_16x16x32_bf16 v[68:71], v[136:139], a[100:103], v[68:71]
    v_mfma_f32_16x16x32_bf16 v[72:75], v[136:139], a[104:107], v[72:75]
    v_mfma_f32_16x16x32_bf16 v[76:79], v[136:139], a[108:111], v[76:79]
    ds_write_b128 v60, v[196:199] offset:33792
    s_waitcnt vmcnt(9)
    v_mfma_f32_16x16x32_bf16 v[64:67], v[140:143], a[112:115], v[64:67]
    s_add_u32 s51, s39, 5120
    buffer_load_dwordx4 v[180:183], v0, s[4:7], s51 offen offset:0 sc1
    v_mfma_f32_16x16x32_bf16 v[68:71], v[140:143], a[116:119], v[68:71]
    v_mfma_f32_16x16x32_bf16 v[72:75], v[140:143], a[120:123], v[72:75]
    v_mfma_f32_16x16x32_bf16 v[76:79], v[140:143], a[124:127], v[76:79]
    ds_write_b128 v60, v[200:203] offset:34816
    s_waitcnt vmcnt(9)
    v_mfma_f32_16x16x32_bf16 v[64:67], v[144:147], a[128:131], v[64:67]
    buffer_load_dwordx4 v[184:187], v0, s[4:7], s51 offen offset:2048 sc1
    v_mfma_f32_16x16x32_bf16 v[68:71], v[144:147], a[132:135], v[68:71]
    v_mfma_f32_16x16x32_bf16 v[72:75], v[144:147], a[136:139], v[72:75]
    v_mfma_f32_16x16x32_bf16 v[76:79], v[144:147], a[140:143], v[76:79]
    ds_write_b128 v60, v[204:207] offset:35840
    s_waitcnt vmcnt(9)
    v_mfma_f32_16x16x32_bf16 v[64:67], v[148:151], a[144:147], v[64:67]
    s_add_u32 s51, s39, 9216
    buffer_load_dwordx4 v[188:191], v0, s[4:7], s51 offen offset:0 sc1
    v_mfma_f32_16x16x32_bf16 v[68:71], v[148:151], a[148:151], v[68:71]
    v_mfma_f32_16x16x32_bf16 v[72:75], v[148:151], a[152:155], v[72:75]
    v_mfma_f32_16x16x32_bf16 v[76:79], v[148:151], a[156:159], v[76:79]
    ds_write_b128 v60, v[208:211] offset:49152
    s_waitcnt vmcnt(9)
    v_mfma_f32_16x16x32_bf16 v[64:67], v[152:155], a[160:163], v[64:67]
    buffer_load_dwordx4 v[128:131], v0, s[4:7], s51 offen offset:2048 sc1
    v_mfma_f32_16x16x32_bf16 v[68:71], v[152:155], a[164:167], v[68:71]
    v_mfma_f32_16x16x32_bf16 v[72:75], v[152:155], a[168:171], v[72:75]
    v_mfma_f32_16x16x32_bf16 v[76:79], v[152:155], a[172:175], v[76:79]
    ds_write_b128 v60, v[212:215] offset:50176
    s_waitcnt vmcnt(9)
    v_mfma_f32_16x16x32_bf16 v[64:67], v[156:159], a[176:179], v[64:67]
    s_add_u32 s51, s39, 13312
    buffer_load_dwordx4 v[132:135], v0, s[4:7], s51 offen offset:0 sc1
    v_mfma_f32_16x16x32_bf16 v[68:71], v[156:159], a[180:183], v[68:71]
    v_mfma_f32_16x16x32_bf16 v[72:75], v[156:159], a[184:187], v[72:75]
    v_mfma_f32_16x16x32_bf16 v[76:79], v[156:159], a[188:191], v[76:79]
    ds_write_b128 v60, v[216:219] offset:51200
    s_waitcnt vmcnt(9)
    v_mfma_f32_16x16x32_bf16 v[64:67], v[160:163], a[192:195], v[64:67]
    buffer_load_dwordx4 v[136:139], v0, s[4:7], s51 offen offset:2048 sc1
    v_mfma_f32_16x16x32_bf16 v[68:71], v[160:163], a[196:199], v[68:71]
    v_mfma_f32_16x16x32_bf16 v[72:75], v[160:163], a[200:203], v[72:75]
    v_mfma_f32_16x16x32_bf16 v[76:79], v[160:163], a[204:207], v[76:79]
    ds_write_b128 v60, v[220:223] offset:52224
    s_waitcnt vmcnt(9)
    v_mfma_f32_16x16x32_bf16 v[64:67], v[164:167], a[208:211], v[64:67]
    s_add_u32 s51, s39, 17408
    buffer_load_dwordx4 v[140:143], v0, s[4:7], s51 offen offset:0 sc1
    v_mfma_f32_16x16x32_bf16 v[68:71], v[164:167], a[212:215], v[68:71]
    v_mfma_f32_16x16x32_bf16 v[72:75], v[164:167], a[216:219], v[72:75]
    v_mfma_f32_16x16x32_bf16 v[76:79], v[164:167], a[220:223], v[76:79]
    s_waitcnt vmcnt(9)
    v_mfma_f32_16x16x32_bf16 v[64:67], v[168:171], a[224:227], v[64:67]
    buffer_load_dwordx4 v[144:147], v0, s[4:7], s51 offen offset:2048 sc1
    v_mfma_f32_16x16x32_bf16 v[68:71], v[168:171], a[228:231], v[68:71]
    v_mfma_f32_16x16x32_bf16 v[72:75], v[168:171], a[232:235], v[72:75]
    v_mfma_f32_16x16x32_bf16 v[76:79], v[168:171], a[236:239], v[76:79]
    s_waitcnt vmcnt(9)
    v_mfma_f32_16x16x32_bf16 v[80:83], v[172:175], a[64:67], 0
    s_add_u32 s51, s39, 21504
    s_cmp_eq_u32 s16, 3
    s_cselect_b32 s51, 268435456, s51
    buffer_load_dwordx4 v[148:151], v0, s[4:7], s51 offen offset:0 sc1
    ds_write_b32 v48, v64 offset:0
    v_mfma_f32_16x16x32_bf16 v[84:87], v[172:175], a[68:71], 0
    ds_write_b32 v49, v65 offset:256
    v_mfma_f32_16x16x32_bf16 v[88:91], v[172:175], a[72:75], 0
    ds_write_b32 v50, v66 offset:512
    v_mfma_f32_16x16x32_bf16 v[92:95], v[172:175], a[76:79], 0
    ds_write_b32 v51, v67 offset:768
    s_waitcnt vmcnt(9)
    v_mfma_f32_16x16x32_bf16 v[80:83], v[176:179], a[80:83], v[80:83]
    s_add_u32 s51, s39, 88064
    buffer_load_dwordx4 v[152:155], v0, s[4:7], s51 offen offset:0 sc1
    ds_write_b32 v48, v68 offset:1024
    v_mfma_f32_16x16x32_bf16 v[84:87], v[176:179], a[84:87], v[84:87]
    ds_write_b32 v49, v69 offset:1280
    v_mfma_f32_16x16x32_bf16 v[88:91], v[176:179], a[88:91], v[88:91]
    ds_write_b32 v50, v70 offset:1536
    v_mfma_f32_16x16x32_bf16 v[92:95], v[176:179], a[92:95], v[92:95]
    ds_write_b32 v51, v71 offset:1792
    s_waitcnt vmcnt(9)
    v_mfma_f32_16x16x32_bf16 v[80:83], v[180:183], a[96:99], v[80:83]
    buffer_load_dwordx4 v[156:159], v0, s[4:7], s51 offen offset:2048 sc1
    ds_write_b32 v48, v72 offset:2048
    v_mfma_f32_16x16x32_bf16 v[84:87], v[180:183], a[100:103], v[84:87]
    ds_write_b32 v49, v73 offset:2304
    v_mfma_f32_16x16x32_bf16 v[88:91], v[180:183], a[104:107], v[88:91]
    ds_write_b32 v50, v74 offset:2560
    v_mfma_f32_16x16x32_bf16 v[92:95], v[180:183], a[108:111], v[92:95]
    ds_write_b32 v51, v75 offset:2816
    s_waitcnt vmcnt(9)
    v_mfma_f32_16x16x32_bf16 v[80:83], v[184:187], a[112:115], v[80:83]
    s_add_u32 s51, s39, 92160
    buffer_load_dwordx4 v[160:163], v0, s[4:7], s51 offen offset:0 sc1
    ds_write_b32 v48, v76 offset:3072
    v_mfma_f32_16x16x32_bf16 v[84:87], v[184:187], a[116:119], v[84:87]
    ds_write_b32 v49, v77 offset:3328
    v_mfma_f32_16x16x32_bf16 v[88:91], v[184:187], a[120:123], v[88:91]
    ds_write_b32 v50, v78 offset:3584
    v_mfma_f32_16x16x32_bf16 v[92:95], v[184:187], a[124:127], v[92:95]
    ds_write_b32 v51, v79 offset:3840
    s_waitcnt vmcnt(9)
    v_mfma_f32_16x16x32_bf16 v[80:83], v[188:191], a[128:131], v[80:83]
    buffer_load_dwordx4 v[164:167], v0, s[4:7], s51 offen offset:2048 sc1
    v_mfma_f32_16x16x32_bf16 v[84:87], v[188:191], a[132:135], v[84:87]
    v_mfma_f32_16x16x32_bf16 v[88:91], v[188:191], a[136:139], v[88:91]
    v_mfma_f32_16x16x32_bf16 v[92:95], v[188:191], a[140:143], v[92:95]
    s_waitcnt vmcnt(9)
    v_mfma_f32_16x16x32_bf16 v[80:83], v[128:131], a[144:147], v[80:83]
    s_add_u32 s51, s39, 96256
    buffer_load_dwordx4 v[168:171], v0, s[4:7], s51 offen offset:0 sc1
    v_mfma_f32_16x16x32_bf16 v[84:87], v[128:131], a[148:151], v[84:87]
    v_mfma_f32_16x16x32_bf16 v[88:91], v[128:131], a[152:155], v[88:91]
    v_mfma_f32_16x16x32_bf16 v[92:95], v[128:131], a[156:159], v[92:95]
    s_waitcnt vmcnt(9)
    v_mfma_f32_16x16x32_bf16 v[80:83], v[132:135], a[160:163], v[80:83]
    buffer_load_dwordx4 v[172:175], v0, s[4:7], s51 offen offset:2048 sc1
    v_mfma_f32_16x16x32_bf16 v[84:87], v[132:135], a[164:167], v[84:87]
    v_mfma_f32_16x16x32_bf16 v[88:91], v[132:135], a[168:171], v[88:91]
    v_mfma_f32_16x16x32_bf16 v[92:95], v[132:135], a[172:175], v[92:95]
    s_waitcnt vmcnt(9)
    v_mfma_f32_16x16x32_bf16 v[80:83], v[136:139], a[176:179], v[80:83]
    s_add_u32 s51, s39, 100352
    buffer_load_dwordx4 v[176:179], v0, s[4:7], s51 offen offset:0 sc1
    v_mfma_f32_16x16x32_bf16 v[84:87], v[136:139], a[180:183], v[84:87]
    v_mfma_f32_16x16x32_bf16 v[88:91], v[136:139], a[184:187], v[88:91]
    v_mfma_f32_16x16x32_bf16 v[92:95], v[136:139], a[188:191], v[92:95]
    s_waitcnt vmcnt(9)
    v_mfma_f32_16x16x32_bf16 v[80:83], v[140:143], a[192:195], v[80:83]
    buffer_load_dwordx4 v[180:183], v0, s[4:7], s51 offen offset:2048 sc1
    v_mfma_f32_16x16x32_bf16 v[84:87], v[140:143], a[196:199], v[84:87]
    v_mfma_f32_16x16x32_bf16 v[88:91], v[140:143], a[200:203], v[88:91]
    v_mfma_f32_16x16x32_bf16 v[92:95], v[140:143], a[204:207], v[92:95]
    s_waitcnt vmcnt(9)
    v_mfma_f32_16x16x32_bf16 v[80:83], v[144:147], a[208:211], v[80:83]
    s_add_u32 s51, s39, 104448
    buffer_load_dwordx4 v[184:187], v0, s[4:7], s51 offen offset:0 sc1
    v_mfma_f32_16x16x32_bf16 v[84:87], v[144:147], a[212:215], v[84:87]
    v_mfma_f32_16x16x32_bf16 v[88:91], v[144:147], a[216:219], v[88:91]
    v_mfma_f32_16x16x32_bf16 v[92:95], v[144:147], a[220:223], v[92:95]
    s_waitcnt vmcnt(9)
    v_mfma_f32_16x16x32_bf16 v[80:83], v[148:151], a[224:227], v[80:83]
    buffer_load_dwordx4 v[188:191], v0, s[4:7], s51 offen offset:2048 sc1
    v_mfma_f32_16x16x32_bf16 v[84:87], v[148:151], a[228:231], v[84:87]
    v_mfma_f32_16x16x32_bf16 v[88:91], v[148:151], a[232:235], v[88:91]
    v_mfma_f32_16x16x32_bf16 v[92:95], v[148:151], a[236:239], v[92:95]
    s_waitcnt vmcnt(9)
    v_mfma_f32_16x16x32_bf16 v[96:99], v[152:155], a[64:67], 0
    s_add_u32 s51, s39, 108544
    s_cmp_eq_u32 s16, 3
    s_cselect_b32 s51, 268435456, s51
    buffer_load_dwordx4 v[128:131], v0, s[4:7], s51 offen offset:0 sc1
    ds_write_b32 v48, v80 offset:4096
    v_mfma_f32_16x16x32_bf16 v[100:103], v[152:155], a[68:71], 0
    ds_write_b32 v49, v81 offset:4352
    v_mfma_f32_16x16x32_bf16 v[104:107], v[152:155], a[72:75], 0
    ds_write_b32 v50, v82 offset:4608
    v_mfma_f32_16x16x32_bf16 v[108:111], v[152:155], a[76:79], 0
    ds_write_b32 v51, v83 offset:4864
    s_waitcnt vmcnt(9)
    v_mfma_f32_16x16x32_bf16 v[96:99], v[156:159], a[80:83], v[96:99]
    s_add_u32 s51, s39, 89088
    buffer_load_dwordx4 v[132:135], v0, s[4:7], s51 offen offset:0 sc1
    ds_write_b32 v48, v84 offset:5120
    v_mfma_f32_16x16x32_bf16 v[100:103], v[156:159], a[84:87], v[100:103]
    ds_write_b32 v49, v85 offset:5376
    v_mfma_f32_16x16x32_bf16 v[104:107], v[156:159], a[88:91], v[104:107]
    ds_write_b32 v50, v86 offset:5632
    v_mfma_f32_16x16x32_bf16 v[108:111], v[156:159], a[92:95], v[108:111]
    ds_write_b32 v51, v87 offset:5888
    s_waitcnt vmcnt(9)
    v_mfma_f32_16x16x32_bf16 v[96:99], v[160:163], a[96:99], v[96:99]
    buffer_load_dwordx4 v[136:139], v0, s[4:7], s51 offen offset:2048 sc1
    ds_write_b32 v48, v88 offset:6144
    v_mfma_f32_16x16x32_bf16 v[100:103], v[160:163], a[100:103], v[100:103]
    ds_write_b32 v49, v89 offset:6400
    v_mfma_f32_16x16x32_bf16 v[104:107], v[160:163], a[104:107], v[104:107]
    ds_write_b32 v50, v90 offset:6656
    v_mfma_f32_16x16x32_bf16 v[108:111], v[160:163], a[108:111], v[108:111]
    ds_write_b32 v51, v91 offset:6912
    s_waitcnt vmcnt(9)
    v_mfma_f32_16x16x32_bf16 v[96:99], v[164:167], a[112:115], v[96:99]
    s_add_u32 s51, s39, 93184
    buffer_load_dwordx4 v[140:143], v0, s[4:7], s51 offen offset:0 sc1
    ds_write_b32 v48, v92 offset:7168
    v_mfma_f32_16x16x32_bf16 v[100:103], v[164:167], a[116:119], v[100:103]
    ds_write_b32 v49, v93 offset:7424
    v_mfma_f32_16x16x32_bf16 v[104:107], v[164:167], a[120:123], v[104:107]
    ds_write_b32 v50, v94 offset:7680
    v_mfma_f32_16x16x32_bf16 v[108:111], v[164:167], a[124:127], v[108:111]
    ds_write_b32 v51, v95 offset:7936
    s_waitcnt vmcnt(9)
    v_mfma_f32_16x16x32_bf16 v[96:99], v[168:171], a[128:131], v[96:99]
    buffer_load_dwordx4 v[144:147], v0, s[4:7], s51 offen offset:2048 sc1
    v_mfma_f32_16x16x32_bf16 v[100:103], v[168:171], a[132:135], v[100:103]
    v_mfma_f32_16x16x32_bf16 v[104:107], v[168:171], a[136:139], v[104:107]
    v_mfma_f32_16x16x32_bf16 v[108:111], v[168:171], a[140:143], v[108:111]
    s_waitcnt lgkmcnt(0)
    s_barrier
    s_waitcnt vmcnt(9)
    v_mfma_f32_16x16x32_bf16 v[96:99], v[172:175], a[144:147], v[96:99]
    s_add_u32 s51, s39, 97280
    buffer_load_dwordx4 v[148:151], v0, s[4:7], s51 offen offset:0 sc1
    v_mfma_f32_16x16x32_bf16 v[100:103], v[172:175], a[148:151], v[100:103]
    ds_read_b128 v[64:67], v57 offset:0
    ds_read_b128 v[68:71], v58 offset:0
    v_mfma_f32_16x16x32_bf16 v[104:107], v[172:175], a[152:155], v[104:107]
    ds_read_b128 v[72:75], v57 offset:8192
    ds_read_b128 v[76:79], v58 offset:8192
    v_mfma_f32_16x16x32_bf16 v[108:111], v[172:175], a[156:159], v[108:111]
    ds_read_b128 v[80:83], v57 offset:16384
    s_waitcnt vmcnt(9)
    v_mfma_f32_16x16x32_bf16 v[96:99], v[176:179], a[160:163], v[96:99]
    buffer_load_dwordx4 v[152:155], v0, s[4:7], s51 offen offset:2048 sc1
    ds_read_b128 v[84:87], v58 offset:16384
    v_mfma_f32_16x16x32_bf16 v[100:103], v[176:179], a[164:167], v[100:103]
    ds_read_b128 v[88:91], v57 offset:24576
    ds_read_b128 v[92:95], v58 offset:24576
    v_mfma_f32_16x16x32_bf16 v[104:107], v[176:179], a[168:171], v[104:107]
    v_subrev_u32 v57, 98304, v57
    v_subrev_u32 v58, 98304, v58
    v_mfma_f32_16x16x32_bf16 v[108:111], v[176:179], a[172:175], v[108:111]
    s_nop 0
    s_waitcnt vmcnt(9)
    v_mfma_f32_16x16x32_bf16 v[96:99], v[180:183], a[176:179], v[96:99]
    s_add_u32 s51, s39, 101376
    buffer_load_dwordx4 v[156:159], v0, s[4:7], s51 offen offset:0 sc1
    v_mfma_f32_16x16x32_bf16 v[100:103], v[180:183], a[180:183], v[100:103]
    s_nop 0
    s_nop 0
    v_mfma_f32_16x16x32_bf16 v[104:107], v[180:183], a[184:187], v[104:107]
    s_nop 0
    s_waitcnt lgkmcnt(0)
    v_mfma_f32_16x16x32_bf16 v[108:111], v[180:183], a[188:191], v[108:111]
    v_add_f32 v24, v24, v64
    s_waitcnt vmcnt(9)
    v_mfma_f32_16x16x32_bf16 v[96:99], v[184:187], a[192:195], v[96:99]
    buffer_load_dwordx4 v[160:163], v0, s[4:7], s51 offen offset:2048 sc1
    v_add_f32 v25, v25, v65
    v_mfma_f32_16x16x32_bf16 v[100:103], v[184:187], a[196:199], v[100:103]
    v_add_f32 v26, v26, v66
    v_add_f32 v27, v27, v67
    v_mfma_f32_16x16x32_bf16 v[104:107], v[184:187], a[200:203], v[104:107]
    v_add_f32 v28, v28, v68
    v_add_f32 v29, v29, v69
    v_mfma_f32_16x16x32_bf16 v[108:111], v[184:187], a[204:207], v[108:111]
    v_add_f32 v30, v30, v70
    s_waitcnt vmcnt(9)
    v_mfma_f32_16x16x32_bf16 v[96:99], v[188:191], a[208:211], v[96:99]
    s_add_u32 s51, s39, 105472
    buffer_load_dwordx4 v[164:167], v0, s[4:7], s51 offen offset:0 sc1
    v_mfma_f32_16x16x32_bf16 v[100:103], v[188:191], a[212:215], v[100:103]
    v_add_f32 v31, v31, v71
    v_add_f32 v24, v24, v72
    v_mfma_f32_16x16x32_bf16 v[104:107], v[188:191], a[216:219], v[104:107]
    v_add_f32 v25, v25, v73
    v_add_f32 v26, v26, v74
    v_mfma_f32_16x16x32_bf16 v[108:111], v[188:191], a[220:223], v[108:111]
    v_add_f32 v27, v27, v75
    s_waitcnt vmcnt(9)
    v_mfma_f32_16x16x32_bf16 v[96:99], v[128:131], a[224:227], v[96:99]
    buffer_load_dwordx4 v[168:171], v0, s[4:7], s51 offen offset:2048 sc1
    v_add_f32 v28, v28, v76
    v_mfma_f32_16x16x32_bf16 v[100:103], v[128:131], a[228:231], v[100:103]
    v_add_f32 v29, v29, v77
    v_add_f32 v30, v30, v78
    v_mfma_f32_16x16x32_bf16 v[104:107], v[128:131], a[232:235], v[104:107]
    v_add_f32 v31, v31, v79
    v_add_f32 v24, v24, v80
    v_mfma_f32_16x16x32_bf16 v[108:111], v[128:131], a[236:239], v[108:111]
    v_add_f32 v25, v25, v81
    s_waitcnt vmcnt(9)
    v_mfma_f32_16x16x32_bf16 v[112:115], v[132:135], a[64:67], 0
    s_add_u32 s51, s39, 109568
    s_cmp_eq_u32 s16, 3
    s_cselect_b32 s51, 268435456, s51
    buffer_load_dwordx4 v[172:175], v0, s[4:7], s51 offen offset:0 sc1
    ds_write_b32 v52, v96 offset:0
    v_mfma_f32_16x16x32_bf16 v[116:119], v[132:135], a[68:71], 0
    ds_write_b32 v53, v97 offset:256
    v_add_f32 v26, v26, v82
    v_mfma_f32_16x16x32_bf16 v[120:123], v[132:135], a[72:75], 0
    ds_write_b32 v54, v98 offset:512
    v_add_f32 v27, v27, v83
    v_mfma_f32_16x16x32_bf16 v[124:127], v[132:135], a[76:79], 0
    ds_write_b32 v55, v99 offset:768
    s_waitcnt vmcnt(9)
    v_mfma_f32_16x16x32_bf16 v[112:115], v[136:139], a[80:83], v[112:115]
    ds_write_b32 v52, v100 offset:1024
    v_add_f32 v28, v28, v84
    v_mfma_f32_16x16x32_bf16 v[116:119], v[136:139], a[84:87], v[116:119]
    ds_write_b32 v53, v101 offset:1280
    v_add_f32 v29, v29, v85
    v_mfma_f32_16x16x32_bf16 v[120:123], v[136:139], a[88:91], v[120:123]
    ds_write_b32 v54, v102 offset:1536
    v_add_f32 v30, v30, v86
    v_mfma_f32_16x16x32_bf16 v[124:127], v[136:139], a[92:95], v[124:127]
    ds_write_b32 v55, v103 offset:1792
    s_waitcnt vmcnt(8)
    v_mfma_f32_16x16x32_bf16 v[112:115], v[140:143], a[96:99], v[112:115]
    ds_write_b32 v52, v104 offset:2048
    v_add_f32 v31, v31, v87
    v_mfma_f32_16x16x32_bf16 v[116:119], v[140:143], a[100:103], v[116:119]
    ds_write_b32 v53, v105 offset:2304
    v_add_f32 v24, v24, v88
    v_mfma_f32_16x16x32_bf16 v[120:123], v[140:143], a[104:107], v[120:123]
    ds_write_b32 v54, v106 offset:2560
    v_add_f32 v25, v25, v89
    v_mfma_f32_16x16x32_bf16 v[124:127], v[140:143], a[108:111], v[124:127]
    ds_write_b32 v55, v107 offset:2816
    s_waitcnt vmcnt(7)
    v_mfma_f32_16x16x32_bf16 v[112:115], v[144:147], a[112:115], v[112:115]
    ds_write_b32 v52, v108 offset:3072
    v_add_f32 v26, v26, v90
    v_mfma_f32_16x16x32_bf16 v[116:119], v[144:147], a[116:119], v[116:119]
    ds_write_b32 v53, v109 offset:3328
    v_add_f32 v27, v27, v91
    v_mfma_f32_16x16x32_bf16 v[120:123], v[144:147], a[120:123], v[120:123]
    ds_write_b32 v54, v110 offset:3584
    v_add_f32 v28, v28, v92
    v_mfma_f32_16x16x32_bf16 v[124:127], v[144:147], a[124:127], v[124:127]
    ds_write_b32 v55, v111 offset:3840
    s_waitcnt vmcnt(6)
    v_mfma_f32_16x16x32_bf16 v[112:115], v[148:151], a[128:131], v[112:115]
    v_add_f32 v29, v29, v93
    v_add_f32 v30, v30, v94
    v_mfma_f32_16x16x32_bf16 v[116:119], v[148:151], a[132:135], v[116:119]
    v_add_f32 v31, v31, v95
    v_cvt_pk_bf16_f32 v40, v24, v25
    v_mfma_f32_16x16x32_bf16 v[120:123], v[148:151], a[136:139], v[120:123]
    v_cvt_pk_bf16_f32 v41, v26, v27
    v_cvt_pk_bf16_f32 v42, v28, v29
    v_mfma_f32_16x16x32_bf16 v[124:127], v[148:151], a[140:143], v[124:127]
    v_cvt_pk_bf16_f32 v43, v30, v31
    s_waitcnt vmcnt(5)
    v_mfma_f32_16x16x32_bf16 v[112:115], v[152:155], a[144:147], v[112:115]
    buffer_store_dwordx4 v[40:43], v19, s[8:11], s33 offen sc1
    v_mfma_f32_16x16x32_bf16 v[116:119], v[152:155], a[148:151], v[116:119]
    v_add_f32 v64, v24, v25
    v_mul_f32 v65, v24, v24
    v_mfma_f32_16x16x32_bf16 v[120:123], v[152:155], a[152:155], v[120:123]
    v_fmac_f32 v65, v25, v25
    v_add_f32 v64, v64, v26
    v_mfma_f32_16x16x32_bf16 v[124:127], v[152:155], a[156:159], v[124:127]
    v_fmac_f32 v65, v26, v26
    s_waitcnt vmcnt(5)
    v_mfma_f32_16x16x32_bf16 v[112:115], v[156:159], a[160:163], v[112:115]
    v_add_f32 v64, v64, v27
    v_fmac_f32 v65, v27, v27
    v_mfma_f32_16x16x32_bf16 v[116:119], v[156:159], a[164:167], v[116:119]
    v_add_f32 v64, v64, v28
    v_fmac_f32 v65, v28, v28
    v_mfma_f32_16x16x32_bf16 v[120:123], v[156:159], a[168:171], v[120:123]
    v_add_f32 v64, v64, v29
    v_fmac_f32 v65, v29, v29
    v_mfma_f32_16x16x32_bf16 v[124:127], v[156:159], a[172:175], v[124:127]
    v_add_f32 v64, v64, v30
    s_waitcnt vmcnt(4)
    v_mfma_f32_16x16x32_bf16 v[112:115], v[160:163], a[176:179], v[112:115]
    v_fmac_f32 v65, v30, v30
    s_waitcnt vmcnt(3)
    v_mfma_f32_16x16x32_bf16 v[112:115], v[164:167], a[192:195], v[112:115]
    v_add_f32 v64, v64, v31
    s_waitcnt vmcnt(2)
    v_mfma_f32_16x16x32_bf16 v[112:115], v[168:171], a[208:211], v[112:115]
    v_fmac_f32 v65, v31, v31
    s_waitcnt vmcnt(1)
    v_mfma_f32_16x16x32_bf16 v[112:115], v[172:175], a[224:227], v[112:115]
    v_permlane16_swap_b32 v64, v65
    v_add_f32 v64, v64, v65
    v_mfma_f32_16x16x32_bf16 v[116:119], v[160:163], a[180:183], v[116:119]
    s_nop 0
    v_add_f32_dpp v65, v64, v64 row_ror:8 row_mask:0xf bank_mask:0xf
    v_add_f32_dpp v64, v64, v64 row_ror:8 row_mask:0xf bank_mask:0xf
    v_mfma_f32_16x16x32_bf16 v[116:119], v[164:167], a[196:199], v[116:119]
    s_nop 0
    v_permlane32_swap_b32 v64, v65
    v_add_f32 v64, v64, v65
    v_mfma_f32_16x16x32_bf16 v[116:119], v[168:171], a[212:215], v[116:119]
    s_mov_b64 exec, 0x00ff00ff
    buffer_store_dword v64, v20, s[4:7], s34 offen offset:0 sc1
    s_mov_b64 exec, -1
    v_mfma_f32_16x16x32_bf16 v[116:119], v[172:175], a[228:231], v[116:119]
    ds_write_b32 v52, v112 offset:4096
    v_mfma_f32_16x16x32_bf16 v[120:123], v[160:163], a[184:187], v[120:123]
    ds_write_b32 v53, v113 offset:4352
    v_mfma_f32_16x16x32_bf16 v[120:123], v[164:167], a[200:203], v[120:123]
    ds_write_b32 v54, v114 offset:4608
    v_mfma_f32_16x16x32_bf16 v[120:123], v[168:171], a[216:219], v[120:123]
    ds_write_b32 v55, v115 offset:4864
    v_mfma_f32_16x16x32_bf16 v[120:123], v[172:175], a[232:235], v[120:123]
    ds_write_b32 v52, v116 offset:5120
    v_mfma_f32_16x16x32_bf16 v[124:127], v[160:163], a[188:191], v[124:127]
    ds_write_b32 v53, v117 offset:5376
    v_mfma_f32_16x16x32_bf16 v[124:127], v[164:167], a[204:207], v[124:127]
    ds_write_b32 v54, v118 offset:5632
    v_mfma_f32_16x16x32_bf16 v[124:127], v[168:171], a[220:223], v[124:127]
    ds_write_b32 v55, v119 offset:5888
    v_mfma_f32_16x16x32_bf16 v[124:127], v[172:175], a[236:239], v[124:127]
    ds_write_b32 v52, v120 offset:6144
    ds_write_b32 v53, v121 offset:6400
    ds_write_b32 v54, v122 offset:6656
    ds_write_b32 v55, v123 offset:6912
    s_nop 3
    ds_write_b32 v52, v124 offset:7168
    ds_write_b32 v53, v125 offset:7424
    ds_write_b32 v54, v126 offset:7680
    ds_write_b32 v55, v127 offset:7936
    s_waitcnt lgkmcnt(0)
    s_barrier
    ds_read_b128 v[128:131], v57 offset:0
    ds_read_b128 v[132:135], v58 offset:0
    ds_read_b128 v[136:139], v57 offset:8192
    ds_read_b128 v[140:143], v58 offset:8192
    ds_read_b128 v[144:147], v57 offset:16384
    ds_read_b128 v[148:151], v58 offset:16384
    ds_read_b128 v[152:155], v57 offset:24576
    ds_read_b128 v[156:159], v58 offset:24576
    s_add_u32 s45, s98, 2
    s_mov_b64 exec, 1
    v_mov_b32 v56, s45
    s_waitcnt vmcnt(0)
    buffer_store_dword v56, off, s[4:7], s35 offset:0 sc1
    s_mov_b64 exec, -1
    s_waitcnt lgkmcnt(6)
    v_pk_add_f32 v[32:33], v[32:33], v[128:129]
    v_pk_add_f32 v[34:35], v[34:35], v[130:131]
    v_pk_add_f32 v[36:37], v[36:37], v[132:133]
    v_pk_add_f32 v[38:39], v[38:39], v[134:135]
    s_waitcnt lgkmcnt(4)
    v_pk_add_f32 v[32:33], v[32:33], v[136:137]
    v_pk_add_f32 v[34:35], v[34:35], v[138:139]
    v_pk_add_f32 v[36:37], v[36:37], v[140:141]
    v_pk_add_f32 v[38:39], v[38:39], v[142:143]
    s_waitcnt lgkmcnt(2)
    v_pk_add_f32 v[32:33], v[32:33], v[144:145]
    v_pk_add_f32 v[34:35], v[34:35], v[146:147]
    v_pk_add_f32 v[36:37], v[36:37], v[148:149]
    v_pk_add_f32 v[38:39], v[38:39], v[150:151]
    s_waitcnt lgkmcnt(0)
    v_pk_add_f32 v[32:33], v[32:33], v[152:153]
    v_pk_add_f32 v[34:35], v[34:35], v[154:155]
    v_pk_add_f32 v[36:37], v[36:37], v[156:157]
    v_pk_add_f32 v[38:39], v[38:39], v[158:159]
    v_cvt_pk_bf16_f32 v44, v32, v33
    v_cvt_pk_bf16_f32 v45, v34, v35
    v_cvt_pk_bf16_f32 v46, v36, v37
    v_cvt_pk_bf16_f32 v47, v38, v39
    buffer_store_dwordx4 v[44:47], v19, s[8:11], s96 offen sc1
    v_pk_add_f32 v[128:129], v[32:33], v[34:35]
    v_pk_mul_f32 v[130:131], v[32:33], v[32:33]
    v_pk_add_f32 v[128:129], v[128:129], v[36:37]
    v_pk_fma_f32 v[130:131], v[34:35], v[34:35], v[130:131]
    v_pk_add_f32 v[128:129], v[128:129], v[38:39]
    v_pk_fma_f32 v[130:131], v[36:37], v[36:37], v[130:131]
    v_add_f32 v128, v128, v129
    v_pk_fma_f32 v[130:131], v[38:39], v[38:39], v[130:131]
    v_add_f32 v129, v130, v131
    s_nop 1
    v_permlane16_swap_b32 v128, v129
    v_add_f32 v128, v128, v129
    s_nop 1
    v_add_f32_dpp v129, v128, v128 row_ror:8 row_mask:0xf bank_mask:0xf
    v_add_f32_dpp v128, v128, v128 row_ror:8 row_mask:0xf bank_mask:0xf
    s_nop 1
    v_permlane32_swap_b32 v128, v129
    v_add_f32 v128, v128, v129
    s_mov_b64 exec, 0x00ff00ff
    buffer_store_dword v128, v20, s[4:7], s34 offen offset:2048 sc1
    s_mov_b64 exec, -1
    buffer_load_dword v22, v2, s[4:7], s26 offen sc1
    s_add_u32 s45, s98, 2
    s_mov_b64 exec, 1
    v_mov_b32 v56, s45
    s_waitcnt vmcnt(1)
    buffer_store_dword v56, off, s[4:7], s35 offset:128 sc1
    s_mov_b64 exec, -1
    s_barrier
    v_mov_b32 v55, v61
    v_mov_b32 v57, 0
    ds_write_b32 v2, v57
    s_add_u32 s27, s27, 524288
    s_add_u32 s28, s28, 65536
    ds_read_b64_tr_b16 v[96:97], v6 offset:0
    ds_read_b64_tr_b16 v[98:99], v6 offset:256
    ds_read_b64_tr_b16 v[100:101], v7 offset:0
    ds_read_b64_tr_b16 v[102:103], v7 offset:256
    ds_read_b64_tr_b16 v[104:105], v6 offset:512
    ds_read_b64_tr_b16 v[106:107], v6 offset:768
    ds_read_b64_tr_b16 v[108:109], v7 offset:512
    ds_read_b64_tr_b16 v[110:111], v7 offset:768
    s_add_u32 s45, s98, 2
    s_waitcnt vmcnt(1)
    v_cmp_ne_u32 vcc, s45, v22
    s_cmp_eq_u32 vcc_lo, 0
    s_cbranch_scc1 Lpolls_18_s
    s_add_u32 s45, s98, 2
    s_mov_b32 exec_hi, 0
    s_mov_b32 s50, 0
Lpoll_17_s:
    buffer_load_dword v56, v2, s[4:7], s26 offen sc1
    s_add_u32 s50, s50, 1
    s_cmp_gt_u32 s50, 0x40000
    s_cbranch_scc1 Labort
    s_waitcnt vmcnt(0)
    v_cmp_ne_u32 vcc, s45, v56
    s_cbranch_vccnz Lpoll_17_s
    s_mov_b64 exec, -1
Lpolls_18_s:
    s_add_u32 s51, s84, 0
    s_and_b32 s51, s51, 7
    s_lshl_b32 s51, s51, 12
    s_add_u32 s51, s51, s24
    buffer_load_dwordx4 v[128:131], v0, s[8:11], s51 offen offset:0 sc1
    buffer_load_dwordx4 v[132:135], v0, s[8:11], s51 offen offset:1024 sc1
    buffer_load_dwordx4 v[136:139], v0, s[8:11], s51 offen offset:2048 sc1
    buffer_load_dwordx4 v[140:143], v0, s[8:11], s51 offen offset:3072 sc1
    s_add_u32 s51, s84, 1
    s_and_b32 s51, s51, 7
    s_lshl_b32 s51, s51, 12
    s_add_u32 s51, s51, s24
    buffer_load_dwordx4 v[144:147], v0, s[8:11], s51 offen offset:0 sc1
    buffer_load_dwordx4 v[148:151], v0, s[8:11], s51 offen offset:1024 sc1
    ds_read_b64_tr_b16 v[112:113], v6 offset:2048
    ds_read_b64_tr_b16 v[114:115], v6 offset:2304
    ds_read_b64_tr_b16 v[116:117], v7 offset:2048
    ds_read_b64_tr_b16 v[118:119], v7 offset:2304
    s_waitcnt vmcnt(5) lgkmcnt(8)
    v_mfma_f32_32x32x16_bf16 v[64:79], v[96:99], v[128:131], 0
    ds_read_b64_tr_b16 v[96:97], v6 offset:2560
    ds_read_b64_tr_b16 v[98:99], v6 offset:2816
    buffer_load_dwordx4 v[152:155], v0, s[8:11], s51 offen offset:2048 sc1
    v_mfma_f32_32x32x16_bf16 v[80:95], v[100:103], v[128:131], 0
    ds_read_b64_tr_b16 v[100:101], v7 offset:2560
    ds_read_b64_tr_b16 v[102:103], v7 offset:2816
    ds_write_b128 v55, v[224:227] offset:32768
    s_waitcnt vmcnt(5) lgkmcnt(9)
    v_mfma_f32_32x32x16_bf16 v[64:79], v[104:107], v[132:135], v[64:79]
    ds_read_b64_tr_b16 v[104:105], v6 offset:4096
    ds_read_b64_tr_b16 v[106:107], v6 offset:4352
    buffer_load_dwordx4 v[156:159], v0, s[8:11], s51 offen offset:3072 sc1
    v_mfma_f32_32x32x16_bf16 v[80:95], v[108:111], v[132:135], v[80:95]
    ds_read_b64_tr_b16 v[108:109], v7 offset:4096
    ds_read_b64_tr_b16 v[110:111], v7 offset:4352
    ds_write_b128 v55, v[228:231] offset:33792
    s_waitcnt vmcnt(5) lgkmcnt(10)
    v_mfma_f32_32x32x16_bf16 v[64:79], v[112:115], v[136:139], v[64:79]
    ds_read_b64_tr_b16 v[112:113], v6 offset:4608
    ds_read_b64_tr_b16 v[114:115], v6 offset:4864
    s_add_u32 s51, s84, 2
    s_and_b32 s51, s51, 7
    s_lshl_b32 s51, s51, 12
    s_add_u32 s51, s51, s24
    buffer_load_dwordx4 v[160:163], v0, s[8:11], s51 offen offset:0 sc1
    v_mfma_f32_32x32x16_bf16 v[80:95], v[116:119], v[136:139], v[80:95]
    ds_read_b64_tr_b16 v[116:117], v7 offset:4608
    ds_read_b64_tr_b16 v[118:119], v7 offset:4864
    ds_write_b128 v55, v[232:235] offset:34816
    s_waitcnt vmcnt(5) lgkmcnt(11)
    v_mfma_f32_32x32x16_bf16 v[64:79], v[96:99], v[140:143], v[64:79]
    ds_read_b64_tr_b16 v[96:97], v6 offset:6144
    ds_read_b64_tr_b16 v[98:99], v6 offset:6400
    buffer_load_dwordx4 v[164:167], v0, s[8:11], s51 offen offset:1024 sc1
    buffer_load_dwordx4 v[168:171], v0, s[8:11], s51 offen offset:2048 sc1
    v_mfma_f32_32x32x16_bf16 v[80:95], v[100:103], v[140:143], v[80:95]
    ds_read_b64_tr_b16 v[100:101], v7 offset:6144
    ds_read_b64_tr_b16 v[102:103], v7 offset:6400
    ds_write_b128 v55, v[236:239] offset:35840
    s_waitcnt vmcnt(6) lgkmcnt(11)
    v_mfma_f32_32x32x16_bf16 v[64:79], v[104:107], v[144:147], v[64:79]
    ds_read_b64_tr_b16 v[104:105], v6 offset:6656
    ds_read_b64_tr_b16 v[106:107], v6 offset:6912
    buffer_load_dwordx4 v[172:175], v0, s[8:11], s51 offen offset:3072 sc1
    v_mfma_f32_32x32x16_bf16 v[80:95], v[108:111], v[144:147], v[80:95]
    ds_read_b64_tr_b16 v[108:109], v7 offset:6656
    ds_read_b64_tr_b16 v[110:111], v7 offset:6912
    ds_write_b128 v55, v[240:243] offset:49152
    s_waitcnt vmcnt(6) lgkmcnt(11)
    v_mfma_f32_32x32x16_bf16 v[64:79], v[112:115], v[148:151], v[64:79]
    ds_read_b64_tr_b16 v[112:113], v6 offset:8192
    ds_read_b64_tr_b16 v[114:115], v6 offset:8448
    s_add_u32 s51, s84, 3
    s_and_b32 s51, s51, 7
    s_lshl_b32 s51, s51, 12
    s_add_u32 s51, s51, s24
    buffer_load_dwordx4 v[176:179], v0, s[8:11], s51 offen offset:0 sc1
    v_mfma_f32_32x32x16_bf16 v[80:95], v[116:119], v[148:151], v[80:95]
    ds_read_b64_tr_b16 v[116:117], v7 offset:8192
    ds_read_b64_tr_b16 v[118:119], v7 offset:8448
    ds_write_b128 v55, v[244:247] offset:50176
    s_waitcnt vmcnt(6) lgkmcnt(11)
    v_mfma_f32_32x32x16_bf16 v[64:79], v[96:99], v[152:155], v[64:79]
    ds_read_b64_tr_b16 v[96:97], v6 offset:8704
    ds_read_b64_tr_b16 v[98:99], v6 offset:8960
    buffer_load_dwordx4 v[180:183], v0, s[8:11], s51 offen offset:1024 sc1
    buffer_load_dwordx4 v[184:187], v0, s[8:11], s51 offen offset:2048 sc1
    v_mfma_f32_32x32x16_bf16 v[80:95], v[100:103], v[152:155], v[80:95]
    ds_read_b64_tr_b16 v[100:101], v7 offset:8704
    ds_read_b64_tr_b16 v[102:103], v7 offset:8960
    ds_write_b128 v55, v[248:251] offset:51200
    s_waitcnt vmcnt(7) lgkmcnt(11)
    v_mfma_f32_32x32x16_bf16 v[64:79], v[104:107], v[156:159], v[64:79]
    ds_read_b64_tr_b16 v[104:105], v6 offset:10240
    ds_read_b64_tr_b16 v[106:107], v6 offset:10496
    buffer_load_dwordx4 v[188:191], v0, s[8:11], s51 offen offset:3072 sc1
    v_mfma_f32_32x32x16_bf16 v[80:95], v[108:111], v[156:159], v[80:95]
    ds_read_b64_tr_b16 v[108:109], v7 offset:10240
    ds_read_b64_tr_b16 v[110:111], v7 offset:10496
    ds_write_b128 v55, v[252:255] offset:52224
    s_waitcnt vmcnt(7) lgkmcnt(11)
    v_mfma_f32_32x32x16_bf16 v[64:79], v[112:115], v[160:163], v[64:79]
    ds_read_b64_tr_b16 v[112:113], v6 offset:10752
    ds_read_b64_tr_b16 v[114:115], v6 offset:11008
    s_add_u32 s51, s84, 4
    s_and_b32 s51, s51, 7
    s_lshl_b32 s51, s51, 12
    s_add_u32 s51, s51, s24
    buffer_load_dwordx4 v[192:195], v0, s[8:11], s51 offen offset:0 sc1
    v_mfma_f32_32x32x16_bf16 v[80:95], v[116:119], v[160:163], v[80:95]
    ds_read_b64_tr_b16 v[116:117], v7 offset:10752
    ds_read_b64_tr_b16 v[118:119], v7 offset:11008
    s_waitcnt vmcnt(7) lgkmcnt(10)
    v_mfma_f32_32x32x16_bf16 v[64:79], v[96:99], v[164:167], v[64:79]
    ds_read_b64_tr_b16 v[96:97], v6 offset:12288
    ds_read_b64_tr_b16 v[98:99], v6 offset:12544
    buffer_load_dwordx2 v[56:57], v3, s[4:7], s25 offen offset:0 sc1
    buffer_load_dwordx2 v[58:59], v3, s[4:7], s25 offen offset:256 sc1
    v_mfma_f32_32x32x16_bf16 v[80:95], v[100:103], v[164:167], v[80:95]
    ds_read_b64_tr_b16 v[100:101], v7 offset:12288
    ds_read_b64_tr_b16 v[102:103], v7 offset:12544
    s_waitcnt vmcnt(8) lgkmcnt(9)
    v_mfma_f32_32x32x16_bf16 v[64:79], v[104:107], v[168:171], v[64:79]
    ds_read_b64_tr_b16 v[104:105], v6 offset:12800
    ds_read_b64_tr_b16 v[106:107], v6 offset:13056
    buffer_load_dwordx2 v[60:61], v3, s[4:7], s25 offen offset:512 sc1
    v_mfma_f32_32x32x16_bf16 v[80:95], v[108:111], v[168:171], v[80:95]
    ds_read_b64_tr_b16 v[108:109], v7 offset:12800
    ds_read_b64_tr_b16 v[110:111], v7 offset:13056
    s_waitcnt vmcnt(8) lgkmcnt(8)
    v_mfma_f32_32x32x16_bf16 v[64:79], v[112:115], v[172:175], v[64:79]
    ds_read_b64_tr_b16 v[112:113], v6 offset:14336
    ds_read_b64_tr_b16 v[114:115], v6 offset:14592
    buffer_load_dwordx2 v[62:63], v3, s[4:7], s25 offen offset:768 sc1
    v_mfma_f32_32x32x16_bf16 v[80:95], v[116:119], v[172:175], v[80:95]
    ds_read_b64_tr_b16 v[116:117], v7 offset:14336
    ds_read_b64_tr_b16 v[118:119], v7 offset:14592
    s_waitcnt vmcnt(8) lgkmcnt(8)
    v_mfma_f32_32x32x16_bf16 v[64:79], v[96:99], v[176:179], v[64:79]
    ds_read_b64_tr_b16 v[96:97], v6 offset:14848
    ds_read_b64_tr_b16 v[98:99], v6 offset:15104
    buffer_load_dwordx4 v[196:199], v0, s[8:11], s51 offen offset:1024 sc1
    v_mfma_f32_32x32x16_bf16 v[80:95], v[100:103], v[176:179], v[80:95]
    ds_read_b64_tr_b16 v[100:101], v7 offset:14848
    ds_read_b64_tr_b16 v[102:103], v7 offset:15104
    s_waitcnt vmcnt(8) lgkmcnt(8)
    v_mfma_f32_32x32x16_bf16 v[64:79], v[104:107], v[180:183], v[64:79]
    ds_read_b64_tr_b16 v[104:105], v6 offset:16384
    ds_read_b64_tr_b16 v[106:107], v6 offset:16640
    buffer_load_dwordx4 v[200:203], v0, s[8:11], s51 offen offset:2048 sc1
    buffer_load_dwordx4 v[204:207], v0, s[8:11], s51 offen offset:3072 sc1
    v_mfma_f32_32x32x16_bf16 v[80:95], v[108:111], v[180:183], v[80:95]
    ds_read_b64_tr_b16 v[108:109], v7 offset:16384
    ds_read_b64_tr_b16 v[110:111], v7 offset:16640
    s_waitcnt vmcnt(9) lgkmcnt(8)
    v_mfma_f32_32x32x16_bf16 v[64:79], v[112:115], v[184:187], v[64:79]
    ds_read_b64_tr_b16 v[112:113], v6 offset:16896
    ds_read_b64_tr_b16 v[114:115], v6 offset:17152
    s_add_u32 s51, s84, 5
    s_and_b32 s51, s51, 7
    s_lshl_b32 s51, s51, 12
    s_add_u32 s51, s51, s24
    buffer_load_dwordx4 v[208:211], v0, s[8:11], s51 offen offset:0 sc1
    v_mfma_f32_32x32x16_bf16 v[80:95], v[116:119], v[184:187], v[80:95]
    ds_read_b64_tr_b16 v[116:117], v7 offset:16896
    ds_read_b64_tr_b16 v[118:119], v7 offset:17152
    s_waitcnt vmcnt(9) lgkmcnt(8)
    v_mfma_f32_32x32x16_bf16 v[64:79], v[96:99], v[188:191], v[64:79]
    ds_read_b64_tr_b16 v[96:97], v6 offset:18432
    ds_read_b64_tr_b16 v[98:99], v6 offset:18688
    buffer_load_dwordx4 v[212:215], v0, s[8:11], s51 offen offset:1024 sc1
    v_mfma_f32_32x32x16_bf16 v[80:95], v[100:103], v[188:191], v[80:95]
    ds_read_b64_tr_b16 v[100:101], v7 offset:18432
    ds_read_b64_tr_b16 v[102:103], v7 offset:18688
    s_waitcnt vmcnt(9) lgkmcnt(8)
    v_mfma_f32_32x32x16_bf16 v[64:79], v[104:107], v[192:195], v[64:79]
    ds_read_b64_tr_b16 v[104:105], v6 offset:18944
    ds_read_b64_tr_b16 v[106:107], v6 offset:19200
    buffer_load_dwordx4 v[216:219], v0, s[8:11], s51 offen offset:2048 sc1
    buffer_load_dwordx4 v[220:223], v0, s[8:11], s51 offen offset:3072 sc1
    v_mfma_f32_32x32x16_bf16 v[80:95], v[108:111], v[192:195], v[80:95]
    ds_read_b64_tr_b16 v[108:109], v7 offset:18944
    ds_read_b64_tr_b16 v[110:111], v7 offset:19200
    s_waitcnt vmcnt(6) lgkmcnt(8)
    v_mfma_f32_32x32x16_bf16 v[64:79], v[112:115], v[196:199], v[64:79]
    ds_read_b64_tr_b16 v[112:113], v6 offset:20480
    ds_read_b64_tr_b16 v[114:115], v6 offset:20736
    s_add_u32 s51, s84, 6
    s_and_b32 s51, s51, 7
    s_lshl_b32 s51, s51, 12
    s_add_u32 s51, s51, s24
    buffer_load_dwordx4 v[224:227], v0, s[8:11], s51 offen offset:0 sc1
    v_mfma_f32_32x32x16_bf16 v[80:95], v[116:119], v[196:199], v[80:95]
    ds_read_b64_tr_b16 v[116:117], v7 offset:20480
    ds_read_b64_tr_b16 v[118:119], v7 offset:20736
    s_waitcnt vmcnt(6) lgkmcnt(8)
    v_mfma_f32_32x32x16_bf16 v[64:79], v[96:99], v[200:203], v[64:79]
    ds_read_b64_tr_b16 v[96:97], v6 offset:20992
    ds_read_b64_tr_b16 v[98:99], v6 offset:21248
    buffer_load_dwordx4 v[228:231], v0, s[8:11], s51 offen offset:1024 sc1
    v_mfma_f32_32x32x16_bf16 v[80:95], v[100:103], v[200:203], v[80:95]
    ds_read_b64_tr_b16 v[100:101], v7 offset:20992
    ds_read_b64_tr_b16 v[102:103], v7 offset:21248
    s_waitcnt vmcnt(6) lgkmcnt(8)
    v_mfma_f32_32x32x16_bf16 v[64:79], v[104:107], v[204:207], v[64:79]
    ds_read_b64_tr_b16 v[104:105], v6 offset:22528
    ds_read_b64_tr_b16 v[106:107], v6 offset:22784
    buffer_load_dwordx4 v[232:235], v0, s[8:11], s51 offen offset:2048 sc1
    buffer_load_dwordx4 v[236:239], v0, s[8:11], s51 offen offset:3072 sc1
    v_mfma_f32_32x32x16_bf16 v[80:95], v[108:111], v[204:207], v[80:95]
    ds_read_b64_tr_b16 v[108:109], v7 offset:22528
    ds_read_b64_tr_b16 v[110:111], v7 offset:22784
    v_mov_b32 v42, 0
    v_mov_b32 v43, 0
    v_mov_b32 v46, 0
    v_mov_b32 v47, 0
    s_waitcnt vmcnt(7) lgkmcnt(8)
    v_mfma_f32_32x32x16_bf16 v[64:79], v[112:115], v[208:211], v[64:79]
    ds_read_b64_tr_b16 v[112:113], v6 offset:23040
    ds_read_b64_tr_b16 v[114:115], v6 offset:23296
    s_add_u32 s51, s84, 7
    s_and_b32 s51, s51, 7
    s_lshl_b32 s51, s51, 12
    s_add_u32 s51, s51, s24
    buffer_load_dwordx4 v[240:243], v0, s[8:11], s51 offen offset:0 sc1
    v_mfma_f32_32x32x16_bf16 v[80:95], v[116:119], v[208:211], v[80:95]
    ds_read_b64_tr_b16 v[116:117], v7 offset:23040
    ds_read_b64_tr_b16 v[118:119], v7 offset:23296
    v_accvgpr_read_b32 v50, a248
    v_cvt_pk_bf16_f32 v41, v50, 0
    v_lshlrev_b32 v51, 16, v41
    v_sub_f32 v51, v50, v51
    s_waitcnt vmcnt(7) lgkmcnt(8)
    v_mfma_f32_32x32x16_bf16 v[64:79], v[96:99], v[212:215], v[64:79]
    ds_read_b64_tr_b16 v[96:97], v6 offset:24576
    ds_read_b64_tr_b16 v[98:99], v6 offset:24832
    buffer_load_dwordx4 v[244:247], v0, s[8:11], s51 offen offset:1024 sc1
    v_cvt_pk_bf16_f32 v40, v50, v51
    v_mfma_f32_32x32x16_bf16 v[80:95], v[100:103], v[212:215], v[80:95]
    ds_read_b64_tr_b16 v[100:101], v7 offset:24576
    ds_read_b64_tr_b16 v[102:103], v7 offset:24832
    v_add_f32 v56, v56, v58
    v_add_f32 v57, v57, v59
    s_waitcnt vmcnt(7) lgkmcnt(8)
    v_mfma_f32_32x32x16_bf16 v[64:79], v[104:107], v[216:219], v[64:79]
    ds_read_b64_tr_b16 v[104:105], v6 offset:25088
    ds_read_b64_tr_b16 v[106:107], v6 offset:25344
    buffer_load_dwordx4 v[248:251], v0, s[8:11], s51 offen offset:2048 sc1
    v_add_f32 v60, v60, v62
    v_add_f32 v61, v61, v63
    v_mfma_f32_32x32x16_bf16 v[80:95], v[108:111], v[216:219], v[80:95]
    ds_read_b64_tr_b16 v[108:109], v7 offset:25088
    ds_read_b64_tr_b16 v[110:111], v7 offset:25344
    v_add_f32 v56, v56, v60
    v_add_f32 v57, v57, v61
    s_waitcnt vmcnt(7) lgkmcnt(8)
    v_mfma_f32_32x32x16_bf16 v[64:79], v[112:115], v[220:223], v[64:79]
    ds_read_b64_tr_b16 v[112:113], v6 offset:26624
    ds_read_b64_tr_b16 v[114:115], v6 offset:26880
    buffer_load_dwordx4 v[252:255], v0, s[8:11], s51 offen offset:3072 sc1
    v_permlane32_swap_b32 v56, v57
    v_add_f32 v56, v56, v57
    v_mfma_f32_32x32x16_bf16 v[80:95], v[116:119], v[220:223], v[80:95]
    ds_read_b64_tr_b16 v[116:117], v7 offset:26624
    ds_read_b64_tr_b16 v[118:119], v7 offset:26880
    v_mov_b32 v57, v56
    s_nop 1
    v_permlane32_swap_b32 v56, v57
    s_waitcnt vmcnt(7) lgkmcnt(8)
    v_mfma_f32_32x32x16_bf16 v[64:79], v[96:99], v[224:227], v[64:79]
    ds_read_b64_tr_b16 v[96:97], v6 offset:27136
    ds_read_b64_tr_b16 v[98:99], v6 offset:27392
    v_mul_f32 v22, 989855744, v56
    v_mul_f32 v57, 989855744, v57
    v_mfma_f32_32x32x16_bf16 v[80:95], v[100:103], v[224:227], v[80:95]
    ds_read_b64_tr_b16 v[100:101], v7 offset:27136
    ds_read_b64_tr_b16 v[102:103], v7 offset:27392
    v_fma_f32 v57, -v22, v22, v57
    v_max_f32 v57, 0, v57
    s_waitcnt vmcnt(6) lgkmcnt(8)
    v_mfma_f32_32x32x16_bf16 v[64:79], v[104:107], v[228:231], v[64:79]
    ds_read_b64_tr_b16 v[104:105], v6 offset:28672
    ds_read_b64_tr_b16 v[106:107], v6 offset:28928
    v_add_f32 v58, 925353388, v57
    v_rsq_f32 v23, v58
    v_mfma_f32_32x32x16_bf16 v[80:95], v[108:111], v[228:231], v[80:95]
    ds_read_b64_tr_b16 v[108:109], v7 offset:28672
    ds_read_b64_tr_b16 v[110:111], v7 offset:28928
    v_cndmask_b32 v48, 0, -v22, s[58:59]
    s_waitcnt vmcnt(5) lgkmcnt(8)
    v_mfma_f32_32x32x16_bf16 v[64:79], v[112:115], v[232:235], v[64:79]
    ds_read_b64_tr_b16 v[112:113], v6 offset:29184
    ds_read_b64_tr_b16 v[114:115], v6 offset:29440
    v_cvt_pk_bf16_f32 v44, v48, v48
    v_and_b32 v49, 0xffff0000, v44
    v_mfma_f32_32x32x16_bf16 v[80:95], v[116:119], v[232:235], v[80:95]
    ds_read_b64_tr_b16 v[116:117], v7 offset:29184
    ds_read_b64_tr_b16 v[118:119], v7 offset:29440
    v_sub_f32 v48, v48, v49
    v_cvt_pk_bf16_f32 v45, v48, 0
    s_waitcnt vmcnt(4) lgkmcnt(8)
    v_mfma_f32_32x32x16_bf16 v[64:79], v[96:99], v[236:239], v[64:79]
    ds_read_b64_tr_b16 v[96:97], v6 offset:30720
    ds_read_b64_tr_b16 v[98:99], v6 offset:30976
    v_mfma_f32_32x32x16_bf16 v[64:79], v[40:43], v[44:47], v[64:79]
    v_cndmask_b32 v48, -v22, 0, s[58:59]
    v_mfma_f32_32x32x16_bf16 v[80:95], v[100:103], v[236:239], v[80:95]
    ds_read_b64_tr_b16 v[100:101], v7 offset:30720
    ds_read_b64_tr_b16 v[102:103], v7 offset:30976
    v_cvt_pk_bf16_f32 v44, v48, v48
    v_and_b32 v49, 0xffff0000, v44
    s_waitcnt vmcnt(3) lgkmcnt(8)
    v_mfma_f32_32x32x16_bf16 v[64:79], v[104:107], v[240:243], v[64:79]
    ds_read_b64_tr_b16 v[104:105], v6 offset:31232
    ds_read_b64_tr_b16 v[106:107], v6 offset:31488
    v_sub_f32 v48, v48, v49
    v_cvt_pk_bf16_f32 v45, v48, 0
    v_mfma_f32_32x32x16_bf16 v[80:95], v[108:111], v[240:243], v[80:95]
    ds_read_b64_tr_b16 v[108:109], v7 offset:31232
    ds_read_b64_tr_b16 v[110:111], v7 offset:31488
    v_mfma_f32_32x32x16_bf16 v[80:95], v[40:43], v[44:47], v[80:95]
    v_mov_b32 v62, s98
    s_or_b32 s44, s2, s16
    s_cselect_b32 s44, 268435456, 0
    s_mov_b64 exec, 1
    buffer_store_dword v62, off, s[4:7], s44 sc1
    s_mov_b64 exec, -1
    s_waitcnt vmcnt(3) lgkmcnt(8)
    v_mfma_f32_32x32x16_bf16 v[64:79], v[112:115], v[244:247], v[64:79]
    v_mfma_f32_32x32x16_bf16 v[80:95], v[116:119], v[244:247], v[80:95]
    s_waitcnt vmcnt(2) lgkmcnt(4)
    v_mfma_f32_32x32x16_bf16 v[64:79], v[96:99], v[248:251], v[64:79]
    v_mfma_f32_32x32x16_bf16 v[80:95], v[100:103], v[248:251], v[80:95]
    s_waitcnt vmcnt(1) lgkmcnt(0)
    v_mfma_f32_32x32x16_bf16 v[64:79], v[104:107], v[252:255], v[64:79]
    v_mfma_f32_32x32x16_bf16 v[80:95], v[108:111], v[252:255], v[80:95]
    v_mul_f32 v60, 1069066811, v23
    s_lshl_b32 s46, s17, 9
    s_add_u32 s46, s46, s27
    s_lshl_b32 s48, s17, 6
    s_add_u32 s48, s48, s28
    s_mov_b32 s52, 0x00010001
    s_mov_b32 s53, 0x00010001
    v_lshrrev_b32 v116, 4, v0
    v_min_u32 v62, 240, v0
    v_lshlrev_b32 v62, 3, v62
    buffer_load_dword a253, v62, s[4:7], s29 offen sc1
    v_cvt_pk_bf16_f32 v40, v64, v65
    v_cvt_pk_bf16_f32 v41, v66, v67
    v_cvt_pk_bf16_f32 v42, v68, v69
    v_cvt_pk_bf16_f32 v43, v70, v71
    v_cvt_pk_bf16_f32 v44, v72, v73
    v_cvt_pk_bf16_f32 v45, v74, v75
    v_mfma_f32_32x32x16_bf16 v[96:111], a[240:243], v[40:43], 0
    v_cvt_pk_bf16_f32 v46, v76, v77
    v_cvt_pk_bf16_f32 v47, v78, v79
    v_mul_f32 v80, v80, v23
    v_mul_f32 v81, v81, v23
    v_mul_f32 v82, v82, v23
    v_mul_f32 v83, v83, v23
    v_mfma_f32_32x32x16_bf16 v[96:111], a[244:247], v[44:47], v[96:111]
    v_mul_f32 v84, v84, v23
    v_mul_f32 v85, v85, v23
    v_mul_f32 v86, v86, v23
    v_mul_f32 v87, v87, v23
    v_mul_f32 v88, v88, v23
    v_mul_f32 v89, v89, v23
    v_cvt_pk_bf16_f32 v48, v80, v81
    v_cvt_pk_bf16_f32 v49, v82, v83
    v_cvt_pk_bf16_f32 v50, v84, v85
    v_cvt_pk_bf16_f32 v51, v86, v87
    v_cvt_pk_bf16_f32 v52, v88, v89
    ds_write_b128 v10, v[48:51] offset:128
    v_pk_mul_f32 v[90:91], v[90:91], v[22:23] op_sel:[0,1]
    v_pk_mul_f32 v[92:93], v[92:93], v[22:23] op_sel:[0,1]
    v_pk_mul_f32 v[94:95], v[94:95], v[22:23] op_sel:[0,1]
    v_cvt_pk_bf16_f32 v53, v90, v91
    v_cvt_pk_bf16_f32 v54, v92, v93
    v_cvt_pk_bf16_f32 v55, v94, v95
    ds_write_b128 v10, v[52:55] offset:144
    v_max3_f32 v56, v96, v97, v98
    v_min3_f32 v58, v96, v97, v98
    v_max3_f32 v56, v56, v99, v100
    v_min3_f32 v58, v58, v99, v100
    v_max3_f32 v56, v56, v101, v102
    v_min3_f32 v58, v58, v101, v102
    v_max3_f32 v56, v56, v103, v104
    v_min3_f32 v58, v58, v103, v104
    v_max3_f32 v56, v56, v105, v106
    v_min3_f32 v58, v58, v105, v106
    v_max3_f32 v56, v56, v107, v108
    v_min3_f32 v58, v58, v107, v108
    v_max3_f32 v56, v56, v109, v110
    v_min3_f32 v58, v58, v109, v110
    v_max_f32 v56, v56, v111
    v_min_f32 v58, v58, v111
    v_mul_f32 v56, v56, v60
    v_mul_f32 v58, v58, v60
    v_pk_fma_f32 v[64:65], v[96:97], v[60:61], v[56:57] op_sel_hi:[1,0,0] neg_lo:[0,0,1] neg_hi:[0,0,1]
    v_pk_fma_f32 v[66:67], v[98:99], v[60:61], v[56:57] op_sel_hi:[1,0,0] neg_lo:[0,0,1] neg_hi:[0,0,1]
    v_pk_fma_f32 v[68:69], v[100:101], v[60:61], v[56:57] op_sel_hi:[1,0,0] neg_lo:[0,0,1] neg_hi:[0,0,1]
    v_pk_fma_f32 v[70:71], v[102:103], v[60:61], v[56:57] op_sel_hi:[1,0,0] neg_lo:[0,0,1] neg_hi:[0,0,1]
    v_pk_fma_f32 v[72:73], v[104:105], v[60:61], v[56:57] op_sel_hi:[1,0,0] neg_lo:[0,0,1] neg_hi:[0,0,1]
    v_pk_fma_f32 v[74:75], v[106:107], v[60:61], v[56:57] op_sel_hi:[1,0,0] neg_lo:[0,0,1] neg_hi:[0,0,1]
    v_pk_fma_f32 v[76:77], v[108:109], v[60:61], v[56:57] op_sel_hi:[1,0,0] neg_lo:[0,0,1] neg_hi:[0,0,1]
    v_pk_fma_f32 v[78:79], v[110:111], v[60:61], v[56:57] op_sel_hi:[1,0,0] neg_lo:[0,0,1] neg_hi:[0,0,1]
    v_pk_fma_f32 v[96:97], v[96:97], v[60:61], v[58:59] op_sel_hi:[1,0,0] neg_lo:[1,0,0] neg_hi:[1,0,0]
    v_pk_fma_f32 v[98:99], v[98:99], v[60:61], v[58:59] op_sel_hi:[1,0,0] neg_lo:[1,0,0] neg_hi:[1,0,0]
    v_pk_fma_f32 v[100:101], v[100:101], v[60:61], v[58:59] op_sel_hi:[1,0,0] neg_lo:[1,0,0] neg_hi:[1,0,0]
    v_pk_fma_f32 v[102:103], v[102:103], v[60:61], v[58:59] op_sel_hi:[1,0,0] neg_lo:[1,0,0] neg_hi:[1,0,0]
    v_pk_fma_f32 v[104:105], v[104:105], v[60:61], v[58:59] op_sel_hi:[1,0,0] neg_lo:[1,0,0] neg_hi:[1,0,0]
    v_pk_fma_f32 v[106:107], v[106:107], v[60:61], v[58:59] op_sel_hi:[1,0,0] neg_lo:[1,0,0] neg_hi:[1,0,0]
    v_pk_fma_f32 v[108:109], v[108:109], v[60:61], v[58:59] op_sel_hi:[1,0,0] neg_lo:[1,0,0] neg_hi:[1,0,0]
    v_pk_fma_f32 v[110:111], v[110:111], v[60:61], v[58:59] op_sel_hi:[1,0,0] neg_lo:[1,0,0] neg_hi:[1,0,0]
    v_exp_f32 v64, v64
    v_exp_f32 v65, v65
    v_exp_f32 v66, v66
    v_exp_f32 v67, v67
    v_exp_f32 v68, v68
    v_exp_f32 v69, v69
    v_exp_f32 v70, v70
    v_exp_f32 v71, v71
    v_exp_f32 v72, v72
    v_exp_f32 v73, v73
    v_exp_f32 v74, v74
    v_exp_f32 v75, v75
    v_exp_f32 v76, v76
    v_exp_f32 v77, v77
    v_exp_f32 v78, v78
    v_exp_f32 v79, v79
    v_exp_f32 v96, v96
    v_exp_f32 v97, v97
    v_pk_add_f32 v[56:57], v[64:65], v[66:67]
    v_pk_add_f32 v[56:57], v[56:57], v[68:69]
    v_pk_add_f32 v[56:57], v[56:57], v[70:71]
    v_pk_add_f32 v[56:57], v[56:57], v[72:73]
    v_pk_add_f32 v[56:57], v[56:57], v[74:75]
    v_pk_add_f32 v[56:57], v[56:57], v[76:77]
    v_pk_add_f32 v[56:57], v[56:57], v[78:79]
    v_add_f32 v56, v56, v57
    v_rcp_f32 v56, v56
    v_exp_f32 v98, v98
    v_exp_f32 v99, v99
    v_pk_mul_f32 v[64:65], v[64:65], v[56:57] op_sel_hi:[1,0]
    v_pk_mul_f32 v[66:67], v[66:67], v[56:57] op_sel_hi:[1,0]
    v_pk_mul_f32 v[68:69], v[68:69], v[56:57] op_sel_hi:[1,0]
    v_pk_mul_f32 v[70:71], v[70:71], v[56:57] op_sel_hi:[1,0]
    v_pk_mul_f32 v[72:73], v[72:73], v[56:57] op_sel_hi:[1,0]
    v_pk_mul_f32 v[74:75], v[74:75], v[56:57] op_sel_hi:[1,0]
    v_pk_mul_f32 v[76:77], v[76:77], v[56:57] op_sel_hi:[1,0]
    v_pk_mul_f32 v[78:79], v[78:79], v[56:57] op_sel_hi:[1,0]
    v_cvt_pk_bf16_f32 v80, v64, v65
    v_cvt_pk_bf16_f32 v81, v66, v67
    v_cvt_pk_bf16_f32 v82, v68, v69
    v_cvt_pk_bf16_f32 v83, v70, v71
    v_cvt_pk_bf16_f32 v84, v72, v73
    v_cvt_pk_bf16_f32 v85, v74, v75
    v_cvt_pk_bf16_f32 v86, v76, v77
    v_cvt_pk_bf16_f32 v87, v78, v79
    ds_write_b128 v9, v[80:83]
    ds_write_b128 v9, v[84:87] offset:16
    v_exp_f32 v100, v100
    v_exp_f32 v101, v101
    v_exp_f32 v102, v102
    v_exp_f32 v103, v103
    v_exp_f32 v104, v104
    v_exp_f32 v105, v105
    v_exp_f32 v106, v106
    v_exp_f32 v107, v107
    v_exp_f32 v108, v108
    v_exp_f32 v109, v109
    v_exp_f32 v110, v110
    v_exp_f32 v111, v111
    v_pk_add_f32 v[58:59], v[96:97], v[98:99]
    v_pk_add_f32 v[58:59], v[58:59], v[100:101]
    v_pk_add_f32 v[58:59], v[58:59], v[102:103]
    v_pk_add_f32 v[58:59], v[58:59], v[104:105]
    v_pk_add_f32 v[58:59], v[58:59], v[106:107]
    v_pk_add_f32 v[58:59], v[58:59], v[108:109]
    v_pk_add_f32 v[58:59], v[58:59], v[110:111]
    v_add_f32 v58, v58, v59
    v_rcp_f32 v58, v58
    s_nop 0
    v_pk_mul_f32 v[96:97], v[96:97], v[58:59] op_sel_hi:[1,0]
    v_pk_mul_f32 v[98:99], v[98:99], v[58:59] op_sel_hi:[1,0]
    v_pk_mul_f32 v[100:101], v[100:101], v[58:59] op_sel_hi:[1,0]
    v_pk_mul_f32 v[102:103], v[102:103], v[58:59] op_sel_hi:[1,0]
    v_cvt_pk_bf16_f32 v88, v96, v97
    v_cvt_pk_bf16_f32 v89, v98, v99
    v_cvt_pk_bf16_f32 v90, v100, v101
    v_cvt_pk_bf16_f32 v91, v102, v103
    ds_write_b128 v9, v[88:91] offset:32
    v_pk_mul_f32 v[104:105], v[104:105], v[58:59] op_sel_hi:[1,0]
    v_pk_mul_f32 v[106:107], v[106:107], v[58:59] op_sel_hi:[1,0]
    v_pk_mul_f32 v[108:109], v[108:109], v[58:59] op_sel_hi:[1,0]
    v_pk_mul_f32 v[110:111], v[110:111], v[58:59] op_sel_hi:[1,0]
    v_cvt_pk_bf16_f32 v92, v104, v105
    v_cvt_pk_bf16_f32 v93, v106, v107
    v_cvt_pk_bf16_f32 v94, v108, v109
    v_cvt_pk_bf16_f32 v95, v110, v111
    ds_write_b128 v9, v[92:95] offset:48
    v_mov_b32 v56, 0x3f803f80
    v_mov_b32 v57, 0x3f803f80
    v_mov_b32 v58, 0x3f803f80
    v_mov_b32 v59, 0x3f803f80
    s_waitcnt lgkmcnt(0)
    s_barrier
    ds_read_b64_tr_b16 v[64:65], v11 offset:0
    ds_read_b64_tr_b16 v[80:81], v12 offset:0
    ds_read_b64_tr_b16 v[66:67], v11 offset:3584
    ds_read_b64_tr_b16 v[82:83], v12 offset:3584
    ds_read_b64_tr_b16 v[68:69], v11 offset:7168
    ds_read_b64_tr_b16 v[84:85], v12 offset:7168
    ds_read_b64_tr_b16 v[70:71], v11 offset:10752
    ds_read_b64_tr_b16 v[86:87], v12 offset:10752
    ds_read_b64_tr_b16 v[72:73], v11 offset:14336
    ds_read_b64_tr_b16 v[88:89], v12 offset:14336
    ds_read_b64_tr_b16 v[74:75], v11 offset:17920
    ds_read_b64_tr_b16 v[90:91], v12 offset:17920
    ds_read_b64_tr_b16 v[76:77], v11 offset:21504
    ds_read_b64_tr_b16 v[92:93], v12 offset:21504
    ds_read_b64_tr_b16 v[78:79], v11 offset:25088
    ds_read_b64_tr_b16 v[94:95], v12 offset:25088
    s_waitcnt lgkmcnt(12)
    v_mfma_f32_16x16x32_bf16 v[60:63], v[64:67], v[80:83], 0
    v_mfma_f32_16x16x32_bf16 v[40:43], v[64:67], v[56:59], 0
    s_waitcnt lgkmcnt(8)
    v_mfma_f32_16x16x32_bf16 v[60:63], v[68:71], v[84:87], v[60:63]
    v_mfma_f32_16x16x32_bf16 v[40:43], v[68:71], v[56:59], v[40:43]
    s_waitcnt lgkmcnt(4)
    v_mfma_f32_16x16x32_bf16 v[60:63], v[72:75], v[88:91], v[60:63]
    v_mfma_f32_16x16x32_bf16 v[40:43], v[72:75], v[56:59], v[40:43]
    s_waitcnt lgkmcnt(0)
    v_mfma_f32_16x16x32_bf16 v[60:63], v[76:79], v[92:95], v[60:63]
    v_mfma_f32_16x16x32_bf16 v[40:43], v[76:79], v[56:59], v[40:43]
    ds_read_b64_tr_b16 v[96:97], v6 offset:32768
    ds_read_b64_tr_b16 v[98:99], v6 offset:33024
    ds_read_b64_tr_b16 v[100:101], v6 offset:33280
    ds_read_b64_tr_b16 v[102:103], v6 offset:33536
    ds_read_b64_tr_b16 v[104:105], v6 offset:34816
    ds_read_b64_tr_b16 v[106:107], v6 offset:35072
    s_nop 0
    v_cvt_pk_bf16_f32 v48, v60, v61
    v_cvt_pk_bf16_f32 v49, v62, v63
    v_cvt_pk_bf16_f32 v50, v60, v61
    v_cvt_pk_bf16_f32 v51, v62, v63
    s_nop 0
    v_permlane16_swap_b32 v48, v50
    v_permlane16_swap_b32 v49, v51
    s_mov_b32 exec_lo, 0xffff
    s_mov_b32 exec_hi, 0xffff
    buffer_store_dwordx4 v[48:51], v16, s[4:7], s46 offen sc1
    s_mov_b64 exec, s[52:53]
    buffer_store_dwordx4 v[40:43], v116, s[4:7], s48 offen sc1
    s_mov_b64 exec, -1
    ds_read_b64_tr_b16 v[108:109], v6 offset:35328
    ds_read_b64_tr_b16 v[110:111], v6 offset:35584
    ds_read_b64_tr_b16 v[64:65], v6 offset:36864
    ds_read_b64_tr_b16 v[66:67], v6 offset:37120
    ds_read_b64_tr_b16 v[68:69], v6 offset:37376
    ds_read_b64_tr_b16 v[70:71], v6 offset:37632
    s_add_u32 m0, s23, 98304
    s_add_u32 s49, s42, 131072
    buffer_load_dwordx4 v0, s[4:7], s49 offen offset:0 sc1 lds
    s_waitcnt lgkmcnt(8)
    v_mfma_f32_32x32x16_bf16 v[112:127], v[96:99], v[128:131], 0
    ds_read_b64_tr_b16 v[96:97], v6 offset:38912
    ds_read_b64_tr_b16 v[98:99], v6 offset:39168
    v_mfma_f32_32x32x16_bf16 v[112:127], v[100:103], v[132:135], v[112:127]
    ds_read_b64_tr_b16 v[100:101], v6 offset:39424
    ds_read_b64_tr_b16 v[102:103], v6 offset:39680
    buffer_load_dwordx4 v0, s[4:7], s49 offen offset:1024 sc1 lds
    s_waitcnt lgkmcnt(8)
    v_mfma_f32_32x32x16_bf16 v[112:127], v[104:107], v[136:139], v[112:127]
    ds_read_b64_tr_b16 v[104:105], v6 offset:40960
    ds_read_b64_tr_b16 v[106:107], v6 offset:41216
    v_bfe_u32 v58, v0, 4, 4
    v_bfe_u32 v56, v0, 8, 1
    v_mfma_f32_32x32x16_bf16 v[112:127], v[108:111], v[140:143], v[112:127]
    ds_read_b64_tr_b16 v[108:109], v6 offset:41472
    ds_read_b64_tr_b16 v[110:111], v6 offset:41728
    v_lshlrev_b32 v56, 3, v56
    v_xor_b32 v58, v58, v56
    buffer_load_dwordx4 v0, s[4:7], s49 offen offset:2048 sc1 lds
    s_waitcnt lgkmcnt(8)
    v_mfma_f32_32x32x16_bf16 v[112:127], v[64:67], v[144:147], v[112:127]
    ds_read_b64_tr_b16 v[64:65], v6 offset:43008
    ds_read_b64_tr_b16 v[66:67], v6 offset:43264
    v_mov_b32 v56, 0x3f80
    v_mov_b32 v57, 0x3f800000
    v_mfma_f32_32x32x16_bf16 v[112:127], v[68:71], v[148:151], v[112:127]
    ds_read_b64_tr_b16 v[68:69], v6 offset:43520
    ds_read_b64_tr_b16 v[70:71], v6 offset:43776
    v_cmp_eq_u32 vcc, 0, v58
    v_cmp_eq_u32 s[60:61], 1, v58
    s_nop 0
    v_cndmask_b32 v76, 0, v56, vcc
    v_cndmask_b32 v76, v76, v57, s[60:61]
    buffer_load_dwordx4 v0, s[4:7], s49 offen offset:3072 sc1 lds
    s_waitcnt lgkmcnt(8)
    v_mfma_f32_32x32x16_bf16 v[112:127], v[96:99], v[152:155], v[112:127]
    ds_read_b64_tr_b16 v[96:97], v6 offset:45056
    ds_read_b64_tr_b16 v[98:99], v6 offset:45312
    v_cmp_eq_u32 vcc, 2, v58
    v_cmp_eq_u32 s[60:61], 3, v58
    s_nop 0
    v_cndmask_b32 v77, 0, v56, vcc
    v_cndmask_b32 v77, v77, v57, s[60:61]
    v_mfma_f32_32x32x16_bf16 v[112:127], v[100:103], v[156:159], v[112:127]
    ds_read_b64_tr_b16 v[100:101], v6 offset:45568
    ds_read_b64_tr_b16 v[102:103], v6 offset:45824
    s_add_u32 m0, s23, 114688
    s_add_u32 s49, s42, 147456
    buffer_load_dwordx4 v0, s[4:7], s49 offen offset:0 sc1 lds
    s_waitcnt lgkmcnt(8)
    v_mfma_f32_32x32x16_bf16 v[112:127], v[104:107], v[160:163], v[112:127]
    ds_read_b64_tr_b16 v[104:105], v6 offset:47104
    ds_read_b64_tr_b16 v[106:107], v6 offset:47360
    v_cmp_eq_u32 vcc, 4, v58
    v_cmp_eq_u32 s[60:61], 5, v58
    s_nop 0
    v_cndmask_b32 v78, 0, v56, vcc
    v_cndmask_b32 v78, v78, v57, s[60:61]
    v_mfma_f32_32x32x16_bf16 v[112:127], v[108:111], v[164:167], v[112:127]
    ds_read_b64_tr_b16 v[108:109], v6 offset:47616
    ds_read_b64_tr_b16 v[110:111], v6 offset:47872
    v_cmp_eq_u32 vcc, 6, v58
    v_cmp_eq_u32 s[60:61], 7, v58
    s_nop 0
    v_cndmask_b32 v79, 0, v56, vcc
    v_cndmask_b32 v79, v79, v57, s[60:61]
    buffer_load_dwordx4 v0, s[4:7], s49 offen offset:1024 sc1 lds
    s_waitcnt lgkmcnt(8)
    v_mfma_f32_32x32x16_bf16 v[112:127], v[64:67], v[168:171], v[112:127]
    ds_read_b64_tr_b16 v[64:65], v6 offset:49152
    ds_read_b64_tr_b16 v[66:67], v6 offset:49408
    v_mfma_f32_32x32x16_bf16 v[112:127], v[68:71], v[172:175], v[112:127]
    ds_read_b64_tr_b16 v[68:69], v6 offset:49664
    ds_read_b64_tr_b16 v[70:71], v6 offset:49920
    buffer_load_dwordx4 v0, s[4:7], s49 offen offset:2048 sc1 lds
    s_waitcnt lgkmcnt(8)
    v_mfma_f32_32x32x16_bf16 v[112:127], v[96:99], v[176:179], v[112:127]
    ds_read_b64_tr_b16 v[96:97], v6 offset:51200
    ds_read_b64_tr_b16 v[98:99], v6 offset:51456
    v_mfma_f32_32x32x16_bf16 v[112:127], v[100:103], v[180:183], v[112:127]
    ds_read_b64_tr_b16 v[100:101], v6 offset:51712
    ds_read_b64_tr_b16 v[102:103], v6 offset:51968
    buffer_load_dwordx4 v0, s[4:7], s49 offen offset:3072 sc1 lds
    s_waitcnt lgkmcnt(8)
    v_mfma_f32_32x32x16_bf16 v[112:127], v[104:107], v[184:187], v[112:127]
    ds_read_b64_tr_b16 v[104:105], v6 offset:53248
    ds_read_b64_tr_b16 v[106:107], v6 offset:53504
    v_mov_b32 v42, 0
    v_mov_b32 v43, 0
    v_mfma_f32_32x32x16_bf16 v[112:127], v[108:111], v[188:191], v[112:127]
    ds_read_b64_tr_b16 v[108:109], v6 offset:53760
    ds_read_b64_tr_b16 v[110:111], v6 offset:54016
    v_mov_b32 v46, 0
    v_mov_b32 v47, 0
    v_cndmask_b32 v48, 0, -v22, s[58:59]
    s_waitcnt lgkmcnt(8)
    v_mfma_f32_32x32x16_bf16 v[112:127], v[64:67], v[192:195], v[112:127]
    ds_read_b64_tr_b16 v[64:65], v6 offset:55296
    ds_read_b64_tr_b16 v[66:67], v6 offset:55552
    v_cvt_pk_bf16_f32 v44, v48, v48
    v_and_b32 v49, 0xffff0000, v44
    v_mfma_f32_32x32x16_bf16 v[112:127], v[68:71], v[196:199], v[112:127]
    ds_read_b64_tr_b16 v[68:69], v6 offset:55808
    ds_read_b64_tr_b16 v[70:71], v6 offset:56064
    v_sub_f32 v48, v48, v49
    v_cvt_pk_bf16_f32 v45, v48, 0
    s_waitcnt lgkmcnt(8)
    v_mfma_f32_32x32x16_bf16 v[112:127], v[96:99], v[200:203], v[112:127]
    ds_read_b64_tr_b16 v[96:97], v6 offset:57344
    ds_read_b64_tr_b16 v[98:99], v6 offset:57600
    buffer_load_dwordx4 v[160:163], v15, s[4:7], s28 offen sc1
    v_mfma_f32_32x32x16_bf16 v[112:127], v[100:103], v[204:207], v[112:127]
    ds_read_b64_tr_b16 v[100:101], v6 offset:57856
    ds_read_b64_tr_b16 v[102:103], v6 offset:58112
    v_accvgpr_read_b32 v50, a249
    v_cvt_pk_bf16_f32 v41, v50, 0
    v_lshlrev_b32 v51, 16, v41
    s_add_u32 s51, s27, 0
    buffer_load_dwordx4 v[128:131], v0, s[4:7], s51 offen offset:0 sc1
    s_waitcnt lgkmcnt(8)
    v_mfma_f32_32x32x16_bf16 v[112:127], v[104:107], v[208:211], v[112:127]
    ds_read_b64_tr_b16 v[104:105], v6 offset:59392
    ds_read_b64_tr_b16 v[106:107], v6 offset:59648
    v_sub_f32 v51, v50, v51
    v_cvt_pk_bf16_f32 v40, v50, v51
    buffer_load_dwordx4 v[132:135], v0, s[4:7], s51 offen offset:1024 sc1
    v_mfma_f32_32x32x16_bf16 v[112:127], v[108:111], v[212:215], v[112:127]
    ds_read_b64_tr_b16 v[108:109], v6 offset:59904
    ds_read_b64_tr_b16 v[110:111], v6 offset:60160
    v_mfma_f32_32x32x16_bf16 v[112:127], v[40:43], v[44:47], v[112:127]
    buffer_load_dwordx4 v[136:139], v0, s[4:7], s51 offen offset:2048 sc1
    s_waitcnt lgkmcnt(8)
    v_mfma_f32_32x32x16_bf16 v[112:127], v[64:67], v[216:219], v[112:127]
    ds_read_b64_tr_b16 v[64:65], v6 offset:61440
    ds_read_b64_tr_b16 v[66:67], v6 offset:61696
    buffer_load_dwordx4 v[140:143], v0, s[4:7], s51 offen offset:3072 sc1
    v_mfma_f32_32x32x16_bf16 v[112:127], v[68:71], v[220:223], v[112:127]
    ds_read_b64_tr_b16 v[68:69], v6 offset:61952
    ds_read_b64_tr_b16 v[70:71], v6 offset:62208
    s_add_u32 s51, s27, 4096
    buffer_load_dwordx4 v[144:147], v0, s[4:7], s51 offen offset:0 sc1
    s_waitcnt lgkmcnt(8)
    v_mfma_f32_32x32x16_bf16 v[112:127], v[96:99], v[224:227], v[112:127]
    ds_read_b64_tr_b16 v[96:97], v6 offset:63488
    ds_read_b64_tr_b16 v[98:99], v6 offset:63744
    buffer_load_dwordx4 v[148:151], v0, s[4:7], s51 offen offset:1024 sc1
    v_mfma_f32_32x32x16_bf16 v[112:127], v[100:103], v[228:231], v[112:127]
    ds_read_b64_tr_b16 v[100:101], v6 offset:64000
    ds_read_b64_tr_b16 v[102:103], v6 offset:64256
    buffer_load_dwordx4 v[152:155], v0, s[4:7], s51 offen offset:2048 sc1
    s_waitcnt lgkmcnt(8)
    v_mfma_f32_32x32x16_bf16 v[112:127], v[104:107], v[232:235], v[112:127]
    buffer_load_dwordx4 v[156:159], v0, s[4:7], s51 offen offset:3072 sc1
    v_mfma_f32_32x32x16_bf16 v[112:127], v[108:111], v[236:239], v[112:127]
    s_waitcnt lgkmcnt(4)
    v_mfma_f32_32x32x16_bf16 v[112:127], v[64:67], v[240:243], v[112:127]
    v_mfma_f32_32x32x16_bf16 v[112:127], v[68:71], v[244:247], v[112:127]
    s_waitcnt lgkmcnt(0)
    v_mfma_f32_32x32x16_bf16 v[112:127], v[96:99], v[248:251], v[112:127]
    v_mfma_f32_32x32x16_bf16 v[112:127], v[100:103], v[252:255], v[112:127]
    v_mul_f32 v60, 1069066811, v23
    s_lshl_b32 s44, s16, 5
    s_add_u32 s44, s44, 163584
    v_lshrrev_b32 v72, 8, v0
    v_lshl_add_u32 v72, v72, 3, s44
    s_nop 6
    v_cvt_pk_bf16_f32 v64, v112, v113
    v_cvt_pk_bf16_f32 v65, v114, v115
    v_cvt_pk_bf16_f32 v66, v116, v117
    v_cvt_pk_bf16_f32 v67, v118, v119
    v_cvt_pk_bf16_f32 v68, v120, v121
    v_cvt_pk_bf16_f32 v69, v122, v123
    v_mfma_f32_32x32x16_bf16 v[96:111], a[240:243], v[64:67], 0
    v_cvt_pk_bf16_f32 v70, v124, v125
    v_cvt_pk_bf16_f32 v71, v126, v127
    s_nop 1
    v_mfma_f32_32x32x16_bf16 v[96:111], a[244:247], v[68:71], v[96:111]
    s_nop 11
    v_max3_f32 v56, v96, v97, v98
    v_min3_f32 v58, v96, v97, v98
    v_max3_f32 v56, v56, v99, v100
    v_min3_f32 v58, v58, v99, v100
    v_max3_f32 v56, v56, v101, v102
    v_min3_f32 v58, v58, v101, v102
    v_max3_f32 v56, v56, v103, v104
    v_min3_f32 v58, v58, v103, v104
    v_max3_f32 v56, v56, v105, v106
    v_min3_f32 v58, v58, v105, v106
    v_max3_f32 v56, v56, v107, v108
    v_min3_f32 v58, v58, v107, v108
    v_max3_f32 v56, v56, v109, v110
    v_min3_f32 v58, v58, v109, v110
    v_max_f32 v56, v56, v111
    v_min_f32 v58, v58, v111
    v_mul_f32 v56, v56, v60
    v_mul_f32 v58, v58, v60
    v_pk_fma_f32 v[112:113], v[96:97], v[60:61], v[56:57] op_sel_hi:[1,0,0] neg_lo:[0,0,1] neg_hi:[0,0,1]
    v_pk_fma_f32 v[114:115], v[98:99], v[60:61], v[56:57] op_sel_hi:[1,0,0] neg_lo:[0,0,1] neg_hi:[0,0,1]
    v_pk_fma_f32 v[116:117], v[100:101], v[60:61], v[56:57] op_sel_hi:[1,0,0] neg_lo:[0,0,1] neg_hi:[0,0,1]
    v_pk_fma_f32 v[118:119], v[102:103], v[60:61], v[56:57] op_sel_hi:[1,0,0] neg_lo:[0,0,1] neg_hi:[0,0,1]
    v_pk_fma_f32 v[120:121], v[104:105], v[60:61], v[56:57] op_sel_hi:[1,0,0] neg_lo:[0,0,1] neg_hi:[0,0,1]
    v_pk_fma_f32 v[122:123], v[106:107], v[60:61], v[56:57] op_sel_hi:[1,0,0] neg_lo:[0,0,1] neg_hi:[0,0,1]
    v_pk_fma_f32 v[124:125], v[108:109], v[60:61], v[56:57] op_sel_hi:[1,0,0] neg_lo:[0,0,1] neg_hi:[0,0,1]
    v_pk_fma_f32 v[126:127], v[110:111], v[60:61], v[56:57] op_sel_hi:[1,0,0] neg_lo:[0,0,1] neg_hi:[0,0,1]
    v_pk_fma_f32 v[96:97], v[96:97], v[60:61], v[58:59] op_sel_hi:[1,0,0] neg_lo:[1,0,0] neg_hi:[1,0,0]
    v_pk_fma_f32 v[98:99], v[98:99], v[60:61], v[58:59] op_sel_hi:[1,0,0] neg_lo:[1,0,0] neg_hi:[1,0,0]
    v_pk_fma_f32 v[100:101], v[100:101], v[60:61], v[58:59] op_sel_hi:[1,0,0] neg_lo:[1,0,0] neg_hi:[1,0,0]
    v_pk_fma_f32 v[102:103], v[102:103], v[60:61], v[58:59] op_sel_hi:[1,0,0] neg_lo:[1,0,0] neg_hi:[1,0,0]
    v_pk_fma_f32 v[104:105], v[104:105], v[60:61], v[58:59] op_sel_hi:[1,0,0] neg_lo:[1,0,0] neg_hi:[1,0,0]
    v_pk_fma_f32 v[106:107], v[106:107], v[60:61], v[58:59] op_sel_hi:[1,0,0] neg_lo:[1,0,0] neg_hi:[1,0,0]
    v_pk_fma_f32 v[108:109], v[108:109], v[60:61], v[58:59] op_sel_hi:[1,0,0] neg_lo:[1,0,0] neg_hi:[1,0,0]
    v_pk_fma_f32 v[110:111], v[110:111], v[60:61], v[58:59] op_sel_hi:[1,0,0] neg_lo:[1,0,0] neg_hi:[1,0,0]
    s_waitcnt vmcnt(8)
    v_cmp_eq_u32 vcc, -1, v160
    s_cbranch_vccz Lzb_20_s
    buffer_load_dwordx4 v[160:163], v15, s[4:7], s28 offen sc1
    s_add_u32 s51, s27, 0
    buffer_load_dwordx4 v[128:131], v0, s[4:7], s51 offen offset:0 sc1
    buffer_load_dwordx4 v[132:135], v0, s[4:7], s51 offen offset:1024 sc1
    buffer_load_dwordx4 v[136:139], v0, s[4:7], s51 offen offset:2048 sc1
    buffer_load_dwordx4 v[140:143], v0, s[4:7], s51 offen offset:3072 sc1
    s_add_u32 s51, s27, 4096
    buffer_load_dwordx4 v[144:147], v0, s[4:7], s51 offen offset:0 sc1
    buffer_load_dwordx4 v[148:151], v0, s[4:7], s51 offen offset:1024 sc1
    buffer_load_dwordx4 v[152:155], v0, s[4:7], s51 offen offset:2048 sc1
    buffer_load_dwordx4 v[156:159], v0, s[4:7], s51 offen offset:3072 sc1
Lzb_20_s:
    v_exp_f32 v112, v112
    v_exp_f32 v113, v113
    v_exp_f32 v114, v114
    v_exp_f32 v115, v115
    v_exp_f32 v116, v116
    v_exp_f32 v117, v117
    v_exp_f32 v118, v118
    v_exp_f32 v119, v119
    v_exp_f32 v120, v120
    v_exp_f32 v121, v121
    v_exp_f32 v122, v122
    v_exp_f32 v123, v123
    v_exp_f32 v124, v124
    v_exp_f32 v125, v125
    v_exp_f32 v126, v126
    v_exp_f32 v127, v127
    v_exp_f32 v96, v96
    v_exp_f32 v97, v97
    v_pk_add_f32 v[56:57], v[112:113], v[114:115]
    v_pk_add_f32 v[56:57], v[56:57], v[116:117]
    v_pk_add_f32 v[56:57], v[56:57], v[118:119]
    v_pk_add_f32 v[56:57], v[56:57], v[120:121]
    v_pk_add_f32 v[56:57], v[56:57], v[122:123]
    v_pk_add_f32 v[56:57], v[56:57], v[124:125]
    v_pk_add_f32 v[56:57], v[56:57], v[126:127]
    v_add_f32 v22, v56, v57
    v_exp_f32 v98, v98
    v_exp_f32 v99, v99
    v_cvt_pk_bf16_f32 v40, v112, v113
    v_cvt_pk_bf16_f32 v41, v114, v115
    v_cvt_pk_bf16_f32 v42, v116, v117
    v_cvt_pk_bf16_f32 v43, v118, v119
    v_cvt_pk_bf16_f32 v44, v120, v121
    v_cvt_pk_bf16_f32 v45, v122, v123
    v_cvt_pk_bf16_f32 v46, v124, v125
    v_cvt_pk_bf16_f32 v47, v126, v127
    v_exp_f32 v100, v100
    v_exp_f32 v101, v101
    v_exp_f32 v102, v102
    v_exp_f32 v103, v103
    v_exp_f32 v104, v104
    v_exp_f32 v105, v105
    v_exp_f32 v106, v106
    v_exp_f32 v107, v107
    v_exp_f32 v108, v108
    v_exp_f32 v109, v109
    v_exp_f32 v110, v110
    v_exp_f32 v111, v111
    v_pk_add_f32 v[58:59], v[96:97], v[98:99]
    v_pk_add_f32 v[58:59], v[58:59], v[100:101]
    v_pk_add_f32 v[58:59], v[58:59], v[102:103]
    v_pk_add_f32 v[58:59], v[58:59], v[104:105]
    v_pk_add_f32 v[58:59], v[58:59], v[106:107]
    v_pk_add_f32 v[58:59], v[58:59], v[108:109]
    v_pk_add_f32 v[58:59], v[58:59], v[110:111]
    v_add_f32 v58, v58, v59
    v_rcp_f32 v58, v58
    s_nop 0
    v_mul_f32 v58, v58, v22
    v_pk_mul_f32 v[96:97], v[96:97], v[58:59] op_sel_hi:[1,0]
    v_pk_mul_f32 v[98:99], v[98:99], v[58:59] op_sel_hi:[1,0]
    v_pk_mul_f32 v[100:101], v[100:101], v[58:59] op_sel_hi:[1,0]
    v_pk_mul_f32 v[102:103], v[102:103], v[58:59] op_sel_hi:[1,0]
    v_cvt_pk_bf16_f32 v48, v96, v97
    v_cvt_pk_bf16_f32 v49, v98, v99
    v_cvt_pk_bf16_f32 v50, v100, v101
    v_cvt_pk_bf16_f32 v51, v102, v103
    v_pk_mul_f32 v[104:105], v[104:105], v[58:59] op_sel_hi:[1,0]
    v_pk_mul_f32 v[106:107], v[106:107], v[58:59] op_sel_hi:[1,0]
    v_pk_mul_f32 v[108:109], v[108:109], v[58:59] op_sel_hi:[1,0]
    v_pk_mul_f32 v[110:111], v[110:111], v[58:59] op_sel_hi:[1,0]
    v_cvt_pk_bf16_f32 v52, v104, v105
    v_cvt_pk_bf16_f32 v53, v106, v107
    v_cvt_pk_bf16_f32 v54, v108, v109
    v_cvt_pk_bf16_f32 v55, v110, v111
    s_mov_b32 s50, 0
Lkvretry_21_s:
    s_waitcnt vmcnt(6)
    v_mfma_f32_16x16x32_bf16 v[64:67], v[76:79], v[128:131], 0
    v_add_f32_dpp v80, v160, v160 row_ror:8 row_mask:0xf bank_mask:0xf
    v_add_f32_dpp v81, v161, v161 row_ror:8 row_mask:0xf bank_mask:0xf
    v_mfma_f32_16x16x32_bf16 v[64:67], v[76:79], v[132:135], v[64:67]
    v_add_f32_dpp v82, v162, v162 row_ror:8 row_mask:0xf bank_mask:0xf
    v_add_f32_dpp v83, v163, v163 row_ror:8 row_mask:0xf bank_mask:0xf
    s_waitcnt vmcnt(4)
    v_mfma_f32_16x16x32_bf16 v[64:67], v[76:79], v[136:139], v[64:67]
    v_add_f32_dpp v80, v80, v80 row_ror:4 row_mask:0xf bank_mask:0xf
    v_add_f32_dpp v81, v81, v81 row_ror:4 row_mask:0xf bank_mask:0xf
    v_mfma_f32_16x16x32_bf16 v[64:67], v[76:79], v[140:143], v[64:67]
    v_add_f32_dpp v82, v82, v82 row_ror:4 row_mask:0xf bank_mask:0xf
    v_add_f32_dpp v83, v83, v83 row_ror:4 row_mask:0xf bank_mask:0xf
    s_waitcnt vmcnt(2)
    v_mfma_f32_16x16x32_bf16 v[64:67], v[76:79], v[144:147], v[64:67]
    v_add_f32_dpp v80, v80, v80 row_ror:2 row_mask:0xf bank_mask:0xf
    v_add_f32_dpp v81, v81, v81 row_ror:2 row_mask:0xf bank_mask:0xf
    v_mfma_f32_16x16x32_bf16 v[64:67], v[76:79], v[148:151], v[64:67]
    v_add_f32_dpp v82, v82, v82 row_ror:2 row_mask:0xf bank_mask:0xf
    v_add_f32_dpp v83, v83, v83 row_ror:2 row_mask:0xf bank_mask:0xf
    s_waitcnt vmcnt(0)
    v_mfma_f32_16x16x32_bf16 v[64:67], v[76:79], v[152:155], v[64:67]
    v_add_f32_dpp v80, v80, v80 row_ror:1 row_mask:0xf bank_mask:0xf
    v_add_f32_dpp v81, v81, v81 row_ror:1 row_mask:0xf bank_mask:0xf
    v_mfma_f32_16x16x32_bf16 v[64:67], v[76:79], v[156:159], v[64:67]
    v_add_f32_dpp v82, v82, v82 row_ror:1 row_mask:0xf bank_mask:0xf
    v_add_f32_dpp v83, v83, v83 row_ror:1 row_mask:0xf bank_mask:0xf
    v_cvt_pk_bf16_f32 v90, v80, v81
    v_cvt_pk_bf16_f32 v91, v82, v83
    v_add_f32 v84, v80, v81
    v_add_f32 v85, v82, v83
    v_add_f32 v84, v84, v85
    s_nop 0
    v_cmp_u_f32 vcc, v84, v64
    s_cbranch_vccnz Lkvslow_23_s
Lkvgo_22_s:
    v_cvt_pk_bf16_f32 v88, v64, v65
    v_cvt_pk_bf16_f32 v89, v66, v67
    ds_write_b64 v13, v[88:89]
    ds_write_b64 v72, v[90:91]
    s_waitcnt lgkmcnt(0)
    s_barrier
    ds_read_b128 v[128:131], v4 offset:3840
    ds_read_b128 v[132:135], v4 offset:3856
    ds_read_b128 v[136:139], v4 offset:3872
    ds_read_b128 v[140:143], v4 offset:3888
    ds_read_b128 v[64:67], v14 offset:0
    ds_read_b128 v[68:71], v14 offset:16
    ds_read_b128 v[72:75], v14 offset:32
    ds_read_b128 v[76:79], v14 offset:48
    v_mul_f32 v56, 897988541, v22
    v_mov_b32 v57, 0
    s_waitcnt lgkmcnt(6)
    v_dot2_f32_bf16 v56, v40, v128, v56
    v_dot2_f32_bf16 v57, v41, v129, v57
    v_dot2_f32_bf16 v56, v42, v130, v56
    v_dot2_f32_bf16 v57, v43, v131, v57
    v_dot2_f32_bf16 v56, v44, v132, v56
    v_dot2_f32_bf16 v57, v45, v133, v57
    v_dot2_f32_bf16 v56, v46, v134, v56
    v_dot2_f32_bf16 v57, v47, v135, v57
    s_waitcnt lgkmcnt(4)
    v_dot2_f32_bf16 v56, v48, v136, v56
    v_dot2_f32_bf16 v57, v49, v137, v57
    v_dot2_f32_bf16 v56, v50, v138, v56
    v_dot2_f32_bf16 v57, v51, v139, v57
    v_dot2_f32_bf16 v56, v52, v140, v56
    v_dot2_f32_bf16 v57, v53, v141, v57
    v_dot2_f32_bf16 v56, v54, v142, v56
    v_dot2_f32_bf16 v57, v55, v143, v57
    s_waitcnt lgkmcnt(0)
    v_mfma_f32_32x32x16_bf16 v[80:95], v[64:67], v[40:43], 0
    v_mfma_f32_32x32x16_bf16 v[80:95], v[68:71], v[44:47], v[80:95]
    v_mfma_f32_32x32x16_bf16 v[80:95], v[72:75], v[48:51], v[80:95]
    v_mfma_f32_32x32x16_bf16 v[80:95], v[76:79], v[52:55], v[80:95]
    v_add_f32 v56, v56, v57
    v_rcp_f32 v56, v56
    s_nop 9
    v_pk_mul_f32 v[80:81], v[80:81], v[56:57] op_sel_hi:[1,0]
    v_pk_mul_f32 v[82:83], v[82:83], v[56:57] op_sel_hi:[1,0]
    v_pk_mul_f32 v[84:85], v[84:85], v[56:57] op_sel_hi:[1,0]
    v_pk_mul_f32 v[86:87], v[86:87], v[56:57] op_sel_hi:[1,0]
    v_cvt_pk_bf16_f32 v64, v80, v81
    v_cvt_pk_bf16_f32 v65, v82, v83
    v_cvt_pk_bf16_f32 v66, v84, v85
    v_cvt_pk_bf16_f32 v67, v86, v87
    buffer_store_dwordx4 v[64:67], v5, s[4:7], s29 offen offset:0 sc1
    v_pk_mul_f32 v[88:89], v[88:89], v[56:57] op_sel_hi:[1,0]
    v_pk_mul_f32 v[90:91], v[90:91], v[56:57] op_sel_hi:[1,0]
    v_pk_mul_f32 v[92:93], v[92:93], v[56:57] op_sel_hi:[1,0]
    v_pk_mul_f32 v[94:95], v[94:95], v[56:57] op_sel_hi:[1,0]
    v_cvt_pk_bf16_f32 v68, v88, v89
    v_cvt_pk_bf16_f32 v69, v90, v91
    v_cvt_pk_bf16_f32 v70, v92, v93
    v_cvt_pk_bf16_f32 v71, v94, v95
    buffer_store_dwordx4 v[68:71], v5, s[4:7], s29 offen offset:256 sc1
    v_bfe_u32 v59, v0, 7, 3
    v_lshlrev_b32 v59, 4, v59
    s_lshl_b32 s47, s19, 7
    s_add_u32 s45, s98, 2
    s_mov_b64 exec, 1
    v_mov_b32 v56, s45
    s_waitcnt vmcnt(0)
    buffer_store_dword v56, off, s[4:7], s30 offset:0 sc1
    s_mov_b64 exec, -1
    s_add_u32 s45, s98, 2
    s_mov_b32 exec_hi, 0
    s_mov_b32 s50, 0
Lpoll_26_s:
    buffer_load_dword v56, v21, s[4:7], s32 offen sc1
    s_add_u32 s50, s50, 1
    s_cmp_gt_u32 s50, 0x40000
    s_cbranch_scc1 Labort
    s_waitcnt vmcnt(0)
    v_cmp_ne_u32 vcc, s45, v56
    s_cbranch_vccnz Lpoll_26_s
    s_mov_b64 exec, -1
    s_add_u32 s51, s31, 0
    buffer_load_dwordx4 v[128:131], v0, s[4:7], s51 offen offset:0 sc1
    buffer_load_dwordx4 v[132:135], v0, s[4:7], s51 offen offset:2048 sc1
    s_add_u32 s51, s31, 4096
    buffer_load_dwordx4 v[136:139], v0, s[4:7], s51 offen offset:0 sc1
    buffer_load_dwordx4 v[140:143], v0, s[4:7], s51 offen offset:2048 sc1
    s_add_u32 s51, s31, 1024
    buffer_load_dwordx4 v[144:147], v0, s[4:7], s51 offen offset:0 sc1
    buffer_load_dwordx4 v[148:151], v0, s[4:7], s51 offen offset:2048 sc1
    s_add_u32 s51, s31, 5120
    buffer_load_dwordx4 v[152:155], v0, s[4:7], s51 offen offset:0 sc1
    s_barrier
    s_waitcnt vmcnt(6)
    v_mfma_f32_16x16x32_bf16 v[64:67], a[0:3], v[128:131], 0
    buffer_load_dwordx4 v[156:159], v0, s[4:7], s51 offen offset:2048 sc1
    v_mfma_f32_16x16x32_bf16 v[68:71], a[4:7], v[128:131], 0
    v_mfma_f32_16x16x32_bf16 v[72:75], a[8:11], v[128:131], 0
    v_mfma_f32_16x16x32_bf16 v[76:79], a[12:15], v[128:131], 0
    s_waitcnt vmcnt(6)
    v_mfma_f32_16x16x32_bf16 v[64:67], a[16:19], v[132:135], v[64:67]
    s_add_u32 s51, s31, 32768
    buffer_load_dwordx4 v[160:163], v0, s[4:7], s51 offen offset:0 sc1
    v_mfma_f32_16x16x32_bf16 v[68:71], a[20:23], v[132:135], v[68:71]
    v_mfma_f32_16x16x32_bf16 v[72:75], a[24:27], v[132:135], v[72:75]
    v_mfma_f32_16x16x32_bf16 v[76:79], a[28:31], v[132:135], v[76:79]
    s_waitcnt vmcnt(6)
    v_mfma_f32_16x16x32_bf16 v[64:67], a[32:35], v[136:139], v[64:67]
    buffer_load_dwordx4 v[164:167], v0, s[4:7], s51 offen offset:2048 sc1
    v_mfma_f32_16x16x32_bf16 v[68:71], a[36:39], v[136:139], v[68:71]
    v_mfma_f32_16x16x32_bf16 v[72:75], a[40:43], v[136:139], v[72:75]
    v_mfma_f32_16x16x32_bf16 v[76:79], a[44:47], v[136:139], v[76:79]
    s_waitcnt vmcnt(6)
    v_mfma_f32_16x16x32_bf16 v[64:67], a[48:51], v[140:143], v[64:67]
    s_add_u32 s51, s31, 36864
    buffer_load_dwordx4 v[168:171], v0, s[4:7], s51 offen offset:0 sc1
    v_mfma_f32_16x16x32_bf16 v[68:71], a[52:55], v[140:143], v[68:71]
    v_mfma_f32_16x16x32_bf16 v[72:75], a[56:59], v[140:143], v[72:75]
    v_mfma_f32_16x16x32_bf16 v[76:79], a[60:63], v[140:143], v[76:79]
    s_waitcnt vmcnt(6)
    v_mfma_f32_16x16x32_bf16 v[80:83], a[0:3], v[144:147], 0
    buffer_load_dwordx4 v[172:175], v0, s[4:7], s51 offen offset:2048 sc1
    v_mfma_f32_16x16x32_bf16 v[84:87], a[4:7], v[144:147], 0
    v_mfma_f32_16x16x32_bf16 v[88:91], a[8:11], v[144:147], 0
    v_mfma_f32_16x16x32_bf16 v[92:95], a[12:15], v[144:147], 0
    ds_write_b128 v17, v[64:67] offset:0
    s_waitcnt vmcnt(6)
    v_mfma_f32_16x16x32_bf16 v[80:83], a[16:19], v[148:151], v[80:83]
    s_add_u32 s51, s31, 33792
    buffer_load_dwordx4 v[176:179], v0, s[4:7], s51 offen offset:0 sc1
    v_mfma_f32_16x16x32_bf16 v[84:87], a[20:23], v[148:151], v[84:87]
    v_mfma_f32_16x16x32_bf16 v[88:91], a[24:27], v[148:151], v[88:91]
    v_mfma_f32_16x16x32_bf16 v[92:95], a[28:31], v[148:151], v[92:95]
    ds_write_b128 v17, v[68:71] offset:1024
    s_waitcnt vmcnt(6)
    v_mfma_f32_16x16x32_bf16 v[80:83], a[32:35], v[152:155], v[80:83]
    buffer_load_dwordx4 v[180:183], v0, s[4:7], s51 offen offset:2048 sc1
    v_mfma_f32_16x16x32_bf16 v[84:87], a[36:39], v[152:155], v[84:87]
    v_mfma_f32_16x16x32_bf16 v[88:91], a[40:43], v[152:155], v[88:91]
    v_mfma_f32_16x16x32_bf16 v[92:95], a[44:47], v[152:155], v[92:95]
    ds_write_b128 v17, v[72:75] offset:2048
    s_waitcnt vmcnt(6)
    v_mfma_f32_16x16x32_bf16 v[80:83], a[48:51], v[156:159], v[80:83]
    s_add_u32 s51, s31, 37888
    buffer_load_dwordx4 v[184:187], v0, s[4:7], s51 offen offset:0 sc1
    v_mfma_f32_16x16x32_bf16 v[84:87], a[52:55], v[156:159], v[84:87]
    v_mfma_f32_16x16x32_bf16 v[88:91], a[56:59], v[156:159], v[88:91]
    v_mfma_f32_16x16x32_bf16 v[92:95], a[60:63], v[156:159], v[92:95]
    ds_write_b128 v17, v[76:79] offset:3072
    s_waitcnt vmcnt(6)
    v_mfma_f32_16x16x32_bf16 v[96:99], a[0:3], v[160:163], 0
    buffer_load_dwordx4 v[188:191], v0, s[4:7], s51 offen offset:2048 sc1
    v_mfma_f32_16x16x32_bf16 v[100:103], a[4:7], v[160:163], 0
    v_mfma_f32_16x16x32_bf16 v[104:107], a[8:11], v[160:163], 0
    v_mfma_f32_16x16x32_bf16 v[108:111], a[12:15], v[160:163], 0
    ds_write_b128 v17, v[80:83] offset:4096
    s_waitcnt vmcnt(6)
    v_mfma_f32_16x16x32_bf16 v[96:99], a[16:19], v[164:167], v[96:99]
    s_add_u32 m0, s23, 32768
    s_add_u32 s49, s43, 0
    buffer_load_dwordx4 v0, s[4:7], s49 offen offset:0 sc1 lds
    buffer_load_dwordx4 v0, s[4:7], s49 offen offset:1024 sc1 lds
    v_mfma_f32_16x16x32_bf16 v[100:103], a[20:23], v[164:167], v[100:103]
    v_mfma_f32_16x16x32_bf16 v[104:107], a[24:27], v[164:167], v[104:107]
    v_mfma_f32_16x16x32_bf16 v[108:111], a[28:31], v[164:167], v[108:111]
    ds_write_b128 v17, v[84:87] offset:5120
    buffer_load_dwordx4 v[60:63], v59, s[12:15], s47 offen
    s_waitcnt vmcnt(8)
    v_mfma_f32_16x16x32_bf16 v[96:99], a[32:35], v[168:171], v[96:99]
    v_mfma_f32_16x16x32_bf16 v[100:103], a[36:39], v[168:171], v[100:103]
    v_mfma_f32_16x16x32_bf16 v[104:107], a[40:43], v[168:171], v[104:107]
    v_mfma_f32_16x16x32_bf16 v[108:111], a[44:47], v[168:171], v[108:111]
    ds_write_b128 v17, v[88:91] offset:6144
    s_waitcnt vmcnt(7)
    v_mfma_f32_16x16x32_bf16 v[96:99], a[48:51], v[172:175], v[96:99]
    buffer_load_dwordx4 v0, s[4:7], s49 offen offset:2048 sc1 lds
    v_mfma_f32_16x16x32_bf16 v[100:103], a[52:55], v[172:175], v[100:103]
    v_mfma_f32_16x16x32_bf16 v[104:107], a[56:59], v[172:175], v[104:107]
    v_mfma_f32_16x16x32_bf16 v[108:111], a[60:63], v[172:175], v[108:111]
    ds_write_b128 v17, v[92:95] offset:7168
    s_waitcnt vmcnt(7)
    v_mfma_f32_16x16x32_bf16 v[112:115], a[0:3], v[176:179], 0
    buffer_load_dwordx4 v0, s[4:7], s49 offen offset:3072 sc1 lds
    v_mfma_f32_16x16x32_bf16 v[116:119], a[4:7], v[176:179], 0
    v_mfma_f32_16x16x32_bf16 v[120:123], a[8:11], v[176:179], 0
    v_mfma_f32_16x16x32_bf16 v[124:127], a[12:15], v[176:179], 0
    s_waitcnt vmcnt(7)
    v_mfma_f32_16x16x32_bf16 v[112:115], a[16:19], v[180:183], v[112:115]
    s_add_u32 m0, s23, 49152
    s_add_u32 s49, s43, 16384
    buffer_load_dwordx4 v0, s[4:7], s49 offen offset:0 sc1 lds
    v_mfma_f32_16x16x32_bf16 v[116:119], a[20:23], v[180:183], v[116:119]
    v_mfma_f32_16x16x32_bf16 v[120:123], a[24:27], v[180:183], v[120:123]
    v_mfma_f32_16x16x32_bf16 v[124:127], a[28:31], v[180:183], v[124:127]
    s_waitcnt lgkmcnt(0)
    s_barrier
    ds_read_b128 v[64:67], v18 offset:0
    ds_read_b128 v[68:71], v18 offset:256
    ds_read_b128 v[72:75], v18 offset:8192
    ds_read_b128 v[76:79], v18 offset:8448
    ds_read_b128 v[80:83], v18 offset:16384
    ds_read_b128 v[84:87], v18 offset:16640
    ds_read_b128 v[88:91], v18 offset:24576
    ds_read_b128 v[92:95], v18 offset:24832
    s_waitcnt vmcnt(7)
    v_mfma_f32_16x16x32_bf16 v[112:115], a[32:35], v[184:187], v[112:115]
    buffer_load_dwordx4 v0, s[4:7], s49 offen offset:1024 sc1 lds
    v_mfma_f32_16x16x32_bf16 v[116:119], a[36:39], v[184:187], v[116:119]
    v_mfma_f32_16x16x32_bf16 v[120:123], a[40:43], v[184:187], v[120:123]
    v_mfma_f32_16x16x32_bf16 v[124:127], a[44:47], v[184:187], v[124:127]
    s_waitcnt vmcnt(7)
    v_mfma_f32_16x16x32_bf16 v[112:115], a[48:51], v[188:191], v[112:115]
    buffer_load_dwordx4 v0, s[4:7], s49 offen offset:2048 sc1 lds
    v_mfma_f32_16x16x32_bf16 v[116:119], a[52:55], v[188:191], v[116:119]
    v_mfma_f32_16x16x32_bf16 v[120:123], a[56:59], v[188:191], v[120:123]
    v_mfma_f32_16x16x32_bf16 v[124:127], a[60:63], v[188:191], v[124:127]
    s_waitcnt lgkmcnt(0)
    s_barrier
    ds_write_b128 v17, v[96:99] offset:0
    v_pk_add_f32 v[24:25], v[24:25], v[64:65]
    v_pk_add_f32 v[26:27], v[26:27], v[66:67]
    v_pk_add_f32 v[28:29], v[28:29], v[68:69]
    v_pk_add_f32 v[30:31], v[30:31], v[70:71]
    v_pk_add_f32 v[24:25], v[24:25], v[72:73]
    v_pk_add_f32 v[26:27], v[26:27], v[74:75]
    v_pk_add_f32 v[28:29], v[28:29], v[76:77]
    v_pk_add_f32 v[30:31], v[30:31], v[78:79]
    buffer_load_dwordx4 v0, s[4:7], s49 offen offset:3072 sc1 lds
    ds_write_b128 v17, v[100:103] offset:1024
    v_pk_add_f32 v[24:25], v[24:25], v[80:81]
    v_pk_add_f32 v[26:27], v[26:27], v[82:83]
    v_pk_add_f32 v[28:29], v[28:29], v[84:85]
    v_pk_add_f32 v[30:31], v[30:31], v[86:87]
    v_pk_add_f32 v[24:25], v[24:25], v[88:89]
    v_pk_add_f32 v[26:27], v[26:27], v[90:91]
    v_pk_add_f32 v[28:29], v[28:29], v[92:93]
    v_pk_add_f32 v[30:31], v[30:31], v[94:95]
    ds_write_b128 v17, v[104:107] offset:2048
    v_cvt_pk_bf16_f32 v40, v24, v25
    v_cvt_pk_bf16_f32 v41, v26, v27
    v_cvt_pk_bf16_f32 v42, v28, v29
    v_cvt_pk_bf16_f32 v43, v30, v31
    buffer_store_dwordx4 v[40:43], v19, s[8:11], s33 offen sc1
    v_pk_add_f32 v[64:65], v[24:25], v[26:27]
    ds_write_b128 v17, v[108:111] offset:3072
    v_pk_mul_f32 v[66:67], v[24:25], v[24:25]
    v_pk_add_f32 v[64:65], v[64:65], v[28:29]
    v_pk_fma_f32 v[66:67], v[26:27], v[26:27], v[66:67]
    v_pk_add_f32 v[64:65], v[64:65], v[30:31]
    v_pk_fma_f32 v[66:67], v[28:29], v[28:29], v[66:67]
    v_add_f32 v64, v64, v65
    v_pk_fma_f32 v[66:67], v[30:31], v[30:31], v[66:67]
    v_add_f32 v65, v66, v67
    ds_write_b128 v17, v[112:115] offset:4096
    s_nop 0
    v_permlane16_swap_b32 v64, v65
    v_add_f32 v64, v64, v65
    s_nop 1
    v_add_f32_dpp v65, v64, v64 row_ror:8 row_mask:0xf bank_mask:0xf
    v_add_f32_dpp v64, v64, v64 row_ror:8 row_mask:0xf bank_mask:0xf
    s_nop 1
    v_permlane32_swap_b32 v64, v65
    v_add_f32 v64, v64, v65
    s_mov_b64 exec, 0x00ff00ff
    buffer_store_dword v64, v20, s[4:7], s34 offen offset:0 sc1
    s_mov_b64 exec, -1
    ds_write_b128 v17, v[116:119] offset:5120
    ds_write_b128 v17, v[120:123] offset:6144
    ds_write_b128 v17, v[124:127] offset:7168
    s_waitcnt vmcnt(2)
    s_waitcnt lgkmcnt(0)
    s_barrier
    ds_read_b128 v[192:195], v18 offset:0
    ds_read_b128 v[196:199], v18 offset:256
    ds_read_b128 v[200:203], v18 offset:8192
    ds_read_b128 v[204:207], v18 offset:8448
    ds_read_b128 v[208:211], v18 offset:16384
    ds_read_b128 v[212:215], v18 offset:16640
    ds_read_b128 v[216:219], v18 offset:24576
    ds_read_b128 v[220:223], v18 offset:24832
    s_add_u32 s45, s98, 3
    s_mov_b64 exec, 1
    v_mov_b32 v56, s45
    s_waitcnt vmcnt(0)
    buffer_store_dword v56, off, s[4:7], s35 offset:0 sc1
    s_mov_b64 exec, -1
    s_waitcnt lgkmcnt(6)
    v_pk_add_f32 v[32:33], v[32:33], v[192:193]
    v_pk_add_f32 v[34:35], v[34:35], v[194:195]
    v_pk_add_f32 v[36:37], v[36:37], v[196:197]
    v_pk_add_f32 v[38:39], v[38:39], v[198:199]
    s_waitcnt lgkmcnt(4)
    v_pk_add_f32 v[32:33], v[32:33], v[200:201]
    v_pk_add_f32 v[34:35], v[34:35], v[202:203]
    v_pk_add_f32 v[36:37], v[36:37], v[204:205]
    v_pk_add_f32 v[38:39], v[38:39], v[206:207]
    s_waitcnt lgkmcnt(2)
    v_pk_add_f32 v[32:33], v[32:33], v[208:209]
    v_pk_add_f32 v[34:35], v[34:35], v[210:211]
    v_pk_add_f32 v[36:37], v[36:37], v[212:213]
    v_pk_add_f32 v[38:39], v[38:39], v[214:215]
    s_waitcnt lgkmcnt(0)
    v_pk_add_f32 v[32:33], v[32:33], v[216:217]
    v_pk_add_f32 v[34:35], v[34:35], v[218:219]
    v_pk_add_f32 v[36:37], v[36:37], v[220:221]
    v_pk_add_f32 v[38:39], v[38:39], v[222:223]
    v_cvt_pk_bf16_f32 v44, v32, v33
    v_cvt_pk_bf16_f32 v45, v34, v35
    v_cvt_pk_bf16_f32 v46, v36, v37
    v_cvt_pk_bf16_f32 v47, v38, v39
    buffer_store_dwordx4 v[44:47], v19, s[8:11], s96 offen sc1
    v_pk_add_f32 v[192:193], v[32:33], v[34:35]
    v_pk_mul_f32 v[194:195], v[32:33], v[32:33]
    v_pk_add_f32 v[192:193], v[192:193], v[36:37]
    v_pk_fma_f32 v[194:195], v[34:35], v[34:35], v[194:195]
    v_pk_add_f32 v[192:193], v[192:193], v[38:39]
    v_pk_fma_f32 v[194:195], v[36:37], v[36:37], v[194:195]
    v_add_f32 v192, v192, v193
    v_pk_fma_f32 v[194:195], v[38:39], v[38:39], v[194:195]
    v_add_f32 v193, v194, v195
    s_nop 1
    v_permlane16_swap_b32 v192, v193
    v_add_f32 v192, v192, v193
    s_nop 1
    v_add_f32_dpp v193, v192, v192 row_ror:8 row_mask:0xf bank_mask:0xf
    v_add_f32_dpp v192, v192, v192 row_ror:8 row_mask:0xf bank_mask:0xf
    s_nop 1
    v_permlane32_swap_b32 v192, v193
    v_add_f32 v192, v192, v193
    s_mov_b64 exec, 0x00ff00ff
    buffer_store_dword v192, v20, s[4:7], s34 offen offset:2048 sc1
    s_mov_b64 exec, -1
    buffer_load_dword v22, v2, s[4:7], s26 offen sc1
    v_lshlrev_b32 v200, 16, v60
    v_and_b32 v201, 0xffff0000, v60
    v_lshlrev_b32 v202, 16, v61
    v_and_b32 v203, 0xffff0000, v61
    v_lshlrev_b32 v204, 16, v62
    v_and_b32 v205, 0xffff0000, v62
    v_lshlrev_b32 v206, 16, v63
    v_and_b32 v207, 0xffff0000, v63
    v_pk_add_f32 v[24:25], v[24:25], v[200:201]
    v_pk_add_f32 v[26:27], v[26:27], v[202:203]
    v_pk_add_f32 v[28:29], v[28:29], v[204:205]
    v_pk_add_f32 v[30:31], v[30:31], v[206:207]
    v_pk_add_f32 v[32:33], v[32:33], v[200:201]
    v_pk_add_f32 v[34:35], v[34:35], v[202:203]
    v_pk_add_f32 v[36:37], v[36:37], v[204:205]
    v_pk_add_f32 v[38:39], v[38:39], v[206:207]
    s_add_u32 s45, s98, 3
    s_mov_b64 exec, 1
    v_mov_b32 v56, s45
    s_waitcnt vmcnt(1)
    buffer_store_dword v56, off, s[4:7], s35 offset:128 sc1
    s_mov_b64 exec, -1
    ds_read_b128 v[112:115], v1 offset:0
    ds_read_b128 v[116:119], v1 offset:32768
    ds_read_b128 v[120:123], v0 offset:32768
    ds_read_b128 v[124:127], v1 offset:1024
    s_add_u32 s45, s98, 3
    s_waitcnt vmcnt(1)
    v_cmp_ne_u32 vcc, s45, v22
    s_cmp_eq_u32 vcc_lo, 0
    s_cbranch_scc1 Lpolls_29_s
    s_add_u32 s45, s98, 3
    s_mov_b32 exec_hi, 0
    s_mov_b32 s50, 0
Lpoll_28_s:
    buffer_load_dword v56, v2, s[4:7], s26 offen sc1
    s_add_u32 s50, s50, 1
    s_cmp_gt_u32 s50, 0x40000
    s_cbranch_scc1 Labort
    s_waitcnt vmcnt(0)
    v_cmp_ne_u32 vcc, s45, v56
    s_cbranch_vccnz Lpoll_28_s
    s_mov_b64 exec, -1
Lpolls_29_s:
    s_add_u32 s51, s24, 0
    buffer_load_dwordx4 v[128:131], v0, s[8:11], s51 offen offset:0 sc1
    buffer_load_dwordx4 v[132:135], v0, s[8:11], s51 offen offset:1024 sc1
    buffer_load_dwordx4 v[136:139], v0, s[8:11], s51 offen offset:2048 sc1
    buffer_load_dwordx4 v[140:143], v0, s[8:11], s51 offen offset:3072 sc1
    s_waitcnt vmcnt(3) lgkmcnt(3)
    v_mfma_f32_32x32x16_bf16 v[64:79], v[112:115], v[128:131], 0
    ds_read_b128 v[112:115], v1 offset:33792
    s_add_u32 s51, s24, 4096
    buffer_load_dwordx4 v[144:147], v0, s[8:11], s51 offen offset:0 sc1
    s_waitcnt lgkmcnt(3)
    v_mfma_f32_32x32x16_bf16 v[80:95], v[116:119], v[128:131], 0
    ds_read_b128 v[116:119], v0 offset:33792
    s_waitcnt lgkmcnt(3)
    v_mfma_f32_32x32x16_bf16 v[96:111], v[120:123], v[128:131], 0
    ds_read_b128 v[120:123], v1 offset:2048
    s_waitcnt vmcnt(3) lgkmcnt(3)
    v_mfma_f32_32x32x16_bf16 v[64:79], v[124:127], v[132:135], v[64:79]
    ds_read_b128 v[124:127], v1 offset:34816
    buffer_load_dwordx4 v[148:151], v0, s[8:11], s51 offen offset:1024 sc1
    s_waitcnt lgkmcnt(3)
    v_mfma_f32_32x32x16_bf16 v[80:95], v[112:115], v[132:135], v[80:95]
    ds_read_b128 v[112:115], v0 offset:34816
    s_waitcnt lgkmcnt(3)
    v_mfma_f32_32x32x16_bf16 v[96:111], v[116:119], v[132:135], v[96:111]
    ds_read_b128 v[116:119], v1 offset:3072
    s_waitcnt vmcnt(3) lgkmcnt(3)
    v_mfma_f32_32x32x16_bf16 v[64:79], v[120:123], v[136:139], v[64:79]
    ds_read_b128 v[120:123], v1 offset:35840
    buffer_load_dwordx4 v[152:155], v0, s[8:11], s51 offen offset:2048 sc1
    s_waitcnt lgkmcnt(3)
    v_mfma_f32_32x32x16_bf16 v[80:95], v[124:127], v[136:139], v[80:95]
    ds_read_b128 v[124:127], v0 offset:35840
    s_waitcnt lgkmcnt(3)
    v_mfma_f32_32x32x16_bf16 v[96:111], v[112:115], v[136:139], v[96:111]
    ds_read_b128 v[112:115], v1 offset:4096
    s_waitcnt vmcnt(3) lgkmcnt(3)
    v_mfma_f32_32x32x16_bf16 v[64:79], v[116:119], v[140:143], v[64:79]
    ds_read_b128 v[116:119], v1 offset:36864
    buffer_load_dwordx4 v[156:159], v0, s[8:11], s51 offen offset:3072 sc1
    s_add_u32 s51, s24, 8192
    buffer_load_dwordx4 v[160:163], v0, s[8:11], s51 offen offset:0 sc1
    s_waitcnt lgkmcnt(3)
    v_mfma_f32_32x32x16_bf16 v[80:95], v[120:123], v[140:143], v[80:95]
    ds_read_b128 v[120:123], v0 offset:36864
    s_waitcnt lgkmcnt(3)
    v_mfma_f32_32x32x16_bf16 v[96:111], v[124:127], v[140:143], v[96:111]
    ds_read_b128 v[124:127], v1 offset:5120
    s_waitcnt vmcnt(4) lgkmcnt(3)
    v_mfma_f32_32x32x16_bf16 v[64:79], v[112:115], v[144:147], v[64:79]
    ds_read_b128 v[112:115], v1 offset:37888
    buffer_load_dwordx4 v[164:167], v0, s[8:11], s51 offen offset:1024 sc1
    s_waitcnt lgkmcnt(3)
    v_mfma_f32_32x32x16_bf16 v[80:95], v[116:119], v[144:147], v[80:95]
    ds_read_b128 v[116:119], v0 offset:37888
    s_waitcnt lgkmcnt(3)
    v_mfma_f32_32x32x16_bf16 v[96:111], v[120:123], v[144:147], v[96:111]
    ds_read_b128 v[120:123], v1 offset:6144
    s_waitcnt vmcnt(4) lgkmcnt(3)
    v_mfma_f32_32x32x16_bf16 v[64:79], v[124:127], v[148:151], v[64:79]
    ds_read_b128 v[124:127], v1 offset:38912
    buffer_load_dwordx4 v[168:171], v0, s[8:11], s51 offen offset:2048 sc1
    s_waitcnt lgkmcnt(3)
    v_mfma_f32_32x32x16_bf16 v[80:95], v[112:115], v[148:151], v[80:95]
    ds_read_b128 v[112:115], v0 offset:38912
    s_waitcnt lgkmcnt(3)
    v_mfma_f32_32x32x16_bf16 v[96:111], v[116:119], v[148:151], v[96:111]
    ds_read_b128 v[116:119], v1 offset:7168
    s_waitcnt vmcnt(4) lgkmcnt(3)
    v_mfma_f32_32x32x16_bf16 v[64:79], v[120:123], v[152:155], v[64:79]
    ds_read_b128 v[120:123], v1 offset:39936
    buffer_load_dwordx4 v[172:175], v0, s[8:11], s51 offen offset:3072 sc1
    buffer_load_dwordx2 v[56:57], v3, s[4:7], s25 offen offset:0 sc1
    s_waitcnt lgkmcnt(3)
    v_mfma_f32_32x32x16_bf16 v[80:95], v[124:127], v[152:155], v[80:95]
    ds_read_b128 v[124:127], v0 offset:39936
    s_waitcnt lgkmcnt(3)
    v_mfma_f32_32x32x16_bf16 v[96:111], v[112:115], v[152:155], v[96:111]
    ds_read_b128 v[112:115], v1 offset:8192
    s_waitcnt vmcnt(5) lgkmcnt(3)
    v_mfma_f32_32x32x16_bf16 v[64:79], v[116:119], v[156:159], v[64:79]
    ds_read_b128 v[116:119], v1 offset:40960
    buffer_load_dwordx2 v[58:59], v3, s[4:7], s25 offen offset:256 sc1
    s_waitcnt lgkmcnt(3)
    v_mfma_f32_32x32x16_bf16 v[80:95], v[120:123], v[156:159], v[80:95]
    ds_read_b128 v[120:123], v0 offset:40960
    s_waitcnt lgkmcnt(3)
    v_mfma_f32_32x32x16_bf16 v[96:111], v[124:127], v[156:159], v[96:111]
    ds_read_b128 v[124:127], v1 offset:9216
    s_waitcnt vmcnt(5) lgkmcnt(3)
    v_mfma_f32_32x32x16_bf16 v[64:79], v[112:115], v[160:163], v[64:79]
    ds_read_b128 v[112:115], v1 offset:41984
    buffer_load_dwordx2 v[60:61], v3, s[4:7], s25 offen offset:512 sc1
    s_waitcnt lgkmcnt(3)
    v_mfma_f32_32x32x16_bf16 v[80:95], v[116:119], v[160:163], v[80:95]
    ds_read_b128 v[116:119], v0 offset:41984
    s_waitcnt lgkmcnt(3)
    v_mfma_f32_32x32x16_bf16 v[96:111], v[120:123], v[160:163], v[96:111]
    ds_read_b128 v[120:123], v1 offset:10240
    s_waitcnt vmcnt(5) lgkmcnt(3)
    v_mfma_f32_32x32x16_bf16 v[64:79], v[124:127], v[164:167], v[64:79]
    ds_read_b128 v[124:127], v1 offset:43008
    buffer_load_dwordx2 v[62:63], v3, s[4:7], s25 offen offset:768 sc1
    s_add_u32 s51, s24, 12288
    buffer_load_dwordx4 v[176:179], v0, s[8:11], s51 offen offset:0 sc1
    s_waitcnt lgkmcnt(3)
    v_mfma_f32_32x32x16_bf16 v[80:95], v[112:115], v[164:167], v[80:95]
    ds_read_b128 v[112:115], v0 offset:43008
    s_waitcnt lgkmcnt(3)
    v_mfma_f32_32x32x16_bf16 v[96:111], v[116:119], v[164:167], v[96:111]
    ds_read_b128 v[116:119], v1 offset:11264
    s_waitcnt vmcnt(6) lgkmcnt(3)
    v_mfma_f32_32x32x16_bf16 v[64:79], v[120:123], v[168:171], v[64:79]
    ds_read_b128 v[120:123], v1 offset:44032
    buffer_load_dwordx4 v[180:183], v0, s[8:11], s51 offen offset:1024 sc1
    s_waitcnt lgkmcnt(3)
    v_mfma_f32_32x32x16_bf16 v[80:95], v[124:127], v[168:171], v[80:95]
    ds_read_b128 v[124:127], v0 offset:44032
    s_waitcnt lgkmcnt(3)
    v_mfma_f32_32x32x16_bf16 v[96:111], v[112:115], v[168:171], v[96:111]
    ds_read_b128 v[112:115], v1 offset:12288
    s_waitcnt vmcnt(6) lgkmcnt(3)
    v_mfma_f32_32x32x16_bf16 v[64:79], v[116:119], v[172:175], v[64:79]
    ds_read_b128 v[116:119], v1 offset:45056
    buffer_load_dwordx4 v[184:187], v0, s[8:11], s51 offen offset:2048 sc1
    s_waitcnt lgkmcnt(3)
    v_mfma_f32_32x32x16_bf16 v[80:95], v[120:123], v[172:175], v[80:95]
    ds_read_b128 v[120:123], v0 offset:45056
    s_waitcnt lgkmcnt(3)
    v_mfma_f32_32x32x16_bf16 v[96:111], v[124:127], v[172:175], v[96:111]
    ds_read_b128 v[124:127], v1 offset:13312
    s_waitcnt vmcnt(2) lgkmcnt(3)
    v_mfma_f32_32x32x16_bf16 v[64:79], v[112:115], v[176:179], v[64:79]
    ds_read_b128 v[112:115], v1 offset:46080
    buffer_load_dwordx4 v[188:191], v0, s[8:11], s51 offen offset:3072 sc1
    s_waitcnt lgkmcnt(3)
    v_mfma_f32_32x32x16_bf16 v[80:95], v[116:119], v[176:179], v[80:95]
    ds_read_b128 v[116:119], v0 offset:46080
    s_waitcnt lgkmcnt(3)
    v_mfma_f32_32x32x16_bf16 v[96:111], v[120:123], v[176:179], v[96:111]
    ds_read_b128 v[120:123], v1 offset:14336
    s_waitcnt vmcnt(2) lgkmcnt(3)
    v_mfma_f32_32x32x16_bf16 v[64:79], v[124:127], v[180:183], v[64:79]
    ds_read_b128 v[124:127], v1 offset:47104
    s_add_u32 s51, s24, 16384
    buffer_load_dwordx4 v[192:195], v0, s[8:11], s51 offen offset:0 sc1
    buffer_load_dwordx4 v[196:199], v0, s[8:11], s51 offen offset:1024 sc1
    s_waitcnt lgkmcnt(3)
    v_mfma_f32_32x32x16_bf16 v[80:95], v[112:115], v[180:183], v[80:95]
    ds_read_b128 v[112:115], v0 offset:47104
    s_waitcnt lgkmcnt(3)
    v_mfma_f32_32x32x16_bf16 v[96:111], v[116:119], v[180:183], v[96:111]
    ds_read_b128 v[116:119], v1 offset:15360
    s_waitcnt vmcnt(3) lgkmcnt(3)
    v_mfma_f32_32x32x16_bf16 v[64:79], v[120:123], v[184:187], v[64:79]
    ds_read_b128 v[120:123], v1 offset:48128
    buffer_load_dwordx4 v[200:203], v0, s[8:11], s51 offen offset:2048 sc1
    v_add_f32 v56, v56, v58
    s_waitcnt lgkmcnt(3)
    v_mfma_f32_32x32x16_bf16 v[80:95], v[124:127], v[184:187], v[80:95]
    ds_read_b128 v[124:127], v0 offset:48128
    v_add_f32 v57, v57, v59
    v_add_f32 v60, v60, v62
    s_waitcnt lgkmcnt(3)
    v_mfma_f32_32x32x16_bf16 v[96:111], v[112:115], v[184:187], v[96:111]
    ds_read_b128 v[112:115], v1 offset:16384
    v_add_f32 v61, v61, v63
    v_add_f32 v56, v56, v60
    s_waitcnt vmcnt(3) lgkmcnt(3)
    v_mfma_f32_32x32x16_bf16 v[64:79], v[116:119], v[188:191], v[64:79]
    ds_read_b128 v[116:119], v1 offset:49152
    buffer_load_dwordx4 v[204:207], v0, s[8:11], s51 offen offset:3072 sc1
    v_add_f32 v57, v57, v61
    s_nop 1
    v_permlane32_swap_b32 v56, v57
    s_waitcnt lgkmcnt(3)
    v_mfma_f32_32x32x16_bf16 v[80:95], v[120:123], v[188:191], v[80:95]
    ds_read_b128 v[120:123], v0 offset:49152
    v_add_f32 v56, v56, v57
    v_mov_b32 v57, v56
    s_waitcnt lgkmcnt(3)
    v_mfma_f32_32x32x16_bf16 v[96:111], v[124:127], v[188:191], v[96:111]
    ds_read_b128 v[124:127], v1 offset:17408
    v_permlane32_swap_b32 v56, v57
    v_mul_f32 v22, 989855744, v56
    s_waitcnt vmcnt(3) lgkmcnt(3)
    v_mfma_f32_32x32x16_bf16 v[64:79], v[112:115], v[192:195], v[64:79]
    ds_read_b128 v[112:115], v1 offset:50176
    s_add_u32 s51, s24, 20480
    buffer_load_dwordx4 v[208:211], v0, s[8:11], s51 offen offset:0 sc1
    buffer_load_dwordx4 v[212:215], v0, s[8:11], s51 offen offset:1024 sc1
    s_waitcnt lgkmcnt(3)
    v_mfma_f32_32x32x16_bf16 v[80:95], v[116:119], v[192:195], v[80:95]
    ds_read_b128 v[116:119], v0 offset:50176
    v_mul_f32 v57, 989855744, v57
    v_fma_f32 v57, -v22, v22, v57
    v_max_f32 v57, 0, v57
    v_add_f32 v58, 925353388, v57
    s_waitcnt lgkmcnt(3)
    v_mfma_f32_32x32x16_bf16 v[96:111], v[120:123], v[192:195], v[96:111]
    ds_read_b128 v[120:123], v1 offset:18432
    v_rsq_f32 v23, v58
    s_waitcnt vmcnt(4) lgkmcnt(3)
    v_mfma_f32_32x32x16_bf16 v[64:79], v[124:127], v[196:199], v[64:79]
    ds_read_b128 v[124:127], v1 offset:51200
    buffer_load_dwordx4 v[216:219], v0, s[8:11], s51 offen offset:2048 sc1
    v_mul_f32 v58, v23, v23
    v_mul_f32 v58, v58, v57
    s_waitcnt lgkmcnt(3)
    v_mfma_f32_32x32x16_bf16 v[80:95], v[112:115], v[196:199], v[80:95]
    ds_read_b128 v[112:115], v0 offset:51200
    v_add_f32 v58, 925353388, v58
    v_rsq_f32 v58, v58
    s_waitcnt lgkmcnt(3)
    v_mfma_f32_32x32x16_bf16 v[96:111], v[116:119], v[196:199], v[96:111]
    ds_read_b128 v[116:119], v1 offset:19456
    v_mul_f32 v23, v23, v58
    s_waitcnt vmcnt(4) lgkmcnt(3)
    v_mfma_f32_32x32x16_bf16 v[64:79], v[120:123], v[200:203], v[64:79]
    ds_read_b128 v[120:123], v1 offset:52224
    buffer_load_dwordx4 v[220:223], v0, s[8:11], s51 offen offset:3072 sc1
    v_rcp_f32 v58, v23
    s_waitcnt lgkmcnt(3)
    v_mfma_f32_32x32x16_bf16 v[80:95], v[124:127], v[200:203], v[80:95]
    ds_read_b128 v[124:127], v0 offset:52224
    v_mul_f32 v56, 3222493025, v23
    v_mul_f32 v57, v23, v23
    s_waitcnt lgkmcnt(3)
    v_mfma_f32_32x32x16_bf16 v[96:111], v[112:115], v[200:203], v[96:111]
    ds_read_b128 v[112:115], v1 offset:20480
    v_mul_f32 v57, v57, v56
    v_mul_f32 v57, 1027024659, v57
    s_waitcnt vmcnt(4) lgkmcnt(3)
    v_mfma_f32_32x32x16_bf16 v[64:79], v[116:119], v[204:207], v[64:79]
    ds_read_b128 v[116:119], v1 offset:53248
    s_add_u32 s51, s24, 24576
    buffer_load_dwordx4 v[224:227], v0, s[8:11], s51 offen offset:0 sc1
    buffer_load_dwordx4 v[228:231], v0, s[8:11], s51 offen offset:1024 sc1
    s_waitcnt lgkmcnt(3)
    v_mfma_f32_32x32x16_bf16 v[80:95], v[120:123], v[204:207], v[80:95]
    ds_read_b128 v[120:123], v0 offset:53248
    v_mov_b32 v42, 0
    v_mov_b32 v43, 0
    v_mov_b32 v46, 0
    v_mov_b32 v47, 0
    s_waitcnt lgkmcnt(3)
    v_mfma_f32_32x32x16_bf16 v[96:111], v[124:127], v[204:207], v[96:111]
    ds_read_b128 v[124:127], v1 offset:21504
    v_cndmask_b32 v48, v58, -v22, s[58:59]
    v_cvt_pk_bf16_f32 v44, v48, v48
    s_waitcnt vmcnt(5) lgkmcnt(3)
    v_mfma_f32_32x32x16_bf16 v[64:79], v[112:115], v[208:211], v[64:79]
    ds_read_b128 v[112:115], v1 offset:54272
    buffer_load_dwordx4 v[232:235], v0, s[8:11], s51 offen offset:2048 sc1
    v_and_b32 v49, 0xffff0000, v44
    v_sub_f32 v48, v48, v49
    s_waitcnt lgkmcnt(3)
    v_mfma_f32_32x32x16_bf16 v[80:95], v[116:119], v[208:211], v[80:95]
    ds_read_b128 v[116:119], v0 offset:54272
    v_cvt_pk_bf16_f32 v45, v48, 0
    v_accvgpr_read_b32 v50, a250
    s_waitcnt lgkmcnt(3)
    v_mfma_f32_32x32x16_bf16 v[96:111], v[120:123], v[208:211], v[96:111]
    ds_read_b128 v[120:123], v1 offset:22528
    v_cvt_pk_bf16_f32 v41, v50, 0
    v_lshlrev_b32 v51, 16, v41
    s_waitcnt vmcnt(5) lgkmcnt(3)
    v_mfma_f32_32x32x16_bf16 v[64:79], v[124:127], v[212:215], v[64:79]
    ds_read_b128 v[124:127], v1 offset:55296
    buffer_load_dwordx4 v[236:239], v0, s[8:11], s51 offen offset:3072 sc1
    v_sub_f32 v51, v50, v51
    v_cvt_pk_bf16_f32 v40, v50, v51
    s_waitcnt lgkmcnt(3)
    v_mfma_f32_32x32x16_bf16 v[80:95], v[112:115], v[212:215], v[80:95]
    ds_read_b128 v[112:115], v0 offset:55296
    v_mfma_f32_32x32x16_bf16 v[64:79], v[40:43], v[44:47], v[64:79]
    v_accvgpr_read_b32 v50, a251
    s_waitcnt lgkmcnt(3)
    v_mfma_f32_32x32x16_bf16 v[96:111], v[116:119], v[212:215], v[96:111]
    ds_read_b128 v[116:119], v1 offset:23552
    v_cvt_pk_bf16_f32 v41, v50, 0
    v_lshlrev_b32 v51, 16, v41
    s_waitcnt vmcnt(5) lgkmcnt(3)
    v_mfma_f32_32x32x16_bf16 v[64:79], v[120:123], v[216:219], v[64:79]
    ds_read_b128 v[120:123], v1 offset:56320
    s_add_u32 s51, s24, 28672
    buffer_load_dwordx4 v[240:243], v0, s[8:11], s51 offen offset:0 sc1
    s_waitcnt lgkmcnt(3)
    v_mfma_f32_32x32x16_bf16 v[80:95], v[124:127], v[216:219], v[80:95]
    ds_read_b128 v[124:127], v0 offset:56320
    v_sub_f32 v51, v50, v51
    v_cvt_pk_bf16_f32 v40, v50, v51
    s_nop 1
    v_mfma_f32_32x32x16_bf16 v[80:95], v[40:43], v[44:47], v[80:95]
    v_accvgpr_read_b32 v50, a252
    s_waitcnt lgkmcnt(3)
    v_mfma_f32_32x32x16_bf16 v[96:111], v[112:115], v[216:219], v[96:111]
    ds_read_b128 v[112:115], v1 offset:24576
    v_cvt_pk_bf16_f32 v41, v50, 0
    v_lshlrev_b32 v51, 16, v41
    s_waitcnt vmcnt(5) lgkmcnt(3)
    v_mfma_f32_32x32x16_bf16 v[64:79], v[116:119], v[220:223], v[64:79]
    ds_read_b128 v[116:119], v1 offset:57344
    buffer_load_dwordx4 v[244:247], v0, s[8:11], s51 offen offset:1024 sc1
    buffer_load_dwordx4 v[248:251], v0, s[8:11], s51 offen offset:2048 sc1
    s_waitcnt lgkmcnt(3)
    v_mfma_f32_32x32x16_bf16 v[80:95], v[120:123], v[220:223], v[80:95]
    ds_read_b128 v[120:123], v0 offset:57344
    v_sub_f32 v51, v50, v51
    v_cvt_pk_bf16_f32 v40, v50, v51
    s_nop 1
    v_mfma_f32_32x32x16_bf16 v[96:111], v[40:43], v[44:47], v[96:111]
    s_waitcnt lgkmcnt(3)
    v_mfma_f32_32x32x16_bf16 v[96:111], v[124:127], v[220:223], v[96:111]
    ds_read_b128 v[124:127], v1 offset:25600
    s_waitcnt vmcnt(6) lgkmcnt(3)
    v_mfma_f32_32x32x16_bf16 v[64:79], v[112:115], v[224:227], v[64:79]
    ds_read_b128 v[112:115], v1 offset:58368
    buffer_load_dwordx4 v[252:255], v0, s[8:11], s51 offen offset:3072 sc1
    s_waitcnt lgkmcnt(3)
    v_mfma_f32_32x32x16_bf16 v[80:95], v[116:119], v[224:227], v[80:95]
    ds_read_b128 v[116:119], v0 offset:58368
    s_waitcnt lgkmcnt(3)
    v_mfma_f32_32x32x16_bf16 v[96:111], v[120:123], v[224:227], v[96:111]
    ds_read_b128 v[120:123], v1 offset:26624
    s_waitcnt vmcnt(6) lgkmcnt(3)
    v_mfma_f32_32x32x16_bf16 v[64:79], v[124:127], v[228:231], v[64:79]
    ds_read_b128 v[124:127], v1 offset:59392
    s_waitcnt lgkmcnt(3)
    v_mfma_f32_32x32x16_bf16 v[80:95], v[112:115], v[228:231], v[80:95]
    ds_read_b128 v[112:115], v0 offset:59392
    s_waitcnt lgkmcnt(3)
    v_mfma_f32_32x32x16_bf16 v[96:111], v[116:119], v[228:231], v[96:111]
    ds_read_b128 v[116:119], v1 offset:27648
    s_waitcnt vmcnt(5) lgkmcnt(3)
    v_mfma_f32_32x32x16_bf16 v[64:79], v[120:123], v[232:235], v[64:79]
    ds_read_b128 v[120:123], v1 offset:60416
    s_waitcnt lgkmcnt(3)
    v_mfma_f32_32x32x16_bf16 v[80:95], v[124:127], v[232:235], v[80:95]
    ds_read_b128 v[124:127], v0 offset:60416
    s_waitcnt lgkmcnt(3)
    v_mfma_f32_32x32x16_bf16 v[96:111], v[112:115], v[232:235], v[96:111]
    ds_read_b128 v[112:115], v1 offset:28672
    s_waitcnt vmcnt(4) lgkmcnt(3)
    v_mfma_f32_32x32x16_bf16 v[64:79], v[116:119], v[236:239], v[64:79]
    ds_read_b128 v[116:119], v1 offset:61440
    s_waitcnt lgkmcnt(3)
    v_mfma_f32_32x32x16_bf16 v[80:95], v[120:123], v[236:239], v[80:95]
    ds_read_b128 v[120:123], v0 offset:61440
    s_waitcnt lgkmcnt(3)
    v_mfma_f32_32x32x16_bf16 v[96:111], v[124:127], v[236:239], v[96:111]
    ds_read_b128 v[124:127], v1 offset:29696
    s_waitcnt vmcnt(3) lgkmcnt(3)
    v_mfma_f32_32x32x16_bf16 v[64:79], v[112:115], v[240:243], v[64:79]
    ds_read_b128 v[112:115], v1 offset:62464
    s_waitcnt lgkmcnt(3)
    v_mfma_f32_32x32x16_bf16 v[80:95], v[116:119], v[240:243], v[80:95]
    ds_read_b128 v[116:119], v0 offset:62464
    s_waitcnt lgkmcnt(3)
    v_mfma_f32_32x32x16_bf16 v[96:111], v[120:123], v[240:243], v[96:111]
    ds_read_b128 v[120:123], v1 offset:30720
    s_waitcnt vmcnt(2) lgkmcnt(3)
    v_mfma_f32_32x32x16_bf16 v[64:79], v[124:127], v[244:247], v[64:79]
    ds_read_b128 v[124:127], v1 offset:63488
    s_waitcnt lgkmcnt(3)
    v_mfma_f32_32x32x16_bf16 v[80:95], v[112:115], v[244:247], v[80:95]
    ds_read_b128 v[112:115], v0 offset:63488
    s_waitcnt lgkmcnt(3)
    v_mfma_f32_32x32x16_bf16 v[96:111], v[116:119], v[244:247], v[96:111]
    ds_read_b128 v[116:119], v1 offset:31744
    s_waitcnt vmcnt(1) lgkmcnt(3)
    v_mfma_f32_32x32x16_bf16 v[64:79], v[120:123], v[248:251], v[64:79]
    ds_read_b128 v[120:123], v1 offset:64512
    s_waitcnt lgkmcnt(3)
    v_mfma_f32_32x32x16_bf16 v[80:95], v[124:127], v[248:251], v[80:95]
    ds_read_b128 v[124:127], v0 offset:64512
    s_waitcnt lgkmcnt(3)
    v_mfma_f32_32x32x16_bf16 v[96:111], v[112:115], v[248:251], v[96:111]
    s_waitcnt vmcnt(0) lgkmcnt(2)
    v_mfma_f32_32x32x16_bf16 v[64:79], v[116:119], v[252:255], v[64:79]
    s_waitcnt lgkmcnt(1)
    v_mfma_f32_32x32x16_bf16 v[80:95], v[120:123], v[252:255], v[80:95]
    s_waitcnt lgkmcnt(0)
    v_mfma_f32_32x32x16_bf16 v[96:111], v[124:127], v[252:255], v[96:111]
    s_nop 7
    v_pk_mul_f32 v[40:41], v[64:65], v[64:65]
    v_pk_mul_f32 v[42:43], v[66:67], v[66:67]
    v_pk_mul_f32 v[44:45], v[68:69], v[68:69]
    v_pk_mul_f32 v[46:47], v[70:71], v[70:71]
    v_pk_fma_f32 v[40:41], v[40:41], v[56:57], v[56:57] op_sel:[0,1,0] op_sel_hi:[1,1,0]
    v_pk_fma_f32 v[42:43], v[42:43], v[56:57], v[56:57] op_sel:[0,1,0] op_sel_hi:[1,1,0]
    v_pk_fma_f32 v[44:45], v[44:45], v[56:57], v[56:57] op_sel:[0,1,0] op_sel_hi:[1,1,0]
    v_pk_fma_f32 v[46:47], v[46:47], v[56:57], v[56:57] op_sel:[0,1,0] op_sel_hi:[1,1,0]
    v_pk_mul_f32 v[40:41], v[40:41], v[64:65]
    v_pk_mul_f32 v[42:43], v[42:43], v[66:67]
    v_pk_mul_f32 v[44:45], v[44:45], v[68:69]
    v_pk_mul_f32 v[46:47], v[46:47], v[70:71]
    v_exp_f32 v40, v40
    v_exp_f32 v41, v41
    v_exp_f32 v42, v42
    v_exp_f32 v43, v43
    v_exp_f32 v44, v44
    v_exp_f32 v45, v45
    v_exp_f32 v46, v46
    v_exp_f32 v47, v47
    v_pk_fma_f32 v[40:41], v[40:41], v[58:59], v[58:59] op_sel_hi:[1,0,0]
    v_pk_fma_f32 v[42:43], v[42:43], v[58:59], v[58:59] op_sel_hi:[1,0,0]
    v_pk_fma_f32 v[44:45], v[44:45], v[58:59], v[58:59] op_sel_hi:[1,0,0]
    v_pk_fma_f32 v[46:47], v[46:47], v[58:59], v[58:59] op_sel_hi:[1,0,0]
    v_rcp_f32 v40, v40
    v_rcp_f32 v41, v41
    v_rcp_f32 v42, v42
    v_rcp_f32 v43, v43
    v_rcp_f32 v44, v44
    v_rcp_f32 v45, v45
    v_rcp_f32 v46, v46
    v_rcp_f32 v47, v47
    v_pk_mul_f32 v[64:65], v[64:65], v[40:41]
    v_pk_mul_f32 v[66:67], v[66:67], v[42:43]
    v_pk_mul_f32 v[68:69], v[68:69], v[44:45]
    v_pk_mul_f32 v[70:71], v[70:71], v[46:47]
    v_cvt_pk_bf16_f32 v64, v64, v65
    v_cvt_pk_bf16_f32 v65, v66, v67
    v_cvt_pk_bf16_f32 v66, v68, v69
    v_cvt_pk_bf16_f32 v67, v70, v71
    buffer_store_dwordx4 v[64:67], v5, s[4:7], s36 offen offset:0 sc1
    v_pk_mul_f32 v[48:49], v[72:73], v[72:73]
    v_pk_mul_f32 v[50:51], v[74:75], v[74:75]
    v_pk_mul_f32 v[52:53], v[76:77], v[76:77]
    v_pk_mul_f32 v[54:55], v[78:79], v[78:79]
    v_pk_fma_f32 v[48:49], v[48:49], v[56:57], v[56:57] op_sel:[0,1,0] op_sel_hi:[1,1,0]
    v_pk_fma_f32 v[50:51], v[50:51], v[56:57], v[56:57] op_sel:[0,1,0] op_sel_hi:[1,1,0]
    v_pk_fma_f32 v[52:53], v[52:53], v[56:57], v[56:57] op_sel:[0,1,0] op_sel_hi:[1,1,0]
    v_pk_fma_f32 v[54:55], v[54:55], v[56:57], v[56:57] op_sel:[0,1,0] op_sel_hi:[1,1,0]
    v_pk_mul_f32 v[48:49], v[48:49], v[72:73]
    v_pk_mul_f32 v[50:51], v[50:51], v[74:75]
    v_pk_mul_f32 v[52:53], v[52:53], v[76:77]
    v_pk_mul_f32 v[54:55], v[54:55], v[78:79]
    v_exp_f32 v48, v48
    v_exp_f32 v49, v49
    v_exp_f32 v50, v50
    v_exp_f32 v51, v51
    v_exp_f32 v52, v52
    v_exp_f32 v53, v53
    v_exp_f32 v54, v54
    v_exp_f32 v55, v55
    v_pk_fma_f32 v[48:49], v[48:49], v[58:59], v[58:59] op_sel_hi:[1,0,0]
    v_pk_fma_f32 v[50:51], v[50:51], v[58:59], v[58:59] op_sel_hi:[1,0,0]
    v_pk_fma_f32 v[52:53], v[52:53], v[58:59], v[58:59] op_sel_hi:[1,0,0]
    v_pk_fma_f32 v[54:55], v[54:55], v[58:59], v[58:59] op_sel_hi:[1,0,0]
    v_rcp_f32 v48, v48
    v_rcp_f32 v49, v49
    v_rcp_f32 v50, v50
    v_rcp_f32 v51, v51
    v_rcp_f32 v52, v52
    v_rcp_f32 v53, v53
    v_rcp_f32 v54, v54
    v_rcp_f32 v55, v55
    v_pk_mul_f32 v[72:73], v[72:73], v[48:49]
    v_pk_mul_f32 v[74:75], v[74:75], v[50:51]
    v_pk_mul_f32 v[76:77], v[76:77], v[52:53]
    v_pk_mul_f32 v[78:79], v[78:79], v[54:55]
    v_cvt_pk_bf16_f32 v72, v72, v73
    v_cvt_pk_bf16_f32 v73, v74, v75
    v_cvt_pk_bf16_f32 v74, v76, v77
    v_cvt_pk_bf16_f32 v75, v78, v79
    buffer_store_dwordx4 v[72:75], v5, s[4:7], s36 offen offset:256 sc1
    v_pk_mul_f32 v[40:41], v[80:81], v[80:81]
    v_pk_mul_f32 v[42:43], v[82:83], v[82:83]
    v_pk_mul_f32 v[44:45], v[84:85], v[84:85]
    v_pk_mul_f32 v[46:47], v[86:87], v[86:87]
    v_pk_fma_f32 v[40:41], v[40:41], v[56:57], v[56:57] op_sel:[0,1,0] op_sel_hi:[1,1,0]
    v_pk_fma_f32 v[42:43], v[42:43], v[56:57], v[56:57] op_sel:[0,1,0] op_sel_hi:[1,1,0]
    v_pk_fma_f32 v[44:45], v[44:45], v[56:57], v[56:57] op_sel:[0,1,0] op_sel_hi:[1,1,0]
    v_pk_fma_f32 v[46:47], v[46:47], v[56:57], v[56:57] op_sel:[0,1,0] op_sel_hi:[1,1,0]
    v_pk_mul_f32 v[40:41], v[40:41], v[80:81]
    v_pk_mul_f32 v[42:43], v[42:43], v[82:83]
    v_pk_mul_f32 v[44:45], v[44:45], v[84:85]
    v_pk_mul_f32 v[46:47], v[46:47], v[86:87]
    v_exp_f32 v40, v40
    v_exp_f32 v41, v41
    v_exp_f32 v42, v42
    v_exp_f32 v43, v43
    v_exp_f32 v44, v44
    v_exp_f32 v45, v45
    v_exp_f32 v46, v46
    v_exp_f32 v47, v47
    v_pk_fma_f32 v[40:41], v[40:41], v[58:59], v[58:59] op_sel_hi:[1,0,0]
    v_pk_fma_f32 v[42:43], v[42:43], v[58:59], v[58:59] op_sel_hi:[1,0,0]
    v_pk_fma_f32 v[44:45], v[44:45], v[58:59], v[58:59] op_sel_hi:[1,0,0]
    v_pk_fma_f32 v[46:47], v[46:47], v[58:59], v[58:59] op_sel_hi:[1,0,0]
    v_rcp_f32 v40, v40
    v_rcp_f32 v41, v41
    v_rcp_f32 v42, v42
    v_rcp_f32 v43, v43
    v_rcp_f32 v44, v44
    v_rcp_f32 v45, v45
    v_rcp_f32 v46, v46
    v_rcp_f32 v47, v47
    v_pk_mul_f32 v[80:81], v[80:81], v[40:41]
    v_pk_mul_f32 v[82:83], v[82:83], v[42:43]
    v_pk_mul_f32 v[84:85], v[84:85], v[44:45]
    v_pk_mul_f32 v[86:87], v[86:87], v[46:47]
    v_cvt_pk_bf16_f32 v80, v80, v81
    v_cvt_pk_bf16_f32 v81, v82, v83
    v_cvt_pk_bf16_f32 v82, v84, v85
    v_cvt_pk_bf16_f32 v83, v86, v87
    buffer_store_dwordx4 v[80:83], v5, s[4:7], s63 offen offset:0 sc1
    v_pk_mul_f32 v[48:49], v[88:89], v[88:89]
    v_pk_mul_f32 v[50:51], v[90:91], v[90:91]
    v_pk_mul_f32 v[52:53], v[92:93], v[92:93]
    v_pk_mul_f32 v[54:55], v[94:95], v[94:95]
    v_pk_fma_f32 v[48:49], v[48:49], v[56:57], v[56:57] op_sel:[0,1,0] op_sel_hi:[1,1,0]
    v_pk_fma_f32 v[50:51], v[50:51], v[56:57], v[56:57] op_sel:[0,1,0] op_sel_hi:[1,1,0]
    v_pk_fma_f32 v[52:53], v[52:53], v[56:57], v[56:57] op_sel:[0,1,0] op_sel_hi:[1,1,0]
    v_pk_fma_f32 v[54:55], v[54:55], v[56:57], v[56:57] op_sel:[0,1,0] op_sel_hi:[1,1,0]
    v_pk_mul_f32 v[48:49], v[48:49], v[88:89]
    v_pk_mul_f32 v[50:51], v[50:51], v[90:91]
    v_pk_mul_f32 v[52:53], v[52:53], v[92:93]
    v_pk_mul_f32 v[54:55], v[54:55], v[94:95]
    v_exp_f32 v48, v48
    v_exp_f32 v49, v49
    v_exp_f32 v50, v50
    v_exp_f32 v51, v51
    v_exp_f32 v52, v52
    v_exp_f32 v53, v53
    v_exp_f32 v54, v54
    v_exp_f32 v55, v55
    v_pk_fma_f32 v[48:49], v[48:49], v[58:59], v[58:59] op_sel_hi:[1,0,0]
    v_pk_fma_f32 v[50:51], v[50:51], v[58:59], v[58:59] op_sel_hi:[1,0,0]
    v_pk_fma_f32 v[52:53], v[52:53], v[58:59], v[58:59] op_sel_hi:[1,0,0]
    v_pk_fma_f32 v[54:55], v[54:55], v[58:59], v[58:59] op_sel_hi:[1,0,0]
    v_rcp_f32 v48, v48
    v_rcp_f32 v49, v49
    v_rcp_f32 v50, v50
    v_rcp_f32 v51, v51
    v_rcp_f32 v52, v52
    v_rcp_f32 v53, v53
    v_rcp_f32 v54, v54
    v_rcp_f32 v55, v55
    v_pk_mul_f32 v[88:89], v[88:89], v[48:49]
    v_pk_mul_f32 v[90:91], v[90:91], v[50:51]
    v_pk_mul_f32 v[92:93], v[92:93], v[52:53]
    v_pk_mul_f32 v[94:95], v[94:95], v[54:55]
    v_cvt_pk_bf16_f32 v88, v88, v89
    v_cvt_pk_bf16_f32 v89, v90, v91
    v_cvt_pk_bf16_f32 v90, v92, v93
    v_cvt_pk_bf16_f32 v91, v94, v95
    buffer_store_dwordx4 v[88:91], v5, s[4:7], s63 offen offset:256 sc1
    v_pk_mul_f32 v[40:41], v[96:97], v[96:97]
    v_pk_mul_f32 v[42:43], v[98:99], v[98:99]
    v_pk_mul_f32 v[44:45], v[100:101], v[100:101]
    v_pk_mul_f32 v[46:47], v[102:103], v[102:103]
    v_pk_fma_f32 v[40:41], v[40:41], v[56:57], v[56:57] op_sel:[0,1,0] op_sel_hi:[1,1,0]
    v_pk_fma_f32 v[42:43], v[42:43], v[56:57], v[56:57] op_sel:[0,1,0] op_sel_hi:[1,1,0]
    v_pk_fma_f32 v[44:45], v[44:45], v[56:57], v[56:57] op_sel:[0,1,0] op_sel_hi:[1,1,0]
    v_pk_fma_f32 v[46:47], v[46:47], v[56:57], v[56:57] op_sel:[0,1,0] op_sel_hi:[1,1,0]
    v_pk_mul_f32 v[40:41], v[40:41], v[96:97]
    v_pk_mul_f32 v[42:43], v[42:43], v[98:99]
    v_pk_mul_f32 v[44:45], v[44:45], v[100:101]
    v_pk_mul_f32 v[46:47], v[46:47], v[102:103]
    v_exp_f32 v40, v40
    v_exp_f32 v41, v41
    v_exp_f32 v42, v42
    v_exp_f32 v43, v43
    v_exp_f32 v44, v44
    v_exp_f32 v45, v45
    v_exp_f32 v46, v46
    v_exp_f32 v47, v47
    v_pk_fma_f32 v[40:41], v[40:41], v[58:59], v[58:59] op_sel_hi:[1,0,0]
    v_pk_fma_f32 v[42:43], v[42:43], v[58:59], v[58:59] op_sel_hi:[1,0,0]
    v_pk_fma_f32 v[44:45], v[44:45], v[58:59], v[58:59] op_sel_hi:[1,0,0]
    v_pk_fma_f32 v[46:47], v[46:47], v[58:59], v[58:59] op_sel_hi:[1,0,0]
    v_rcp_f32 v40, v40
    v_rcp_f32 v41, v41
    v_rcp_f32 v42, v42
    v_rcp_f32 v43, v43
    v_rcp_f32 v44, v44
    v_rcp_f32 v45, v45
    v_rcp_f32 v46, v46
    v_rcp_f32 v47, v47
    v_pk_mul_f32 v[96:97], v[96:97], v[40:41]
    v_pk_mul_f32 v[98:99], v[98:99], v[42:43]
    v_pk_mul_f32 v[100:101], v[100:101], v[44:45]
    v_pk_mul_f32 v[102:103], v[102:103], v[46:47]
    v_cvt_pk_bf16_f32 v96, v96, v97
    v_cvt_pk_bf16_f32 v97, v98, v99
    v_cvt_pk_bf16_f32 v98, v100, v101
    v_cvt_pk_bf16_f32 v99, v102, v103
    buffer_store_dwordx4 v[96:99], v5, s[4:7], s37 offen offset:0 sc1
    v_pk_mul_f32 v[48:49], v[104:105], v[104:105]
    v_pk_mul_f32 v[50:51], v[106:107], v[106:107]
    v_pk_mul_f32 v[52:53], v[108:109], v[108:109]
    v_pk_mul_f32 v[54:55], v[110:111], v[110:111]
    v_pk_fma_f32 v[48:49], v[48:49], v[56:57], v[56:57] op_sel:[0,1,0] op_sel_hi:[1,1,0]
    v_pk_fma_f32 v[50:51], v[50:51], v[56:57], v[56:57] op_sel:[0,1,0] op_sel_hi:[1,1,0]
    v_pk_fma_f32 v[52:53], v[52:53], v[56:57], v[56:57] op_sel:[0,1,0] op_sel_hi:[1,1,0]
    v_pk_fma_f32 v[54:55], v[54:55], v[56:57], v[56:57] op_sel:[0,1,0] op_sel_hi:[1,1,0]
    v_pk_mul_f32 v[48:49], v[48:49], v[104:105]
    v_pk_mul_f32 v[50:51], v[50:51], v[106:107]
    v_pk_mul_f32 v[52:53], v[52:53], v[108:109]
    v_pk_mul_f32 v[54:55], v[54:55], v[110:111]
    v_exp_f32 v48, v48
    v_exp_f32 v49, v49
    v_exp_f32 v50, v50
    v_exp_f32 v51, v51
    v_exp_f32 v52, v52
    v_exp_f32 v53, v53
    v_exp_f32 v54, v54
    v_exp_f32 v55, v55
    v_pk_fma_f32 v[48:49], v[48:49], v[58:59], v[58:59] op_sel_hi:[1,0,0]
    v_pk_fma_f32 v[50:51], v[50:51], v[58:59], v[58:59] op_sel_hi:[1,0,0]
    v_pk_fma_f32 v[52:53], v[52:53], v[58:59], v[58:59] op_sel_hi:[1,0,0]
    v_pk_fma_f32 v[54:55], v[54:55], v[58:59], v[58:59] op_sel_hi:[1,0,0]
    v_rcp_f32 v48, v48
    v_rcp_f32 v49, v49
    v_rcp_f32 v50, v50
    v_rcp_f32 v51, v51
    v_rcp_f32 v52, v52
    v_rcp_f32 v53, v53
    v_rcp_f32 v54, v54
    v_rcp_f32 v55, v55
    v_pk_mul_f32 v[104:105], v[104:105], v[48:49]
    v_pk_mul_f32 v[106:107], v[106:107], v[50:51]
    v_pk_mul_f32 v[108:109], v[108:109], v[52:53]
    v_pk_mul_f32 v[110:111], v[110:111], v[54:55]
    v_cvt_pk_bf16_f32 v104, v104, v105
    v_cvt_pk_bf16_f32 v105, v106, v107
    v_cvt_pk_bf16_f32 v106, v108, v109
    v_cvt_pk_bf16_f32 v107, v110, v111
    buffer_store_dwordx4 v[104:107], v5, s[4:7], s37 offen offset:256 sc1
    s_add_u32 s44, s101, 131072
    v_lshrrev_b32 v48, 2, v0
    v_add_u32 v48, s44, v48
    v_xor_b32 v49, 16, v48
    v_xor_b32 v50, 0x80, v48
    v_xor_b32 v51, 0x90, v48
    s_lshr_b32 s44, s16, 1
    s_lshl_b32 s44, s44, 12
    s_and_b32 s45, s16, 1
    s_lshl_b32 s45, s45, 7
    s_add_u32 s44, s44, s45
    s_add_u32 s44, s44, 131072
    v_bfe_u32 v52, v0, 8, 2
    v_lshl_add_u32 v57, v52, 10, s44
    v_bfe_u32 v52, v0, 4, 2
    v_lshl_add_u32 v57, v52, 8, v57
    v_and_b32 v52, 0x50, v0
    v_add_u32 v57, v57, v52
    v_bfe_u32 v52, v0, 7, 1
    v_lshl_add_u32 v57, v52, 5, v57
    v_and_b32 v52, 0x20, v0
    v_lshlrev_b32 v52, 2, v52
    v_xor_b32 v57, v57, v52
    v_xor_b32 v58, 16, v57
    v_subrev_u32 v52, 98304, v48
    v_subrev_u32 v53, 98304, v49
    v_subrev_u32 v54, 98304, v50
    v_subrev_u32 v55, 98304, v51
    v_bfe_u32 v60, v0, 7, 3
    v_bfe_u32 v61, v0, 4, 3
    v_lshlrev_b32 v19, 10, v61
    v_lshl_add_u32 v19, v60, 4, v19
    s_mov_b32 s33, s97
    s_add_u32 s96, s97, 32768
    s_add_u32 s45, s98, 6
    s_mov_b64 exec, 1
    v_mov_b32 v56, s45
    s_waitcnt vmcnt(0)
    buffer_store_dword v56, off, s[4:7], s38 offset:0 sc1
    s_mov_b64 exec, -1
    s_add_u32 s45, s98, 6
    s_mov_b32 exec_hi, 0
    s_mov_b32 exec_lo, s95
    s_mov_b32 s50, 0
Lpoll_30_s:
    buffer_load_dword v56, v21, s[4:7], s40 offen sc1
    s_add_u32 s50, s50, 1
    s_cmp_gt_u32 s50, 0x40000
    s_cbranch_scc1 Labort
    s_waitcnt vmcnt(0)
    v_cmp_ne_u32 vcc, s45, v56
    s_cbranch_vccnz Lpoll_30_s
    s_mov_b64 exec, -1
    s_add_u32 s51, s39, 0
    buffer_load_dwordx4 v[128:131], v0, s[4:7], s51 offen offset:0 sc1
    buffer_load_dwordx4 v[132:135], v0, s[4:7], s51 offen offset:2048 sc1
    s_add_u32 s51, s39, 4096
    buffer_load_dwordx4 v[136:139], v0, s[4:7], s51 offen offset:0 sc1
    buffer_load_dwordx4 v[140:143], v0, s[4:7], s51 offen offset:2048 sc1
    s_add_u32 s51, s39, 8192
    buffer_load_dwordx4 v[144:147], v0, s[4:7], s51 offen offset:0 sc1
    buffer_load_dwordx4 v[148:151], v0, s[4:7], s51 offen offset:2048 sc1
    s_add_u32 s51, s39, 12288
    buffer_load_dwordx4 v[152:155], v0, s[4:7], s51 offen offset:0 sc1
    buffer_load_dwordx4 v[156:159], v0, s[4:7], s51 offen offset:2048 sc1
    s_add_u32 s51, s39, 16384
    buffer_load_dwordx4 v[160:163], v0, s[4:7], s51 offen offset:0 sc1
    buffer_load_dwordx4 v[164:167], v0, s[4:7], s51 offen offset:2048 sc1
    s_barrier
    s_waitcnt vmcnt(9)
    v_mfma_f32_16x16x32_bf16 v[64:67], v[128:131], a[64:67], 0
    s_add_u32 s51, s39, 20480
    s_cmp_eq_u32 s16, 3
    s_cselect_b32 s51, 268435456, s51
    buffer_load_dwordx4 v[168:171], v0, s[4:7], s51 offen offset:0 sc1
    v_mfma_f32_16x16x32_bf16 v[68:71], v[128:131], a[68:71], 0
    v_mfma_f32_16x16x32_bf16 v[72:75], v[128:131], a[72:75], 0
    v_mfma_f32_16x16x32_bf16 v[76:79], v[128:131], a[76:79], 0
    s_waitcnt vmcnt(9)
    v_mfma_f32_16x16x32_bf16 v[64:67], v[132:135], a[80:83], v[64:67]
    s_add_u32 s51, s39, 1024
    buffer_load_dwordx4 v[172:175], v0, s[4:7], s51 offen offset:0 sc1
    v_mfma_f32_16x16x32_bf16 v[68:71], v[132:135], a[84:87], v[68:71]
    v_mfma_f32_16x16x32_bf16 v[72:75], v[132:135], a[88:91], v[72:75]
    v_mfma_f32_16x16x32_bf16 v[76:79], v[132:135], a[92:95], v[76:79]
    s_waitcnt vmcnt(9)
    v_mfma_f32_16x16x32_bf16 v[64:67], v[136:139], a[96:99], v[64:67]
    buffer_load_dwordx4 v[176:179], v0, s[4:7], s51 offen offset:2048 sc1
    v_mfma_f32_16x16x32_bf16 v[68:71], v[136:139], a[100:103], v[68:71]
    v_mfma_f32_16x16x32_bf16 v[72:75], v[136:139], a[104:107], v[72:75]
    v_mfma_f32_16x16x32_bf16 v[76:79], v[136:139], a[108:111], v[76:79]
    s_waitcnt vmcnt(9)
    v_mfma_f32_16x16x32_bf16 v[64:67], v[140:143], a[112:115], v[64:67]
    s_add_u32 s51, s39, 5120
    buffer_load_dwordx4 v[180:183], v0, s[4:7], s51 offen offset:0 sc1
    v_mfma_f32_16x16x32_bf16 v[68:71], v[140:143], a[116:119], v[68:71]
    v_mfma_f32_16x16x32_bf16 v[72:75], v[140:143], a[120:123], v[72:75]
    v_mfma_f32_16x16x32_bf16 v[76:79], v[140:143], a[124:127], v[76:79]
    s_waitcnt vmcnt(9)
    v_mfma_f32_16x16x32_bf16 v[64:67], v[144:147], a[128:131], v[64:67]
    buffer_load_dwordx4 v[184:187], v0, s[4:7], s51 offen offset:2048 sc1
    v_mfma_f32_16x16x32_bf16 v[68:71], v[144:147], a[132:135], v[68:71]
    v_mfma_f32_16x16x32_bf16 v[72:75], v[144:147], a[136:139], v[72:75]
    v_mfma_f32_16x16x32_bf16 v[76:79], v[144:147], a[140:143], v[76:79]
    s_waitcnt vmcnt(9)
    v_mfma_f32_16x16x32_bf16 v[64:67], v[148:151], a[144:147], v[64:67]
    s_add_u32 s51, s39, 9216
    buffer_load_dwordx4 v[188:191], v0, s[4:7], s51 offen offset:0 sc1
    v_mfma_f32_16x16x32_bf16 v[68:71], v[148:151], a[148:151], v[68:71]
    v_mfma_f32_16x16x32_bf16 v[72:75], v[148:151], a[152:155], v[72:75]
    v_mfma_f32_16x16x32_bf16 v[76:79], v[148:151], a[156:159], v[76:79]
    s_waitcnt vmcnt(9)
    v_mfma_f32_16x16x32_bf16 v[64:67], v[152:155], a[160:163], v[64:67]
    buffer_load_dwordx4 v[192:195], v0, s[4:7], s51 offen offset:2048 sc1
    v_mfma_f32_16x16x32_bf16 v[68:71], v[152:155], a[164:167], v[68:71]
    v_mfma_f32_16x16x32_bf16 v[72:75], v[152:155], a[168:171], v[72:75]
    v_mfma_f32_16x16x32_bf16 v[76:79], v[152:155], a[172:175], v[76:79]
    s_waitcnt vmcnt(9)
    v_mfma_f32_16x16x32_bf16 v[64:67], v[156:159], a[176:179], v[64:67]
    s_add_u32 s51, s39, 13312
    buffer_load_dwordx4 v[196:199], v0, s[4:7], s51 offen offset:0 sc1
    v_mfma_f32_16x16x32_bf16 v[68:71], v[156:159], a[180:183], v[68:71]
    v_mfma_f32_16x16x32_bf16 v[72:75], v[156:159], a[184:187], v[72:75]
    v_mfma_f32_16x16x32_bf16 v[76:79], v[156:159], a[188:191], v[76:79]
    s_waitcnt vmcnt(9)
    v_mfma_f32_16x16x32_bf16 v[64:67], v[160:163], a[192:195], v[64:67]
    buffer_load_dwordx4 v[200:203], v0, s[4:7], s51 offen offset:2048 sc1
    v_mfma_f32_16x16x32_bf16 v[68:71], v[160:163], a[196:199], v[68:71]
    v_mfma_f32_16x16x32_bf16 v[72:75], v[160:163], a[200:203], v[72:75]
    v_mfma_f32_16x16x32_bf16 v[76:79], v[160:163], a[204:207], v[76:79]
    s_waitcnt vmcnt(9)
    v_mfma_f32_16x16x32_bf16 v[64:67], v[164:167], a[208:211], v[64:67]
    s_add_u32 s51, s39, 17408
    buffer_load_dwordx4 v[204:207], v0, s[4:7], s51 offen offset:0 sc1
    v_mfma_f32_16x16x32_bf16 v[68:71], v[164:167], a[212:215], v[68:71]
    v_mfma_f32_16x16x32_bf16 v[72:75], v[164:167], a[216:219], v[72:75]
    v_mfma_f32_16x16x32_bf16 v[76:79], v[164:167], a[220:223], v[76:79]
    s_waitcnt vmcnt(9)
    v_mfma_f32_16x16x32_bf16 v[64:67], v[168:171], a[224:227], v[64:67]
    buffer_load_dwordx4 v[208:211], v0, s[4:7], s51 offen offset:2048 sc1
    v_mfma_f32_16x16x32_bf16 v[68:71], v[168:171], a[228:231], v[68:71]
    v_mfma_f32_16x16x32_bf16 v[72:75], v[168:171], a[232:235], v[72:75]
    v_mfma_f32_16x16x32_bf16 v[76:79], v[168:171], a[236:239], v[76:79]
    s_waitcnt vmcnt(9)
    v_mfma_f32_16x16x32_bf16 v[80:83], v[172:175], a[64:67], 0
    s_add_u32 s51, s39, 21504
    s_cmp_eq_u32 s16, 3
    s_cselect_b32 s51, 268435456, s51
    buffer_load_dwordx4 v[212:215], v0, s[4:7], s51 offen offset:0 sc1
    ds_write_b32 v48, v64 offset:0
    v_mfma_f32_16x16x32_bf16 v[84:87], v[172:175], a[68:71], 0
    ds_write_b32 v49, v65 offset:256
    v_mfma_f32_16x16x32_bf16 v[88:91], v[172:175], a[72:75], 0
    ds_write_b32 v50, v66 offset:512
    v_mfma_f32_16x16x32_bf16 v[92:95], v[172:175], a[76:79], 0
    ds_write_b32 v51, v67 offset:768
    s_waitcnt vmcnt(9)
    v_mfma_f32_16x16x32_bf16 v[80:83], v[176:179], a[80:83], v[80:83]
    s_add_u32 s51, s39, 88064
    buffer_load_dwordx4 v[216:219], v0, s[4:7], s51 offen offset:0 sc1
    ds_write_b32 v48, v68 offset:1024
    v_mfma_f32_16x16x32_bf16 v[84:87], v[176:179], a[84:87], v[84:87]
    ds_write_b32 v49, v69 offset:1280
    v_mfma_f32_16x16x32_bf16 v[88:91], v[176:179], a[88:91], v[88:91]
    ds_write_b32 v50, v70 offset:1536
    v_mfma_f32_16x16x32_bf16 v[92:95], v[176:179], a[92:95], v[92:95]
    ds_write_b32 v51, v71 offset:1792
    s_waitcnt vmcnt(9)
    v_mfma_f32_16x16x32_bf16 v[80:83], v[180:183], a[96:99], v[80:83]
    buffer_load_dwordx4 v[220:223], v0, s[4:7], s51 offen offset:2048 sc1
    ds_write_b32 v48, v72 offset:2048
    v_mfma_f32_16x16x32_bf16 v[84:87], v[180:183], a[100:103], v[84:87]
    ds_write_b32 v49, v73 offset:2304
    v_mfma_f32_16x16x32_bf16 v[88:91], v[180:183], a[104:107], v[88:91]
    ds_write_b32 v50, v74 offset:2560
    v_mfma_f32_16x16x32_bf16 v[92:95], v[180:183], a[108:111], v[92:95]
    ds_write_b32 v51, v75 offset:2816
    s_waitcnt vmcnt(9)
    v_mfma_f32_16x16x32_bf16 v[80:83], v[184:187], a[112:115], v[80:83]
    s_add_u32 s51, s39, 92160
    buffer_load_dwordx4 v[224:227], v0, s[4:7], s51 offen offset:0 sc1
    ds_write_b32 v48, v76 offset:3072
    v_mfma_f32_16x16x32_bf16 v[84:87], v[184:187], a[116:119], v[84:87]
    ds_write_b32 v49, v77 offset:3328
    v_mfma_f32_16x16x32_bf16 v[88:91], v[184:187], a[120:123], v[88:91]
    ds_write_b32 v50, v78 offset:3584
    v_mfma_f32_16x16x32_bf16 v[92:95], v[184:187], a[124:127], v[92:95]
    ds_write_b32 v51, v79 offset:3840
    s_waitcnt vmcnt(9)
    v_mfma_f32_16x16x32_bf16 v[80:83], v[188:191], a[128:131], v[80:83]
    buffer_load_dwordx4 v[228:231], v0, s[4:7], s51 offen offset:2048 sc1
    v_mfma_f32_16x16x32_bf16 v[84:87], v[188:191], a[132:135], v[84:87]
    v_mfma_f32_16x16x32_bf16 v[88:91], v[188:191], a[136:139], v[88:91]
    v_mfma_f32_16x16x32_bf16 v[92:95], v[188:191], a[140:143], v[92:95]
    s_waitcnt vmcnt(9)
    v_mfma_f32_16x16x32_bf16 v[80:83], v[192:195], a[144:147], v[80:83]
    s_add_u32 s51, s39, 96256
    buffer_load_dwordx4 v[232:235], v0, s[4:7], s51 offen offset:0 sc1
    v_mfma_f32_16x16x32_bf16 v[84:87], v[192:195], a[148:151], v[84:87]
    v_mfma_f32_16x16x32_bf16 v[88:91], v[192:195], a[152:155], v[88:91]
    v_mfma_f32_16x16x32_bf16 v[92:95], v[192:195], a[156:159], v[92:95]
    s_waitcnt vmcnt(9)
    v_mfma_f32_16x16x32_bf16 v[80:83], v[196:199], a[160:163], v[80:83]
    buffer_load_dwordx4 v[236:239], v0, s[4:7], s51 offen offset:2048 sc1
    v_mfma_f32_16x16x32_bf16 v[84:87], v[196:199], a[164:167], v[84:87]
    v_mfma_f32_16x16x32_bf16 v[88:91], v[196:199], a[168:171], v[88:91]
    v_mfma_f32_16x16x32_bf16 v[92:95], v[196:199], a[172:175], v[92:95]
    s_waitcnt vmcnt(9)
    v_mfma_f32_16x16x32_bf16 v[80:83], v[200:203], a[176:179], v[80:83]
    s_add_u32 s51, s39, 100352
    buffer_load_dwordx4 v[240:243], v0, s[4:7], s51 offen offset:0 sc1
    v_mfma_f32_16x16x32_bf16 v[84:87], v[200:203], a[180:183], v[84:87]
    v_mfma_f32_16x16x32_bf16 v[88:91], v[200:203], a[184:187], v[88:91]
    v_mfma_f32_16x16x32_bf16 v[92:95], v[200:203], a[188:191], v[92:95]
    s_waitcnt vmcnt(9)
    v_mfma_f32_16x16x32_bf16 v[80:83], v[204:207], a[192:195], v[80:83]
    buffer_load_dwordx4 v[244:247], v0, s[4:7], s51 offen offset:2048 sc1
    v_mfma_f32_16x16x32_bf16 v[84:87], v[204:207], a[196:199], v[84:87]
    v_mfma_f32_16x16x32_bf16 v[88:91], v[204:207], a[200:203], v[88:91]
    v_mfma_f32_16x16x32_bf16 v[92:95], v[204:207], a[204:207], v[92:95]
    s_waitcnt vmcnt(9)
    v_mfma_f32_16x16x32_bf16 v[80:83], v[208:211], a[208:211], v[80:83]
    s_add_u32 s51, s39, 104448
    buffer_load_dwordx4 v[248:251], v0, s[4:7], s51 offen offset:0 sc1
    v_mfma_f32_16x16x32_bf16 v[84:87], v[208:211], a[212:215], v[84:87]
    v_mfma_f32_16x16x32_bf16 v[88:91], v[208:211], a[216:219], v[88:91]
    v_mfma_f32_16x16x32_bf16 v[92:95], v[208:211], a[220:223], v[92:95]
    s_waitcnt vmcnt(9)
    v_mfma_f32_16x16x32_bf16 v[80:83], v[212:215], a[224:227], v[80:83]
    buffer_load_dwordx4 v[252:255], v0, s[4:7], s51 offen offset:2048 sc1
    v_mfma_f32_16x16x32_bf16 v[84:87], v[212:215], a[228:231], v[84:87]
    v_mfma_f32_16x16x32_bf16 v[88:91], v[212:215], a[232:235], v[88:91]
    v_mfma_f32_16x16x32_bf16 v[92:95], v[212:215], a[236:239], v[92:95]
    s_waitcnt vmcnt(9)
    v_mfma_f32_16x16x32_bf16 v[96:99], v[216:219], a[64:67], 0
    s_add_u32 s51, s39, 108544
    s_cmp_eq_u32 s16, 3
    s_cselect_b32 s51, 268435456, s51
    buffer_load_dwordx4 v[128:131], v0, s[4:7], s51 offen offset:0 sc1
    ds_write_b32 v48, v80 offset:4096
    v_mfma_f32_16x16x32_bf16 v[100:103], v[216:219], a[68:71], 0
    ds_write_b32 v49, v81 offset:4352
    v_mfma_f32_16x16x32_bf16 v[104:107], v[216:219], a[72:75], 0
    ds_write_b32 v50, v82 offset:4608
    v_mfma_f32_16x16x32_bf16 v[108:111], v[216:219], a[76:79], 0
    ds_write_b32 v51, v83 offset:4864
    s_waitcnt vmcnt(9)
    v_mfma_f32_16x16x32_bf16 v[96:99], v[220:223], a[80:83], v[96:99]
    s_add_u32 s51, s39, 89088
    buffer_load_dwordx4 v[132:135], v0, s[4:7], s51 offen offset:0 sc1
    ds_write_b32 v48, v84 offset:5120
    v_mfma_f32_16x16x32_bf16 v[100:103], v[220:223], a[84:87], v[100:103]
    ds_write_b32 v49, v85 offset:5376
    v_mfma_f32_16x16x32_bf16 v[104:107], v[220:223], a[88:91], v[104:107]
    ds_write_b32 v50, v86 offset:5632
    v_mfma_f32_16x16x32_bf16 v[108:111], v[220:223], a[92:95], v[108:111]
    ds_write_b32 v51, v87 offset:5888
    s_waitcnt vmcnt(9)
    v_mfma_f32_16x16x32_bf16 v[96:99], v[224:227], a[96:99], v[96:99]
    buffer_load_dwordx4 v[136:139], v0, s[4:7], s51 offen offset:2048 sc1
    ds_write_b32 v48, v88 offset:6144
    v_mfma_f32_16x16x32_bf16 v[100:103], v[224:227], a[100:103], v[100:103]
    ds_write_b32 v49, v89 offset:6400
    v_mfma_f32_16x16x32_bf16 v[104:107], v[224:227], a[104:107], v[104:107]
    ds_write_b32 v50, v90 offset:6656
    v_mfma_f32_16x16x32_bf16 v[108:111], v[224:227], a[108:111], v[108:111]
    ds_write_b32 v51, v91 offset:6912
    s_waitcnt vmcnt(9)
    v_mfma_f32_16x16x32_bf16 v[96:99], v[228:231], a[112:115], v[96:99]
    s_add_u32 s51, s39, 93184
    buffer_load_dwordx4 v[140:143], v0, s[4:7], s51 offen offset:0 sc1
    ds_write_b32 v48, v92 offset:7168
    v_mfma_f32_16x16x32_bf16 v[100:103], v[228:231], a[116:119], v[100:103]
    ds_write_b32 v49, v93 offset:7424
    v_mfma_f32_16x16x32_bf16 v[104:107], v[228:231], a[120:123], v[104:107]
    ds_write_b32 v50, v94 offset:7680
    v_mfma_f32_16x16x32_bf16 v[108:111], v[228:231], a[124:127], v[108:111]
    ds_write_b32 v51, v95 offset:7936
    s_waitcnt vmcnt(9)
    v_mfma_f32_16x16x32_bf16 v[96:99], v[232:235], a[128:131], v[96:99]
    buffer_load_dwordx4 v[144:147], v0, s[4:7], s51 offen offset:2048 sc1
    v_mfma_f32_16x16x32_bf16 v[100:103], v[232:235], a[132:135], v[100:103]
    v_mfma_f32_16x16x32_bf16 v[104:107], v[232:235], a[136:139], v[104:107]
    v_mfma_f32_16x16x32_bf16 v[108:111], v[232:235], a[140:143], v[108:111]
    s_waitcnt lgkmcnt(0)
    s_barrier
    s_waitcnt vmcnt(9)
    v_mfma_f32_16x16x32_bf16 v[96:99], v[236:239], a[144:147], v[96:99]
    s_add_u32 s51, s39, 97280
    buffer_load_dwordx4 v[148:151], v0, s[4:7], s51 offen offset:0 sc1
    v_mfma_f32_16x16x32_bf16 v[100:103], v[236:239], a[148:151], v[100:103]
    ds_read_b128 v[64:67], v57 offset:0
    ds_read_b128 v[68:71], v58 offset:0
    v_mfma_f32_16x16x32_bf16 v[104:107], v[236:239], a[152:155], v[104:107]
    ds_read_b128 v[72:75], v57 offset:8192
    ds_read_b128 v[76:79], v58 offset:8192
    v_mfma_f32_16x16x32_bf16 v[108:111], v[236:239], a[156:159], v[108:111]
    ds_read_b128 v[80:83], v57 offset:16384
    s_waitcnt vmcnt(9)
    v_mfma_f32_16x16x32_bf16 v[96:99], v[240:243], a[160:163], v[96:99]
    buffer_load_dwordx4 v[152:155], v0, s[4:7], s51 offen offset:2048 sc1
    ds_read_b128 v[84:87], v58 offset:16384
    v_mfma_f32_16x16x32_bf16 v[100:103], v[240:243], a[164:167], v[100:103]
    ds_read_b128 v[88:91], v57 offset:24576
    ds_read_b128 v[92:95], v58 offset:24576
    v_mfma_f32_16x16x32_bf16 v[104:107], v[240:243], a[168:171], v[104:107]
    v_subrev_u32 v57, 98304, v57
    v_subrev_u32 v58, 98304, v58
    v_mfma_f32_16x16x32_bf16 v[108:111], v[240:243], a[172:175], v[108:111]
    s_nop 0
    s_waitcnt vmcnt(9)
    v_mfma_f32_16x16x32_bf16 v[96:99], v[244:247], a[176:179], v[96:99]
    s_add_u32 s51, s39, 101376
    buffer_load_dwordx4 v[156:159], v0, s[4:7], s51 offen offset:0 sc1
    v_mfma_f32_16x16x32_bf16 v[100:103], v[244:247], a[180:183], v[100:103]
    s_nop 0
    s_nop 0
    v_mfma_f32_16x16x32_bf16 v[104:107], v[244:247], a[184:187], v[104:107]
    s_nop 0
    s_waitcnt lgkmcnt(0)
    v_mfma_f32_16x16x32_bf16 v[108:111], v[244:247], a[188:191], v[108:111]
    v_add_f32 v24, v24, v64
    s_waitcnt vmcnt(9)
    v_mfma_f32_16x16x32_bf16 v[96:99], v[248:251], a[192:195], v[96:99]
    buffer_load_dwordx4 v[160:163], v0, s[4:7], s51 offen offset:2048 sc1
    v_add_f32 v25, v25, v65
    v_mfma_f32_16x16x32_bf16 v[100:103], v[248:251], a[196:199], v[100:103]
    v_add_f32 v26, v26, v66
    v_add_f32 v27, v27, v67
    v_mfma_f32_16x16x32_bf16 v[104:107], v[248:251], a[200:203], v[104:107]
    v_add_f32 v28, v28, v68
    v_add_f32 v29, v29, v69
    v_mfma_f32_16x16x32_bf16 v[108:111], v[248:251], a[204:207], v[108:111]
    v_add_f32 v30, v30, v70
    s_waitcnt vmcnt(9)
    v_mfma_f32_16x16x32_bf16 v[96:99], v[252:255], a[208:211], v[96:99]
    s_add_u32 s51, s39, 105472
    buffer_load_dwordx4 v[164:167], v0, s[4:7], s51 offen offset:0 sc1
    v_mfma_f32_16x16x32_bf16 v[100:103], v[252:255], a[212:215], v[100:103]
    v_add_f32 v31, v31, v71
    v_add_f32 v24, v24, v72
    v_mfma_f32_16x16x32_bf16 v[104:107], v[252:255], a[216:219], v[104:107]
    v_add_f32 v25, v25, v73
    v_add_f32 v26, v26, v74
    v_mfma_f32_16x16x32_bf16 v[108:111], v[252:255], a[220:223], v[108:111]
    v_add_f32 v27, v27, v75
    s_waitcnt vmcnt(9)
    v_mfma_f32_16x16x32_bf16 v[96:99], v[128:131], a[224:227], v[96:99]
    buffer_load_dwordx4 v[168:171], v0, s[4:7], s51 offen offset:2048 sc1
    v_add_f32 v28, v28, v76
    v_mfma_f32_16x16x32_bf16 v[100:103], v[128:131], a[228:231], v[100:103]
    v_add_f32 v29, v29, v77
    v_add_f32 v30, v30, v78
    v_mfma_f32_16x16x32_bf16 v[104:107], v[128:131], a[232:235], v[104:107]
    v_add_f32 v31, v31, v79
    v_add_f32 v24, v24, v80
    v_mfma_f32_16x16x32_bf16 v[108:111], v[128:131], a[236:239], v[108:111]
    v_add_f32 v25, v25, v81
    s_waitcnt vmcnt(9)
    v_mfma_f32_16x16x32_bf16 v[112:115], v[132:135], a[64:67], 0
    s_add_u32 s51, s39, 109568
    s_cmp_eq_u32 s16, 3
    s_cselect_b32 s51, 268435456, s51
    buffer_load_dwordx4 v[172:175], v0, s[4:7], s51 offen offset:0 sc1
    ds_write_b32 v52, v96 offset:0
    v_mfma_f32_16x16x32_bf16 v[116:119], v[132:135], a[68:71], 0
    ds_write_b32 v53, v97 offset:256
    v_add_f32 v26, v26, v82
    v_mfma_f32_16x16x32_bf16 v[120:123], v[132:135], a[72:75], 0
    ds_write_b32 v54, v98 offset:512
    v_add_f32 v27, v27, v83
    v_mfma_f32_16x16x32_bf16 v[124:127], v[132:135], a[76:79], 0
    ds_write_b32 v55, v99 offset:768
    s_waitcnt vmcnt(9)
    v_mfma_f32_16x16x32_bf16 v[112:115], v[136:139], a[80:83], v[112:115]
    ds_write_b32 v52, v100 offset:1024
    v_add_f32 v28, v28, v84
    v_mfma_f32_16x16x32_bf16 v[116:119], v[136:139], a[84:87], v[116:119]
    ds_write_b32 v53, v101 offset:1280
    v_add_f32 v29, v29, v85
    v_mfma_f32_16x16x32_bf16 v[120:123], v[136:139], a[88:91], v[120:123]
    ds_write_b32 v54, v102 offset:1536
    v_add_f32 v30, v30, v86
    v_mfma_f32_16x16x32_bf16 v[124:127], v[136:139], a[92:95], v[124:127]
    ds_write_b32 v55, v103 offset:1792
    s_waitcnt vmcnt(8)
    v_mfma_f32_16x16x32_bf16 v[112:115], v[140:143], a[96:99], v[112:115]
    ds_write_b32 v52, v104 offset:2048
    v_add_f32 v31, v31, v87
    v_mfma_f32_16x16x32_bf16 v[116:119], v[140:143], a[100:103], v[116:119]
    ds_write_b32 v53, v105 offset:2304
    v_add_f32 v24, v24, v88
    v_mfma_f32_16x16x32_bf16 v[120:123], v[140:143], a[104:107], v[120:123]
    ds_write_b32 v54, v106 offset:2560
    v_add_f32 v25, v25, v89
    v_mfma_f32_16x16x32_bf16 v[124:127], v[140:143], a[108:111], v[124:127]
    ds_write_b32 v55, v107 offset:2816
    s_waitcnt vmcnt(7)
    v_mfma_f32_16x16x32_bf16 v[112:115], v[144:147], a[112:115], v[112:115]
    ds_write_b32 v52, v108 offset:3072
    v_add_f32 v26, v26, v90
    v_mfma_f32_16x16x32_bf16 v[116:119], v[144:147], a[116:119], v[116:119]
    ds_write_b32 v53, v109 offset:3328
    v_add_f32 v27, v27, v91
    v_mfma_f32_16x16x32_bf16 v[120:123], v[144:147], a[120:123], v[120:123]
    ds_write_b32 v54, v110 offset:3584
    v_add_f32 v28, v28, v92
    v_mfma_f32_16x16x32_bf16 v[124:127], v[144:147], a[124:127], v[124:127]
    ds_write_b32 v55, v111 offset:3840
    s_waitcnt vmcnt(6)
    v_mfma_f32_16x16x32_bf16 v[112:115], v[148:151], a[128:131], v[112:115]
    v_add_f32 v29, v29, v93
    v_add_f32 v30, v30, v94
    v_mfma_f32_16x16x32_bf16 v[116:119], v[148:151], a[132:135], v[116:119]
    v_add_f32 v31, v31, v95
    v_cvt_pk_bf16_f32 v40, v24, v25
    v_mfma_f32_16x16x32_bf16 v[120:123], v[148:151], a[136:139], v[120:123]
    v_cvt_pk_bf16_f32 v41, v26, v27
    v_cvt_pk_bf16_f32 v42, v28, v29
    v_mfma_f32_16x16x32_bf16 v[124:127], v[148:151], a[140:143], v[124:127]
    v_cvt_pk_bf16_f32 v43, v30, v31
    s_waitcnt vmcnt(5)
    v_mfma_f32_16x16x32_bf16 v[112:115], v[152:155], a[144:147], v[112:115]
    buffer_store_dwordx4 v[40:43], v19, s[8:11], s33 offen
    v_mfma_f32_16x16x32_bf16 v[116:119], v[152:155], a[148:151], v[116:119]
    v_mfma_f32_16x16x32_bf16 v[120:123], v[152:155], a[152:155], v[120:123]
    v_mfma_f32_16x16x32_bf16 v[124:127], v[152:155], a[156:159], v[124:127]
    s_waitcnt vmcnt(5)
    v_mfma_f32_16x16x32_bf16 v[112:115], v[156:159], a[160:163], v[112:115]
    s_nop 0
    v_mfma_f32_16x16x32_bf16 v[116:119], v[156:159], a[164:167], v[116:119]
    s_nop 0
    v_mfma_f32_16x16x32_bf16 v[120:123], v[156:159], a[168:171], v[120:123]
    s_nop 0
    v_mfma_f32_16x16x32_bf16 v[124:127], v[156:159], a[172:175], v[124:127]
    s_nop 0
    s_waitcnt vmcnt(4)
    v_mfma_f32_16x16x32_bf16 v[112:115], v[160:163], a[176:179], v[112:115]
    s_nop 0
    s_waitcnt vmcnt(3)
    v_mfma_f32_16x16x32_bf16 v[112:115], v[164:167], a[192:195], v[112:115]
    s_nop 0
    s_waitcnt vmcnt(2)
    v_mfma_f32_16x16x32_bf16 v[112:115], v[168:171], a[208:211], v[112:115]
    s_nop 0
    s_waitcnt vmcnt(1)
    v_mfma_f32_16x16x32_bf16 v[112:115], v[172:175], a[224:227], v[112:115]
    s_nop 0
    v_mfma_f32_16x16x32_bf16 v[116:119], v[160:163], a[180:183], v[116:119]
    s_nop 0
    v_mfma_f32_16x16x32_bf16 v[116:119], v[164:167], a[196:199], v[116:119]
    s_nop 0
    v_mfma_f32_16x16x32_bf16 v[116:119], v[168:171], a[212:215], v[116:119]
    s_nop 0
    v_mfma_f32_16x16x32_bf16 v[116:119], v[172:175], a[228:231], v[116:119]
    ds_write_b32 v52, v112 offset:4096
    v_mfma_f32_16x16x32_bf16 v[120:123], v[160:163], a[184:187], v[120:123]
    ds_write_b32 v53, v113 offset:4352
    v_mfma_f32_16x16x32_bf16 v[120:123], v[164:167], a[200:203], v[120:123]
    ds_write_b32 v54, v114 offset:4608
    v_mfma_f32_16x16x32_bf16 v[120:123], v[168:171], a[216:219], v[120:123]
    ds_write_b32 v55, v115 offset:4864
    v_mfma_f32_16x16x32_bf16 v[120:123], v[172:175], a[232:235], v[120:123]
    ds_write_b32 v52, v116 offset:5120
    v_mfma_f32_16x16x32_bf16 v[124:127], v[160:163], a[188:191], v[124:127]
    ds_write_b32 v53, v117 offset:5376
    v_mfma_f32_16x16x32_bf16 v[124:127], v[164:167], a[204:207], v[124:127]
    ds_write_b32 v54, v118 offset:5632
    v_mfma_f32_16x16x32_bf16 v[124:127], v[168:171], a[220:223], v[124:127]
    ds_write_b32 v55, v119 offset:5888
    v_mfma_f32_16x16x32_bf16 v[124:127], v[172:175], a[236:239], v[124:127]
    ds_write_b32 v52, v120 offset:6144
    ds_write_b32 v53, v121 offset:6400
    ds_write_b32 v54, v122 offset:6656
    ds_write_b32 v55, v123 offset:6912
    s_nop 3
    ds_write_b32 v52, v124 offset:7168
    ds_write_b32 v53, v125 offset:7424
    ds_write_b32 v54, v126 offset:7680
    ds_write_b32 v55, v127 offset:7936
    s_waitcnt lgkmcnt(0)
    s_barrier
    ds_read_b128 v[192:195], v57 offset:0
    ds_read_b128 v[196:199], v58 offset:0
    ds_read_b128 v[200:203], v57 offset:8192
    ds_read_b128 v[204:207], v58 offset:8192
    ds_read_b128 v[208:211], v57 offset:16384
    ds_read_b128 v[212:215], v58 offset:16384
    ds_read_b128 v[216:219], v57 offset:24576
    ds_read_b128 v[220:223], v58 offset:24576
    s_waitcnt lgkmcnt(6)
    v_pk_add_f32 v[32:33], v[32:33], v[192:193]
    v_pk_add_f32 v[34:35], v[34:35], v[194:195]
    v_pk_add_f32 v[36:37], v[36:37], v[196:197]
    v_pk_add_f32 v[38:39], v[38:39], v[198:199]
    s_waitcnt lgkmcnt(4)
    v_pk_add_f32 v[32:33], v[32:33], v[200:201]
    v_pk_add_f32 v[34:35], v[34:35], v[202:203]
    v_pk_add_f32 v[36:37], v[36:37], v[204:205]
    v_pk_add_f32 v[38:39], v[38:39], v[206:207]
    s_waitcnt lgkmcnt(2)
    v_pk_add_f32 v[32:33], v[32:33], v[208:209]
    v_pk_add_f32 v[34:35], v[34:35], v[210:211]
    v_pk_add_f32 v[36:37], v[36:37], v[212:213]
    v_pk_add_f32 v[38:39], v[38:39], v[214:215]
    s_waitcnt lgkmcnt(0)
    v_pk_add_f32 v[32:33], v[32:33], v[216:217]
    v_pk_add_f32 v[34:35], v[34:35], v[218:219]
    v_pk_add_f32 v[36:37], v[36:37], v[220:221]
    v_pk_add_f32 v[38:39], v[38:39], v[222:223]
    v_cvt_pk_bf16_f32 v44, v32, v33
    v_cvt_pk_bf16_f32 v45, v34, v35
    v_cvt_pk_bf16_f32 v46, v36, v37
    v_cvt_pk_bf16_f32 v47, v38, v39
    buffer_store_dwordx4 v[44:47], v19, s[8:11], s96 offen
    s_endpgm
Lkvslow_23_s:
    v_max3_u32 v85, v128, v129, v129
    v_max3_u32 v85, v85, v130, v131
    v_max3_u32 v85, v85, v132, v133
    v_max3_u32 v85, v85, v134, v135
    v_max3_u32 v85, v85, v136, v137
    v_max3_u32 v85, v85, v138, v139
    v_max3_u32 v85, v85, v140, v141
    v_max3_u32 v85, v85, v142, v143
    v_max3_u32 v85, v85, v144, v145
    v_max3_u32 v85, v85, v146, v147
    v_max3_u32 v85, v85, v148, v149
    v_max3_u32 v85, v85, v150, v151
    v_max3_u32 v85, v85, v152, v153
    v_max3_u32 v85, v85, v154, v155
    v_max3_u32 v85, v85, v156, v157
    v_max3_u32 v85, v85, v158, v159
    v_max3_u32 v85, v85, v160, v161
    v_max3_u32 v85, v85, v162, v163
    v_cmp_eq_u32 vcc, -1, v85
    s_cbranch_vccz Lkvgo_22_s
Lkvz_24_s:
    s_add_u32 s50, s50, 1
    s_cmp_gt_u32 s50, 0x20000
    s_cbranch_scc1 Labort
    s_cmp_le_u32 s50, 1
    s_cbranch_scc1 Lkvz_25_s
    v_cmp_eq_u32 vcc, -1, v160
    s_cbranch_vccz Lkvz_25_s
    s_mov_b64 exec, vcc
    s_sleep 2
    buffer_load_dword v160, v15, s[4:7], s28 offen sc1
    s_waitcnt vmcnt(0)
    s_mov_b64 exec, -1
    s_branch Lkvz_24_s
Lkvz_25_s:
    s_add_u32 s51, s27, 0
    buffer_load_dwordx4 v[128:131], v0, s[4:7], s51 offen offset:0 sc1
    buffer_load_dwordx4 v[132:135], v0, s[4:7], s51 offen offset:1024 sc1
    buffer_load_dwordx4 v[136:139], v0, s[4:7], s51 offen offset:2048 sc1
    buffer_load_dwordx4 v[140:143], v0, s[4:7], s51 offen offset:3072 sc1
    s_add_u32 s51, s27, 4096
    buffer_load_dwordx4 v[144:147], v0, s[4:7], s51 offen offset:0 sc1
    buffer_load_dwordx4 v[148:151], v0, s[4:7], s51 offen offset:1024 sc1
    buffer_load_dwordx4 v[152:155], v0, s[4:7], s51 offen offset:2048 sc1
    buffer_load_dwordx4 v[156:159], v0, s[4:7], s51 offen offset:3072 sc1
    buffer_load_dwordx4 v[160:163], v15, s[4:7], s28 offen sc1
    s_waitcnt vmcnt(0)
    s_branch Lkvretry_21_s
.section .rodata,"a"
.p2align 6
.amdhsa_kernel interleave_layers__linear_kernel_hedgehog__mixer_channel_mlp__prompt_kernel
  .amdhsa_next_free_vgpr 512
  .amdhsa_next_free_sgpr 102
  .amdhsa_accum_offset 256
  .amdhsa_group_segment_fixed_size 0
  .amdhsa_kernarg_size 96
  .amdhsa_user_sgpr_count 2
  .amdhsa_user_sgpr_kernarg_segment_ptr 1
  .amdhsa_system_sgpr_workgroup_id_x 1
.end_amdhsa_kernel
```
